```python
import torch

def _softmax(x, axis=-1):
    return torch.softmax(x, dim=axis)
def _gelu(x):
    return torch.nn.functional.gelu(x, approximate="tanh")
def _silu(x):
    return torch.nn.functional.silu(x)
def _sigmoid(x):
    return torch.sigmoid(x)
def _layernorm(x, axis=-1, eps=1e-5):
    m = x.mean(dim=axis, keepdim=True)
    v = x.var(dim=axis, keepdim=True, unbiased=False)
    return (x - m) / torch.sqrt(v + eps)
def _scatter_add(tgt, idx, src, axis=0):
    return tgt.clone().index_add_(axis, idx, src)
def _segment_sum(src, seg, n):
    out = torch.zeros((n,) + src.shape[1:], dtype=src.dtype)
    return out.index_add_(0, seg, src)
def _pad(x, pw):
    flat = tuple(v for pair in reversed(pw) for v in pair)
    return torch.nn.functional.pad(x, flat)

kernel_name = 'concat_heads__mha_block_cached__gqa_block_cached__near_ridge'

def setup_inputs():

    _w = (lambda a: (lambda t: t.to(torch.bfloat16) if t.is_floating_point() else t)(torch.as_tensor(a)))
    def _A_setup():
        B, Sq, D = 16, 240, 448
        H, Sk, Dh = 16, 512, 256
        return {
            "x": _w((lambda *s: torch.randn(*s, dtype=torch.bfloat16) * 0.8)(B, Sq, D)),
            "k_cache": _w((lambda *s: torch.randn(*s, dtype=torch.bfloat16) * 0.8)(B, H, Sk, Dh)),
            "v_cache": _w((lambda *s: torch.randn(*s, dtype=torch.bfloat16) * 0.05)(B, H, Sk, Dh)),
            "wq": _w((lambda *s: torch.randn(*s, dtype=torch.bfloat16) * 0.8)(D, H * Dh) * (D ** -0.5)),
            "wo": _w((lambda *s: torch.randn(*s, dtype=torch.bfloat16) * 0.05)(H * Dh, D) * ((H * Dh) ** -0.5)),
        }
    _A_in = _A_setup()

    def _B_setup():
        B, Sq, D = 16, 240, 448
        Hq, Hkv, Sk, Dh = 16, 16, 512, 256
        assert Hq % Hkv == 0, (Hq, Hkv)
        return {
            "x": _w((lambda *s: torch.randn(*s, dtype=torch.bfloat16) * 0.8)(B, Sq, D)),
            "k_cache": _w((lambda *s: torch.randn(*s, dtype=torch.bfloat16) * 0.8)(B, Hkv, Sk, Dh)),
            "v_cache": _w((lambda *s: torch.randn(*s, dtype=torch.bfloat16) * 0.05)(B, Hkv, Sk, Dh)),
            "wq": _w((lambda *s: torch.randn(*s, dtype=torch.bfloat16) * 0.8)(D, Hq * Dh) * (D ** -0.5)),
            "wo": _w((lambda *s: torch.randn(*s, dtype=torch.bfloat16) * 0.05)(Hq * Dh, D) * ((Hq * Dh) ** -0.5)),
        }
    _B_in = _B_setup()

    return {
        "A_x": _A_in["x"],
        "A_k_cache": _A_in["k_cache"],
        "A_v_cache": _A_in["v_cache"],
        "A_wq": _A_in["wq"],
        "A_wo": _A_in["wo"],
        "B_x": _B_in["x"],
        "B_k_cache": _B_in["k_cache"],
        "B_v_cache": _B_in["v_cache"],
        "B_wq": _B_in["wq"],
        "B_wo": _B_in["wo"],
    }

def reference(A_x, A_k_cache, A_v_cache, A_wq, A_wo, B_x, B_k_cache, B_v_cache, B_wq, B_wo):
    def _A_ref(x, k_cache, v_cache, wq, wo):
        B, Sq, D = x.shape
        H, Dh = 16, 256
        q = (lambda x, *d: x.permute(*d))((x @ wq).reshape(B, Sq, H, Dh), 0, 2, 1, 3)
        scores = torch.einsum("bhqd,bhkd->bhqk", q, k_cache) * (Dh ** -0.5)
        p = _softmax(scores, axis=-1)
        o = torch.einsum("bhqk,bhkd->bhqd", p, v_cache)
        return (lambda x, *d: x.permute(*d))(o, 0, 2, 1, 3).reshape(B, Sq, H * Dh) @ wo

    def _B_ref(x, k_cache, v_cache, wq, wo):
        B, Sq, D = x.shape
        Hq, Dh = 16, 256
        Hkv = k_cache.shape[1]
        rep = Hq // Hkv
        q = (lambda x, *d: x.permute(*d))((x @ wq).reshape(B, Sq, Hq, Dh), 0, 2, 1, 3)
        k = (lambda x, n, axis: torch.repeat_interleave(x, n, dim=axis))(k_cache, rep, axis=1)
        v = (lambda x, n, axis: torch.repeat_interleave(x, n, dim=axis))(v_cache, rep, axis=1)
        scores = torch.einsum("bhqd,bhkd->bhqk", q, k) * (Dh ** -0.5)
        p = _softmax(scores, axis=-1)
        o = torch.einsum("bhqk,bhkd->bhqd", p, v)
        return (lambda x, *d: x.permute(*d))(o, 0, 2, 1, 3).reshape(B, Sq, Hq * Dh) @ wo

    a = _A_ref(A_x, A_k_cache, A_v_cache, A_wq, A_wo)
    b = _B_ref(B_x, B_k_cache, B_v_cache, B_wq, B_wo)
    return torch.concatenate([a, b], axis=-1)
```

```asm
; @launch grid=(256,1,1) block=(256,1,1) lds=163840
.amdgcn_target "amdgcn-amd-amdhsa--gfx950"
.macro M df,d,af,a,bf,b
v_mfma_f32_16x16x32_bf16 \df[\d:\d+3], \af[\a:\a+3], \bf[\b:\b+3], \df[\d:\d+3]
.endm
.macro Z df,d,af,a,bf,b
v_mfma_f32_16x16x32_bf16 \df[\d:\d+3], \af[\a:\a+3], \bf[\b:\b+3], 0
.endm
.macro MC d,af,a,b,c
v_mfma_f32_16x16x32_bf16 v[\d:\d+3], \af[\a:\a+3], v[\b:\b+3], v[\c:\c+3]
.endm
.macro TR f,d,o
ds_read_b64_tr_b16 \f[\d:\d+1], v2 offset:\o
.endm
.macro TW f,d,o
ds_read_b64_tr_b16 \f[\d:\d+1], v11 offset:\o
.endm
.macro RD f,d,a,o
ds_read_b128 \f[\d:\d+3], v[\a] offset:\o
.endm
.macro AR d,a
v_accvgpr_read_b32 v[\d], a[\a]
.endm
.macro AW d,a
v_accvgpr_write_b32 a[\d], v[\a]
.endm
.macro CV d,a
v_cvt_pk_bf16_f32 v[\d], v[\a], v[\a+1]
.endm
.macro EX d
v_exp_f32 v[\d], v[\d]
.endm
.macro AD d,a,b
v_add_f32 v[\d], v[\a], v[\b]
.endm
.macro MU d,a
v_mul_f32 v[\d], v[\a], v[\d]
.endm
.macro FM d,m
v_fmamk_f32 v[\d], v[\d], 0x3db8aa3b, v[\m]
.endm
.macro SW a,b
v_permlane32_swap_b32 v[\a], v[\b]
.endm
.macro DL v,s,r,o
buffer_load_dwordx4 v[\v], s[\s:\s+3], s[\r] offen offset:\o lds
.endm
.macro DN v,s,r,o
buffer_load_dwordx4 v[\v], s[\s:\s+3], s[\r] offen offset:\o nt lds
.endm
.macro ST q
buffer_store_dwordx4 v[\q:\q+3], v4, s[88:91], s94 offen sc1
.endm

.set PF_A, 69
.text
.globl concat_heads__mha_block_cached__gqa_block_cached__near_ridge_kernel
.p2align 8
.type concat_heads__mha_block_cached__gqa_block_cached__near_ridge_kernel,@function
concat_heads__mha_block_cached__gqa_block_cached__near_ridge_kernel:
s_cmp_ge_u32 s2, 256
s_cbranch_scc0 L_go
s_endpgm
L_go:
s_bfe_u32 s32, s2, 0x10002
s_mul_i32 s3, s32, 40
s_add_u32 s20, s0, s3
s_addc_u32 s21, s1, 0
s_load_dwordx2 s[40:41], s[20:21], 24
s_load_dwordx2 s[56:57], s[20:21], 0
s_load_dwordx2 s[8:9], s[20:21], 8
s_load_dwordx2 s[24:25], s[20:21], 16
s_load_dwordx2 s[72:73], s[20:21], 32
s_load_dwordx4 s[16:19], s[0:1], 80
s_load_dwordx2 s[88:89], s[0:1], 96
v_lshrrev_b32 v20, 6, v0
v_and_b32 v11, 63, v0
s_lshr_b32 s37, s2, 3
v_readfirstlane_b32 s33, v20
s_bfe_u32 s3, s2, 65536
s_lshl_b32 s3, s3, 3
s_bfe_u32 s5, s2, 65537
s_lshl_b32 s5, s5, 2
s_lshr_b32 s36, s37, 2
s_add_u32 s36, s36, s3
s_and_b32 s37, s37, 3
s_add_u32 s37, s37, s5
v_lshrrev_b32 v23, 4, v11
v_and_b32 v26, 7, v11
v_lshlrev_b32 v26, 4, v26
v_lshrrev_b32 v27, 3, v11
v_and_b32 v28, 1, v27
v_lshlrev_b32 v28, 2, v28
v_lshl_add_u32 v28, v20, 3, v28
v_lshl_add_u32 v29, v23, 5, v28
v_lshl_add_u32 v5, v29, 13, v26
v_and_b32 v29, 1, v23
v_lshl_add_u32 v29, v29, 5, v28
v_lshl_add_u32 v6, v29, 13, v26
v_lshrrev_b32 v29, 5, v11
v_lshl_add_u32 v6, v29, 7, v6
s_lshr_b32 s3, s37, 1
s_xor_b32 s3, s3, 3
s_cmp_eq_u32 s33, 3
s_cselect_b32 s3, 0, s3
s_and_b32 s5, s3, 1
s_lshl_b32 s5, s5, 2
s_lshr_b32 s3, s3, 1
s_mul_i32 s4, s3, 28672
v_xor_b32 v29, s5, v27
v_lshlrev_b32 v29, 2, v29
v_lshl_add_u32 v29, v20, 6, v29
v_mul_u32_u24 v29, 896, v29
v_add_u32 v7, v29, v26
s_mul_i32 s92, s33, 4224
s_lshl_b32 s44, s37, 10
s_mul_i32 s60, s36, 215040
s_sub_u32 s42, 3670016, s44
s_mov_b32 s43, 0x20000
s_sub_u32 s46, 3662856, s44
s_mov_b32 s47, 0x20000
s_sub_u32 s50, 3655744, s44
s_mov_b32 s51, 0x20000
s_sub_u32 s54, 3648584, s44
s_mov_b32 s55, 0x20000
s_mov_b32 s58, 215040
s_mov_b32 s59, 0x20000
s_mov_b32 s62, 215200
s_mov_b32 s63, 0x20000
s_mov_b32 s66, 215360
s_mov_b32 s67, 0x20000
s_mov_b32 s70, 215520
s_mov_b32 s71, 0x20000
v_lshlrev_b32 v4, 4, v11
v_lshl_add_u32 v4, v20, 12, v4
v_and_b32 v22, 15, v11
v_mul_u32_u24 v1, 1056, v22
v_lshl_add_u32 v1, v23, 4, v1
v_add_u32 v1, 81920, v1
v_lshrrev_b32 v24, 2, v11
v_mul_u32_u24 v2, 1056, v24
v_and_b32 v25, 1, v11
v_lshl_add_u32 v2, v25, 4, v2
v_and_b32 v25, 2, v11
v_lshl_add_u32 v2, v25, 2, v2
v_and_b32 v25, 3, v11
v_mul_u32_u24 v3, 1056, v25
v_and_b32 v25, 3, v24
v_lshl_add_u32 v3, v25, 7, v3
v_lshl_add_u32 v3, v23, 4, v3
v_add_u32 v3, s92, v3
v_mul_u32_u24 v22, 2112, v27
v_and_b32 v25, 1, v24
v_mul_u32_u24 v25, 1032, v25
v_add_u32 v22, v22, v25
v_and_b32 v25, 3, v11
v_lshl_add_u32 v11, v25, 4, v22
s_waitcnt lgkmcnt(0)
s_add_u32 m0, s92, 0
s_mov_b32 s93, 1048576
s_add_u32 s40, s40, s44
s_addc_u32 s41, s41, 0
DL 6,40,93,0
s_add_u32 s44, s40, 7160
s_addc_u32 s45, s41, 0
DL 6,44,93,1032
s_add_u32 s48, s40, 14272
s_addc_u32 s49, s41, 0
DL 6,48,93,2112
s_add_u32 s52, s40, 21432
s_addc_u32 s53, s41, 0
DL 6,52,93,3144
s_add_u32 m0, s92, 16896
s_xor_b32 s93, s4, 256
s_add_u32 s56, s56, s60
s_addc_u32 s57, s57, 0
DL 7,56,93,0
s_sub_u32 s60, s56, 160
s_subb_u32 s61, s57, 0
DL 7,60,93,1056
s_sub_u32 s64, s56, 320
s_subb_u32 s65, s57, 0
DL 7,64,93,2112
s_sub_u32 s68, s56, 480
s_subb_u32 s69, s57, 0
DL 7,68,93,3168
s_add_u32 m0, s92, 81920
s_xor_b32 s93, s4, 28928
DL 7,56,93,0
DL 7,60,93,1056
DL 7,64,93,2112
DL 7,68,93,3168
s_cmp_eq_u32 s92, 12672
s_cbranch_scc1 L_B
s_branch L_A
.p2align 12
L_A:
s_getpc_b64 s[12:13]
s_sub_u32 s12, s12, .-L_go
s_subb_u32 s13, s13, 0
s_add_u32 s12, s12, L_A-L_go
s_addc_u32 s13, s13, 0
s_lshr_b32 s97, s2, 3
s_lshl_b32 s97, s97, 9
s_cmp_eq_u32 s33, 3
s_cselect_b32 s96, L_B-L_A, 0
s_add_u32 s97, s97, s96
s_add_u32 s97, s97, 4096
v_lshl_add_u32 v24, v23, 7, s97
v_mov_b32 v25, 0
v_lshl_add_u64 v[16:17], v[24:25], 0, s[12:13]
s_lshl_b32 s97, s2, 2
s_add_u32 s97, s97, s33
s_lshl_b32 s97, s97, 2
v_add_u32 v24, s97, v23
v_min_u32 v24, PF_A*32, v24
v_lshlrev_b32 v24, 7, v24
v_lshl_add_u64 v[18:19], v[24:25], 0, s[12:13]
s_lshl_b32 s96, s32, 4
s_add_u32 s96, s96, s36
s_lshr_b32 s97, s96, 5
s_mul_i32 s97, s97, 3040
s_add_u32 s97, s97, s96
s_lshl_b32 s97, s97, 5
s_add_u32 s97, s97, s37
s_lshl_b32 s94, s33, 2
s_add_u32 s97, s97, s94
s_lshl_b32 s97, s97, 10
s_add_u32 s88, s88, s97
s_addc_u32 s89, s89, 0
s_lshl_b32 s96, s96, 3
s_add_u32 s0, s18, s96
s_addc_u32 s1, s19, 0
s_mul_i32 s97, s36, 15
s_lshr_b32 s96, s37, 1
s_add_u32 s97, s97, s96
s_add_u32 s97, s97, s94
s_mul_i32 s97, s97, 28672
s_mul_i32 s96, s32, 896
s_add_u32 s97, s97, s96
s_and_b32 s96, s37, 1
s_lshl_b32 s96, s96, 6
s_add_u32 s97, s97, s96
s_add_u32 s6, s16, s97
s_addc_u32 s7, s17, 0
s_lshl_b32 s95, s37, 2
s_add_u32 s95, s95, s33
s_lshl_b32 s96, s36, 8
s_add_u32 s95, s95, s96
s_lshr_b32 s96, s2, 3
s_lshl_b32 s96, s96, 16
s_add_u32 s95, s95, s96
s_mul_i32 s96, s37, 458752
s_lshl_b32 s97, s36, 3
s_add_u32 s97, s97, s37
s_lshl_b32 s97, s97, 19
s_add_u32 s72, s72, s96
s_addc_u32 s73, s73, 0
s_mov_b32 s74, 458752
s_mov_b32 s75, 0x20000
s_sub_u32 s76, s72, 160
s_subb_u32 s77, s73, 0
s_mov_b32 s78, 458912
s_mov_b32 s79, 0x20000
s_sub_u32 s80, s72, 320
s_subb_u32 s81, s73, 0
s_mov_b32 s82, 459072
s_mov_b32 s83, 0x20000
s_sub_u32 s84, s72, 480
s_subb_u32 s85, s73, 0
s_mov_b32 s86, 459232
s_mov_b32 s87, 0x20000
s_add_u32 s8, s8, s97
s_addc_u32 s9, s9, 0
s_mov_b32 s10, 524288
s_mov_b32 s11, 0x20000
s_sub_u32 s12, s8, 32
s_subb_u32 s13, s9, 0
s_mov_b32 s14, 524320
s_mov_b32 s15, 0x20000
s_sub_u32 s16, s8, 64
s_subb_u32 s17, s9, 0
s_mov_b32 s18, 524352
s_mov_b32 s19, 0x20000
s_sub_u32 s20, s8, 96
s_subb_u32 s21, s9, 0
s_mov_b32 s22, 524384
s_mov_b32 s23, 0x20000
s_add_u32 s24, s24, s97
s_addc_u32 s25, s25, 0
s_mov_b32 s26, 524288
s_mov_b32 s27, 0x20000
s_sub_u32 s28, s24, 32
s_subb_u32 s29, s25, 0
s_mov_b32 s30, 524320
s_mov_b32 s31, 0x20000
s_sub_u32 s32, s24, 64
s_subb_u32 s33, s25, 0
s_mov_b32 s34, 524352
s_mov_b32 s35, 0x20000
s_sub_u32 s36, s24, 96
s_subb_u32 s37, s25, 0
s_mov_b32 s38, 524384
s_mov_b32 s39, 0x20000
s_mov_b32 s90, 100663296
s_mov_b32 s91, 0x20000
s_mov_b32 s94, 94371840
v_mul_u32_u24 v28, 896, v27
v_add_u32 v28, v28, v4
v_mov_b32 v12, 0
v_mov_b32 v13, 0
v_mov_b32 v14, 0
v_mov_b32 v15, 0
s_add_u32 m0, s92, 33792
s_mov_b32 s93, 1048832
DL 6,40,93,0
DL 6,44,93,1032
DL 6,48,93,2112
DL 6,52,93,3144
s_add_u32 m0, s92, 98816
s_xor_b32 s93, s4, 384
DL 7,56,93,0
DL 7,60,93,1056
DL 7,64,93,2112
DL 7,68,93,3168
global_load_dword v10, v[16:17], off
global_load_dword v10, v[18:19], off
s_waitcnt vmcnt(10)
s_barrier
RD a,0,3,16896
RD a,16,3,16960
RD a,4,3,17408
RD a,20,3,17472
TW a,224,0
TW a,226,128
TW a,228,256
TW a,230,384
TW a,232,8
TW a,234,136
TW a,236,264
TW a,238,392
v_xor_b32 v3, 81920, v3
RD a,8,3,0
RD a,24,3,64
RD a,12,3,512
RD a,28,3,576
s_add_u32 m0, s92, 50688
s_xor_b32 s93, s4, 29056
TW a,240,64
TW a,242,192
TW a,244,320
TW a,246,448
TW a,248,72
TW a,250,200
TW a,252,328
TW a,254,456
s_waitcnt lgkmcnt(8)
Z v,128,a,224,a,0
DL 7,56,93,0
M v,128,a,228,a,16
Z v,132,a,224,a,4
M v,132,a,228,a,20
Z v,136,a,224,a,8
M v,136,a,228,a,24
DL 7,60,93,1056
Z v,140,a,224,a,12
TW a,224,512
M v,140,a,228,a,28
TW a,226,640
Z v,64,a,232,a,0
TW a,228,768
M v,64,a,236,a,16
TW a,230,896
Z v,68,a,232,a,4
DL 7,64,93,2112
M v,68,a,236,a,20
Z v,72,a,232,a,8
M v,72,a,236,a,24
Z v,76,a,232,a,12
TW a,232,520
M v,76,a,236,a,28
DL 7,68,93,3168
s_waitcnt lgkmcnt(5)
Z v,144,a,240,a,0
s_add_u32 m0, s92, 115712
s_mov_b32 s93, 1572864
M v,144,a,244,a,16
TW a,234,648
Z v,148,a,240,a,4
TW a,236,776
M v,148,a,244,a,20
TW a,238,904
Z v,152,a,240,a,8
DL 6,40,93,0
M v,152,a,244,a,24
Z v,156,a,240,a,12
TW a,240,576
M v,156,a,244,a,28
TW a,242,704
Z v,80,a,248,a,0
TW a,244,832
M v,80,a,252,a,16
DL 6,44,93,1032
Z v,84,a,248,a,4
TW a,246,960
M v,84,a,252,a,20
Z v,88,a,248,a,8
M v,88,a,252,a,24
Z v,92,a,248,a,12
DL 6,48,93,2112
M v,92,a,252,a,28
s_waitcnt lgkmcnt(4)
TW a,248,584
Z v,160,a,224,a,0
TW a,250,712
M v,160,a,228,a,16
TW a,252,840
Z v,164,a,224,a,4
TW a,254,968
M v,164,a,228,a,20
DL 6,52,93,3144
Z v,168,a,224,a,8
s_add_u32 m0, s92, 132608
s_xor_b32 s93, s4, 0
M v,168,a,228,a,24
Z v,172,a,224,a,12
M v,172,a,228,a,28
Z v,96,a,232,a,0
DL 7,56,93,0
M v,96,a,236,a,16
Z v,100,a,232,a,4
M v,100,a,236,a,20
Z v,104,a,232,a,8
M v,104,a,236,a,24
DL 7,60,93,1056
Z v,108,a,232,a,12
M v,108,a,236,a,28
s_waitcnt lgkmcnt(0)
s_waitcnt vmcnt(14)
Z v,176,a,240,a,0
s_barrier
TW a,224,33792
M v,176,a,244,a,16
TW a,226,33920
Z v,180,a,240,a,4
DL 7,64,93,2112
M v,180,a,244,a,20
TW a,228,34048
Z v,184,a,240,a,8
TW a,230,34176
M v,184,a,244,a,24
TW a,232,33800
Z v,188,a,240,a,12
TW a,234,33928
M v,188,a,244,a,28
DL 7,68,93,3168
Z v,112,a,248,a,0
TW a,236,34056
s_add_u32 m0, s92, 0
M v,112,a,252,a,16
TW a,238,34184
s_mov_b32 s93, 1573120
Z v,116,a,248,a,4
TW a,240,33856
M v,116,a,252,a,20
DL 6,40,93,0
Z v,120,a,248,a,8
TW a,242,33984
M v,120,a,252,a,24
TW a,244,34112
Z v,124,a,248,a,12
TW a,246,34240
M v,124,a,252,a,28
s_waitcnt lgkmcnt(4)
TW a,248,33864
Z v,192,a,224,a,0
DL 6,44,93,1032
M v,192,a,228,a,16
TW a,250,33992
Z v,196,a,224,a,4
TW a,252,34120
M v,196,a,228,a,20
DL 6,48,93,2112
Z v,200,a,224,a,8
TW a,254,34248
M v,200,a,228,a,24
Z v,204,a,224,a,12
TW a,224,34304
M v,204,a,228,a,28
DL 6,52,93,3144
Z a,144,a,232,a,0
s_add_u32 m0, s92, 16896
s_xor_b32 s93, s4, 28672
M a,144,a,236,a,16
TW a,226,34432
Z a,148,a,232,a,4
TW a,228,34560
M a,148,a,236,a,20
DL 7,56,93,0
Z a,152,a,232,a,8
TW a,230,34688
M a,152,a,236,a,24
Z a,156,a,232,a,12
TW a,232,34312
M a,156,a,236,a,28
s_waitcnt lgkmcnt(5)
TW a,234,34440
Z v,208,a,240,a,0
s_waitcnt vmcnt(13)
TW a,236,34568
M v,208,a,244,a,16
DL 7,60,93,1056
Z v,212,a,240,a,4
TW a,238,34696
M v,212,a,244,a,20
RD a,32,3,16896
Z v,216,a,240,a,8
DL 7,64,93,2112
M v,216,a,244,a,24
RD a,48,3,16960
Z v,220,a,240,a,12
RD a,36,3,17408
M v,220,a,244,a,28
DL 7,68,93,3168
Z a,176,a,248,a,0
s_add_u32 m0, s92, 81920
s_xor_b32 s93, s4, 128
M a,176,a,252,a,16
RD a,52,3,17472
v_xor_b32 v3, 81920, v3
Z a,180,a,248,a,4
RD a,40,3,50688
M a,180,a,252,a,20
DL 7,56,93,0
Z a,184,a,248,a,8
RD a,56,3,50752
M a,184,a,252,a,24
RD a,44,3,51200
Z a,188,a,248,a,12
RD a,60,3,51264
v_xor_b32 v3, 81920, v3
M a,188,a,252,a,28
s_waitcnt lgkmcnt(8)
TW a,240,34368
Z v,224,a,224,a,0
DL 7,60,93,1056
M v,224,a,228,a,16
TW a,242,34496
Z v,228,a,224,a,4
TW a,244,34624
M v,228,a,228,a,20
DL 7,64,93,2112
Z v,232,a,224,a,8
TW a,246,34752
M v,232,a,228,a,24
TW a,248,34376
Z v,236,a,224,a,12
TW a,250,34504
M v,236,a,228,a,28
TW a,252,34632
Z v,32,a,232,a,0
TW a,254,34760
v_xor_b32 v11, 81920, v11
M v,32,a,236,a,16
DL 7,68,93,3168
Z v,36,a,232,a,4
M v,36,a,236,a,20
Z v,40,a,232,a,8
M v,40,a,236,a,24
Z v,44,a,232,a,12
M v,44,a,236,a,28
s_waitcnt lgkmcnt(0)
s_waitcnt vmcnt(12)
Z v,240,a,240,a,0
s_barrier
TW a,224,33792
M v,240,a,244,a,16
TW a,226,33920
s_add_u32 m0, s92, 33792
Z v,244,a,240,a,4
TW a,228,34048
s_mov_b32 s93, 0
M v,244,a,244,a,20
TW a,230,34176
Z v,248,a,240,a,8
TW a,232,33800
M v,248,a,244,a,24
TW a,234,33928
Z v,252,a,240,a,12
DL 5,40,93,0
M v,252,a,244,a,28
TW a,236,34056
Z v,48,a,248,a,0
TW a,238,34184
M v,48,a,252,a,16
TW a,240,33856
Z v,52,a,248,a,4
TW a,242,33984
M v,52,a,252,a,20
TW a,244,34112
Z v,56,a,248,a,8
DL 5,44,93,1032
M v,56,a,252,a,24
TW a,246,34240
Z v,60,a,248,a,12
TW a,248,33864
M v,60,a,252,a,28
s_waitcnt lgkmcnt(5)
TW a,250,33992
M v,128,a,224,a,32
TW a,252,34120
M v,128,a,228,a,48
TW a,254,34248
M v,132,a,224,a,36
DL 5,48,93,2112
M v,132,a,228,a,52
RD a,64,3,50688
M v,136,a,224,a,40
RD a,80,3,50752
M v,136,a,228,a,56
RD a,68,3,51200
M v,140,a,224,a,44
RD a,84,3,51264
M v,140,a,228,a,60
TW a,224,34304
M v,64,a,232,a,32
DL 5,52,93,3144
M v,64,a,236,a,48
s_add_u32 m0, s92, 98816
s_xor_b32 s93, s4, 28800
M v,68,a,232,a,36
TW a,226,34432
M v,68,a,236,a,52
TW a,228,34560
M v,72,a,232,a,40
TW a,230,34688
M v,72,a,236,a,56
M v,76,a,232,a,44
DL 7,56,93,0
M v,76,a,236,a,60
s_waitcnt lgkmcnt(8)
TW a,232,34312
M v,144,a,240,a,32
TW a,234,34440
M v,144,a,244,a,48
TW a,236,34568
M v,148,a,240,a,36
TW a,238,34696
M v,148,a,244,a,52
M v,152,a,240,a,40
DL 7,60,93,1056
M v,152,a,244,a,56
v_xor_b32 v3, 81920, v3
M v,156,a,240,a,44
TW a,240,34368
M v,156,a,244,a,60
TW a,242,34496
M v,80,a,248,a,32
TW a,244,34624
M v,80,a,252,a,48
TW a,246,34752
M v,84,a,248,a,36
DL 7,64,93,2112
M v,84,a,252,a,52
M v,88,a,248,a,40
M v,88,a,252,a,56
M v,92,a,248,a,44
TW a,248,34376
M v,92,a,252,a,60
s_waitcnt lgkmcnt(5)
TW a,250,34504
M v,160,a,224,a,32
DL 7,68,93,3168
M v,160,a,228,a,48
TW a,252,34632
s_add_u32 m0, s92, 50688
M v,164,a,224,a,36
TW a,254,34760
s_mov_b32 s93, 128
M v,164,a,228,a,52
v_xor_b32 v11, 81920, v11
M v,168,a,224,a,40
M v,168,a,228,a,56
M v,172,a,224,a,44
M v,172,a,228,a,60
M v,96,a,232,a,32
DL 5,40,93,0
M v,96,a,236,a,48
M v,100,a,232,a,36
M v,100,a,236,a,52
M v,104,a,232,a,40
M v,104,a,236,a,56
M v,108,a,232,a,44
M v,108,a,236,a,60
s_waitcnt lgkmcnt(0)
s_waitcnt vmcnt(9)
M v,176,a,240,a,32
s_barrier
TW a,224,0
M v,176,a,244,a,48
DL 5,44,93,1032
M v,180,a,240,a,36
TW a,226,128
M v,180,a,244,a,52
TW a,228,256
M v,184,a,240,a,40
TW a,230,384
M v,184,a,244,a,56
TW a,232,8
M v,188,a,240,a,44
TW a,234,136
M v,188,a,244,a,60
TW a,236,264
M v,112,a,248,a,32
TW a,238,392
M v,112,a,252,a,48
DL 5,48,93,2112
M v,116,a,248,a,36
TW a,240,64
M v,116,a,252,a,52
TW a,242,192
M v,120,a,248,a,40
TW a,244,320
M v,120,a,252,a,56
TW a,246,448
M v,124,a,248,a,44
TW a,248,72
M v,124,a,252,a,60
s_waitcnt lgkmcnt(5)
TW a,250,200
M v,192,a,224,a,32
DL 5,52,93,3144
M v,192,a,228,a,48
TW a,252,328
s_add_u32 m0, s92, 115712
M v,196,a,224,a,36
TW a,254,456
s_xor_b32 s93, s4, 512
M v,196,a,228,a,52
RD a,72,3,16896
M v,200,a,224,a,40
RD a,88,3,16960
M v,200,a,228,a,56
RD a,76,3,17408
M v,204,a,224,a,44
RD a,92,3,17472
v_xor_b32 v3, 81920, v3
M v,204,a,228,a,60
RD a,96,3,0
M a,144,a,232,a,32
DL 7,56,93,0
M a,144,a,236,a,48
RD a,112,3,64
M a,148,a,232,a,36
RD a,100,3,512
M a,148,a,236,a,52
RD a,116,3,576
L_pad0:
s_cbranch_execz L_ret0
M a,152,a,232,a,40
TW a,224,512
M a,152,a,236,a,56
TW a,226,640
M a,156,a,232,a,44
TW a,228,768
M a,156,a,236,a,60
s_waitcnt lgkmcnt(11)
TW a,230,896
M v,208,a,240,a,32
DL 7,60,93,1056
M v,208,a,244,a,48
TW a,232,520
M v,212,a,240,a,36
TW a,234,648
M v,212,a,244,a,52
TW a,236,776
M v,216,a,240,a,40
TW a,238,904
M v,216,a,244,a,56
M v,220,a,240,a,44
TW a,240,576
M v,220,a,244,a,60
TW a,242,704
M a,176,a,248,a,32
DL 7,64,93,2112
M a,176,a,252,a,48
TW a,244,832
M a,180,a,248,a,36
TW a,246,960
M a,180,a,252,a,52
M a,184,a,248,a,40
M a,184,a,252,a,56
M a,188,a,248,a,44
TW a,248,584
M a,188,a,252,a,60
s_waitcnt lgkmcnt(5)
TW a,250,712
M v,224,a,224,a,32
DL 7,68,93,3168
M v,224,a,228,a,48
TW a,252,840
s_add_u32 m0, s92, 132608
M v,228,a,224,a,36
TW a,254,968
s_mov_b32 s93, 256
M v,228,a,228,a,52
M v,232,a,224,a,40
M v,232,a,228,a,56
M v,236,a,224,a,44
DL 5,40,93,0
M v,236,a,228,a,60
M v,32,a,232,a,32
M v,32,a,236,a,48
M v,36,a,232,a,36
M v,36,a,236,a,52
M v,40,a,232,a,40
DL 5,44,93,1032
M v,40,a,236,a,56
M v,44,a,232,a,44
M v,44,a,236,a,60
s_waitcnt lgkmcnt(0)
s_waitcnt vmcnt(10)
M v,240,a,240,a,32
s_barrier
RD a,104,3,16896
M v,240,a,244,a,48
RD a,120,3,16960
M v,244,a,240,a,36
DL 5,48,93,2112
M v,244,a,244,a,52
RD a,108,3,17408
M v,248,a,240,a,40
RD a,124,3,17472
M v,248,a,244,a,56
TW a,224,33792
M v,252,a,240,a,44
TW a,226,33920
M v,252,a,244,a,60
TW a,228,34048
M v,48,a,248,a,32
TW a,230,34176
M v,48,a,252,a,48
TW a,232,34304
M v,52,a,248,a,36
TW a,234,34432
TW a,236,34560
M v,52,a,252,a,52
TW a,238,34688
M v,56,a,248,a,40
DL 5,52,93,3144
M v,56,a,252,a,56
s_add_u32 m0, s92, 0
s_xor_b32 s93, s4, 29184
M v,60,a,248,a,44
TW a,240,33800
M v,60,a,252,a,60
s_waitcnt lgkmcnt(1)
TW a,242,33928
M v,128,a,224,a,64
DL 7,56,93,0
M v,128,a,228,a,80
TW a,244,34056
M v,128,a,232,a,96
TW a,246,34184
M v,128,a,236,a,112
TW a,248,34312
M v,132,a,224,a,68
DL 7,60,93,1056
M v,132,a,228,a,84
TW a,250,34440
M v,132,a,232,a,100
TW a,252,34568
M v,132,a,236,a,116
TW a,254,34696
M v,136,a,224,a,72
M v,136,a,228,a,88
M v,136,a,232,a,104
DL 7,64,93,2112
M v,136,a,236,a,120
M v,140,a,224,a,76
TW a,224,33856
M v,140,a,228,a,92
TW a,226,33984
M v,140,a,232,a,108
TW a,228,34112
M v,140,a,236,a,124
s_waitcnt lgkmcnt(3)
TW a,230,34240
M v,64,a,240,a,64
DL 7,68,93,3168
M v,64,a,244,a,80
TW a,232,34368
s_add_u32 m0, s92, 16896
M v,64,a,248,a,96
TW a,234,34496
s_mov_b32 s93, 384
M v,64,a,252,a,112
TW a,236,34624
M v,68,a,240,a,68
TW a,238,34752
M v,68,a,244,a,84
M v,68,a,248,a,100
DL 5,40,93,0
M v,68,a,252,a,116
M v,72,a,240,a,72
M v,72,a,244,a,88
M v,72,a,248,a,104
M v,72,a,252,a,120
M v,76,a,240,a,76
DL 5,44,93,1032
M v,76,a,244,a,92
TW a,240,33864
M v,76,a,248,a,108
TW a,242,33992
M v,76,a,252,a,124
s_waitcnt lgkmcnt(2)
TW a,244,34120
M v,144,a,224,a,64
TW a,246,34248
M v,144,a,228,a,80
TW a,248,34376
M v,144,a,232,a,96
DL 5,48,93,2112
M v,144,a,236,a,112
TW a,250,34504
M v,148,a,224,a,68
TW a,252,34632
M v,148,a,228,a,84
TW a,254,34760
M v,148,a,232,a,100
M v,148,a,236,a,116
M v,152,a,224,a,72
DL 5,52,93,3144
M v,152,a,228,a,88
s_add_u32 m0, s92, 81920
s_xor_b32 s93, s4, 640
M v,152,a,232,a,104
M v,152,a,236,a,120
M v,156,a,224,a,76
M v,156,a,228,a,92
M v,156,a,232,a,108
DL 7,56,93,0
M v,156,a,236,a,124
s_waitcnt lgkmcnt(0)
s_waitcnt vmcnt(13)
M v,80,a,240,a,64
s_barrier
TW a,224,50688
M v,80,a,244,a,80
TW a,226,50816
M v,80,a,248,a,96
TW a,228,50944
M v,80,a,252,a,112
TW a,230,51072
M v,84,a,240,a,68
DL 7,60,93,1056
M v,84,a,244,a,84
TW a,232,51200
M v,84,a,248,a,100
TW a,234,51328
M v,84,a,252,a,116
TW a,236,51456
M v,88,a,240,a,72
TW a,238,51584
M v,88,a,244,a,88
RD a,128,3,33792
M v,88,a,248,a,104
DL 7,64,93,2112
M v,88,a,252,a,120
RD a,160,3,33856
M v,92,a,240,a,76
TW a,240,50696
M v,92,a,244,a,92
TW a,242,50824
M v,92,a,248,a,108
TW a,244,50952
M v,92,a,252,a,124
s_waitcnt lgkmcnt(5)
TW a,246,51080
M v,160,a,224,a,64
DL 7,68,93,3168
M v,160,a,228,a,80
TW a,248,51208
s_add_u32 m0, s92, 33792
M v,160,a,232,a,96
TW a,250,51336
s_xor_b32 s93, s4, 29312
M v,160,a,236,a,112
TW a,252,51464
M v,164,a,224,a,68
TW a,254,51592
M v,164,a,228,a,84
RD a,132,3,34304
M v,164,a,232,a,100
DL 7,56,93,0
M v,164,a,236,a,116
RD a,164,3,34368
M v,168,a,224,a,72
M v,168,a,228,a,88
M v,168,a,232,a,104
M v,168,a,236,a,120
M v,172,a,224,a,76
DL 7,60,93,1056
M v,172,a,228,a,92
TW a,224,50752
M v,172,a,232,a,108
TW a,226,50880
M v,172,a,236,a,124
s_waitcnt lgkmcnt(4)
TW a,228,51008
M v,96,a,240,a,64
TW a,230,51136
M v,96,a,244,a,80
TW a,232,51264
M v,96,a,248,a,96
DL 7,64,93,2112
M v,96,a,252,a,112
TW a,234,51392
M v,100,a,240,a,68
TW a,236,51520
v_xor_b32 v3, 81920, v3
M v,100,a,244,a,84
TW a,238,51648
M v,100,a,248,a,100
M v,100,a,252,a,116
M v,104,a,240,a,72
DL 7,68,93,3168
M v,104,a,244,a,88
s_add_u32 m0, s92, 98816
s_mov_b32 s93, 2097152
M v,104,a,248,a,104
M v,104,a,252,a,120
M v,108,a,240,a,76
TW a,240,50760
M v,108,a,244,a,92
TW a,242,50888
M v,108,a,248,a,108
DL 6,40,93,0
M v,108,a,252,a,124
s_waitcnt lgkmcnt(2)
TW a,244,51016
M v,176,a,224,a,64
TW a,246,51144
M v,176,a,228,a,80
TW a,248,51272
M v,176,a,232,a,96
TW a,250,51400
M v,176,a,236,a,112
TW a,252,51528
M v,180,a,224,a,68
TW a,254,51656
v_xor_b32 v11, 81920, v11
M v,180,a,228,a,84
DL 6,44,93,1032
M v,180,a,232,a,100
M v,180,a,236,a,116
M v,184,a,224,a,72
M v,184,a,228,a,88
M v,184,a,232,a,104
DL 6,48,93,2112
M v,184,a,236,a,120
M v,188,a,224,a,76
M v,188,a,228,a,92
M v,188,a,232,a,108
M v,188,a,236,a,124
s_waitcnt lgkmcnt(0)
s_waitcnt vmcnt(15)
M v,112,a,240,a,64
s_barrier
TW a,224,50688
M v,112,a,244,a,80
DL 6,52,93,3144
M v,112,a,248,a,96
TW a,226,50816
s_add_u32 m0, s92, 50688
M v,112,a,252,a,112
TW a,228,50944
s_xor_b32 s93, s4, 768
M v,116,a,240,a,68
TW a,230,51072
M v,116,a,244,a,84
TW a,232,51200
M v,116,a,248,a,100
DL 7,56,93,0
M v,116,a,252,a,116
TW a,234,51328
M v,120,a,240,a,72
TW a,236,51456
M v,120,a,244,a,88
TW a,238,51584
M v,120,a,248,a,104
RD a,136,3,0
M v,120,a,252,a,120
RD a,168,3,64
M v,124,a,240,a,76
DL 7,60,93,1056
M v,124,a,244,a,92
TW a,240,50696
M v,124,a,248,a,108
TW a,242,50824
M v,124,a,252,a,124
s_waitcnt lgkmcnt(4)
TW a,244,50952
M v,192,a,224,a,64
TW a,246,51080
M v,192,a,228,a,80
TW a,248,51208
M v,192,a,232,a,96
DL 7,64,93,2112
M v,192,a,236,a,112
TW a,250,51336
M v,196,a,224,a,68
TW a,252,51464
M v,196,a,228,a,84
TW a,254,51592
M v,196,a,232,a,100
RD a,140,3,512
M v,196,a,236,a,116
RD a,172,3,576
M v,200,a,224,a,72
DL 7,68,93,3168
M v,200,a,228,a,88
s_add_u32 m0, s92, 115712
s_xor_b32 s93, s4, 29440
M v,200,a,232,a,104
M v,200,a,236,a,120
M v,204,a,224,a,76
TW a,224,50752
M v,204,a,228,a,92
TW a,226,50880
M v,204,a,232,a,108
DL 7,56,93,0
M v,204,a,236,a,124
s_waitcnt lgkmcnt(4)
TW a,228,51008
M a,144,a,240,a,64
TW a,230,51136
M a,144,a,244,a,80
TW a,232,51264
M a,144,a,248,a,96
TW a,234,51392
M a,144,a,252,a,112
TW a,236,51520
M a,148,a,240,a,68
TW a,238,51648
v_xor_b32 v3, 81920, v3
M a,148,a,244,a,84
DL 7,60,93,1056
M a,148,a,248,a,100
s_and_b32 s97, s95, 28
s_cbranch_scc1 L_clA
buffer_store_dwordx4 v[12:15], v28, s[88:91], s94 offen offset:0 sc1
buffer_store_dwordx4 v[12:15], v28, s[88:91], s94 offen offset:128 sc1
buffer_store_dwordx4 v[12:15], v28, s[88:91], s94 offen offset:256 sc1
buffer_store_dwordx4 v[12:15], v28, s[88:91], s94 offen offset:384 sc1
buffer_store_dwordx4 v[12:15], v28, s[88:91], s94 offen offset:512 sc1
buffer_store_dwordx4 v[12:15], v28, s[88:91], s94 offen offset:640 sc1
buffer_store_dwordx4 v[12:15], v28, s[88:91], s94 offen offset:768 sc1
L_clA:
M a,148,a,252,a,116
M a,152,a,240,a,72
M a,152,a,244,a,88
M a,152,a,248,a,104
DL 7,64,93,2112
M a,152,a,252,a,120
M a,156,a,240,a,76
TW a,240,50760
M a,156,a,244,a,92
TW a,242,50888
M a,156,a,248,a,108
TW a,244,51016
M a,156,a,252,a,124
s_waitcnt lgkmcnt(3)
TW a,246,51144
M v,208,a,224,a,64
DL 7,68,93,3168
M v,208,a,228,a,80
TW a,248,51272
M v,208,a,232,a,96
TW a,250,51400
M v,208,a,236,a,112
TW a,252,51528
M v,212,a,224,a,68
TW a,254,51656
v_xor_b32 v11, 81920, v11
M v,212,a,228,a,84
M v,212,a,232,a,100
M v,212,a,236,a,116
M v,216,a,224,a,72
M v,216,a,228,a,88
M v,216,a,232,a,104
M v,216,a,236,a,120
M v,220,a,224,a,76
M v,220,a,228,a,92
M v,220,a,232,a,108
M v,220,a,236,a,124
s_waitcnt lgkmcnt(0)
s_waitcnt vmcnt(12)
M a,176,a,240,a,64
s_barrier
TW a,224,16896
M a,176,a,244,a,80
TW a,226,17024
s_add_u32 m0, s92, 132608
M a,176,a,248,a,96
TW a,228,17152
s_mov_b32 s93, 2621440
M a,176,a,252,a,112
TW a,230,17280
M a,180,a,240,a,68
TW a,232,17408
M a,180,a,244,a,84
TW a,234,17536
M a,180,a,248,a,100
TW a,236,17664
M a,180,a,252,a,116
TW a,238,17792
M a,184,a,240,a,72
RD a,0,3,0
M a,184,a,244,a,88
RD a,16,3,64
M a,184,a,248,a,104
RD a,4,3,512
M a,184,a,252,a,120
DL 5,40,93,0
M a,188,a,240,a,76
TW a,240,16904
M a,188,a,244,a,92
TW a,242,17032
M a,188,a,248,a,108
TW a,244,17160
M a,188,a,252,a,124
s_waitcnt lgkmcnt(6)
TW a,246,17288
M v,224,a,224,a,64
TW a,248,17416
M v,224,a,228,a,80
TW a,250,17544
M v,224,a,232,a,96
TW a,252,17672
M v,224,a,236,a,112
DL 5,44,93,1032
M v,228,a,224,a,68
TW a,254,17800
M v,228,a,228,a,84
RD a,20,3,576
v_xor_b32 v3, 81920, v3
M v,228,a,232,a,100
RD a,8,3,33792
M v,228,a,236,a,116
RD a,24,3,33856
M v,232,a,224,a,72
RD a,12,3,34304
M v,232,a,228,a,88
RD a,28,3,34368
M v,232,a,232,a,104
M v,232,a,236,a,120
DL 5,48,93,2112
M v,236,a,224,a,76
TW a,224,16960
v_bfe_u32 v8, v4, 8, 2
M v,236,a,228,a,92
TW a,226,17088
v_lshrrev_b32 v9, 14, s95
M v,236,a,232,a,108
TW a,228,17216
v_add_lshl_u32 v8, v8, v9, 7
M v,236,a,236,a,124
s_waitcnt lgkmcnt(8)
TW a,230,17344
M v,32,a,240,a,64
TW a,232,17472
v_add_u32 v8, 4096, v8
M v,32,a,244,a,80
TW a,234,17600
v_mov_b32 v9, 0
M v,32,a,248,a,96
s_getpc_b64 s[100:101]
s_and_b32 s100, s100, 0xfffff000
M v,32,a,252,a,112
DL 5,52,93,3144
M v,36,a,240,a,68
TW a,236,17728
s_add_u32 m0, s92, 0
M v,36,a,244,a,84
TW a,238,17856
s_mov_b32 s93, 2621568
M v,36,a,248,a,100
v_lshl_add_u64 v[8:9], v[8:9], 0, s[100:101]
M v,36,a,252,a,116
global_load_dword v10, v[8:9], off
M v,40,a,240,a,72
L_pad1:
s_cbranch_execz L_ret1
M v,40,a,244,a,88
M v,40,a,248,a,104
M v,40,a,252,a,120
DL 5,40,93,0
M v,44,a,240,a,76
TW a,240,16968
M v,44,a,244,a,92
TW a,242,17096
M v,44,a,248,a,108
TW a,244,17224
M v,44,a,252,a,124
s_waitcnt lgkmcnt(3)
TW a,246,17352
M v,240,a,224,a,64
TW a,248,17480
s_mov_b32 s2, 0
M v,240,a,228,a,80
TW a,250,17608
M v,240,a,232,a,96
TW a,252,17736
M v,240,a,236,a,112
DL 5,44,93,1032
M v,244,a,224,a,68
TW a,254,17864
v_xor_b32 v11, 81920, v11
M v,244,a,228,a,84
M v,244,a,232,a,100
M v,244,a,236,a,116
M v,248,a,224,a,72
M v,248,a,228,a,88
M v,248,a,232,a,104
M v,248,a,236,a,120
DL 5,48,93,2112
M v,252,a,224,a,76
M v,252,a,228,a,92
M v,252,a,232,a,108
M v,252,a,236,a,124
s_waitcnt lgkmcnt(0)
s_waitcnt vmcnt(8)
M v,48,a,240,a,64
s_barrier
TW a,224,16896
M v,48,a,244,a,80
TW a,226,17024
M v,48,a,248,a,96
TW a,228,17152
M v,48,a,252,a,112
DL 5,52,93,3144
M v,52,a,240,a,68
TW a,230,17280
s_add_u32 m0, s92, 16896
M v,52,a,244,a,84
TW a,232,16904
s_mov_b32 s93, 2097408
M v,52,a,248,a,100
TW a,234,17032
M v,52,a,252,a,116
TW a,236,17160
M v,56,a,240,a,72
TW a,238,17288
M v,56,a,244,a,88
RD a,32,3,50688
M v,56,a,248,a,104
RD a,48,3,50752
M v,56,a,252,a,120
DL 6,40,93,0
M v,60,a,240,a,76
TW a,240,16960
M v,60,a,244,a,92
TW a,242,17088
M v,60,a,248,a,108
TW a,244,17216
M v,60,a,252,a,124
s_waitcnt lgkmcnt(5)
TW a,246,17344
M v,128,a,224,a,128
TW a,248,16968
M v,128,a,228,a,160
TW a,250,17096
M v,132,a,224,a,132
TW a,252,17224
M v,132,a,228,a,164
DL 6,44,93,1032
M v,136,a,224,a,136
TW a,254,17352
M v,136,a,228,a,168
RD a,36,3,51200
M v,140,a,224,a,140
RD a,52,3,51264
v_xor_b32 v3, 81920, v3
M v,140,a,228,a,172
RD a,40,3,33792
M v,64,a,232,a,128
RD a,56,3,33856
M v,64,a,236,a,160
RD a,44,3,34304
M v,68,a,232,a,132
RD a,60,3,34368
M v,68,a,236,a,164
DL 6,48,93,2112
M v,72,a,232,a,136
s_add_u32 m0, s92, 81920
TW a,224,17408
M v,72,a,236,a,168
TW a,226,17536
M v,76,a,232,a,140
TW a,228,17664
M v,76,a,236,a,172
s_waitcnt lgkmcnt(9)
TW a,230,17792
M v,144,a,240,a,128
TW a,232,17416
M v,144,a,244,a,160
TW a,234,17544
M v,148,a,240,a,132
DN 4,8,2,0
M v,148,a,244,a,164
TW a,236,17672
s_add_u32 m0, s92, 16896
M v,152,a,240,a,136
TW a,238,17800
M v,152,a,244,a,168
M v,156,a,240,a,140
DL 6,52,93,3144
M v,156,a,244,a,172
s_add_u32 m0, s92, 81920
TW a,240,17472
M v,80,a,248,a,128
TW a,242,17600
s_mov_b32 s93, 2621696
M v,80,a,252,a,160
TW a,244,17728
M v,84,a,248,a,132
TW a,246,17856
M v,84,a,252,a,164
M v,88,a,248,a,136
M v,88,a,252,a,168
M v,92,a,248,a,140
TW a,248,17480
M v,92,a,252,a,172
s_waitcnt lgkmcnt(5)
TW a,250,17608
M v,160,a,224,a,128
TW a,252,17736
M v,160,a,228,a,160
TW a,254,17864
M v,164,a,224,a,132
M v,164,a,228,a,164
DN 4,12,2,1056
M v,168,a,224,a,136
s_add_u32 m0, s92, 33792
M v,168,a,228,a,168
M v,172,a,224,a,140
M v,172,a,228,a,172
DL 5,40,93,0
M v,96,a,232,a,128
M v,96,a,236,a,160
M v,100,a,232,a,132
M v,100,a,236,a,164
M v,104,a,232,a,136
M v,104,a,236,a,168
M v,108,a,232,a,140
M v,108,a,236,a,172
s_waitcnt lgkmcnt(0)
s_waitcnt vmcnt(12)
M v,176,a,240,a,128
s_barrier
TW a,224,50688
M v,176,a,244,a,160
TW a,226,50816
M v,180,a,240,a,132
TW a,228,50944
M v,180,a,244,a,164
DL 5,44,93,1032
M v,184,a,240,a,136
TW a,230,51072
s_add_u32 m0, s92, 81920
M v,184,a,244,a,168
TW a,232,51200
M v,188,a,240,a,140
TW a,234,51328
M v,188,a,244,a,172
TW a,236,51456
M v,112,a,248,a,128
TW a,238,51584
M v,112,a,252,a,160
DN 4,16,2,2112
M v,116,a,248,a,132
s_add_u32 m0, s92, 33792
TW a,240,50696
M v,116,a,252,a,164
TW a,242,50824
M v,120,a,248,a,136
TW a,244,50952
M v,120,a,252,a,168
TW a,246,51080
M v,124,a,248,a,140
TW a,248,51208
M v,124,a,252,a,172
s_waitcnt lgkmcnt(5)
TW a,250,51336
M v,128,a,224,a,0
TW a,252,51464
M v,128,a,228,a,16
TW a,254,51592
M v,128,a,232,a,32
M v,128,a,236,a,48
DL 5,48,93,2112
M v,132,a,224,a,4
s_add_u32 m0, s92, 81920
M v,132,a,228,a,20
M v,132,a,232,a,36
M v,132,a,236,a,52
DN 4,20,2,3168
M v,136,a,224,a,8
s_add_u32 m0, s92, 33792
s_mov_b32 s2, 16384
M v,136,a,228,a,24
v_mul_f32 v128, 0x3db8aa3b, v128
v_mul_f32 v129, 0x3db8aa3b, v129
M v,136,a,232,a,40
v_mul_f32 v130, 0x3db8aa3b, v130
v_mul_f32 v131, 0x3db8aa3b, v131
M v,136,a,236,a,56
CV 128,128
CV 129,130
M v,140,a,224,a,12
TW a,224,50752
v_mul_f32 v132, 0x3db8aa3b, v132
M v,140,a,228,a,28
TW a,226,50880
v_mul_f32 v133, 0x3db8aa3b, v133
M v,140,a,232,a,44
TW a,228,51008
v_mul_f32 v134, 0x3db8aa3b, v134
M v,140,a,236,a,60
s_waitcnt lgkmcnt(3)
TW a,230,51136
M v,64,a,240,a,0
TW a,232,51264
v_mul_f32 v135, 0x3db8aa3b, v135
M v,64,a,244,a,16
TW a,234,51392
CV 132,132
M v,64,a,248,a,32
TW a,236,51520
CV 133,134
M v,64,a,252,a,48
DL 5,52,93,3144
M v,68,a,240,a,4
TW a,238,51648
s_add_u32 m0, s92, 98816
M v,68,a,244,a,20
s_mov_b32 s93, 2621824
v_mul_f32 v136, 0x3db8aa3b, v136
M v,68,a,248,a,36
v_mul_f32 v64, 0x3db8aa3b, v64
v_mul_f32 v65, 0x3db8aa3b, v65
M v,68,a,252,a,52
DN 4,8,2,0
M v,72,a,240,a,8
s_add_u32 m0, s92, 50688
v_mul_f32 v66, 0x3db8aa3b, v66
M v,72,a,244,a,24
v_mul_f32 v67, 0x3db8aa3b, v67
CV 130,64
M v,72,a,248,a,40
CV 131,66
v_mul_f32 v68, 0x3db8aa3b, v68
M v,72,a,252,a,56
v_mul_f32 v69, 0x3db8aa3b, v69
v_mul_f32 v70, 0x3db8aa3b, v70
M v,76,a,240,a,12
TW a,240,50760
v_mul_f32 v71, 0x3db8aa3b, v71
M v,76,a,244,a,28
TW a,242,50888
CV 134,68
M v,76,a,248,a,44
TW a,244,51016
CV 135,70
M v,76,a,252,a,60
s_waitcnt lgkmcnt(3)
TW a,246,51144
M v,144,a,224,a,0
TW a,248,51272
v_mul_f32 v137, 0x3db8aa3b, v137
M v,144,a,228,a,16
TW a,250,51400
v_mul_f32 v138, 0x3db8aa3b, v138
M v,144,a,232,a,32
TW a,252,51528
v_mul_f32 v139, 0x3db8aa3b, v139
M v,144,a,236,a,48
DL 5,40,93,0
M v,148,a,224,a,4
TW a,254,51656
s_add_u32 m0, s92, 98816
M v,148,a,228,a,20
v_xor_b32 v11, 81920, v11
CV 136,136
M v,148,a,232,a,36
v_mul_f32 v144, 0x3db8aa3b, v144
v_mul_f32 v145, 0x3db8aa3b, v145
M v,148,a,236,a,52
DN 4,12,2,1056
M v,152,a,224,a,8
s_add_u32 m0, s92, 50688
v_mul_f32 v146, 0x3db8aa3b, v146
M v,152,a,228,a,24
v_mul_f32 v147, 0x3db8aa3b, v147
CV 144,144
M v,152,a,232,a,40
CV 145,146
v_mul_f32 v148, 0x3db8aa3b, v148
M v,152,a,236,a,56
v_mul_f32 v149, 0x3db8aa3b, v149
v_mul_f32 v150, 0x3db8aa3b, v150
M v,156,a,224,a,12
v_mul_f32 v151, 0x3db8aa3b, v151
CV 148,148
M v,156,a,228,a,28
CV 149,150
CV 137,138
M v,156,a,232,a,44
v_mul_f32 v72, 0x3db8aa3b, v72
v_mul_f32 v73, 0x3db8aa3b, v73
M v,156,a,236,a,60
s_waitcnt lgkmcnt(0)
s_waitcnt vmcnt(15)
M v,80,a,240,a,0
s_barrier
TW a,224,0
M v,80,a,244,a,16
TW a,226,128
v_mul_f32 v74, 0x3db8aa3b, v74
M v,80,a,248,a,32
TW a,228,256
v_mul_f32 v75, 0x3db8aa3b, v75
M v,80,a,252,a,48
DL 5,44,93,1032
M v,84,a,240,a,4
TW a,230,384
s_add_u32 m0, s92, 98816
M v,84,a,244,a,20
TW a,232,512
v_mul_f32 v152, 0x3db8aa3b, v152
M v,84,a,248,a,36
TW a,234,640
v_mul_f32 v80, 0x3db8aa3b, v80
M v,84,a,252,a,52
TW a,236,768
v_mul_f32 v81, 0x3db8aa3b, v81
M v,88,a,240,a,8
TW a,238,896
v_mul_f32 v82, 0x3db8aa3b, v82
M v,88,a,244,a,24
DN 4,16,2,2112
M v,88,a,248,a,40
s_add_u32 m0, s92, 50688
v_mul_f32 v83, 0x3db8aa3b, v83
M v,88,a,252,a,56
CV 146,80
CV 147,82
M v,92,a,240,a,12
TW a,240,8
v_mul_f32 v84, 0x3db8aa3b, v84
M v,92,a,244,a,28
TW a,242,136
v_mul_f32 v85, 0x3db8aa3b, v85
M v,92,a,248,a,44
TW a,244,264
v_mul_f32 v86, 0x3db8aa3b, v86
M v,92,a,252,a,60
s_waitcnt lgkmcnt(3)
TW a,246,392
M v,160,a,224,a,0
TW a,248,520
v_mul_f32 v87, 0x3db8aa3b, v87
M v,160,a,228,a,16
TW a,250,648
CV 150,84
M v,160,a,232,a,32
TW a,252,776
CV 151,86
M v,160,a,236,a,48
DL 5,48,93,2112
M v,164,a,224,a,4
TW a,254,904
s_add_u32 m0, s92, 98816
M v,164,a,228,a,20
v_mul_f32 v153, 0x3db8aa3b, v153
CV 138,72
M v,164,a,232,a,36
v_mul_f32 v160, 0x3db8aa3b, v160
v_mul_f32 v161, 0x3db8aa3b, v161
M v,164,a,236,a,52
v_mul_f32 v162, 0x3db8aa3b, v162
v_mul_f32 v163, 0x3db8aa3b, v163
M v,168,a,224,a,8
CV 160,160
CV 161,162
M v,168,a,228,a,24
DN 4,20,2,3168
M v,168,a,232,a,40
s_add_u32 m0, s92, 50688
s_mov_b32 s2, 0
M v,168,a,236,a,56
v_mul_f32 v164, 0x3db8aa3b, v164
v_mul_f32 v165, 0x3db8aa3b, v165
M v,172,a,224,a,12
TW a,224,64
v_mul_f32 v166, 0x3db8aa3b, v166
M v,172,a,228,a,28
TW a,226,192
v_mul_f32 v167, 0x3db8aa3b, v167
M v,172,a,232,a,44
TW a,228,320
CV 164,164
M v,172,a,236,a,60
s_waitcnt lgkmcnt(3)
TW a,230,448
M v,96,a,240,a,0
TW a,232,576
CV 165,166
M v,96,a,244,a,16
TW a,234,704
CV 139,74
M v,96,a,248,a,32
TW a,236,832
v_mul_f32 v154, 0x3db8aa3b, v154
M v,96,a,252,a,48
DL 5,52,93,3144
M v,100,a,240,a,4
TW a,238,960
s_add_u32 m0, s92, 115712
M v,100,a,244,a,20
v_mul_f32 v155, 0x3db8aa3b, v155
CV 152,152
M v,100,a,248,a,36
v_mul_f32 v96, 0x3db8aa3b, v96
v_mul_f32 v97, 0x3db8aa3b, v97
M v,100,a,252,a,52
v_mul_f32 v98, 0x3db8aa3b, v98
v_mul_f32 v99, 0x3db8aa3b, v99
M v,104,a,240,a,8
CV 162,96
CV 163,98
M v,104,a,244,a,24
CV 153,154
v_mul_f32 v88, 0x3db8aa3b, v88
M v,104,a,248,a,40
DN 4,24,2,0
M v,104,a,252,a,56
v_mul_f32 v100, 0x3db8aa3b, v100
v_mul_f32 v101, 0x3db8aa3b, v101
M v,108,a,240,a,12
TW a,240,72
v_mul_f32 v102, 0x3db8aa3b, v102
M v,108,a,244,a,28
TW a,242,200
v_mul_f32 v103, 0x3db8aa3b, v103
M v,108,a,248,a,44
TW a,244,328
CV 166,100
M v,108,a,252,a,60
s_waitcnt lgkmcnt(3)
TW a,246,456
M v,176,a,224,a,0
TW a,248,584
CV 167,102
M v,176,a,228,a,16
TW a,250,712
v_mul_f32 v89, 0x3db8aa3b, v89
M v,176,a,232,a,32
TW a,252,840
v_mul_f32 v90, 0x3db8aa3b, v90
M v,176,a,236,a,48
TW a,254,968
v_mul_f32 v91, 0x3db8aa3b, v91
M v,180,a,224,a,4
v_mul_f32 v168, 0x3db8aa3b, v168
v_mul_f32 v169, 0x3db8aa3b, v169
M v,180,a,228,a,20
CV 154,88
CV 155,90
M v,180,a,232,a,36
v_mul_f32 v176, 0x3db8aa3b, v176
v_mul_f32 v177, 0x3db8aa3b, v177
M v,180,a,236,a,52
v_mul_f32 v178, 0x3db8aa3b, v178
v_mul_f32 v179, 0x3db8aa3b, v179
M v,184,a,224,a,8
CV 176,176
CV 177,178
M v,184,a,228,a,24
v_mul_f32 v170, 0x3db8aa3b, v170
v_mul_f32 v171, 0x3db8aa3b, v171
M v,184,a,232,a,40
v_mul_f32 v180, 0x3db8aa3b, v180
v_mul_f32 v181, 0x3db8aa3b, v181
M v,184,a,236,a,56
DN 4,28,2,1056
M v,188,a,224,a,12
v_mul_f32 v182, 0x3db8aa3b, v182
v_mul_f32 v183, 0x3db8aa3b, v183
M v,188,a,228,a,28
CV 180,180
CV 181,182
M v,188,a,232,a,44
CV 168,168
CV 169,170
M v,188,a,236,a,60
s_waitcnt lgkmcnt(0)
s_waitcnt vmcnt(17)
M v,112,a,240,a,0
s_barrier
TW a,224,16896
M v,112,a,244,a,16
TW a,226,17024
v_mul_f32 v104, 0x3db8aa3b, v104
L_pad2:
s_cbranch_execz L_ret2
M v,112,a,248,a,32
TW a,228,17152
v_mul_f32 v105, 0x3db8aa3b, v105
M v,112,a,252,a,48
TW a,230,17280
v_mul_f32 v106, 0x3db8aa3b, v106
M v,116,a,240,a,4
TW a,232,16904
v_mul_f32 v107, 0x3db8aa3b, v107
M v,116,a,244,a,20
TW a,234,17032
v_mul_f32 v184, 0x3db8aa3b, v184
M v,116,a,248,a,36
TW a,236,17160
v_mul_f32 v112, 0x3db8aa3b, v112
M v,116,a,252,a,52
TW a,238,17288
v_mul_f32 v113, 0x3db8aa3b, v113
M v,120,a,240,a,8
v_mul_f32 v114, 0x3db8aa3b, v114
v_mul_f32 v115, 0x3db8aa3b, v115
M v,120,a,244,a,24
CV 178,112
CV 179,114
M v,120,a,248,a,40
v_mul_f32 v116, 0x3db8aa3b, v116
v_mul_f32 v117, 0x3db8aa3b, v117
M v,120,a,252,a,56
v_mul_f32 v118, 0x3db8aa3b, v118
v_mul_f32 v119, 0x3db8aa3b, v119
M v,124,a,240,a,12
DN 4,32,2,2112
M v,124,a,244,a,28
TW a,240,16960
CV 182,116
M v,124,a,248,a,44
TW a,242,17088
CV 183,118
M v,124,a,252,a,60
s_waitcnt lgkmcnt(2)
TW a,244,17216
M v,192,a,224,a,128
TW a,246,17344
v_mul_f32 v185, 0x3db8aa3b, v185
M v,192,a,228,a,160
TW a,248,16968
CV 170,104
M v,196,a,224,a,132
TW a,250,17096
CV 171,106
M v,196,a,228,a,164
TW a,252,17224
v_mul_f32 v186, 0x3db8aa3b, v186
M v,200,a,224,a,136
TW a,254,17352
v_mul_f32 v187, 0x3db8aa3b, v187
M v,200,a,228,a,168
CV 184,184
v_mul_f32 v140, 0x3db8aa3b, v140
M v,204,a,224,a,140
TW a,224,17408
v_mul_f32 v141, 0x3db8aa3b, v141
M v,204,a,228,a,172
TW a,226,17536
CV 185,186
M a,144,a,232,a,128
TW a,228,17664
v_mul_f32 v120, 0x3db8aa3b, v120
M a,144,a,236,a,160
TW a,230,17792
v_mul_f32 v121, 0x3db8aa3b, v121
M a,148,a,232,a,132
v_mul_f32 v122, 0x3db8aa3b, v122
v_mul_f32 v123, 0x3db8aa3b, v123
M a,148,a,236,a,164
v_mul_f32 v142, 0x3db8aa3b, v142
v_mul_f32 v143, 0x3db8aa3b, v143
M a,152,a,232,a,136
CV 140,140
CV 186,120
M a,152,a,236,a,168
DN 4,36,2,3168
M a,156,a,232,a,140
TW a,232,17416
s_add_u32 m0, s92, 132608
M a,156,a,236,a,172
s_waitcnt lgkmcnt(5)
TW a,234,17544
M v,208,a,240,a,128
TW a,236,17672
s_mov_b32 s2, 32768
M v,208,a,244,a,160
TW a,238,17800
CV 187,122
M v,212,a,240,a,132
CV 141,142
v_mul_f32 v76, 0x3db8aa3b, v76
M v,212,a,244,a,164
v_mul_f32 v77, 0x3db8aa3b, v77
v_mul_f32 v78, 0x3db8aa3b, v78
M v,216,a,240,a,136
v_mul_f32 v79, 0x3db8aa3b, v79
v_mul_f32 v156, 0x3db8aa3b, v156
M v,216,a,244,a,168
v_mul_f32 v157, 0x3db8aa3b, v157
CV 142,76
M v,220,a,240,a,140
TW a,240,17472
CV 143,78
M v,220,a,244,a,172
TW a,242,17600
v_mul_f32 v158, 0x3db8aa3b, v158
M a,176,a,248,a,128
TW a,244,17728
v_mul_f32 v159, 0x3db8aa3b, v159
M a,176,a,252,a,160
TW a,246,17856
CV 156,156
M a,180,a,248,a,132
CV 157,158
v_mul_f32 v92, 0x3db8aa3b, v92
M a,180,a,252,a,164
v_mul_f32 v93, 0x3db8aa3b, v93
v_mul_f32 v94, 0x3db8aa3b, v94
M a,184,a,248,a,136
v_mul_f32 v95, 0x3db8aa3b, v95
v_mul_f32 v172, 0x3db8aa3b, v172
M a,184,a,252,a,168
v_mul_f32 v173, 0x3db8aa3b, v173
CV 158,92
M a,188,a,248,a,140
DN 4,8,2,0
M a,188,a,252,a,172
s_waitcnt lgkmcnt(4)
TW a,248,17480
M v,224,a,224,a,128
TW a,250,17608
CV 159,94
M v,224,a,228,a,160
TW a,252,17736
v_mul_f32 v174, 0x3db8aa3b, v174
M v,228,a,224,a,132
TW a,254,17864
v_mul_f32 v175, 0x3db8aa3b, v175
M v,228,a,228,a,164
CV 172,172
CV 173,174
M v,232,a,224,a,136
v_mul_f32 v108, 0x3db8aa3b, v108
v_mul_f32 v109, 0x3db8aa3b, v109
M v,232,a,228,a,168
v_mul_f32 v110, 0x3db8aa3b, v110
v_mul_f32 v111, 0x3db8aa3b, v111
M v,236,a,224,a,140
v_mul_f32 v188, 0x3db8aa3b, v188
v_mul_f32 v189, 0x3db8aa3b, v189
M v,236,a,228,a,172
CV 174,108
CV 175,110
M v,32,a,232,a,128
v_mul_f32 v190, 0x3db8aa3b, v190
v_mul_f32 v191, 0x3db8aa3b, v191
M v,32,a,236,a,160
CV 188,188
CV 189,190
M v,36,a,232,a,132
v_mul_f32 v124, 0x3db8aa3b, v124
v_mul_f32 v125, 0x3db8aa3b, v125
M v,36,a,236,a,164
v_mul_f32 v126, 0x3db8aa3b, v126
v_mul_f32 v127, 0x3db8aa3b, v127
M v,40,a,232,a,136
CV 190,124
CV 191,126
M v,40,a,236,a,168
M v,44,a,232,a,140
M v,44,a,236,a,172
s_waitcnt lgkmcnt(0)
s_waitcnt vmcnt(13)
M v,240,a,240,a,128
s_barrier
TW a,224,33792
M v,240,a,244,a,160
DN 4,12,2,1056
M v,244,a,240,a,132
TW a,226,33920
M v,244,a,244,a,164
TW a,228,34048
M v,248,a,240,a,136
TW a,230,34176
M v,248,a,244,a,168
TW a,232,34304
M v,252,a,240,a,140
TW a,234,34432
M v,252,a,244,a,172
TW a,236,34560
M v,48,a,248,a,128
TW a,238,34688
M v,48,a,252,a,160
TW a,240,33800
M v,52,a,248,a,132
TW a,242,33928
M v,52,a,252,a,164
TW a,244,34056
M v,56,a,248,a,136
TW a,246,34184
M v,56,a,252,a,168
M v,60,a,248,a,140
TW a,248,34312
M v,60,a,252,a,172
s_waitcnt lgkmcnt(5)
TW a,250,34440
M v,192,a,224,a,0
DN 4,16,2,2112
M v,192,a,228,a,16
TW a,252,34568
M v,192,a,232,a,32
TW a,254,34696
M v,192,a,236,a,48
M v,196,a,224,a,4
M v,196,a,228,a,20
M v,196,a,232,a,36
M v,196,a,236,a,52
M v,200,a,224,a,8
M v,200,a,228,a,24
M v,200,a,232,a,40
M v,200,a,236,a,56
v_mul_f32 v192, 0x3db8aa3b, v192
v_mul_f32 v193, 0x3db8aa3b, v193
M v,204,a,224,a,12
TW a,224,33856
v_mul_f32 v194, 0x3db8aa3b, v194
M v,204,a,228,a,28
TW a,226,33984
v_mul_f32 v195, 0x3db8aa3b, v195
M v,204,a,232,a,44
TW a,228,34112
CV 192,192
M v,204,a,236,a,60
s_waitcnt lgkmcnt(3)
TW a,230,34240
M a,144,a,240,a,0
TW a,232,34368
CV 193,194
M a,144,a,244,a,16
DN 4,20,2,3168
M a,144,a,248,a,32
TW a,234,34496
s_add_u32 m0, s92, 0
M a,144,a,252,a,48
TW a,236,34624
s_mov_b32 s2, 16384
M a,148,a,240,a,4
TW a,238,34752
v_mul_f32 v200, 0x3db8aa3b, v200
M a,148,a,244,a,20
v_mul_f32 v201, 0x3db8aa3b, v201
v_mul_f32 v202, 0x3db8aa3b, v202
M a,148,a,248,a,36
AR 20,144
AR 21,145
M a,148,a,252,a,52
AR 22,146
AR 23,147
M a,152,a,240,a,8
v_mul_f32 v20, 0x3db8aa3b, v20
v_mul_f32 v21, 0x3db8aa3b, v21
M a,152,a,244,a,24
v_mul_f32 v22, 0x3db8aa3b, v22
v_mul_f32 v23, 0x3db8aa3b, v23
M a,152,a,248,a,40
CV 194,20
CV 195,22
M a,152,a,252,a,56
v_mul_f32 v203, 0x3db8aa3b, v203
CV 200,200
M a,156,a,240,a,12
TW a,240,33864
CV 201,202
M a,156,a,244,a,28
TW a,242,33992
v_mul_f32 v196, 0x3db8aa3b, v196
M a,156,a,248,a,44
TW a,244,34120
AR 20,152
M a,156,a,252,a,60
s_waitcnt lgkmcnt(3)
TW a,246,34248
M v,208,a,224,a,0
TW a,248,34376
AR 21,153
M v,208,a,228,a,16
TW a,250,34504
AR 22,154
M v,208,a,232,a,32
DN 4,24,2,0
M v,208,a,236,a,48
TW a,252,34632
AR 23,155
M v,212,a,224,a,4
TW a,254,34760
v_mul_f32 v20, 0x3db8aa3b, v20
M v,212,a,228,a,20
v_mul_f32 v21, 0x3db8aa3b, v21
v_mul_f32 v22, 0x3db8aa3b, v22
M v,212,a,232,a,36
v_mul_f32 v23, 0x3db8aa3b, v23
CV 202,20
M v,212,a,236,a,52
CV 203,22
v_mul_f32 v208, 0x3db8aa3b, v208
M v,216,a,224,a,8
v_mul_f32 v209, 0x3db8aa3b, v209
v_mul_f32 v210, 0x3db8aa3b, v210
M v,216,a,228,a,24
v_mul_f32 v211, 0x3db8aa3b, v211
CV 208,208
M v,216,a,232,a,40
v_mul_f32 v197, 0x3db8aa3b, v197
CV 209,210
M v,216,a,236,a,56
v_mul_f32 v198, 0x3db8aa3b, v198
v_mul_f32 v199, 0x3db8aa3b, v199
M v,220,a,224,a,12
CV 196,196
AR 24,148
M v,220,a,228,a,28
AR 25,149
AR 26,150
M v,220,a,232,a,44
AR 27,151
CV 197,198
M v,220,a,236,a,60
s_waitcnt lgkmcnt(0)
s_waitcnt vmcnt(9)
M a,176,a,240,a,0
s_barrier
TW a,224,50688
M a,176,a,244,a,16
TW a,226,50816
v_mul_f32 v24, 0x3db8aa3b, v24
M a,176,a,248,a,32
TW a,228,50944
v_mul_f32 v25, 0x3db8aa3b, v25
M a,176,a,252,a,48
DN 4,28,2,1056
M a,180,a,240,a,4
TW a,230,51072
v_mul_f32 v26, 0x3db8aa3b, v26
M a,180,a,244,a,20
TW a,232,51200
v_mul_f32 v27, 0x3db8aa3b, v27
M a,180,a,248,a,36
TW a,234,51328
AR 20,176
M a,180,a,252,a,52
TW a,236,51456
AR 21,177
M a,184,a,240,a,8
TW a,238,51584
AR 22,178
M a,184,a,244,a,24
AR 23,179
v_mul_f32 v20, 0x3db8aa3b, v20
M a,184,a,248,a,40
v_mul_f32 v21, 0x3db8aa3b, v21
v_mul_f32 v22, 0x3db8aa3b, v22
M a,184,a,252,a,56
v_mul_f32 v23, 0x3db8aa3b, v23
CV 210,20
M a,188,a,240,a,12
TW a,240,50696
CV 211,22
M a,188,a,244,a,28
TW a,242,50824
v_mul_f32 v204, 0x3db8aa3b, v204
M a,188,a,248,a,44
TW a,244,50952
v_mul_f32 v205, 0x3db8aa3b, v205
M a,188,a,252,a,60
s_waitcnt lgkmcnt(3)
TW a,246,51080
M v,224,a,224,a,0
TW a,248,51208
CV 198,24
M v,224,a,228,a,16
TW a,250,51336
CV 199,26
M v,224,a,232,a,32
TW a,252,51464
v_mul_f32 v206, 0x3db8aa3b, v206
M v,224,a,236,a,48
TW a,254,51592
v_mul_f32 v207, 0x3db8aa3b, v207
M v,228,a,224,a,4
DN 4,32,2,2112
M v,228,a,228,a,20
CV 204,204
AR 24,156
M v,228,a,232,a,36
v_mul_f32 v224, 0x3db8aa3b, v224
v_mul_f32 v225, 0x3db8aa3b, v225
M v,228,a,236,a,52
v_mul_f32 v226, 0x3db8aa3b, v226
v_mul_f32 v227, 0x3db8aa3b, v227
M v,232,a,224,a,8
CV 224,224
CV 225,226
M v,232,a,228,a,24
AR 25,157
AR 26,158
M v,232,a,232,a,40
AR 27,159
CV 205,206
M v,232,a,236,a,56
v_mul_f32 v24, 0x3db8aa3b, v24
v_mul_f32 v25, 0x3db8aa3b, v25
M v,236,a,224,a,12
TW a,224,50752
v_mul_f32 v26, 0x3db8aa3b, v26
M v,236,a,228,a,28
TW a,226,50880
v_mul_f32 v27, 0x3db8aa3b, v27
M v,236,a,232,a,44
TW a,228,51008
CV 206,24
M v,236,a,236,a,60
s_waitcnt lgkmcnt(3)
TW a,230,51136
M v,32,a,240,a,0
TW a,232,51264
CV 207,26
M v,32,a,244,a,16
TW a,234,51392
v_mul_f32 v212, 0x3db8aa3b, v212
M v,32,a,248,a,32
TW a,236,51520
v_mul_f32 v213, 0x3db8aa3b, v213
M v,32,a,252,a,48
TW a,238,51648
v_mul_f32 v214, 0x3db8aa3b, v214
M v,36,a,240,a,4
v_mul_f32 v215, 0x3db8aa3b, v215
CV 212,212
M v,36,a,244,a,20
DN 4,36,2,3168
M v,36,a,248,a,36
s_add_u32 m0, s92, 16896
s_mov_b32 s2, 49152
M v,36,a,252,a,52
v_mul_f32 v32, 0x3db8aa3b, v32
v_mul_f32 v33, 0x3db8aa3b, v33
M v,40,a,240,a,8
v_mul_f32 v34, 0x3db8aa3b, v34
v_mul_f32 v35, 0x3db8aa3b, v35
M v,40,a,244,a,24
CV 226,32
CV 227,34
M v,40,a,248,a,40
AR 24,180
AR 25,181
M v,40,a,252,a,56
AR 26,182
AR 27,183
M v,44,a,240,a,12
TW a,240,50760
CV 213,214
M v,44,a,244,a,28
TW a,242,50888
v_mul_f32 v24, 0x3db8aa3b, v24
M v,44,a,248,a,44
TW a,244,51016
v_mul_f32 v25, 0x3db8aa3b, v25
M v,44,a,252,a,60
s_waitcnt lgkmcnt(3)
TW a,246,51144
M v,240,a,224,a,0
TW a,248,51272
v_mul_f32 v26, 0x3db8aa3b, v26
M v,240,a,228,a,16
TW a,250,51400
v_mul_f32 v27, 0x3db8aa3b, v27
M v,240,a,232,a,32
TW a,252,51528
v_mul_f32 v228, 0x3db8aa3b, v228
M v,240,a,236,a,48
TW a,254,51656
v_mul_f32 v229, 0x3db8aa3b, v229
M v,244,a,224,a,4
CV 214,24
CV 215,26
M v,244,a,228,a,20
v_mul_f32 v230, 0x3db8aa3b, v230
v_mul_f32 v231, 0x3db8aa3b, v231
M v,244,a,232,a,36
DN 4,8,2,0
M v,244,a,236,a,52
v_mul_f32 v240, 0x3db8aa3b, v240
v_mul_f32 v241, 0x3db8aa3b, v241
M v,248,a,224,a,8
v_mul_f32 v242, 0x3db8aa3b, v242
v_mul_f32 v243, 0x3db8aa3b, v243
M v,248,a,228,a,24
CV 240,240
CV 241,242
M v,248,a,232,a,40
CV 228,228
CV 229,230
M v,248,a,236,a,56
v_mul_f32 v36, 0x3db8aa3b, v36
v_mul_f32 v37, 0x3db8aa3b, v37
M v,252,a,224,a,12
v_mul_f32 v38, 0x3db8aa3b, v38
v_mul_f32 v39, 0x3db8aa3b, v39
M v,252,a,228,a,28
v_mul_f32 v244, 0x3db8aa3b, v244
v_mul_f32 v245, 0x3db8aa3b, v245
L_pad3:
s_cbranch_execz L_ret3
M v,252,a,232,a,44
CV 230,36
CV 231,38
M v,252,a,236,a,60
s_waitcnt lgkmcnt(0)
s_waitcnt vmcnt(13)
M v,48,a,240,a,0
s_barrier
RD a,224,1,0
M v,48,a,244,a,16
RD a,228,1,64
v_mul_f32 v246, 0x3db8aa3b, v246
M v,48,a,248,a,32
RD a,232,1,128
v_mul_f32 v247, 0x3db8aa3b, v247
M v,48,a,252,a,48
RD a,236,1,192
CV 244,244
M v,52,a,240,a,4
CV 245,246
v_mul_f32 v216, 0x3db8aa3b, v216
M v,52,a,244,a,20
v_mul_f32 v217, 0x3db8aa3b, v217
v_mul_f32 v218, 0x3db8aa3b, v218
M v,52,a,248,a,36
v_mul_f32 v48, 0x3db8aa3b, v48
v_mul_f32 v49, 0x3db8aa3b, v49
M v,52,a,252,a,52
DN 4,12,2,1056
M v,56,a,240,a,8
v_mul_f32 v50, 0x3db8aa3b, v50
v_mul_f32 v51, 0x3db8aa3b, v51
M v,56,a,244,a,24
CV 242,48
CV 243,50
M v,56,a,248,a,40
v_mul_f32 v52, 0x3db8aa3b, v52
v_mul_f32 v53, 0x3db8aa3b, v53
M v,56,a,252,a,56
v_mul_f32 v54, 0x3db8aa3b, v54
v_mul_f32 v55, 0x3db8aa3b, v55
M v,60,a,240,a,12
RD a,240,1,512
CV 246,52
M v,60,a,244,a,28
RD a,244,1,576
CV 247,54
M v,60,a,248,a,44
RD a,248,1,640
v_mul_f32 v219, 0x3db8aa3b, v219
M v,60,a,252,a,60
s_waitcnt lgkmcnt(3)
RD a,252,1,704
Z v,64,a,224,v,128
CV 216,216
AR 20,184
M v,64,a,228,v,144
AR 21,185
AR 22,186
M v,64,a,232,v,160
AR 23,187
CV 217,218
M v,64,a,236,v,176
v_mul_f32 v20, 0x3db8aa3b, v20
v_mul_f32 v21, 0x3db8aa3b, v21
Z v,68,a,224,v,132
v_mul_f32 v22, 0x3db8aa3b, v22
v_mul_f32 v23, 0x3db8aa3b, v23
M v,68,a,228,v,148
v_mul_f32 v232, 0x3db8aa3b, v232
v_mul_f32 v233, 0x3db8aa3b, v233
M v,68,a,232,v,164
CV 218,20
CV 219,22
M v,68,a,236,v,180
v_mul_f32 v234, 0x3db8aa3b, v234
v_mul_f32 v235, 0x3db8aa3b, v235
Z v,72,a,224,v,136
DN 4,16,2,2112
M v,72,a,228,v,152
CV 232,232
CV 233,234
M v,72,a,232,v,168
v_mul_f32 v40, 0x3db8aa3b, v40
v_mul_f32 v41, 0x3db8aa3b, v41
M v,72,a,236,v,184
v_mul_f32 v42, 0x3db8aa3b, v42
v_mul_f32 v43, 0x3db8aa3b, v43
Z v,76,a,224,v,140
RD a,224,1,256
v_mul_f32 v248, 0x3db8aa3b, v248
M v,76,a,228,v,156
RD a,228,1,320
v_mul_f32 v249, 0x3db8aa3b, v249
M v,76,a,232,v,172
RD a,232,1,384
CV 234,40
M v,76,a,236,v,188
s_waitcnt lgkmcnt(3)
RD a,236,1,448
Z v,80,a,240,v,128
CV 235,42
v_mul_f32 v250, 0x3db8aa3b, v250
M v,80,a,244,v,144
v_mul_f32 v251, 0x3db8aa3b, v251
CV 248,248
M v,80,a,248,v,160
CV 249,250
v_mul_f32 v56, 0x3db8aa3b, v56
M v,80,a,252,v,176
v_mul_f32 v57, 0x3db8aa3b, v57
v_mul_f32 v58, 0x3db8aa3b, v58
Z v,84,a,240,v,132
v_mul_f32 v59, 0x3db8aa3b, v59
CV 250,56
M v,84,a,244,v,148
CV 251,58
v_mul_f32 v220, 0x3db8aa3b, v220
M v,84,a,248,v,164
v_mul_f32 v221, 0x3db8aa3b, v221
v_mul_f32 v222, 0x3db8aa3b, v222
M v,84,a,252,v,180
v_mul_f32 v223, 0x3db8aa3b, v223
CV 220,220
Z v,88,a,240,v,136
AR 24,188
AR 25,189
M v,88,a,244,v,152
DN 4,20,2,3168
M v,88,a,248,v,168
AR 26,190
AR 27,191
M v,88,a,252,v,184
CV 221,222
v_mul_f32 v24, 0x3db8aa3b, v24
Z v,92,a,240,v,140
RD a,240,1,768
v_mul_f32 v25, 0x3db8aa3b, v25
M v,92,a,244,v,156
RD a,244,1,832
v_mul_f32 v26, 0x3db8aa3b, v26
M v,92,a,248,v,172
RD a,248,1,896
v_mul_f32 v27, 0x3db8aa3b, v27
M v,92,a,252,v,188
s_waitcnt lgkmcnt(3)
RD a,252,1,960
M v,64,a,224,v,192
v_mul_f32 v236, 0x3db8aa3b, v236
v_mul_f32 v237, 0x3db8aa3b, v237
M v,64,a,228,v,208
CV 222,24
CV 223,26
M v,64,a,232,v,224
v_mul_f32 v238, 0x3db8aa3b, v238
v_mul_f32 v239, 0x3db8aa3b, v239
M v,64,a,236,v,240
CV 236,236
CV 237,238
M v,68,a,224,v,196
v_mul_f32 v44, 0x3db8aa3b, v44
v_mul_f32 v45, 0x3db8aa3b, v45
M v,68,a,228,v,212
v_mul_f32 v46, 0x3db8aa3b, v46
v_mul_f32 v47, 0x3db8aa3b, v47
M v,68,a,232,v,228
v_mul_f32 v252, 0x3db8aa3b, v252
v_mul_f32 v253, 0x3db8aa3b, v253
M v,68,a,236,v,244
CV 238,44
CV 239,46
M v,72,a,224,v,200
v_mul_f32 v254, 0x3db8aa3b, v254
v_mul_f32 v255, 0x3db8aa3b, v255
M v,72,a,228,v,216
CV 252,252
CV 253,254
M v,72,a,232,v,232
v_mul_f32 v60, 0x3db8aa3b, v60
v_mul_f32 v61, 0x3db8aa3b, v61
M v,72,a,236,v,248
v_mul_f32 v62, 0x3db8aa3b, v62
v_mul_f32 v63, 0x3db8aa3b, v63
M v,76,a,224,v,204
CV 254,60
CV 255,62
M v,76,a,228,v,220
s_add_u32 m0, s92, 33792
s_mov_b32 s2, 32768
M v,76,a,232,v,236
DN 4,24,2,0
M v,76,a,236,v,252
s_waitcnt lgkmcnt(0)
s_waitcnt vmcnt(17)
M v,80,a,240,v,192
s_barrier
RD a,224,1,16896
M v,80,a,244,v,208
RD a,228,1,16960
v_max3_f32 v24, v64, v65, v66
M v,80,a,248,v,224
RD a,232,1,17024
v_max3_f32 v25, v68, v69, v70
M v,80,a,252,v,240
RD a,236,1,17088
v_max3_f32 v26, v72, v73, v74
M v,84,a,240,v,196
v_max3_f32 v27, v76, v77, v78
M v,84,a,244,v,212
M v,84,a,248,v,228
M v,84,a,252,v,244
M v,88,a,240,v,200
v_max3_f32 v24, v24, v67, v80
v_max3_f32 v24, v24, v81, v82
M v,88,a,244,v,216
v_max_f32 v24, v24, v83
M v,88,a,248,v,232
M v,88,a,252,v,248
DN 4,28,2,1056
M v,92,a,240,v,204
RD a,240,1,17152
v_max3_f32 v25, v25, v71, v84
M v,92,a,244,v,220
RD a,244,1,17216
v_max3_f32 v25, v25, v85, v86
M v,92,a,248,v,236
RD a,248,1,17280
v_max3_f32 v26, v26, v75, v88
M v,92,a,252,v,252
s_waitcnt lgkmcnt(3)
RD a,252,1,17344
Z v,96,a,224,v,128
v_max3_f32 v26, v26, v89, v90
v_max_f32 v25, v25, v87
M v,96,a,228,v,144
v_max_f32 v26, v26, v91
M v,96,a,232,v,160
v_max3_f32 v27, v27, v79, v92
v_max3_f32 v27, v27, v93, v94
M v,96,a,236,v,176
v_permlane32_swap_b32 v24, v26
Z v,100,a,224,v,132
v_max_f32 v27, v27, v95
v_max_f32 v24, v24, v26
M v,100,a,228,v,148
v_permlane32_swap_b32 v25, v27
M v,100,a,232,v,164
v_max_f32 v25, v25, v27
M v,100,a,236,v,180
Z v,104,a,224,v,136
v_permlane16_swap_b32 v24, v25
M v,104,a,228,v,152
v_max_f32 v24, v24, v25
v_sub_f32 v24, 0, v24
M v,104,a,232,v,168
v_mov_b32 v25, v24
M v,104,a,236,v,184
Z v,108,a,224,v,140
DN 4,32,2,2112
M v,108,a,228,v,156
v_permlane16_swap_b32 v24, v25
M v,108,a,232,v,172
RD a,224,1,17408
v_mov_b32 v26, v24
M v,108,a,236,v,188
s_waitcnt lgkmcnt(1)
RD a,228,1,17472
M v,96,a,240,v,192
RD a,232,1,17536
v_mov_b32 v27, v25
M v,96,a,244,v,208
v_permlane32_swap_b32 v24, v26
M v,96,a,248,v,224
RD a,236,1,17600
AD 64,64,24
M v,96,a,252,v,240
AD 65,65,24
AD 66,66,24
M v,100,a,240,v,196
v_xor_b32 v2, 81920, v2
AD 67,67,24
M v,100,a,244,v,212
v_permlane32_swap_b32 v25, v27
M v,100,a,248,v,228
EX 64
M v,100,a,252,v,244
EX 65
M v,104,a,240,v,200
AD 68,68,25
AD 69,69,25
M v,104,a,244,v,216
EX 66
M v,104,a,248,v,232
AD 80,80,24
AD 70,70,25
M v,104,a,252,v,248
AD 12,64,65
AD 81,81,24
M v,108,a,240,v,204
RD a,240,1,17664
AD 71,71,25
M v,108,a,244,v,220
DN 4,36,2,3168
M v,108,a,248,v,236
RD a,244,1,17728
s_add_u32 m0, s92, 50688
M v,108,a,252,v,252
s_waitcnt lgkmcnt(2)
RD a,248,1,17792
Z v,112,a,224,v,128
RD a,252,1,17856
s_mov_b32 s2, 65536
M v,112,a,228,v,144
EX 67
M v,112,a,232,v,160
EX 68
M v,112,a,236,v,176
EX 69
Z v,116,a,224,v,132
AD 72,72,26
AD 73,73,26
M v,116,a,228,v,148
AD 12,12,66
AD 82,82,24
M v,116,a,232,v,164
EX 80
M v,116,a,236,v,180
EX 70
Z v,120,a,224,v,136
AD 84,84,25
AD 74,74,26
M v,120,a,228,v,152
AD 12,12,67
AD 13,68,69
M v,120,a,232,v,168
AD 83,83,24
AD 85,85,25
M v,120,a,236,v,184
EX 81
Z v,124,a,224,v,140
EX 71
M v,124,a,228,v,156
AD 75,75,26
AD 76,76,27
M v,124,a,232,v,172
DN 4,8,2,0
M v,124,a,236,v,188
s_waitcnt lgkmcnt(0)
s_waitcnt vmcnt(17)
M v,112,a,240,v,192
s_barrier
TR a,224,33792
M v,112,a,244,v,208
TR a,226,34304
AD 77,77,27
M v,112,a,248,v,224
TR a,228,33824
AD 12,12,80
M v,112,a,252,v,240
TR a,230,34336
AD 13,13,70
M v,116,a,240,v,196
TR a,232,33856
AD 86,86,25
M v,116,a,244,v,212
TR a,234,34368
AD 88,88,26
M v,116,a,248,v,228
TR a,236,33888
AD 78,78,27
M v,116,a,252,v,244
TR a,238,34400
AD 12,12,81
M v,120,a,240,v,200
EX 72
M v,120,a,244,v,216
EX 73
M v,120,a,248,v,232
EX 82
M v,120,a,252,v,248
EX 84
M v,124,a,240,v,204
EX 74
M v,124,a,244,v,220
AD 13,13,71
AD 14,72,73
M v,124,a,248,v,236
EX 83
M v,124,a,252,v,252
AD 87,87,25
AD 89,89,26
EX 85
EX 75
AD 79,79,27
EX 76
EX 77
AD 12,12,82
AD 13,13,84
AD 14,14,74
EX 86
v_pk_add_f32 v[90:91], v[90:91], v[26:27] op_sel:[0,0] op_sel_hi:[1,0]
EX 88
EX 78
v_pk_add_f32 v[92:93], v[92:93], v[26:27] op_sel:[0,1] op_sel_hi:[1,1]
AD 12,12,83
AD 13,13,85
AD 14,14,75
AD 15,76,77
EX 87
EX 89
EX 79
AD 13,13,86
AD 14,14,88
AD 15,15,78
CV 83,82
EX 90
v_pk_add_f32 v[94:95], v[94:95], v[26:27] op_sel:[0,1] op_sel_hi:[1,1]
EX 92
AD 13,13,87
AD 14,14,89
AD 15,15,79
CV 82,80
EX 91
EX 93
AD 14,14,90
AD 15,15,92
CV 81,66
CV 80,64
CV 87,86
EX 94
AD 14,14,91
AD 15,15,93
CV 86,84
EX 95
s_waitcnt lgkmcnt(0)
Z a,0,a,224,v,80
AD 15,15,94
CV 85,70
CV 84,68
CV 91,90
AD 15,15,95
Z a,4,a,224,v,84
CV 90,88
CV 89,74
CV 88,72
CV 95,94
CV 94,92
Z a,8,a,224,v,88
CV 93,78
CV 92,76
DN 4,12,2,1056
TR a,240,33920
Z a,12,a,224,v,92
TR a,242,34432
AD 96,96,24
Z a,16,a,228,v,80
TR a,244,33952
AD 97,97,24
Z a,20,a,228,v,84
TR a,246,34464
AD 100,100,25
Z a,24,a,228,v,88
TR a,248,33984
AD 101,101,25
Z a,28,a,228,v,92
TR a,250,34496
AD 104,104,26
Z a,32,a,232,v,80
TR a,252,34016
AD 105,105,26
Z a,36,a,232,v,84
TR a,254,34528
AD 98,98,24
Z a,40,a,232,v,88
TR a,224,34048
AD 102,102,25
Z a,44,a,232,v,92
TR a,226,34560
AD 106,106,26
Z a,48,a,236,v,80
TR a,228,34080
v_bfe_u32 v8, v4, 8, 2
Z a,52,a,236,v,84
TR a,230,34592
v_lshrrev_b32 v9, 14, s95
Z a,56,a,236,v,88
TR a,232,34112
v_add_lshl_u32 v8, v8, v9, 7
Z a,60,a,236,v,92
s_waitcnt lgkmcnt(5)
TR a,234,34624
Z a,64,a,240,v,80
DN 4,16,2,2112
Z a,68,a,240,v,84
TR a,236,34144
v_add_u32 v8, 4096, v8
Z a,72,a,240,v,88
TR a,238,34656
v_mov_b32 v9, 0
Z a,76,a,240,v,92
s_getpc_b64 s[100:101]
s_and_b32 s100, s100, 0xfffff000
Z a,80,a,244,v,80
TR a,240,34176
v_lshl_add_u64 v[8:9], v[8:9], 0, s[100:101]
Z a,84,a,244,v,84
TR a,242,34688
AD 108,108,27
Z a,88,a,244,v,88
global_load_dword v10, v[8:9], off
Z a,92,a,244,v,92
TR a,244,34208
AD 109,109,27
Z a,96,a,248,v,80
TR a,246,34720
AD 99,99,24
Z a,100,a,248,v,84
EX 96
Z a,104,a,248,v,88
EX 97
Z a,108,a,248,v,92
TR a,248,34240
AD 103,103,25
Z a,112,a,252,v,80
TR a,250,34752
AD 107,107,26
Z a,116,a,252,v,84
EX 100
Z a,120,a,252,v,88
EX 101
Z a,124,a,252,v,92
s_waitcnt lgkmcnt(6)
TR a,252,34272
Z a,128,a,224,v,80
TR a,254,34784
AD 110,110,27
Z a,132,a,224,v,84
DN 4,20,2,3168
Z a,136,a,224,v,88
s_add_u32 m0, s92, 81920
s_mov_b32 s2, 49152
Z a,140,a,224,v,92
EX 104
Z a,144,a,228,v,80
EX 105
Z a,148,a,228,v,84
EX 98
Z a,152,a,228,v,88
EX 102
Z a,156,a,228,v,92
EX 106
Z a,160,a,232,v,80
AD 111,111,27
AD 112,112,24
Z a,164,a,232,v,84
EX 108
Z a,168,a,232,v,88
EX 109
Z a,172,a,232,v,92
AD 116,116,25
AD 120,120,26
Z a,176,a,236,v,80
AD 16,96,97
AD 17,100,101
Z a,180,a,236,v,84
AD 18,104,105
AD 113,113,24
Z a,184,a,236,v,88
EX 99
Z a,188,a,236,v,92
s_waitcnt lgkmcnt(0)
s_waitcnt vmcnt(17)
Z a,192,a,240,v,80
s_barrier
RD a,224,1,50688
Z a,196,a,240,v,84
RD a,228,1,50752
AD 117,117,25
Z a,200,a,240,v,88
DN 4,24,2,0
Z a,204,a,240,v,92
RD a,232,1,50816
AD 121,121,26
Z a,208,a,244,v,80
RD a,236,1,50880
AD 124,124,27
Z a,212,a,244,v,84
EX 103
Z a,216,a,244,v,88
EX 107
Z a,220,a,244,v,92
EX 110
Z v,32,a,248,v,80
AD 16,16,98
AD 17,17,102
Z v,36,a,248,v,84
AD 18,18,106
AD 19,108,109
L_pad4:
s_cbranch_execz L_ret4
Z v,40,a,248,v,88
EX 111
Z v,44,a,248,v,92
AD 114,114,24
AD 118,118,25
Z v,48,a,252,v,80
EX 112
Z v,52,a,252,v,84
EX 116
Z v,56,a,252,v,88
AD 122,122,26
AD 125,125,27
Z v,60,a,252,v,92
EX 120
AD 16,16,99
AD 17,17,103
AD 18,18,107
AD 19,19,110
AD 115,115,24
EX 113
AD 119,119,25
EX 117
AD 123,123,26
EX 121
v_pk_add_f32 v[126:127], v[126:127], v[26:27] op_sel:[0,1] op_sel_hi:[1,1]
EX 124
AD 19,19,111
AD 16,16,112
AD 17,17,116
AD 18,18,120
EX 114
EX 118
EX 122
EX 125
AD 16,16,113
AD 17,17,117
AD 18,18,121
AD 19,19,124
EX 115
EX 119
EX 123
EX 126
AD 16,16,114
AD 17,17,118
AD 18,18,122
AD 19,19,125
EX 127
AD 16,16,115
AD 17,17,119
AD 18,18,123
AD 19,19,126
AD 19,19,127
v_max3_f32 v20, v16, v17, v18
v_max_f32 v20, v20, v19
v_cmp_lt_f32 vcc, 0x4b800000, v20
v_mov_b32 v64, v24
v_mov_b32 v65, v24
v_mov_b32 v66, v24
v_mov_b32 v67, v24
v_mov_b32 v68, v25
v_mov_b32 v69, v25
v_mov_b32 v70, v25
v_mov_b32 v71, v25
v_mov_b32 v72, v26
v_mov_b32 v73, v26
v_mov_b32 v74, v26
v_mov_b32 v75, v26
v_mov_b32 v76, v27
v_mov_b32 v77, v27
v_mov_b32 v78, v27
v_mov_b32 v79, v27
s_waitcnt lgkmcnt(0)
CV 80,96
CV 81,98
s_cbranch_vccnz L_rsA0
L_rbA0:
MC 96,a,224,128,64
CV 84,100
CV 85,102
M v,96,a,228,v,144
CV 88,104
CV 89,106
M v,96,a,232,v,160
RD a,240,1,50944
CV 92,108
M v,96,a,236,v,176
DN 4,28,2,1056
MC 100,a,224,132,68
RD a,244,1,51008
CV 93,110
M v,100,a,228,v,148
RD a,248,1,51072
CV 82,112
M v,100,a,232,v,164
RD a,252,1,51136
CV 83,114
M v,100,a,236,v,180
CV 86,116
CV 87,118
MC 104,a,224,136,72
CV 90,120
CV 91,122
M v,104,a,228,v,152
CV 94,124
CV 95,126
M v,104,a,232,v,168
AD 12,12,16
AD 13,13,17
M v,104,a,236,v,184
AD 14,14,18
AD 15,15,19
MC 108,a,224,140,76
RD a,224,1,51200
M v,108,a,228,v,156
RD a,228,1,51264
M v,108,a,232,v,172
RD a,232,1,51328
M v,108,a,236,v,188
s_waitcnt lgkmcnt(3)
RD a,236,1,51392
M v,96,a,240,v,192
M v,96,a,244,v,208
M v,96,a,248,v,224
M v,96,a,252,v,240
M v,100,a,240,v,196
DN 4,32,2,2112
M v,100,a,244,v,212
v_xor_b32 v2, 81920, v2
M v,100,a,248,v,228
M v,100,a,252,v,244
M v,104,a,240,v,200
M v,104,a,244,v,216
EX 96
M v,104,a,248,v,232
EX 97
M v,104,a,252,v,248
EX 98
M v,108,a,240,v,204
RD a,240,1,51456
AD 16,96,97
M v,108,a,244,v,220
RD a,244,1,51520
AD 16,16,98
M v,108,a,248,v,236
EX 100
M v,108,a,252,v,252
s_waitcnt lgkmcnt(2)
RD a,248,1,51584
MC 112,a,224,128,64
EX 101
M v,112,a,228,v,144
RD a,252,1,51648
AD 17,100,101
M v,112,a,232,v,160
EX 104
M v,112,a,236,v,176
EX 105
MC 116,a,224,132,68
EX 102
M v,116,a,228,v,148
DN 4,36,2,3168
M v,116,a,232,v,164
s_add_u32 m0, s92, 98816
s_mov_b32 s2, 81920
M v,116,a,236,v,180
EX 106
MC 120,a,224,136,72
EX 108
M v,120,a,228,v,152
EX 109
M v,120,a,232,v,168
AD 18,104,105
AD 17,17,102
M v,120,a,236,v,184
EX 99
MC 124,a,224,140,76
EX 103
M v,124,a,228,v,156
EX 107
M v,124,a,232,v,172
EX 110
M v,124,a,236,v,188
s_waitcnt lgkmcnt(0)
s_waitcnt vmcnt(17)
M v,112,a,240,v,192
s_barrier
TR a,224,0
M v,112,a,244,v,208
TR a,226,512
AD 18,18,106
M v,112,a,248,v,224
TR a,228,32
AD 19,108,109
M v,112,a,252,v,240
TR a,230,544
AD 16,16,99
M v,116,a,240,v,196
TR a,232,64
AD 17,17,103
M v,116,a,244,v,212
TR a,234,576
AD 18,18,107
M v,116,a,248,v,228
TR a,236,96
AD 19,19,110
M v,116,a,252,v,244
TR a,238,608
M v,120,a,240,v,200
DN 4,8,2,0
M v,120,a,244,v,216
EX 111
M v,120,a,248,v,232
EX 112
M v,120,a,252,v,248
EX 116
M v,124,a,240,v,204
TR a,240,128
AD 19,19,111
M v,124,a,244,v,220
TR a,242,640
AD 16,16,112
M v,124,a,248,v,236
TR a,244,160
AD 17,17,116
M v,124,a,252,v,252
s_waitcnt lgkmcnt(3)
TR a,246,672
M a,0,a,224,v,80
EX 120
M a,4,a,224,v,84
TR a,248,192
AD 18,18,120
M a,8,a,224,v,88
EX 113
M a,12,a,224,v,92
TR a,250,704
AD 16,16,113
M a,16,a,228,v,80
EX 117
M a,20,a,228,v,84
TR a,252,224
AD 17,17,117
M a,24,a,228,v,88
EX 121
M a,28,a,228,v,92
TR a,254,736
AD 18,18,121
M a,32,a,232,v,80
DN 4,12,2,1056
M a,36,a,232,v,84
EX 124
M a,40,a,232,v,88
TR a,224,256
AD 19,19,124
M a,44,a,232,v,92
EX 114
M a,48,a,236,v,80
TR a,226,768
AD 16,16,114
M a,52,a,236,v,84
EX 118
M a,56,a,236,v,88
TR a,228,288
AD 17,17,118
M a,60,a,236,v,92
s_waitcnt lgkmcnt(3)
TR a,230,800
M a,64,a,240,v,80
EX 122
M a,68,a,240,v,84
TR a,232,320
AD 18,18,122
M a,72,a,240,v,88
EX 125
M a,76,a,240,v,92
TR a,234,832
AD 19,19,125
M a,80,a,244,v,80
TR a,236,352
v_xor_b32 v1, 81920, v1
M a,84,a,244,v,84
EX 115
M a,88,a,244,v,88
TR a,238,864
AD 16,16,115
M a,92,a,244,v,92
EX 119
M a,96,a,248,v,80
DN 4,16,2,2112
M a,100,a,248,v,84
TR a,240,384
AD 17,17,119
M a,104,a,248,v,88
EX 123
M a,108,a,248,v,92
TR a,242,896
AD 18,18,123
M a,112,a,252,v,80
TR a,244,416
v_max3_f32 v20, v16, v17, v18
M a,116,a,252,v,84
EX 126
M a,120,a,252,v,88
TR a,246,928
AD 19,19,126
M a,124,a,252,v,92
s_waitcnt lgkmcnt(4)
TR a,248,448
M a,128,a,224,v,80
EX 127
M a,132,a,224,v,84
TR a,250,960
AD 19,19,127
M a,136,a,224,v,88
TR a,252,480
v_max_f32 v20, v20, v19
M a,140,a,224,v,92
TR a,254,992
v_cmp_lt_f32 vcc, 0x4b800000, v20
M a,144,a,228,v,80
M a,148,a,228,v,84
M a,152,a,228,v,88
M a,156,a,228,v,92
M a,160,a,232,v,80
M a,164,a,232,v,84
DN 4,20,2,3168
M a,168,a,232,v,88
s_add_u32 m0, s92, 115712
s_mov_b32 s2, 65536
M a,172,a,232,v,92
M a,176,a,236,v,80
M a,180,a,236,v,84
M a,184,a,236,v,88
M a,188,a,236,v,92
s_waitcnt lgkmcnt(0)
s_waitcnt vmcnt(17)
M a,192,a,240,v,80
s_barrier
RD a,224,1,16896
M a,196,a,240,v,84
RD a,228,1,16960
M a,200,a,240,v,88
RD a,232,1,17024
M a,204,a,240,v,92
RD a,236,1,17088
M a,208,a,244,v,80
RD a,240,1,17152
M a,212,a,244,v,84
M a,216,a,244,v,88
M a,220,a,244,v,92
RD a,244,1,17216
M v,32,a,248,v,80
M v,36,a,248,v,84
M v,40,a,248,v,88
DN 4,24,2,0
M v,44,a,248,v,92
RD a,248,1,17280
M v,48,a,252,v,80
CV 80,96
CV 81,98
M v,52,a,252,v,84
CV 84,100
CV 85,102
M v,56,a,252,v,88
s_waitcnt lgkmcnt(3)
CV 88,104
M v,60,a,252,v,92
s_cbranch_vccnz L_rsA1
L_rbA1:
MC 96,a,224,128,64
RD a,252,1,17344
CV 89,106
M v,96,a,228,v,144
CV 92,108
CV 93,110
M v,96,a,232,v,160
CV 82,112
CV 83,114
M v,96,a,236,v,176
CV 86,116
CV 87,118
MC 100,a,224,132,68
CV 90,120
CV 91,122
M v,100,a,228,v,148
CV 94,124
CV 95,126
M v,100,a,232,v,164
AD 12,12,16
AD 13,13,17
M v,100,a,236,v,180
AD 14,14,18
AD 15,15,19
MC 104,a,224,136,72
M v,104,a,228,v,152
M v,104,a,232,v,168
M v,104,a,236,v,184
DN 4,28,2,1056
MC 108,a,224,140,76
RD a,224,1,17408
M v,108,a,228,v,156
RD a,228,1,17472
M v,108,a,232,v,172
RD a,232,1,17536
M v,108,a,236,v,188
s_waitcnt lgkmcnt(3)
RD a,236,1,17600
M v,96,a,240,v,192
M v,96,a,244,v,208
M v,96,a,248,v,224
M v,96,a,252,v,240
M v,100,a,240,v,196
M v,100,a,244,v,212
M v,100,a,248,v,228
M v,100,a,252,v,244
M v,104,a,240,v,200
M v,104,a,244,v,216
M v,104,a,248,v,232
M v,104,a,252,v,248
EX 96
M v,108,a,240,v,204
DN 4,32,2,2112
M v,108,a,244,v,220
EX 97
M v,108,a,248,v,236
RD a,240,1,17664
AD 16,96,97
M v,108,a,252,v,252
s_waitcnt lgkmcnt(1)
RD a,244,1,17728
MC 112,a,224,128,64
EX 100
M v,112,a,228,v,144
EX 101
M v,112,a,232,v,160
RD a,248,1,17792
AD 17,100,101
M v,112,a,236,v,176
EX 104
MC 116,a,224,132,68
EX 105
M v,116,a,228,v,148
RD a,252,1,17856
AD 18,104,105
M v,116,a,232,v,164
EX 98
M v,116,a,236,v,180
EX 102
MC 120,a,224,136,72
EX 106
M v,120,a,228,v,152
EX 108
M v,120,a,232,v,168
EX 109
M v,120,a,236,v,184
EX 99
MC 124,a,224,140,76
EX 103
M v,124,a,228,v,156
DN 4,36,2,3168
M v,124,a,232,v,172
s_add_u32 m0, s92, 132608
s_mov_b32 s2, 98304
M v,124,a,236,v,188
s_waitcnt lgkmcnt(0)
s_waitcnt vmcnt(17)
M v,112,a,240,v,192
s_barrier
TR a,224,33792
M v,112,a,244,v,208
TR a,226,34304
AD 16,16,98
M v,112,a,248,v,224
TR a,228,33824
AD 17,17,102
M v,112,a,252,v,240
TR a,230,34336
AD 18,18,106
M v,116,a,240,v,196
TR a,232,33856
AD 19,108,109
M v,116,a,244,v,212
TR a,234,34368
AD 16,16,99
M v,116,a,248,v,228
TR a,236,33888
AD 17,17,103
M v,116,a,252,v,244
TR a,238,34400
M v,120,a,240,v,200
EX 107
M v,120,a,244,v,216
EX 110
M v,120,a,248,v,232
EX 111
M v,120,a,252,v,248
EX 112
M v,124,a,240,v,204
TR a,240,33920
AD 18,18,107
M v,124,a,244,v,220
TR a,242,34432
AD 19,19,110
M v,124,a,248,v,236
DN 4,8,2,0
M v,124,a,252,v,252
s_waitcnt lgkmcnt(2)
TR a,244,33952
M a,0,a,224,v,80
TR a,246,34464
AD 19,19,111
M a,4,a,224,v,84
TR a,248,33984
AD 16,16,112
M a,8,a,224,v,88
EX 116
M a,12,a,224,v,92
TR a,250,34496
AD 17,17,116
M a,16,a,228,v,80
EX 120
M a,20,a,228,v,84
TR a,252,34016
AD 18,18,120
M a,24,a,228,v,88
EX 113
M a,28,a,228,v,92
TR a,254,34528
AD 16,16,113
M a,32,a,232,v,80
EX 117
M a,36,a,232,v,84
TR a,224,34048
AD 17,17,117
M a,40,a,232,v,88
EX 121
M a,44,a,232,v,92
TR a,226,34560
AD 18,18,121
M a,48,a,236,v,80
EX 124
M a,52,a,236,v,84
TR a,228,34080
AD 19,19,124
M a,56,a,236,v,88
EX 114
M a,60,a,236,v,92
s_waitcnt lgkmcnt(3)
TR a,230,34592
M a,64,a,240,v,80
DN 4,12,2,1056
M a,68,a,240,v,84
TR a,232,34112
AD 16,16,114
M a,72,a,240,v,88
EX 118
M a,76,a,240,v,92
TR a,234,34624
AD 17,17,118
M a,80,a,244,v,80
EX 122
M a,84,a,244,v,84
TR a,236,34144
AD 18,18,122
M a,88,a,244,v,88
EX 125
M a,92,a,244,v,92
TR a,238,34656
AD 19,19,125
M a,96,a,248,v,80
EX 115
M a,100,a,248,v,84
TR a,240,34176
AD 16,16,115
M a,104,a,248,v,88
EX 119
M a,108,a,248,v,92
TR a,242,34688
AD 17,17,119
M a,112,a,252,v,80
EX 123
M a,116,a,252,v,84
TR a,244,34208
AD 18,18,123
M a,120,a,252,v,88
TR a,246,34720
v_max3_f32 v20, v16, v17, v18
M a,124,a,252,v,92
s_waitcnt lgkmcnt(4)
TR a,248,34240
M a,128,a,224,v,80
DN 4,16,2,2112
M a,132,a,224,v,84
EX 126
M a,136,a,224,v,88
TR a,250,34752
AD 19,19,126
M a,140,a,224,v,92
EX 127
M a,144,a,228,v,80
TR a,252,34272
AD 19,19,127
M a,148,a,228,v,84
TR a,254,34784
v_max_f32 v20, v20, v19
M a,152,a,228,v,88
v_cmp_lt_f32 vcc, 0x4b800000, v20
M a,156,a,228,v,92
M a,160,a,232,v,80
M a,164,a,232,v,84
M a,168,a,232,v,88
M a,172,a,232,v,92
M a,176,a,236,v,80
M a,180,a,236,v,84
M a,184,a,236,v,88
M a,188,a,236,v,92
s_waitcnt lgkmcnt(0)
s_waitcnt vmcnt(15)
M a,192,a,240,v,80
s_barrier
RD a,224,1,50688
M a,196,a,240,v,84
DN 4,20,2,3168
L_pad5:
s_cbranch_execz L_ret5
M a,200,a,240,v,88
RD a,228,1,50752
s_add_u32 m0, s92, 0
M a,204,a,240,v,92
RD a,232,1,50816
s_mov_b32 s2, 81920
M a,208,a,244,v,80
RD a,236,1,50880
M a,212,a,244,v,84
RD a,240,1,50944
M a,216,a,244,v,88
M a,220,a,244,v,92
RD a,244,1,51008
M v,32,a,248,v,80
M v,36,a,248,v,84
M v,40,a,248,v,88
M v,44,a,248,v,92
RD a,248,1,51072
M v,48,a,252,v,80
CV 80,96
CV 81,98
M v,52,a,252,v,84
CV 84,100
CV 85,102
M v,56,a,252,v,88
s_waitcnt lgkmcnt(3)
CV 88,104
M v,60,a,252,v,92
s_cbranch_vccnz L_rsA2
L_rbA2:
MC 96,a,224,128,64
RD a,252,1,51136
CV 89,106
M v,96,a,228,v,144
CV 92,108
CV 93,110
M v,96,a,232,v,160
DN 4,24,2,0
M v,96,a,236,v,176
CV 82,112
CV 83,114
MC 100,a,224,132,68
CV 86,116
CV 87,118
M v,100,a,228,v,148
CV 90,120
CV 91,122
M v,100,a,232,v,164
CV 94,124
CV 95,126
M v,100,a,236,v,180
AD 12,12,16
AD 13,13,17
MC 104,a,224,136,72
AD 14,14,18
AD 15,15,19
M v,104,a,228,v,152
M v,104,a,232,v,168
M v,104,a,236,v,184
MC 108,a,224,140,76
RD a,224,1,51200
M v,108,a,228,v,156
RD a,228,1,51264
M v,108,a,232,v,172
RD a,232,1,51328
M v,108,a,236,v,188
s_waitcnt lgkmcnt(3)
RD a,236,1,51392
M v,96,a,240,v,192
M v,96,a,244,v,208
M v,96,a,248,v,224
M v,96,a,252,v,240
DN 4,28,2,1056
M v,100,a,240,v,196
v_xor_b32 v2, 81920, v2
M v,100,a,244,v,212
M v,100,a,248,v,228
M v,100,a,252,v,244
M v,104,a,240,v,200
M v,104,a,244,v,216
EX 96
M v,104,a,248,v,232
EX 97
M v,104,a,252,v,248
EX 98
M v,108,a,240,v,204
RD a,240,1,51456
AD 16,96,97
M v,108,a,244,v,220
RD a,244,1,51520
AD 16,16,98
M v,108,a,248,v,236
EX 100
M v,108,a,252,v,252
s_waitcnt lgkmcnt(2)
RD a,248,1,51584
MC 112,a,224,128,64
EX 101
M v,112,a,228,v,144
RD a,252,1,51648
AD 17,100,101
M v,112,a,232,v,160
EX 104
M v,112,a,236,v,176
EX 105
MC 116,a,224,132,68
DN 4,32,2,2112
M v,116,a,228,v,148
EX 102
M v,116,a,232,v,164
EX 106
M v,116,a,236,v,180
EX 108
MC 120,a,224,136,72
EX 109
M v,120,a,228,v,152
AD 18,104,105
AD 17,17,102
M v,120,a,232,v,168
EX 99
M v,120,a,236,v,184
EX 103
MC 124,a,224,140,76
EX 107
M v,124,a,228,v,156
EX 110
M v,124,a,232,v,172
AD 18,18,106
AD 19,108,109
M v,124,a,236,v,188
s_waitcnt lgkmcnt(0)
s_waitcnt vmcnt(15)
M v,112,a,240,v,192
s_barrier
TR a,224,0
M v,112,a,244,v,208
TR a,226,512
AD 16,16,99
M v,112,a,248,v,224
TR a,228,32
AD 17,17,103
M v,112,a,252,v,240
TR a,230,544
AD 18,18,107
M v,116,a,240,v,196
TR a,232,64
AD 19,19,110
M v,116,a,244,v,212
DN 4,36,2,3168
M v,116,a,248,v,228
TR a,234,576
s_add_u32 m0, s92, 16896
M v,116,a,252,v,244
TR a,236,96
s_mov_b32 s2, 114688
M v,120,a,240,v,200
TR a,238,608
M v,120,a,244,v,216
EX 111
M v,120,a,248,v,232
EX 112
M v,120,a,252,v,248
EX 116
M v,124,a,240,v,204
TR a,240,128
AD 19,19,111
M v,124,a,244,v,220
TR a,242,640
AD 16,16,112
M v,124,a,248,v,236
TR a,244,160
AD 17,17,116
M v,124,a,252,v,252
s_waitcnt lgkmcnt(3)
TR a,246,672
M a,0,a,224,v,80
EX 120
M a,4,a,224,v,84
TR a,248,192
AD 18,18,120
M a,8,a,224,v,88
EX 113
M a,12,a,224,v,92
TR a,250,704
AD 16,16,113
M a,16,a,228,v,80
EX 117
M a,20,a,228,v,84
TR a,252,224
AD 17,17,117
M a,24,a,228,v,88
DN 4,8,2,0
M a,28,a,228,v,92
TR a,254,736
M a,32,a,232,v,80
EX 121
M a,36,a,232,v,84
TR a,224,256
AD 18,18,121
M a,40,a,232,v,88
EX 124
M a,44,a,232,v,92
TR a,226,768
AD 19,19,124
M a,48,a,236,v,80
EX 114
M a,52,a,236,v,84
TR a,228,288
AD 16,16,114
M a,56,a,236,v,88
EX 118
M a,60,a,236,v,92
s_waitcnt lgkmcnt(3)
TR a,230,800
M a,64,a,240,v,80
TR a,232,320
AD 17,17,118
M a,68,a,240,v,84
EX 122
M a,72,a,240,v,88
TR a,234,832
AD 18,18,122
M a,76,a,240,v,92
EX 125
M a,80,a,244,v,80
TR a,236,352
v_xor_b32 v1, 81920, v1
M a,84,a,244,v,84
TR a,238,864
AD 19,19,125
M a,88,a,244,v,88
EX 115
M a,92,a,244,v,92
DN 4,12,2,1056
M a,96,a,248,v,80
TR a,240,384
AD 16,16,115
M a,100,a,248,v,84
EX 119
M a,104,a,248,v,88
TR a,242,896
AD 17,17,119
M a,108,a,248,v,92
EX 123
M a,112,a,252,v,80
TR a,244,416
AD 18,18,123
M a,116,a,252,v,84
TR a,246,928
v_max3_f32 v20, v16, v17, v18
M a,120,a,252,v,88
EX 126
M a,124,a,252,v,92
s_waitcnt lgkmcnt(4)
TR a,248,448
M a,128,a,224,v,80
TR a,250,960
AD 19,19,126
M a,132,a,224,v,84
EX 127
M a,136,a,224,v,88
TR a,252,480
AD 19,19,127
M a,140,a,224,v,92
TR a,254,992
v_max_f32 v20, v20, v19
M a,144,a,228,v,80
v_cmp_lt_f32 vcc, 0x4b800000, v20
M a,148,a,228,v,84
M a,152,a,228,v,88
M a,156,a,228,v,92
M a,160,a,232,v,80
DN 4,16,2,2112
M a,164,a,232,v,84
M a,168,a,232,v,88
M a,172,a,232,v,92
M a,176,a,236,v,80
M a,180,a,236,v,84
M a,184,a,236,v,88
M a,188,a,236,v,92
s_waitcnt lgkmcnt(0)
s_waitcnt vmcnt(15)
M a,192,a,240,v,80
s_barrier
RD a,224,1,16896
M a,196,a,240,v,84
RD a,228,1,16960
M a,200,a,240,v,88
RD a,232,1,17024
M a,204,a,240,v,92
RD a,236,1,17088
M a,208,a,244,v,80
RD a,240,1,17152
M a,212,a,244,v,84
M a,216,a,244,v,88
M a,220,a,244,v,92
RD a,244,1,17216
M v,32,a,248,v,80
M v,36,a,248,v,84
DN 4,20,2,3168
M v,40,a,248,v,88
s_add_u32 m0, s92, 33792
s_mov_b32 s2, 98304
M v,44,a,248,v,92
RD a,248,1,17280
M v,48,a,252,v,80
CV 80,96
CV 81,98
M v,52,a,252,v,84
CV 84,100
CV 85,102
M v,56,a,252,v,88
s_waitcnt lgkmcnt(3)
CV 88,104
M v,60,a,252,v,92
s_cbranch_vccnz L_rsA3
L_rbA3:
MC 96,a,224,128,64
RD a,252,1,17344
CV 89,106
M v,96,a,228,v,144
CV 92,108
CV 93,110
M v,96,a,232,v,160
CV 82,112
CV 83,114
M v,96,a,236,v,176
CV 86,116
CV 87,118
MC 100,a,224,132,68
CV 90,120
CV 91,122
M v,100,a,228,v,148
CV 94,124
CV 95,126
M v,100,a,232,v,164
AD 12,12,16
AD 13,13,17
M v,100,a,236,v,180
AD 14,14,18
AD 15,15,19
MC 104,a,224,136,72
M v,104,a,228,v,152
M v,104,a,232,v,168
DN 4,24,2,0
M v,104,a,236,v,184
MC 108,a,224,140,76
RD a,224,1,17408
M v,108,a,228,v,156
RD a,228,1,17472
M v,108,a,232,v,172
RD a,232,1,17536
M v,108,a,236,v,188
s_waitcnt lgkmcnt(3)
RD a,236,1,17600
M v,96,a,240,v,192
M v,96,a,244,v,208
M v,96,a,248,v,224
M v,96,a,252,v,240
M v,100,a,240,v,196
M v,100,a,244,v,212
M v,100,a,248,v,228
M v,100,a,252,v,244
M v,104,a,240,v,200
M v,104,a,244,v,216
M v,104,a,248,v,232
M v,104,a,252,v,248
DN 4,28,2,1056
M v,108,a,240,v,204
EX 96
M v,108,a,244,v,220
EX 97
M v,108,a,248,v,236
RD a,240,1,17664
AD 16,96,97
M v,108,a,252,v,252
s_waitcnt lgkmcnt(1)
RD a,244,1,17728
MC 112,a,224,128,64
EX 100
M v,112,a,228,v,144
EX 101
M v,112,a,232,v,160
RD a,248,1,17792
AD 17,100,101
M v,112,a,236,v,176
EX 104
MC 116,a,224,132,68
EX 105
M v,116,a,228,v,148
RD a,252,1,17856
AD 18,104,105
M v,116,a,232,v,164
EX 98
M v,116,a,236,v,180
EX 102
MC 120,a,224,136,72
EX 106
M v,120,a,228,v,152
EX 108
M v,120,a,232,v,168
EX 109
M v,120,a,236,v,184
EX 99
MC 124,a,224,140,76
DN 4,32,2,2112
M v,124,a,228,v,156
EX 103
M v,124,a,232,v,172
EX 107
M v,124,a,236,v,188
s_waitcnt lgkmcnt(0)
s_waitcnt vmcnt(15)
M v,112,a,240,v,192
s_barrier
TR a,224,33792
M v,112,a,244,v,208
TR a,226,34304
AD 16,16,98
M v,112,a,248,v,224
TR a,228,33824
AD 17,17,102
M v,112,a,252,v,240
TR a,230,34336
AD 18,18,106
M v,116,a,240,v,196
TR a,232,33856
AD 19,108,109
M v,116,a,244,v,212
TR a,234,34368
AD 16,16,99
M v,116,a,248,v,228
TR a,236,33888
AD 17,17,103
M v,116,a,252,v,244
TR a,238,34400
AD 18,18,107
M v,120,a,240,v,200
EX 110
M v,120,a,244,v,216
EX 111
M v,120,a,248,v,232
EX 112
M v,120,a,252,v,248
EX 116
M v,124,a,240,v,204
TR a,240,33920
AD 19,19,110
M v,124,a,244,v,220
DN 4,36,2,3168
M v,124,a,248,v,236
TR a,242,34432
s_add_u32 m0, s92, 50688
M v,124,a,252,v,252
s_waitcnt lgkmcnt(2)
TR a,244,33952
M a,0,a,224,v,80
TR a,246,34464
s_mov_b32 s2, 131072
M a,4,a,224,v,84
TR a,248,33984
AD 19,19,111
M a,8,a,224,v,88
TR a,250,34496
AD 16,16,112
M a,12,a,224,v,92
TR a,252,34016
AD 17,17,116
M a,16,a,228,v,80
EX 120
M a,20,a,228,v,84
TR a,254,34528
AD 18,18,120
M a,24,a,228,v,88
EX 113
M a,28,a,228,v,92
TR a,224,34048
AD 16,16,113
M a,32,a,232,v,80
EX 117
M a,36,a,232,v,84
TR a,226,34560
AD 17,17,117
M a,40,a,232,v,88
EX 121
M a,44,a,232,v,92
TR a,228,34080
AD 18,18,121
M a,48,a,236,v,80
TR a,230,34592
v_bfe_u32 v8, v4, 8, 2
M a,52,a,236,v,84
TR a,232,34112
v_lshrrev_b32 v9, 14, s95
M a,56,a,236,v,88
DN 4,8,2,0
M a,60,a,236,v,92
s_waitcnt lgkmcnt(5)
TR a,234,34624
M a,64,a,240,v,80
TR a,236,34144
v_add_lshl_u32 v8, v8, v9, 7
M a,68,a,240,v,84
TR a,238,34656
v_mov_b32 v9, 0
M a,72,a,240,v,88
s_getpc_b64 s[100:101]
s_add_u32 s100, s100, L_c1A-.
s_addc_u32 s101, s101, 0
M a,76,a,240,v,92
TR a,240,34176
v_lshl_add_u64 v[8:9], v[8:9], 0, s[100:101]
M a,80,a,244,v,80
global_load_dword v10, v[8:9], off
M a,84,a,244,v,84
EX 124
M a,88,a,244,v,88
TR a,242,34688
AD 19,19,124
M a,92,a,244,v,92
EX 114
M a,96,a,248,v,80
TR a,244,34208
AD 16,16,114
M a,100,a,248,v,84
EX 118
M a,104,a,248,v,88
TR a,246,34720
AD 17,17,118
M a,108,a,248,v,92
EX 122
M a,112,a,252,v,80
TR a,248,34240
AD 18,18,122
M a,116,a,252,v,84
EX 125
M a,120,a,252,v,88
TR a,250,34752
AD 19,19,125
M a,124,a,252,v,92
s_waitcnt lgkmcnt(6)
TR a,252,34272
M a,128,a,224,v,80
DN 4,12,2,1056
M a,132,a,224,v,84
EX 115
M a,136,a,224,v,88
TR a,254,34784
AD 16,16,115
M a,140,a,224,v,92
EX 119
M a,144,a,228,v,80
EX 123
M a,148,a,228,v,84
EX 126
M a,152,a,228,v,88
EX 127
M a,156,a,228,v,92
AD 17,17,119
AD 18,18,123
M a,160,a,232,v,80
AD 19,19,126
AD 19,19,127
M a,164,a,232,v,84
v_max3_f32 v20, v16, v17, v18
v_max_f32 v20, v20, v19
M a,168,a,232,v,88
v_cmp_lt_f32 vcc, 0x4b800000, v20
M a,172,a,232,v,92
M a,176,a,236,v,80
M a,180,a,236,v,84
M a,184,a,236,v,88
M a,188,a,236,v,92
s_waitcnt lgkmcnt(0)
s_waitcnt vmcnt(15)
M a,192,a,240,v,80
s_barrier
RD a,224,1,50688
M a,196,a,240,v,84
DN 4,16,2,2112
M a,200,a,240,v,88
RD a,228,1,50752
M a,204,a,240,v,92
RD a,232,1,50816
M a,208,a,244,v,80
RD a,236,1,50880
M a,212,a,244,v,84
RD a,240,1,50944
M a,216,a,244,v,88
M a,220,a,244,v,92
RD a,244,1,51008
M v,32,a,248,v,80
L_pad6:
s_cbranch_execz L_ret6
M v,36,a,248,v,84
M v,40,a,248,v,88
M v,44,a,248,v,92
RD a,248,1,51072
M v,48,a,252,v,80
CV 80,96
CV 81,98
M v,52,a,252,v,84
CV 84,100
CV 85,102
M v,56,a,252,v,88
s_waitcnt lgkmcnt(3)
CV 88,104
M v,60,a,252,v,92
s_cbranch_vccnz L_rsA4
L_rbA4:
MC 96,a,224,128,64
RD a,252,1,51136
CV 89,106
M v,96,a,228,v,144
DN 4,20,2,3168
M v,96,a,232,v,160
CV 92,108
CV 93,110
M v,96,a,236,v,176
s_add_u32 m0, s92, 81920
s_mov_b32 s2, 114688
MC 100,a,224,132,68
CV 82,112
CV 83,114
M v,100,a,228,v,148
CV 86,116
CV 87,118
M v,100,a,232,v,164
CV 90,120
CV 91,122
M v,100,a,236,v,180
CV 94,124
CV 95,126
MC 104,a,224,136,72
AD 12,12,16
AD 13,13,17
M v,104,a,228,v,152
AD 14,14,18
AD 15,15,19
M v,104,a,232,v,168
M v,104,a,236,v,184
MC 108,a,224,140,76
RD a,224,1,51200
M v,108,a,228,v,156
RD a,228,1,51264
M v,108,a,232,v,172
RD a,232,1,51328
M v,108,a,236,v,188
s_waitcnt lgkmcnt(3)
RD a,236,1,51392
M v,96,a,240,v,192
M v,96,a,244,v,208
M v,96,a,248,v,224
DN 4,24,2,0
M v,96,a,252,v,240
M v,100,a,240,v,196
v_xor_b32 v2, 81920, v2
M v,100,a,244,v,212
M v,100,a,248,v,228
M v,100,a,252,v,244
M v,104,a,240,v,200
M v,104,a,244,v,216
M v,104,a,248,v,232
EX 96
M v,104,a,252,v,248
EX 97
M v,108,a,240,v,204
RD a,240,1,51456
AD 16,96,97
M v,108,a,244,v,220
EX 100
M v,108,a,248,v,236
EX 101
M v,108,a,252,v,252
s_waitcnt lgkmcnt(1)
RD a,244,1,51520
MC 112,a,224,128,64
RD a,248,1,51584
AD 17,100,101
M v,112,a,228,v,144
EX 104
M v,112,a,232,v,160
EX 105
M v,112,a,236,v,176
RD a,252,1,51648
AD 18,104,105
MC 116,a,224,132,68
DN 4,28,2,1056
M v,116,a,228,v,148
EX 98
M v,116,a,232,v,164
EX 102
M v,116,a,236,v,180
EX 106
MC 120,a,224,136,72
EX 108
M v,120,a,228,v,152
EX 109
M v,120,a,232,v,168
EX 99
M v,120,a,236,v,184
EX 103
MC 124,a,224,140,76
EX 107
M v,124,a,228,v,156
EX 110
M v,124,a,232,v,172
AD 16,16,98
AD 17,17,102
M v,124,a,236,v,188
s_waitcnt lgkmcnt(0)
s_waitcnt vmcnt(15)
M v,112,a,240,v,192
s_barrier
TR a,224,0
M v,112,a,244,v,208
TR a,226,512
AD 18,18,106
M v,112,a,248,v,224
TR a,228,32
AD 19,108,109
M v,112,a,252,v,240
TR a,230,544
AD 16,16,99
M v,116,a,240,v,196
TR a,232,64
AD 17,17,103
M v,116,a,244,v,212
TR a,234,576
AD 18,18,107
M v,116,a,248,v,228
TR a,236,96
AD 19,19,110
M v,116,a,252,v,244
TR a,238,608
M v,120,a,240,v,200
DN 4,32,2,2112
M v,120,a,244,v,216
EX 111
M v,120,a,248,v,232
EX 112
M v,120,a,252,v,248
EX 116
M v,124,a,240,v,204
TR a,240,128
AD 19,19,111
M v,124,a,244,v,220
TR a,242,640
AD 16,16,112
M v,124,a,248,v,236
TR a,244,160
AD 17,17,116
M v,124,a,252,v,252
s_waitcnt lgkmcnt(3)
TR a,246,672
M a,0,a,224,v,80
EX 120
M a,4,a,224,v,84
TR a,248,192
AD 18,18,120
M a,8,a,224,v,88
EX 113
M a,12,a,224,v,92
TR a,250,704
AD 16,16,113
M a,16,a,228,v,80
EX 117
M a,20,a,228,v,84
TR a,252,224
AD 17,17,117
M a,24,a,228,v,88
EX 121
M a,28,a,228,v,92
TR a,254,736
AD 18,18,121
M a,32,a,232,v,80
DN 4,36,2,3168
M a,36,a,232,v,84
TR a,224,256
s_add_u32 m0, s92, 98816
M a,40,a,232,v,88
TR a,226,768
s_mov_b32 s2, 147456
M a,44,a,232,v,92
EX 124
M a,48,a,236,v,80
TR a,228,288
AD 19,19,124
M a,52,a,236,v,84
EX 114
M a,56,a,236,v,88
TR a,230,800
AD 16,16,114
M a,60,a,236,v,92
s_waitcnt lgkmcnt(4)
TR a,232,320
M a,64,a,240,v,80
EX 118
M a,68,a,240,v,84
TR a,234,832
AD 17,17,118
M a,72,a,240,v,88
EX 122
M a,76,a,240,v,92
TR a,236,352
AD 18,18,122
M a,80,a,244,v,80
TR a,238,864
v_xor_b32 v1, 81920, v1
M a,84,a,244,v,84
EX 125
M a,88,a,244,v,88
TR a,240,384
AD 19,19,125
M a,92,a,244,v,92
EX 115
M a,96,a,248,v,80
TR a,242,896
AD 16,16,115
M a,100,a,248,v,84
EX 119
M a,104,a,248,v,88
DN 4,8,2,0
M a,108,a,248,v,92
TR a,244,416
AD 17,17,119
M a,112,a,252,v,80
EX 123
M a,116,a,252,v,84
TR a,246,928
AD 18,18,123
M a,120,a,252,v,88
TR a,248,448
v_max3_f32 v20, v16, v17, v18
M a,124,a,252,v,92
s_waitcnt lgkmcnt(5)
TR a,250,960
M a,128,a,224,v,80
EX 126
M a,132,a,224,v,84
TR a,252,480
AD 19,19,126
M a,136,a,224,v,88
EX 127
M a,140,a,224,v,92
TR a,254,992
AD 19,19,127
M a,144,a,228,v,80
v_max_f32 v20, v20, v19
v_cmp_lt_f32 vcc, 0x4b800000, v20
M a,148,a,228,v,84
M a,152,a,228,v,88
M a,156,a,228,v,92
M a,160,a,232,v,80
M a,164,a,232,v,84
M a,168,a,232,v,88
M a,172,a,232,v,92
M a,176,a,236,v,80
DN 4,12,2,1056
M a,180,a,236,v,84
M a,184,a,236,v,88
M a,188,a,236,v,92
s_waitcnt lgkmcnt(0)
s_waitcnt vmcnt(15)
M a,192,a,240,v,80
s_barrier
RD a,224,1,16896
M a,196,a,240,v,84
RD a,228,1,16960
M a,200,a,240,v,88
RD a,232,1,17024
M a,204,a,240,v,92
RD a,236,1,17088
M a,208,a,244,v,80
RD a,240,1,17152
M a,212,a,244,v,84
M a,216,a,244,v,88
M a,220,a,244,v,92
RD a,244,1,17216
M v,32,a,248,v,80
M v,36,a,248,v,84
M v,40,a,248,v,88
M v,44,a,248,v,92
RD a,248,1,17280
M v,48,a,252,v,80
CV 80,96
CV 81,98
M v,52,a,252,v,84
CV 84,100
CV 85,102
M v,56,a,252,v,88
s_waitcnt lgkmcnt(3)
CV 88,104
M v,60,a,252,v,92
s_cbranch_vccnz L_rsA5
L_rbA5:
MC 96,a,224,128,64
DN 4,16,2,2112
M v,96,a,228,v,144
RD a,252,1,17344
CV 89,106
M v,96,a,232,v,160
CV 92,108
CV 93,110
M v,96,a,236,v,176
CV 82,112
CV 83,114
MC 100,a,224,132,68
CV 86,116
CV 87,118
M v,100,a,228,v,148
CV 90,120
CV 91,122
M v,100,a,232,v,164
CV 94,124
CV 95,126
M v,100,a,236,v,180
AD 12,12,16
AD 13,13,17
MC 104,a,224,136,72
AD 14,14,18
AD 15,15,19
M v,104,a,228,v,152
M v,104,a,232,v,168
M v,104,a,236,v,184
MC 108,a,224,140,76
RD a,224,1,17408
M v,108,a,228,v,156
RD a,228,1,17472
M v,108,a,232,v,172
RD a,232,1,17536
M v,108,a,236,v,188
s_waitcnt lgkmcnt(3)
RD a,236,1,17600
M v,96,a,240,v,192
DN 4,20,2,3168
M v,96,a,244,v,208
s_add_u32 m0, s92, 115712
s_mov_b32 s2, 131072
M v,96,a,248,v,224
M v,96,a,252,v,240
M v,100,a,240,v,196
M v,100,a,244,v,212
M v,100,a,248,v,228
M v,100,a,252,v,244
M v,104,a,240,v,200
M v,104,a,244,v,216
M v,104,a,248,v,232
M v,104,a,252,v,248
EX 96
M v,108,a,240,v,204
EX 97
M v,108,a,244,v,220
RD a,240,1,17664
AD 16,96,97
M v,108,a,248,v,236
EX 100
M v,108,a,252,v,252
s_waitcnt lgkmcnt(1)
RD a,244,1,17728
MC 112,a,224,128,64
EX 101
M v,112,a,228,v,144
RD a,248,1,17792
AD 17,100,101
M v,112,a,232,v,160
DN 4,24,2,0
M v,112,a,236,v,176
EX 104
MC 116,a,224,132,68
EX 105
M v,116,a,228,v,148
RD a,252,1,17856
AD 18,104,105
M v,116,a,232,v,164
EX 98
M v,116,a,236,v,180
EX 102
MC 120,a,224,136,72
EX 106
M v,120,a,228,v,152
EX 108
M v,120,a,232,v,168
EX 109
M v,120,a,236,v,184
EX 99
MC 124,a,224,140,76
EX 103
M v,124,a,228,v,156
EX 107
M v,124,a,232,v,172
EX 110
M v,124,a,236,v,188
s_waitcnt lgkmcnt(0)
s_waitcnt vmcnt(14)
M v,112,a,240,v,192
s_barrier
TR a,224,33792
M v,112,a,244,v,208
TR a,226,34304
AD 16,16,98
M v,112,a,248,v,224
TR a,228,33824
AD 17,17,102
M v,112,a,252,v,240
TR a,230,34336
AD 18,18,106
M v,116,a,240,v,196
TR a,232,33856
AD 19,108,109
M v,116,a,244,v,212
TR a,234,34368
AD 16,16,99
M v,116,a,248,v,228
TR a,236,33888
AD 17,17,103
M v,116,a,252,v,244
TR a,238,34400
AD 18,18,107
M v,120,a,240,v,200
DN 4,28,2,1056
M v,120,a,244,v,216
EX 111
M v,120,a,248,v,232
EX 112
M v,120,a,252,v,248
EX 116
M v,124,a,240,v,204
TR a,240,33920
AD 19,19,110
M v,124,a,244,v,220
TR a,242,34432
AD 19,19,111
M v,124,a,248,v,236
TR a,244,33952
AD 16,16,112
M v,124,a,252,v,252
s_waitcnt lgkmcnt(3)
TR a,246,34464
M a,0,a,224,v,80
TR a,248,33984
AD 17,17,116
M a,4,a,224,v,84
EX 120
M a,8,a,224,v,88
TR a,250,34496
AD 18,18,120
M a,12,a,224,v,92
EX 113
M a,16,a,228,v,80
TR a,252,34016
AD 16,16,113
M a,20,a,228,v,84
EX 117
M a,24,a,228,v,88
TR a,254,34528
AD 17,17,117
M a,28,a,228,v,92
DN 4,32,2,2112
M a,32,a,232,v,80
EX 121
M a,36,a,232,v,84
TR a,224,34048
AD 18,18,121
M a,40,a,232,v,88
EX 124
M a,44,a,232,v,92
TR a,226,34560
AD 19,19,124
M a,48,a,236,v,80
EX 114
M a,52,a,236,v,84
TR a,228,34080
AD 16,16,114
M a,56,a,236,v,88
EX 118
M a,60,a,236,v,92
s_waitcnt lgkmcnt(3)
TR a,230,34592
M a,64,a,240,v,80
TR a,232,34112
AD 17,17,118
M a,68,a,240,v,84
EX 122
M a,72,a,240,v,88
TR a,234,34624
AD 18,18,122
M a,76,a,240,v,92
EX 125
M a,80,a,244,v,80
TR a,236,34144
AD 19,19,125
M a,84,a,244,v,84
EX 115
M a,88,a,244,v,88
TR a,238,34656
AD 16,16,115
M a,92,a,244,v,92
EX 119
M a,96,a,248,v,80
DN 4,36,2,3168
M a,100,a,248,v,84
TR a,240,34176
s_add_u32 m0, s92, 132608
M a,104,a,248,v,88
TR a,242,34688
s_mov_b32 s2, 163840
M a,108,a,248,v,92
TR a,244,34208
AD 17,17,119
M a,112,a,252,v,80
EX 123
M a,116,a,252,v,84
TR a,246,34720
AD 18,18,123
M a,120,a,252,v,88
TR a,248,34240
v_max3_f32 v20, v16, v17, v18
M a,124,a,252,v,92
s_waitcnt lgkmcnt(5)
TR a,250,34752
M a,128,a,224,v,80
EX 126
M a,132,a,224,v,84
TR a,252,34272
AD 19,19,126
M a,136,a,224,v,88
EX 127
M a,140,a,224,v,92
TR a,254,34784
AD 19,19,127
M a,144,a,228,v,80
v_max_f32 v20, v20, v19
v_cmp_lt_f32 vcc, 0x4b800000, v20
M a,148,a,228,v,84
M a,152,a,228,v,88
M a,156,a,228,v,92
M a,160,a,232,v,80
M a,164,a,232,v,84
M a,168,a,232,v,88
DN 4,8,2,0
M a,172,a,232,v,92
M a,176,a,236,v,80
M a,180,a,236,v,84
M a,184,a,236,v,88
M a,188,a,236,v,92
s_waitcnt lgkmcnt(0)
s_waitcnt vmcnt(13)
M a,192,a,240,v,80
s_barrier
RD a,224,1,50688
M a,196,a,240,v,84
RD a,228,1,50752
M a,200,a,240,v,88
RD a,232,1,50816
M a,204,a,240,v,92
RD a,236,1,50880
M a,208,a,244,v,80
RD a,240,1,50944
M a,212,a,244,v,84
M a,216,a,244,v,88
M a,220,a,244,v,92
RD a,244,1,51008
M v,32,a,248,v,80
M v,36,a,248,v,84
M v,40,a,248,v,88
M v,44,a,248,v,92
RD a,248,1,51072
M v,48,a,252,v,80
CV 80,96
CV 81,98
M v,52,a,252,v,84
DN 4,12,2,1056
M v,56,a,252,v,88
s_waitcnt lgkmcnt(3)
CV 84,100
M v,60,a,252,v,92
s_cbranch_vccnz L_rsA6
L_rbA6:
MC 96,a,224,128,64
CV 85,102
CV 88,104
M v,96,a,228,v,144
RD a,252,1,51136
CV 89,106
M v,96,a,232,v,160
CV 92,108
CV 93,110
L_pad7:
s_cbranch_execz L_ret7
M v,96,a,236,v,176
CV 82,112
CV 83,114
MC 100,a,224,132,68
CV 86,116
CV 87,118
M v,100,a,228,v,148
CV 90,120
CV 91,122
M v,100,a,232,v,164
CV 94,124
CV 95,126
M v,100,a,236,v,180
AD 12,12,16
AD 13,13,17
MC 104,a,224,136,72
AD 14,14,18
AD 15,15,19
M v,104,a,228,v,152
s_branch L_c1A
L_rsA0:
s_mov_b32 s100, 16384
s_call_b64 s[98:99], L_rareA
s_branch L_rbA0
L_rsA1:
s_mov_b32 s100, 32768
s_call_b64 s[98:99], L_rareA
s_branch L_rbA1
L_rsA2:
s_mov_b32 s100, 49152
s_call_b64 s[98:99], L_rareA
s_branch L_rbA2
L_rsA3:
s_mov_b32 s100, 65536
s_call_b64 s[98:99], L_rareA
s_branch L_rbA3
L_rsA4:
s_mov_b32 s100, 81920
s_call_b64 s[98:99], L_rareA
s_branch L_rbA4
L_rsA5:
s_mov_b32 s100, 98304
s_call_b64 s[98:99], L_rareA
s_branch L_rbA5
L_rsA6:
s_mov_b32 s100, 114688
s_call_b64 s[98:99], L_rareA
s_branch L_rbA6
.p2align 12
L_B:
s_getpc_b64 s[12:13]
s_sub_u32 s12, s12, .-L_go
s_subb_u32 s13, s13, 0
s_add_u32 s12, s12, L_A-L_go
s_addc_u32 s13, s13, 0
s_lshr_b32 s97, s2, 3
s_lshl_b32 s97, s97, 9
s_cmp_eq_u32 s33, 3
s_cselect_b32 s96, L_B-L_A, 0
s_add_u32 s97, s97, s96
s_add_u32 s97, s97, 4096
v_lshl_add_u32 v24, v23, 7, s97
v_mov_b32 v25, 0
v_lshl_add_u64 v[16:17], v[24:25], 0, s[12:13]
s_lshl_b32 s97, s2, 2
s_add_u32 s97, s97, s33
s_lshl_b32 s97, s97, 2
v_add_u32 v24, s97, v23
v_min_u32 v24, PF_A*32, v24
v_lshlrev_b32 v24, 7, v24
v_lshl_add_u64 v[18:19], v[24:25], 0, s[12:13]
s_lshl_b32 s96, s32, 4
s_add_u32 s96, s96, s36
s_lshr_b32 s97, s96, 5
s_mul_i32 s97, s97, 3040
s_add_u32 s97, s97, s96
s_lshl_b32 s97, s97, 5
s_add_u32 s97, s97, s37
s_lshl_b32 s94, s33, 2
s_add_u32 s97, s97, s94
s_lshl_b32 s97, s97, 10
s_add_u32 s88, s88, s97
s_addc_u32 s89, s89, 0
s_lshl_b32 s96, s96, 3
s_add_u32 s0, s18, s96
s_addc_u32 s1, s19, 0
s_mul_i32 s97, s36, 15
s_lshr_b32 s96, s37, 1
s_add_u32 s97, s97, s96
s_add_u32 s97, s97, s94
s_mul_i32 s97, s97, 28672
s_mul_i32 s96, s32, 896
s_add_u32 s97, s97, s96
s_and_b32 s96, s37, 1
s_lshl_b32 s96, s96, 6
s_add_u32 s97, s97, s96
s_add_u32 s6, s16, s97
s_addc_u32 s7, s17, 0
s_lshl_b32 s95, s37, 2
s_add_u32 s95, s95, s33
s_lshl_b32 s96, s36, 8
s_add_u32 s95, s95, s96
s_lshr_b32 s96, s2, 3
s_lshl_b32 s96, s96, 16
s_add_u32 s95, s95, s96
s_mul_i32 s96, s37, 458752
s_lshl_b32 s97, s36, 3
s_add_u32 s97, s97, s37
s_lshl_b32 s97, s97, 19
s_add_u32 s72, s72, s96
s_addc_u32 s73, s73, 0
s_mov_b32 s74, 458752
s_mov_b32 s75, 0x20000
s_sub_u32 s76, s72, 160
s_subb_u32 s77, s73, 0
s_mov_b32 s78, 458912
s_mov_b32 s79, 0x20000
s_sub_u32 s80, s72, 320
s_subb_u32 s81, s73, 0
s_mov_b32 s82, 459072
s_mov_b32 s83, 0x20000
s_sub_u32 s84, s72, 480
s_subb_u32 s85, s73, 0
s_mov_b32 s86, 459232
s_mov_b32 s87, 0x20000
s_add_u32 s8, s8, s97
s_addc_u32 s9, s9, 0
s_mov_b32 s10, 524288
s_mov_b32 s11, 0x20000
s_sub_u32 s12, s8, 32
s_subb_u32 s13, s9, 0
s_mov_b32 s14, 524320
s_mov_b32 s15, 0x20000
s_sub_u32 s16, s8, 64
s_subb_u32 s17, s9, 0
s_mov_b32 s18, 524352
s_mov_b32 s19, 0x20000
s_sub_u32 s20, s8, 96
s_subb_u32 s21, s9, 0
s_mov_b32 s22, 524384
s_mov_b32 s23, 0x20000
s_add_u32 s24, s24, s97
s_addc_u32 s25, s25, 0
s_mov_b32 s26, 524288
s_mov_b32 s27, 0x20000
s_sub_u32 s28, s24, 32
s_subb_u32 s29, s25, 0
s_mov_b32 s30, 524320
s_mov_b32 s31, 0x20000
s_sub_u32 s32, s24, 64
s_subb_u32 s33, s25, 0
s_mov_b32 s34, 524352
s_mov_b32 s35, 0x20000
s_sub_u32 s36, s24, 96
s_subb_u32 s37, s25, 0
s_mov_b32 s38, 524384
s_mov_b32 s39, 0x20000
s_mov_b32 s90, 100663296
s_mov_b32 s91, 0x20000
s_mov_b32 s94, 94371840
v_mul_u32_u24 v28, 896, v27
v_add_u32 v28, v28, v4
v_mov_b32 v12, 0
v_mov_b32 v13, 0
v_mov_b32 v14, 0
v_mov_b32 v15, 0
s_add_u32 m0, s92, 33792
s_mov_b32 s93, 1048832
DL 6,40,93,0
DL 6,44,93,1032
DL 6,48,93,2112
DL 6,52,93,3144
s_add_u32 m0, s92, 98816
s_xor_b32 s93, s4, 384
DL 7,56,93,0
DL 7,60,93,1056
DL 7,64,93,2112
DL 7,68,93,3168
global_load_dword v10, v[16:17], off
global_load_dword v10, v[18:19], off
s_waitcnt vmcnt(10)
s_barrier
RD a,0,3,16896
RD a,16,3,16960
RD a,4,3,17408
RD a,20,3,17472
TW v,32,0
TW v,34,128
TW v,36,256
TW v,38,384
TW v,40,8
TW v,42,136
TW v,44,264
TW v,46,392
v_xor_b32 v3, 81920, v3
RD a,8,3,0
RD a,24,3,64
s_add_u32 m0, s92, 50688
s_xor_b32 s93, s4, 29056
TW v,48,64
TW v,50,192
TW v,52,320
TW v,54,448
TW v,56,72
TW v,58,200
TW v,60,328
TW v,62,456
s_waitcnt lgkmcnt(8)
Z v,128,v,32,a,0
DL 7,56,93,0
M v,128,v,36,a,16
Z v,132,v,32,a,4
M v,132,v,36,a,20
Z v,136,v,32,a,8
TW v,32,512
M v,136,v,36,a,24
DL 7,60,93,1056
Z v,64,v,40,a,0
TW v,34,640
M v,64,v,44,a,16
TW v,36,768
Z v,68,v,40,a,4
TW v,38,896
M v,68,v,44,a,20
Z v,72,v,40,a,8
DL 7,64,93,2112
M v,72,v,44,a,24
s_waitcnt lgkmcnt(4)
TW v,40,520
Z v,144,v,48,a,0
TW v,42,648
M v,144,v,52,a,16
TW v,44,776
Z v,148,v,48,a,4
TW v,46,904
M v,148,v,52,a,20
DL 7,68,93,3168
Z v,152,v,48,a,8
s_add_u32 m0, s92, 115712
s_mov_b32 s93, 1572864
M v,152,v,52,a,24
TW v,48,576
Z v,80,v,56,a,0
TW v,50,704
M v,80,v,60,a,16
TW v,52,832
Z v,84,v,56,a,4
DL 6,40,93,0
M v,84,v,60,a,20
TW v,54,960
Z v,88,v,56,a,8
TW v,56,584
M v,88,v,60,a,24
s_waitcnt lgkmcnt(5)
TW v,58,712
Z v,160,v,32,a,0
TW v,60,840
M v,160,v,36,a,16
DL 6,44,93,1032
Z v,164,v,32,a,4
TW v,62,968
M v,164,v,36,a,20
Z v,168,v,32,a,8
M v,168,v,36,a,24
Z v,96,v,40,a,0
DL 6,48,93,2112
M v,96,v,44,a,16
Z v,100,v,40,a,4
M v,100,v,44,a,20
Z v,104,v,40,a,8
M v,104,v,44,a,24
DL 6,52,93,3144
s_waitcnt lgkmcnt(0)
Z v,176,v,48,a,0
s_waitcnt vmcnt(12)
s_barrier
M v,176,v,52,a,16
s_add_u32 m0, s92, 132608
s_xor_b32 s93, s4, 0
Z v,180,v,48,a,4
TW v,32,33792
M v,180,v,52,a,20
TW v,34,33920
Z v,184,v,48,a,8
DL 7,56,93,0
M v,184,v,52,a,24
TW v,36,34048
Z v,112,v,56,a,0
TW v,38,34176
TW v,40,33800
M v,112,v,60,a,16
TW v,42,33928
TW v,44,34056
Z v,116,v,56,a,4
TW v,46,34184
M v,116,v,60,a,20
DL 7,60,93,1056
Z v,120,v,56,a,8
TW v,48,33856
M v,120,v,60,a,24
s_waitcnt lgkmcnt(1)
TW v,50,33984
Z v,192,v,32,a,0
TW v,52,34112
M v,192,v,36,a,16
TW v,54,34240
Z v,196,v,32,a,4
DL 7,64,93,2112
M v,196,v,36,a,20
TW v,56,33864
Z v,200,v,32,a,8
TW v,58,33992
M v,200,v,36,a,24
TW v,60,34120
Z a,144,v,40,a,0
TW v,62,34248
M a,144,v,44,a,16
DL 7,68,93,3168
Z a,148,v,40,a,4
s_add_u32 m0, s92, 0
s_mov_b32 s93, 1573120
M a,148,v,44,a,20
TW v,32,34304
Z a,152,v,40,a,8
TW v,34,34432
M a,152,v,44,a,24
s_waitcnt lgkmcnt(2)
TW v,36,34560
Z v,208,v,48,a,0
s_waitcnt vmcnt(8)
TW v,38,34688
M v,208,v,52,a,16
DL 6,40,93,0
Z v,212,v,48,a,4
TW v,40,34312
M v,212,v,52,a,20
TW v,42,34440
Z v,216,v,48,a,8
TW v,44,34568
M v,216,v,52,a,24
TW v,46,34696
Z a,176,v,56,a,0
DL 6,44,93,1032
M a,176,v,60,a,16
RD a,32,3,16896
Z a,180,v,56,a,4
RD a,48,3,16960
M a,180,v,60,a,20
DL 6,48,93,2112
Z a,184,v,56,a,8
RD a,36,3,17408
M a,184,v,60,a,24
s_waitcnt lgkmcnt(3)
RD a,52,3,17472
Z v,224,v,32,a,0
TW v,48,34368
v_xor_b32 v3, 81920, v3
M v,224,v,36,a,16
DL 6,52,93,3144
Z v,228,v,32,a,4
RD a,40,3,50688
s_add_u32 m0, s92, 16896
M v,228,v,36,a,20
RD a,56,3,50752
s_xor_b32 s93, s4, 28672
Z v,232,v,32,a,8
TW v,50,34496
v_xor_b32 v3, 81920, v3
M v,232,v,36,a,24
TW v,52,34624
Z a,208,v,40,a,0
TW v,54,34752
TW v,56,34376
M a,208,v,44,a,16
TW v,58,34504
TW v,60,34632
Z a,212,v,40,a,4
TW v,62,34760
v_xor_b32 v11, 81920, v11
M a,212,v,44,a,20
DL 7,56,93,0
Z a,216,v,40,a,8
M a,216,v,44,a,24
s_waitcnt lgkmcnt(0)
s_waitcnt vmcnt(5)
Z v,240,v,48,a,0
DL 7,60,93,1056
M v,240,v,52,a,16
s_mov_b64 exec, 0
s_branch L_pad0
L_ret0:
s_mov_b64 exec, -1
s_barrier
TW v,32,33792
Z v,244,v,48,a,4
TW v,34,33920
M v,244,v,52,a,20
DL 7,64,93,2112
Z v,248,v,48,a,8
TW v,36,34048
M v,248,v,52,a,24
TW v,38,34176
Z a,240,v,56,a,0
TW v,40,33800
TW v,42,33928
M a,240,v,60,a,16
TW v,44,34056
TW v,46,34184
Z a,244,v,56,a,4
DL 7,68,93,3168
M a,244,v,60,a,20
s_add_u32 m0, s92, 81920
s_xor_b32 s93, s4, 128
Z a,248,v,56,a,8
TW v,48,33856
M a,248,v,60,a,24
s_waitcnt lgkmcnt(1)
TW v,50,33984
M v,128,v,32,a,32
DL 7,56,93,0
M v,128,v,36,a,48
TW v,52,34112
M v,132,v,32,a,36
TW v,54,34240
M v,132,v,36,a,52
DL 7,60,93,1056
M v,136,v,32,a,40
TW v,56,33864
M v,136,v,36,a,56
TW v,58,33992
M v,64,v,40,a,32
TW v,60,34120
TW v,62,34248
M v,64,v,44,a,48
DL 7,64,93,2112
M v,68,v,40,a,36
RD a,64,3,50688
M v,68,v,44,a,52
RD a,80,3,50752
M v,72,v,40,a,40
DL 7,68,93,3168
M v,72,v,44,a,56
s_waitcnt lgkmcnt(2)
s_add_u32 m0, s92, 33792
M v,144,v,48,a,32
s_mov_b32 s93, 0
RD a,68,3,51200
M v,144,v,52,a,48
DL 5,40,93,0
M v,148,v,48,a,36
RD a,84,3,51264
M v,148,v,52,a,52
TW v,32,34304
v_xor_b32 v3, 81920, v3
M v,152,v,48,a,40
TW v,34,34432
M v,152,v,52,a,56
TW v,36,34560
M v,80,v,56,a,32
TW v,38,34688
TW v,40,34312
M v,80,v,60,a,48
TW v,42,34440
TW v,44,34568
M v,84,v,56,a,36
TW v,46,34696
M v,84,v,60,a,52
DL 5,44,93,1032
M v,88,v,56,a,40
TW v,48,34368
M v,88,v,60,a,56
s_waitcnt lgkmcnt(1)
TW v,50,34496
M v,160,v,32,a,32
DL 5,48,93,2112
M v,160,v,36,a,48
TW v,52,34624
M v,164,v,32,a,36
TW v,54,34752
M v,164,v,36,a,52
DL 5,52,93,3144
M v,168,v,32,a,40
TW v,56,34376
s_add_u32 m0, s92, 98816
M v,168,v,36,a,56
TW v,58,34504
s_xor_b32 s93, s4, 28800
M v,96,v,40,a,32
TW v,60,34632
TW v,62,34760
M v,96,v,44,a,48
DL 7,56,93,0
M v,100,v,40,a,36
v_xor_b32 v11, 81920, v11
M v,100,v,44,a,52
M v,104,v,40,a,40
DL 7,60,93,1056
M v,104,v,44,a,56
s_waitcnt lgkmcnt(0)
s_waitcnt vmcnt(6)
M v,176,v,48,a,32
s_barrier
TW v,32,0
M v,176,v,52,a,48
DL 7,64,93,2112
M v,180,v,48,a,36
TW v,34,128
M v,180,v,52,a,52
TW v,36,256
M v,184,v,48,a,40
TW v,38,384
M v,184,v,52,a,56
TW v,40,8
M v,112,v,56,a,32
TW v,42,136
TW v,44,264
M v,112,v,60,a,48
TW v,46,392
M v,116,v,56,a,36
DL 7,68,93,3168
M v,116,v,60,a,52
s_add_u32 m0, s92, 50688
s_mov_b32 s93, 128
M v,120,v,56,a,40
TW v,48,64
M v,120,v,60,a,56
s_waitcnt lgkmcnt(1)
TW v,50,192
M v,192,v,32,a,32
DL 5,40,93,0
M v,192,v,36,a,48
TW v,52,320
M v,196,v,32,a,36
TW v,54,448
M v,196,v,36,a,52
DL 5,44,93,1032
M v,200,v,32,a,40
TW v,56,72
M v,200,v,36,a,56
TW v,58,200
M a,144,v,40,a,32
TW v,60,328
TW v,62,456
M a,144,v,44,a,48
DL 5,48,93,2112
M a,148,v,40,a,36
RD a,72,3,16896
M a,148,v,44,a,52
RD a,88,3,16960
v_xor_b32 v3, 81920, v3
M a,152,v,40,a,40
DL 5,52,93,3144
M a,152,v,44,a,56
s_waitcnt lgkmcnt(2)
s_add_u32 m0, s92, 115712
M v,208,v,48,a,32
s_xor_b32 s93, s4, 512
RD a,96,3,0
M v,208,v,52,a,48
DL 7,56,93,0
M v,212,v,48,a,36
RD a,112,3,64
M v,212,v,52,a,52
RD a,100,3,512
M v,216,v,48,a,40
RD a,116,3,576
M v,216,v,52,a,56
TW v,32,512
M a,176,v,56,a,32
TW v,34,640
TW v,36,768
M a,176,v,60,a,48
TW v,38,896
TW v,40,520
M a,180,v,56,a,36
TW v,42,648
TW v,44,776
M a,180,v,60,a,52
TW v,46,904
M a,184,v,56,a,40
DL 7,60,93,1056
M a,184,v,60,a,56
s_waitcnt lgkmcnt(0)
TW v,48,576
M v,224,v,32,a,32
DL 7,64,93,2112
M v,224,v,36,a,48
TW v,50,704
M v,228,v,32,a,36
TW v,52,832
M v,228,v,36,a,52
TW v,54,960
M v,232,v,32,a,40
TW v,56,584
M v,232,v,36,a,56
TW v,58,712
M a,208,v,40,a,32
TW v,60,840
TW v,62,968
M a,208,v,44,a,48
DL 7,68,93,3168
M a,212,v,40,a,36
s_add_u32 m0, s92, 132608
s_mov_b32 s93, 256
M a,212,v,44,a,52
DL 5,40,93,0
M a,216,v,40,a,40
M a,216,v,44,a,56
s_waitcnt lgkmcnt(0)
s_waitcnt vmcnt(9)
M v,240,v,48,a,32
s_barrier
RD a,104,3,16896
M v,240,v,52,a,48
DL 5,44,93,1032
M v,244,v,48,a,36
RD a,120,3,16960
M v,244,v,52,a,52
TW v,32,33792
M v,248,v,48,a,40
TW v,34,33920
M v,248,v,52,a,56
TW v,36,34048
M a,240,v,56,a,32
TW v,38,34176
TW v,40,34304
M a,240,v,60,a,48
TW v,42,34432
TW v,44,34560
M a,244,v,56,a,36
TW v,46,34688
M a,244,v,60,a,52
DL 5,48,93,2112
M a,248,v,56,a,40
DL 5,52,93,3144
M a,248,v,60,a,56
s_waitcnt lgkmcnt(0)
s_add_u32 m0, s92, 0
M v,128,v,32,a,64
s_xor_b32 s93, s4, 29184
TW v,48,33800
M v,128,v,36,a,80
DL 7,56,93,0
M v,128,v,40,a,96
TW v,50,33928
M v,128,v,44,a,112
TW v,52,34056
M v,132,v,32,a,68
TW v,54,34184
M v,132,v,36,a,84
TW v,56,34312
M v,132,v,40,a,100
TW v,58,34440
TW v,60,34568
M v,132,v,44,a,116
TW v,62,34696
M v,136,v,32,a,72
DL 7,60,93,1056
M v,136,v,36,a,88
TW v,32,33856
M v,136,v,40,a,104
TW v,34,33984
M v,136,v,44,a,120
s_waitcnt lgkmcnt(2)
TW v,36,34112
M v,64,v,48,a,64
DL 7,64,93,2112
M v,64,v,52,a,80
TW v,38,34240
M v,64,v,56,a,96
TW v,40,34368
M v,64,v,60,a,112
TW v,42,34496
M v,68,v,48,a,68
TW v,44,34624
M v,68,v,52,a,84
TW v,46,34752
M v,68,v,56,a,100
DL 7,68,93,3168
M v,68,v,60,a,116
s_add_u32 m0, s92, 16896
s_mov_b32 s93, 384
M v,72,v,48,a,72
DL 5,40,93,0
M v,72,v,52,a,88
TW v,48,33864
M v,72,v,56,a,104
TW v,50,33992
M v,72,v,60,a,120
s_waitcnt lgkmcnt(2)
TW v,52,34120
M v,144,v,32,a,64
DL 5,44,93,1032
M v,144,v,36,a,80
TW v,54,34248
M v,144,v,40,a,96
TW v,56,34376
M v,144,v,44,a,112
TW v,58,34504
M v,148,v,32,a,68
TW v,60,34632
M v,148,v,36,a,84
TW v,62,34760
M v,148,v,40,a,100
DL 5,48,93,2112
M v,148,v,44,a,116
M v,152,v,32,a,72
M v,152,v,36,a,88
DL 5,52,93,3144
M v,152,v,40,a,104
s_add_u32 m0, s92, 81920
s_xor_b32 s93, s4, 640
M v,152,v,44,a,120
s_waitcnt lgkmcnt(0)
s_waitcnt vmcnt(12)
M v,80,v,48,a,64
s_barrier
TW v,32,50688
M v,80,v,52,a,80
DL 7,56,93,0
M v,80,v,56,a,96
TW v,34,50816
M v,80,v,60,a,112
TW v,36,50944
M v,84,v,48,a,68
TW v,38,51072
M v,84,v,52,a,84
TW v,40,51200
M v,84,v,56,a,100
TW v,42,51328
TW v,44,51456
M v,84,v,60,a,116
TW v,46,51584
M v,88,v,48,a,72
DL 7,60,93,1056
M v,88,v,52,a,88
TW v,48,50696
M v,88,v,56,a,104
TW v,50,50824
M v,88,v,60,a,120
s_waitcnt lgkmcnt(2)
TW v,52,50952
M v,160,v,32,a,64
DL 7,64,93,2112
M v,160,v,36,a,80
TW v,54,51080
M v,160,v,40,a,96
TW v,56,51208
M v,160,v,44,a,112
TW v,58,51336
M v,164,v,32,a,68
TW v,60,51464
M v,164,v,36,a,84
TW v,62,51592
M v,164,v,40,a,100
DL 7,68,93,3168
M v,164,v,44,a,116
s_add_u32 m0, s92, 33792
s_xor_b32 s93, s4, 29312
M v,168,v,32,a,72
DL 7,56,93,0
M v,168,v,36,a,88
RD a,128,3,33792
M v,168,v,40,a,104
RD a,160,3,33856
M v,168,v,44,a,120
s_waitcnt lgkmcnt(2)
RD a,132,3,34304
M v,96,v,48,a,64
DL 7,60,93,1056
M v,96,v,52,a,80
RD a,164,3,34368
M v,96,v,56,a,96
TW v,32,50752
M v,96,v,60,a,112
TW v,34,50880
v_xor_b32 v3, 81920, v3
M v,100,v,48,a,68
TW v,36,51008
M v,100,v,52,a,84
TW v,38,51136
M v,100,v,56,a,100
TW v,40,51264
TW v,42,51392
M v,100,v,60,a,116
TW v,44,51520
TW v,46,51648
M v,104,v,48,a,72
DL 7,64,93,2112
M v,104,v,52,a,88
TW v,48,50760
M v,104,v,56,a,104
DL 7,68,93,3168
M v,104,v,60,a,120
s_waitcnt lgkmcnt(1)
s_add_u32 m0, s92, 98816
M v,176,v,32,a,64
s_mov_b32 s93, 2097152
TW v,50,50888
M v,176,v,36,a,80
DL 6,40,93,0
M v,176,v,40,a,96
TW v,52,51016
M v,176,v,44,a,112
TW v,54,51144
M v,180,v,32,a,68
TW v,56,51272
M v,180,v,36,a,84
TW v,58,51400
M v,180,v,40,a,100
TW v,60,51528
TW v,62,51656
M v,180,v,44,a,116
DL 6,44,93,1032
M v,184,v,32,a,72
v_xor_b32 v11, 81920, v11
M v,184,v,36,a,88
M v,184,v,40,a,104
DL 6,48,93,2112
M v,184,v,44,a,120
s_waitcnt lgkmcnt(0)
s_waitcnt vmcnt(15)
M v,112,v,48,a,64
s_mov_b64 exec, 0
s_branch L_pad1
L_ret1:
s_mov_b64 exec, -1
s_barrier
TW v,32,50688
M v,112,v,52,a,80
DL 6,52,93,3144
M v,112,v,56,a,96
TW v,34,50816
s_add_u32 m0, s92, 50688
M v,112,v,60,a,112
TW v,36,50944
s_xor_b32 s93, s4, 768
M v,116,v,48,a,68
TW v,38,51072
M v,116,v,52,a,84
TW v,40,51200
M v,116,v,56,a,100
TW v,42,51328
TW v,44,51456
M v,116,v,60,a,116
TW v,46,51584
M v,120,v,48,a,72
DL 7,56,93,0
M v,120,v,52,a,88
TW v,48,50696
M v,120,v,56,a,104
TW v,50,50824
M v,120,v,60,a,120
s_waitcnt lgkmcnt(2)
TW v,52,50952
M v,192,v,32,a,64
DL 7,60,93,1056
M v,192,v,36,a,80
TW v,54,51080
M v,192,v,40,a,96
TW v,56,51208
M v,192,v,44,a,112
TW v,58,51336
M v,196,v,32,a,68
TW v,60,51464
M v,196,v,36,a,84
TW v,62,51592
M v,196,v,40,a,100
DL 7,64,93,2112
M v,196,v,44,a,116
RD a,136,3,0
M v,200,v,32,a,72
RD a,168,3,64
M v,200,v,36,a,88
DL 7,68,93,3168
M v,200,v,40,a,104
s_add_u32 m0, s92, 115712
s_xor_b32 s93, s4, 29440
M v,200,v,44,a,120
s_waitcnt lgkmcnt(2)
TW v,32,50752
M a,144,v,48,a,64
DL 7,56,93,0
M a,144,v,52,a,80
TW v,34,50880
M a,144,v,56,a,96
TW v,36,51008
M a,144,v,60,a,112
TW v,38,51136
v_xor_b32 v3, 81920, v3
M a,148,v,48,a,68
TW v,40,51264
M a,148,v,52,a,84
TW v,42,51392
M a,148,v,56,a,100
TW v,44,51520
TW v,46,51648
M a,148,v,60,a,116
DL 7,60,93,1056
M a,152,v,48,a,72
s_and_b32 s97, s95, 28
s_cbranch_scc1 L_clB
buffer_store_dwordx4 v[12:15], v28, s[88:91], s94 offen offset:0 sc1
buffer_store_dwordx4 v[12:15], v28, s[88:91], s94 offen offset:128 sc1
buffer_store_dwordx4 v[12:15], v28, s[88:91], s94 offen offset:256 sc1
buffer_store_dwordx4 v[12:15], v28, s[88:91], s94 offen offset:384 sc1
buffer_store_dwordx4 v[12:15], v28, s[88:91], s94 offen offset:512 sc1
buffer_store_dwordx4 v[12:15], v28, s[88:91], s94 offen offset:640 sc1
buffer_store_dwordx4 v[12:15], v28, s[88:91], s94 offen offset:768 sc1
L_clB:
M a,152,v,52,a,88
TW v,48,50760
M a,152,v,56,a,104
DL 7,64,93,2112
M a,152,v,60,a,120
s_waitcnt lgkmcnt(1)
TW v,50,50888
M v,208,v,32,a,64
TW v,52,51016
M v,208,v,36,a,80
DL 7,68,93,3168
M v,208,v,40,a,96
TW v,54,51144
M v,208,v,44,a,112
TW v,56,51272
M v,212,v,32,a,68
TW v,58,51400
M v,212,v,36,a,84
TW v,60,51528
M v,212,v,40,a,100
TW v,62,51656
v_xor_b32 v11, 81920, v11
M v,212,v,44,a,116
M v,216,v,32,a,72
M v,216,v,36,a,88
M v,216,v,40,a,104
M v,216,v,44,a,120
s_waitcnt lgkmcnt(0)
s_waitcnt vmcnt(12)
M a,176,v,48,a,64
s_barrier
TW v,32,16896
M a,176,v,52,a,80
TW v,34,17024
s_add_u32 m0, s92, 132608
M a,176,v,56,a,96
TW v,36,17152
s_mov_b32 s93, 2621440
M a,176,v,60,a,112
TW v,38,17280
M a,180,v,48,a,68
TW v,40,17408
M a,180,v,52,a,84
TW v,42,17536
M a,180,v,56,a,100
TW v,44,17664
TW v,46,17792
M a,180,v,60,a,116
RD a,0,3,0
M a,184,v,48,a,72
TW v,48,16904
M a,184,v,52,a,88
TW v,50,17032
M a,184,v,56,a,104
TW v,52,17160
M a,184,v,60,a,120
s_waitcnt lgkmcnt(4)
TW v,54,17288
M v,224,v,32,a,64
DL 5,40,93,0
M v,224,v,36,a,80
TW v,56,17416
M v,224,v,40,a,96
TW v,58,17544
M v,224,v,44,a,112
TW v,60,17672
M v,228,v,32,a,68
TW v,62,17800
M v,228,v,36,a,84
DL 5,44,93,1032
M v,228,v,40,a,100
RD a,16,3,64
M v,228,v,44,a,116
RD a,4,3,512
M v,232,v,32,a,72
RD a,20,3,576
v_xor_b32 v3, 81920, v3
M v,232,v,36,a,88
RD a,8,3,33792
v_bfe_u32 v8, v4, 8, 2
M v,232,v,40,a,104
RD a,24,3,33856
v_lshrrev_b32 v9, 14, s95
M v,232,v,44,a,120
s_waitcnt lgkmcnt(5)
TW v,32,16960
M a,208,v,48,a,64
DL 5,48,93,2112
M a,208,v,52,a,80
TW v,34,17088
v_add_lshl_u32 v8, v8, v9, 7
M a,208,v,56,a,96
TW v,36,17216
v_add_u32 v8, 4096, v8
M a,208,v,60,a,112
TW v,38,17344
v_mov_b32 v9, 0
M a,212,v,48,a,68
TW v,40,17472
M a,212,v,52,a,84
TW v,42,17600
M a,212,v,56,a,100
TW v,44,17728
TW v,46,17856
M a,212,v,60,a,116
DL 5,52,93,3144
M a,216,v,48,a,72
s_getpc_b64 s[100:101]
s_and_b32 s100, s100, 0xfffff000
M a,216,v,52,a,88
v_lshl_add_u64 v[8:9], v[8:9], 0, s[100:101]
s_add_u32 m0, s92, 0
M a,216,v,56,a,104
s_mov_b32 s93, 2621568
TW v,48,16968
M a,216,v,60,a,120
s_waitcnt lgkmcnt(1)
TW v,50,17096
M v,240,v,32,a,64
DL 5,40,93,0
M v,240,v,36,a,80
TW v,52,17224
s_mov_b32 s2, 0
M v,240,v,40,a,96
TW v,54,17352
M v,240,v,44,a,112
TW v,56,17480
M v,244,v,32,a,68
TW v,58,17608
M v,244,v,36,a,84
TW v,60,17736
M v,244,v,40,a,100
TW v,62,17864
v_xor_b32 v11, 81920, v11
M v,244,v,44,a,116
global_load_dword v10, v[8:9], off
M v,248,v,32,a,72
M v,248,v,36,a,88
DL 5,44,93,1032
M v,248,v,40,a,104
M v,248,v,44,a,120
s_waitcnt lgkmcnt(0)
s_waitcnt vmcnt(7)
M a,240,v,48,a,64
s_barrier
TW v,32,16896
M a,240,v,52,a,80
DL 5,48,93,2112
M a,240,v,56,a,96
TW v,34,17024
M a,240,v,60,a,112
TW v,36,17152
M a,244,v,48,a,68
TW v,38,17280
M a,244,v,52,a,84
TW v,40,16904
M a,244,v,56,a,100
TW v,42,17032
TW v,44,17160
M a,244,v,60,a,116
TW v,46,17288
M a,248,v,48,a,72
DL 5,52,93,3144
M a,248,v,52,a,88
s_add_u32 m0, s92, 16896
s_mov_b32 s93, 2097408
M a,248,v,56,a,104
TW v,48,16960
M a,248,v,60,a,120
s_waitcnt lgkmcnt(1)
TW v,50,17088
M v,128,v,32,a,128
DL 6,40,93,0
M v,128,v,36,a,160
TW v,52,17216
M v,132,v,32,a,132
TW v,54,17344
M v,132,v,36,a,164
TW v,56,16968
M v,136,v,32,a,136
TW v,58,17096
M v,136,v,36,a,168
TW v,60,17224
M v,64,v,40,a,128
TW v,62,17352
M v,64,v,44,a,160
DL 6,44,93,1032
M v,68,v,40,a,132
RD a,32,3,50688
M v,68,v,44,a,164
RD a,48,3,50752
M v,72,v,40,a,136
RD a,36,3,51200
M v,72,v,44,a,168
s_waitcnt lgkmcnt(3)
RD a,52,3,51264
M v,144,v,48,a,128
TW v,32,17408
v_xor_b32 v3, 81920, v3
M v,144,v,52,a,160
DL 6,48,93,2112
M v,148,v,48,a,132
RD a,40,3,33792
s_add_u32 m0, s92, 81920
M v,148,v,52,a,164
RD a,56,3,33856
M v,152,v,48,a,136
TW v,34,17536
M v,152,v,52,a,168
TW v,36,17664
M v,80,v,56,a,128
TW v,38,17792
TW v,40,17416
M v,80,v,60,a,160
TW v,42,17544
TW v,44,17672
M v,84,v,56,a,132
TW v,46,17800
M v,84,v,60,a,164
DN 4,8,2,0
M v,88,v,56,a,136
s_add_u32 m0, s92, 16896
TW v,48,17472
M v,88,v,60,a,168
s_waitcnt lgkmcnt(1)
TW v,50,17600
M v,160,v,32,a,128
DL 6,52,93,3144
M v,160,v,36,a,160
TW v,52,17728
s_add_u32 m0, s92, 81920
M v,164,v,32,a,132
TW v,54,17856
s_mov_b32 s93, 2621696
M v,164,v,36,a,164
TW v,56,17480
M v,168,v,32,a,136
TW v,58,17608
M v,168,v,36,a,168
TW v,60,17736
M v,96,v,40,a,128
TW v,62,17864
M v,96,v,44,a,160
DN 4,12,2,1056
M v,100,v,40,a,132
s_add_u32 m0, s92, 33792
M v,100,v,44,a,164
M v,104,v,40,a,136
DL 5,40,93,0
M v,104,v,44,a,168
s_waitcnt lgkmcnt(0)
s_waitcnt vmcnt(12)
M v,176,v,48,a,128
s_mov_b64 exec, 0
s_branch L_pad2
L_ret2:
s_mov_b64 exec, -1
s_barrier
TW v,32,50688
M v,176,v,52,a,160
TW v,34,50816
s_add_u32 m0, s92, 81920
M v,180,v,48,a,132
TW v,36,50944
M v,180,v,52,a,164
TW v,38,51072
M v,184,v,48,a,136
TW v,40,51200
M v,184,v,52,a,168
TW v,42,51328
M v,112,v,56,a,128
TW v,44,51456
TW v,46,51584
M v,112,v,60,a,160
DN 4,16,2,2112
M v,116,v,56,a,132
s_add_u32 m0, s92, 33792
TW v,48,50696
M v,116,v,60,a,164
TW v,50,50824
M v,120,v,56,a,136
DL 5,44,93,1032
M v,120,v,60,a,168
s_waitcnt lgkmcnt(2)
TW v,52,50952
M v,128,v,32,a,0
TW v,54,51080
s_add_u32 m0, s92, 81920
M v,128,v,36,a,16
TW v,56,51208
M v,128,v,40,a,32
TW v,58,51336
M v,128,v,44,a,48
TW v,60,51464
M v,132,v,32,a,4
TW v,62,51592
M v,132,v,36,a,20
DN 4,20,2,3168
M v,132,v,40,a,36
s_add_u32 m0, s92, 33792
s_mov_b32 s2, 16384
M v,132,v,44,a,52
v_mul_f32 v128, 0x3db8aa3b, v128
v_mul_f32 v129, 0x3db8aa3b, v129
M v,136,v,32,a,8
DL 5,48,93,2112
M v,136,v,36,a,24
TW v,32,50752
s_add_u32 m0, s92, 98816
M v,136,v,40,a,40
TW v,34,50880
v_mul_f32 v130, 0x3db8aa3b, v130
M v,136,v,44,a,56
s_waitcnt lgkmcnt(2)
TW v,36,51008
M v,64,v,48,a,0
TW v,38,51136
v_mul_f32 v131, 0x3db8aa3b, v131
M v,64,v,52,a,16
TW v,40,51264
CV 128,128
M v,64,v,56,a,32
TW v,42,51392
CV 129,130
M v,64,v,60,a,48
TW v,44,51520
v_mul_f32 v132, 0x3db8aa3b, v132
M v,68,v,48,a,4
TW v,46,51648
v_mul_f32 v133, 0x3db8aa3b, v133
M v,68,v,52,a,20
DN 4,8,2,0
M v,68,v,56,a,36
s_add_u32 m0, s92, 33792
v_mul_f32 v64, 0x3db8aa3b, v64
M v,68,v,60,a,52
v_mul_f32 v65, 0x3db8aa3b, v65
v_mul_f32 v66, 0x3db8aa3b, v66
M v,72,v,48,a,8
DL 5,52,93,3144
M v,72,v,52,a,24
TW v,48,50760
s_add_u32 m0, s92, 50688
M v,72,v,56,a,40
TW v,50,50888
s_mov_b32 s93, 2621824
M v,72,v,60,a,56
s_waitcnt lgkmcnt(2)
TW v,52,51016
M v,144,v,32,a,0
TW v,54,51144
v_mul_f32 v67, 0x3db8aa3b, v67
M v,144,v,36,a,16
TW v,56,51272
CV 130,64
M v,144,v,40,a,32
TW v,58,51400
CV 131,66
M v,144,v,44,a,48
TW v,60,51528
v_mul_f32 v134, 0x3db8aa3b, v134
M v,148,v,32,a,4
TW v,62,51656
v_xor_b32 v11, 81920, v11
M v,148,v,36,a,20
DL 5,40,93,0
M v,148,v,40,a,36
s_add_u32 m0, s92, 98816
v_mul_f32 v144, 0x3db8aa3b, v144
M v,148,v,44,a,52
v_mul_f32 v145, 0x3db8aa3b, v145
v_mul_f32 v146, 0x3db8aa3b, v146
M v,152,v,32,a,8
v_mul_f32 v147, 0x3db8aa3b, v147
CV 144,144
M v,152,v,36,a,24
DN 4,12,2,1056
M v,152,v,40,a,40
s_add_u32 m0, s92, 50688
CV 145,146
M v,152,v,44,a,56
s_waitcnt lgkmcnt(0)
s_waitcnt vmcnt(15)
M v,80,v,48,a,0
s_barrier
TW v,32,0
M v,80,v,52,a,16
TW v,34,128
v_mul_f32 v135, 0x3db8aa3b, v135
M v,80,v,56,a,32
TW v,36,256
CV 132,132
M v,80,v,60,a,48
TW v,38,384
CV 133,134
M v,84,v,48,a,4
TW v,40,512
v_mul_f32 v68, 0x3db8aa3b, v68
M v,84,v,52,a,20
TW v,42,640
v_mul_f32 v69, 0x3db8aa3b, v69
M v,84,v,56,a,36
TW v,44,768
TW v,46,896
M v,84,v,60,a,52
DL 5,44,93,1032
M v,88,v,48,a,8
s_add_u32 m0, s92, 98816
TW v,48,8
M v,88,v,52,a,24
TW v,50,136
v_mul_f32 v80, 0x3db8aa3b, v80
M v,88,v,56,a,40
DN 4,16,2,2112
M v,88,v,60,a,56
s_waitcnt lgkmcnt(2)
TW v,52,264
M v,160,v,32,a,0
TW v,54,392
s_add_u32 m0, s92, 50688
M v,160,v,36,a,16
TW v,56,520
v_mul_f32 v81, 0x3db8aa3b, v81
M v,160,v,40,a,32
TW v,58,648
v_mul_f32 v82, 0x3db8aa3b, v82
M v,160,v,44,a,48
TW v,60,776
v_mul_f32 v83, 0x3db8aa3b, v83
M v,164,v,32,a,4
TW v,62,904
CV 146,80
M v,164,v,36,a,20
DL 5,48,93,2112
M v,164,v,40,a,36
s_add_u32 m0, s92, 98816
v_mul_f32 v160, 0x3db8aa3b, v160
M v,164,v,44,a,52
v_mul_f32 v161, 0x3db8aa3b, v161
CV 147,82
M v,168,v,32,a,8
TW v,32,64
v_mul_f32 v162, 0x3db8aa3b, v162
M v,168,v,36,a,24
DN 4,20,2,3168
M v,168,v,40,a,40
TW v,34,192
s_add_u32 m0, s92, 50688
M v,168,v,44,a,56
s_waitcnt lgkmcnt(2)
TW v,36,320
M v,96,v,48,a,0
TW v,38,448
s_mov_b32 s2, 0
M v,96,v,52,a,16
TW v,40,576
v_mul_f32 v163, 0x3db8aa3b, v163
M v,96,v,56,a,32
TW v,42,704
CV 160,160
M v,96,v,60,a,48
TW v,44,832
CV 161,162
M v,100,v,48,a,4
TW v,46,960
v_mul_f32 v70, 0x3db8aa3b, v70
M v,100,v,52,a,20
DL 5,52,93,3144
M v,100,v,56,a,36
s_add_u32 m0, s92, 115712
v_mul_f32 v96, 0x3db8aa3b, v96
M v,100,v,60,a,52
v_mul_f32 v97, 0x3db8aa3b, v97
v_mul_f32 v98, 0x3db8aa3b, v98
M v,104,v,48,a,8
TW v,48,72
v_mul_f32 v99, 0x3db8aa3b, v99
M v,104,v,52,a,24
DN 4,24,2,0
M v,104,v,56,a,40
TW v,50,200
CV 162,96
M v,104,v,60,a,56
s_waitcnt lgkmcnt(2)
TW v,52,328
M v,176,v,32,a,0
TW v,54,456
CV 163,98
M v,176,v,36,a,16
TW v,56,584
v_mul_f32 v71, 0x3db8aa3b, v71
M v,176,v,40,a,32
TW v,58,712
v_mul_f32 v148, 0x3db8aa3b, v148
M v,176,v,44,a,48
TW v,60,840
v_mul_f32 v149, 0x3db8aa3b, v149
M v,180,v,32,a,4
TW v,62,968
CV 134,68
M v,180,v,36,a,20
CV 135,70
v_mul_f32 v150, 0x3db8aa3b, v150
M v,180,v,40,a,36
v_mul_f32 v176, 0x3db8aa3b, v176
v_mul_f32 v177, 0x3db8aa3b, v177
M v,180,v,44,a,52
v_mul_f32 v178, 0x3db8aa3b, v178
v_mul_f32 v179, 0x3db8aa3b, v179
M v,184,v,32,a,8
DN 4,28,2,1056
M v,184,v,36,a,24
CV 176,176
CV 177,178
M v,184,v,40,a,40
v_mul_f32 v151, 0x3db8aa3b, v151
CV 148,148
M v,184,v,44,a,56
s_waitcnt lgkmcnt(0)
s_waitcnt vmcnt(17)
M v,112,v,48,a,0
s_barrier
TW v,32,16896
M v,112,v,52,a,16
TW v,34,17024
CV 149,150
M v,112,v,56,a,32
TW v,36,17152
v_mul_f32 v84, 0x3db8aa3b, v84
M v,112,v,60,a,48
TW v,38,17280
v_mul_f32 v85, 0x3db8aa3b, v85
M v,116,v,48,a,4
TW v,40,16904
v_mul_f32 v86, 0x3db8aa3b, v86
M v,116,v,52,a,20
TW v,42,17032
v_mul_f32 v87, 0x3db8aa3b, v87
M v,116,v,56,a,36
TW v,44,17160
TW v,46,17288
M v,116,v,60,a,52
v_mul_f32 v112, 0x3db8aa3b, v112
v_mul_f32 v113, 0x3db8aa3b, v113
M v,120,v,48,a,8
TW v,48,16960
v_mul_f32 v114, 0x3db8aa3b, v114
M v,120,v,52,a,24
DN 4,32,2,2112
M v,120,v,56,a,40
TW v,50,17088
v_mul_f32 v115, 0x3db8aa3b, v115
M v,120,v,60,a,56
s_waitcnt lgkmcnt(2)
TW v,52,17216
M v,192,v,32,a,128
TW v,54,17344
CV 178,112
M v,192,v,36,a,160
TW v,56,16968
CV 179,114
M v,196,v,32,a,132
TW v,58,17096
v_mul_f32 v164, 0x3db8aa3b, v164
M v,196,v,36,a,164
TW v,60,17224
v_mul_f32 v165, 0x3db8aa3b, v165
M v,200,v,32,a,136
TW v,62,17352
CV 150,84
M v,200,v,36,a,168
TW v,32,17408
CV 151,86
M a,144,v,40,a,128
TW v,34,17536
v_mul_f32 v166, 0x3db8aa3b, v166
M a,144,v,44,a,160
TW v,36,17664
v_mul_f32 v167, 0x3db8aa3b, v167
M a,148,v,40,a,132
TW v,38,17792
CV 164,164
M a,148,v,44,a,164
DN 4,36,2,3168
M a,152,v,40,a,136
TW v,40,17416
s_add_u32 m0, s92, 132608
M a,152,v,44,a,168
s_waitcnt lgkmcnt(5)
TW v,42,17544
M v,208,v,48,a,128
TW v,44,17672
s_mov_b32 s2, 32768
M v,208,v,52,a,160
TW v,46,17800
CV 165,166
M v,212,v,48,a,132
v_mul_f32 v100, 0x3db8aa3b, v100
v_mul_f32 v101, 0x3db8aa3b, v101
M v,212,v,52,a,164
v_mul_f32 v102, 0x3db8aa3b, v102
v_mul_f32 v103, 0x3db8aa3b, v103
M v,216,v,48,a,136
TW v,48,17472
v_mul_f32 v180, 0x3db8aa3b, v180
M v,216,v,52,a,168
TW v,50,17600
v_mul_f32 v181, 0x3db8aa3b, v181
M a,176,v,56,a,128
TW v,52,17728
CV 166,100
M a,176,v,60,a,160
TW v,54,17856
CV 167,102
M a,180,v,56,a,132
v_mul_f32 v182, 0x3db8aa3b, v182
v_mul_f32 v183, 0x3db8aa3b, v183
M a,180,v,60,a,164
CV 180,180
v_mul_f32 v136, 0x3db8aa3b, v136
M a,184,v,56,a,136
DN 4,8,2,0
M a,184,v,60,a,168
s_waitcnt lgkmcnt(4)
TW v,56,17480
M v,224,v,32,a,128
TW v,58,17608
v_mul_f32 v137, 0x3db8aa3b, v137
M v,224,v,36,a,160
TW v,60,17736
CV 181,182
M v,228,v,32,a,132
TW v,62,17864
v_mul_f32 v116, 0x3db8aa3b, v116
M v,228,v,36,a,164
v_mul_f32 v117, 0x3db8aa3b, v117
v_mul_f32 v118, 0x3db8aa3b, v118
M v,232,v,32,a,136
v_mul_f32 v119, 0x3db8aa3b, v119
v_mul_f32 v138, 0x3db8aa3b, v138
M v,232,v,36,a,168
v_mul_f32 v139, 0x3db8aa3b, v139
CV 136,136
M a,208,v,40,a,128
CV 182,116
CV 183,118
M a,208,v,44,a,160
CV 137,138
v_mul_f32 v72, 0x3db8aa3b, v72
M a,212,v,40,a,132
v_mul_f32 v73, 0x3db8aa3b, v73
v_mul_f32 v74, 0x3db8aa3b, v74
M a,212,v,44,a,164
v_mul_f32 v75, 0x3db8aa3b, v75
v_mul_f32 v152, 0x3db8aa3b, v152
M a,216,v,40,a,136
v_mul_f32 v153, 0x3db8aa3b, v153
CV 138,72
M a,216,v,44,a,168
s_waitcnt lgkmcnt(0)
s_waitcnt vmcnt(12)
M v,240,v,48,a,128
s_mov_b64 exec, 0
s_branch L_pad3
L_ret3:
s_mov_b64 exec, -1
s_barrier
TW v,32,33792
M v,240,v,52,a,160
DN 4,12,2,1056
M v,244,v,48,a,132
TW v,34,33920
CV 139,74
M v,244,v,52,a,164
TW v,36,34048
v_mul_f32 v154, 0x3db8aa3b, v154
M v,248,v,48,a,136
TW v,38,34176
v_mul_f32 v155, 0x3db8aa3b, v155
M v,248,v,52,a,168
TW v,40,34304
CV 152,152
M a,240,v,56,a,128
TW v,42,34432
TW v,44,34560
M a,240,v,60,a,160
TW v,46,34688
CV 153,154
M a,244,v,56,a,132
TW v,48,33800
v_mul_f32 v88, 0x3db8aa3b, v88
M a,244,v,60,a,164
TW v,50,33928
v_mul_f32 v89, 0x3db8aa3b, v89
M a,248,v,56,a,136
TW v,52,34056
v_mul_f32 v90, 0x3db8aa3b, v90
M a,248,v,60,a,168
s_waitcnt lgkmcnt(3)
TW v,54,34184
M v,192,v,32,a,0
TW v,56,34312
v_mul_f32 v91, 0x3db8aa3b, v91
v_mul_f32 v168, 0x3db8aa3b, v168
M v,192,v,36,a,16
TW v,58,34440
v_mul_f32 v169, 0x3db8aa3b, v169
CV 154,88
M v,192,v,40,a,32
TW v,60,34568
CV 155,90
v_mul_f32 v170, 0x3db8aa3b, v170
M v,192,v,44,a,48
TW v,62,34696
v_mul_f32 v171, 0x3db8aa3b, v171
CV 168,168
M v,196,v,32,a,4
DN 4,16,2,2112
CV 169,170
M v,196,v,36,a,20
v_mul_f32 v104, 0x3db8aa3b, v104
v_mul_f32 v105, 0x3db8aa3b, v105
v_mul_f32 v106, 0x3db8aa3b, v106
M v,196,v,40,a,36
v_mul_f32 v107, 0x3db8aa3b, v107
v_mul_f32 v184, 0x3db8aa3b, v184
v_mul_f32 v185, 0x3db8aa3b, v185
M v,196,v,44,a,52
CV 170,104
CV 171,106
v_mul_f32 v186, 0x3db8aa3b, v186
M v,200,v,32,a,8
TW v,32,33856
v_mul_f32 v187, 0x3db8aa3b, v187
CV 184,184
M v,200,v,36,a,24
TW v,34,33984
CV 185,186
v_mul_f32 v120, 0x3db8aa3b, v120
M v,200,v,40,a,40
TW v,36,34112
v_mul_f32 v121, 0x3db8aa3b, v121
v_mul_f32 v122, 0x3db8aa3b, v122
M v,200,v,44,a,56
s_waitcnt lgkmcnt(3)
TW v,38,34240
v_mul_f32 v123, 0x3db8aa3b, v123
M a,144,v,48,a,0
TW v,40,34368
CV 186,120
CV 187,122
M a,144,v,52,a,16
TW v,42,34496
v_mul_f32 v196, 0x3db8aa3b, v196
v_mul_f32 v197, 0x3db8aa3b, v197
M a,144,v,56,a,32
TW v,44,34624
v_mul_f32 v192, 0x3db8aa3b, v192
v_mul_f32 v193, 0x3db8aa3b, v193
M a,144,v,60,a,48
TW v,46,34752
v_mul_f32 v198, 0x3db8aa3b, v198
v_mul_f32 v199, 0x3db8aa3b, v199
M a,148,v,48,a,4
DN 4,20,2,3168
s_add_u32 m0, s92, 0
M a,148,v,52,a,20
s_mov_b32 s2, 16384
CV 196,196
v_mul_f32 v194, 0x3db8aa3b, v194
M a,148,v,56,a,36
v_mul_f32 v195, 0x3db8aa3b, v195
CV 192,192
CV 197,198
M a,148,v,60,a,52
AR 20,144
AR 21,145
AR 22,146
M a,152,v,48,a,8
TW v,48,33864
AR 23,147
CV 193,194
M a,152,v,52,a,24
TW v,50,33992
AR 24,148
AR 25,149
M a,152,v,56,a,40
TW v,52,34120
AR 26,150
AR 27,151
M a,152,v,60,a,56
s_waitcnt lgkmcnt(3)
TW v,54,34248
v_mul_f32 v24, 0x3db8aa3b, v24
M v,208,v,32,a,0
TW v,56,34376
v_mul_f32 v25, 0x3db8aa3b, v25
v_mul_f32 v26, 0x3db8aa3b, v26
M v,208,v,36,a,16
TW v,58,34504
v_mul_f32 v27, 0x3db8aa3b, v27
v_mul_f32 v20, 0x3db8aa3b, v20
M v,208,v,40,a,32
TW v,60,34632
v_mul_f32 v21, 0x3db8aa3b, v21
v_mul_f32 v22, 0x3db8aa3b, v22
M v,208,v,44,a,48
TW v,62,34760
v_mul_f32 v23, 0x3db8aa3b, v23
CV 198,24
M v,212,v,32,a,4
DN 4,24,2,0
CV 199,26
M v,212,v,36,a,20
v_mul_f32 v200, 0x3db8aa3b, v200
v_mul_f32 v208, 0x3db8aa3b, v208
v_mul_f32 v209, 0x3db8aa3b, v209
M v,212,v,40,a,36
v_mul_f32 v201, 0x3db8aa3b, v201
CV 194,20
CV 195,22
M v,212,v,44,a,52
v_mul_f32 v210, 0x3db8aa3b, v210
v_mul_f32 v211, 0x3db8aa3b, v211
CV 208,208
M v,216,v,32,a,8
v_mul_f32 v202, 0x3db8aa3b, v202
v_mul_f32 v203, 0x3db8aa3b, v203
CV 200,200
M v,216,v,36,a,24
AR 20,152
AR 21,153
AR 22,154
M v,216,v,40,a,40
AR 23,155
CV 209,210
CV 201,202
M v,216,v,44,a,56
s_waitcnt lgkmcnt(0)
s_waitcnt vmcnt(9)
s_barrier
M a,176,v,48,a,0
TW v,32,50688
v_mul_f32 v20, 0x3db8aa3b, v20
v_mul_f32 v21, 0x3db8aa3b, v21
M a,176,v,52,a,16
TW v,34,50816
v_mul_f32 v22, 0x3db8aa3b, v22
v_mul_f32 v23, 0x3db8aa3b, v23
M a,176,v,56,a,32
TW v,36,50944
v_mul_f32 v216, 0x3db8aa3b, v216
v_mul_f32 v217, 0x3db8aa3b, v217
M a,176,v,60,a,48
TW v,38,51072
CV 202,20
CV 203,22
M a,180,v,48,a,4
TW v,40,51200
v_mul_f32 v212, 0x3db8aa3b, v212
v_mul_f32 v213, 0x3db8aa3b, v213
M a,180,v,52,a,20
TW v,42,51328
AR 24,176
AR 25,177
M a,180,v,56,a,36
TW v,44,51456
TW v,46,51584
AR 26,178
M a,180,v,60,a,52
DN 4,28,2,1056
AR 27,179
M a,184,v,48,a,8
TW v,48,50696
v_mul_f32 v24, 0x3db8aa3b, v24
v_mul_f32 v25, 0x3db8aa3b, v25
M a,184,v,52,a,24
TW v,50,50824
v_mul_f32 v26, 0x3db8aa3b, v26
v_mul_f32 v27, 0x3db8aa3b, v27
M a,184,v,56,a,40
TW v,52,50952
CV 210,24
CV 211,26
M a,184,v,60,a,56
s_waitcnt lgkmcnt(3)
TW v,54,51080
v_mul_f32 v218, 0x3db8aa3b, v218
M v,224,v,32,a,0
TW v,56,51208
v_mul_f32 v219, 0x3db8aa3b, v219
CV 216,216
M v,224,v,36,a,16
TW v,58,51336
AR 24,184
AR 25,185
M v,224,v,40,a,32
TW v,60,51464
AR 26,186
AR 27,187
M v,224,v,44,a,48
TW v,62,51592
v_mul_f32 v214, 0x3db8aa3b, v214
v_mul_f32 v215, 0x3db8aa3b, v215
M v,228,v,32,a,4
DN 4,32,2,2112
CV 212,212
M v,228,v,36,a,20
CV 217,218
AR 20,180
AR 21,181
M v,228,v,40,a,36
AR 22,182
AR 23,183
v_mul_f32 v24, 0x3db8aa3b, v24
M v,228,v,44,a,52
v_mul_f32 v25, 0x3db8aa3b, v25
v_mul_f32 v26, 0x3db8aa3b, v26
v_mul_f32 v27, 0x3db8aa3b, v27
M v,232,v,32,a,8
TW v,32,50752
CV 213,214
v_mul_f32 v20, 0x3db8aa3b, v20
M v,232,v,36,a,24
TW v,34,50880
v_mul_f32 v21, 0x3db8aa3b, v21
v_mul_f32 v22, 0x3db8aa3b, v22
M v,232,v,40,a,40
TW v,36,51008
v_mul_f32 v23, 0x3db8aa3b, v23
CV 218,24
M v,232,v,44,a,56
s_waitcnt lgkmcnt(3)
TW v,38,51136
CV 219,26
M a,208,v,48,a,0
TW v,40,51264
v_mul_f32 v228, 0x3db8aa3b, v228
v_mul_f32 v229, 0x3db8aa3b, v229
M a,208,v,52,a,16
TW v,42,51392
CV 214,20
CV 215,22
M a,208,v,56,a,32
TW v,44,51520
v_mul_f32 v224, 0x3db8aa3b, v224
v_mul_f32 v225, 0x3db8aa3b, v225
M a,208,v,60,a,48
TW v,46,51648
v_mul_f32 v230, 0x3db8aa3b, v230
v_mul_f32 v231, 0x3db8aa3b, v231
M a,212,v,48,a,4
DN 4,36,2,3168
s_add_u32 m0, s92, 16896
M a,212,v,52,a,20
s_mov_b32 s2, 49152
CV 228,228
v_mul_f32 v226, 0x3db8aa3b, v226
M a,212,v,56,a,36
v_mul_f32 v227, 0x3db8aa3b, v227
CV 224,224
CV 229,230
M a,212,v,60,a,52
AR 20,208
AR 21,209
AR 22,210
M a,216,v,48,a,8
TW v,48,50760
AR 23,211
CV 225,226
M a,216,v,52,a,24
TW v,50,50888
AR 24,212
AR 25,213
M a,216,v,56,a,40
TW v,52,51016
AR 26,214
AR 27,215
M a,216,v,60,a,56
s_waitcnt lgkmcnt(3)
TW v,54,51144
v_mul_f32 v24, 0x3db8aa3b, v24
M v,240,v,32,a,0
TW v,56,51272
v_mul_f32 v25, 0x3db8aa3b, v25
v_mul_f32 v26, 0x3db8aa3b, v26
M v,240,v,36,a,16
TW v,58,51400
v_mul_f32 v27, 0x3db8aa3b, v27
v_mul_f32 v20, 0x3db8aa3b, v20
M v,240,v,40,a,32
TW v,60,51528
v_mul_f32 v21, 0x3db8aa3b, v21
v_mul_f32 v22, 0x3db8aa3b, v22
M v,240,v,44,a,48
TW v,62,51656
v_mul_f32 v23, 0x3db8aa3b, v23
CV 230,24
M v,244,v,32,a,4
DN 4,8,2,0
CV 231,26
M v,244,v,36,a,20
CV 226,20
v_mul_f32 v240, 0x3db8aa3b, v240
v_mul_f32 v241, 0x3db8aa3b, v241
M v,244,v,40,a,36
CV 227,22
v_mul_f32 v242, 0x3db8aa3b, v242
v_mul_f32 v243, 0x3db8aa3b, v243
M v,244,v,44,a,52
CV 240,240
CV 241,242
v_mul_f32 v232, 0x3db8aa3b, v232
M v,248,v,32,a,8
v_mul_f32 v233, 0x3db8aa3b, v233
v_mul_f32 v234, 0x3db8aa3b, v234
v_mul_f32 v235, 0x3db8aa3b, v235
M v,248,v,36,a,24
CV 232,232
AR 20,216
AR 21,217
M v,248,v,40,a,40
AR 22,218
AR 23,219
CV 233,234
M v,248,v,44,a,56
s_waitcnt lgkmcnt(0)
s_waitcnt vmcnt(13)
s_barrier
M a,240,v,48,a,0
RD v,32,1,0
v_mul_f32 v20, 0x3db8aa3b, v20
v_mul_f32 v21, 0x3db8aa3b, v21
M a,240,v,52,a,16
RD v,36,1,64
v_mul_f32 v22, 0x3db8aa3b, v22
v_mul_f32 v23, 0x3db8aa3b, v23
M a,240,v,56,a,32
RD v,40,1,128
CV 234,20
CV 235,22
M a,240,v,60,a,48
RD v,44,1,192
v_mul_f32 v244, 0x3db8aa3b, v244
v_mul_f32 v245, 0x3db8aa3b, v245
M a,244,v,48,a,4
v_mul_f32 v246, 0x3db8aa3b, v246
v_mul_f32 v247, 0x3db8aa3b, v247
CV 244,244
M a,244,v,52,a,20
DN 4,12,2,1056
AR 24,240
M a,244,v,56,a,36
AR 25,241
AR 26,242
AR 27,243
M a,244,v,60,a,52
v_mul_f32 v24, 0x3db8aa3b, v24
v_mul_f32 v25, 0x3db8aa3b, v25
v_mul_f32 v26, 0x3db8aa3b, v26
M a,248,v,48,a,8
RD v,48,1,512
v_mul_f32 v27, 0x3db8aa3b, v27
CV 242,24
M a,248,v,52,a,24
RD v,52,1,576
CV 243,26
AR 20,244
M a,248,v,56,a,40
RD v,56,1,640
AR 21,245
AR 22,246
M a,248,v,60,a,56
s_waitcnt lgkmcnt(3)
RD v,60,1,704
AR 23,247
Z v,64,v,32,v,128
CV 245,246
v_mul_f32 v20, 0x3db8aa3b, v20
v_mul_f32 v21, 0x3db8aa3b, v21
M v,64,v,36,v,144
v_mul_f32 v22, 0x3db8aa3b, v22
v_mul_f32 v23, 0x3db8aa3b, v23
CV 246,20
M v,64,v,40,v,160
CV 247,22
v_mul_f32 v248, 0x3db8aa3b, v248
v_mul_f32 v249, 0x3db8aa3b, v249
M v,64,v,44,v,176
v_mul_f32 v250, 0x3db8aa3b, v250
v_mul_f32 v251, 0x3db8aa3b, v251
CV 248,248
Z v,68,v,32,v,132
AR 24,248
AR 25,249
AR 26,250
M v,68,v,36,v,148
AR 27,251
CV 249,250
v_mul_f32 v24, 0x3db8aa3b, v24
M v,68,v,40,v,164
DN 4,16,2,2112
v_mul_f32 v25, 0x3db8aa3b, v25
M v,68,v,44,v,180
v_mul_f32 v26, 0x3db8aa3b, v26
v_mul_f32 v27, 0x3db8aa3b, v27
CV 250,24
Z v,72,v,32,v,136
RD v,32,1,256
CV 251,26
M v,72,v,36,v,152
RD v,36,1,320
M v,72,v,40,v,168
RD v,40,1,384
M v,72,v,44,v,184
s_waitcnt lgkmcnt(3)
RD v,44,1,448
Z v,80,v,48,v,128
M v,80,v,52,v,144
M v,80,v,56,v,160
M v,80,v,60,v,176
Z v,84,v,48,v,132
M v,84,v,52,v,148
M v,84,v,56,v,164
DN 4,20,2,3168
s_add_u32 m0, s92, 33792
M v,84,v,60,v,180
s_mov_b32 s2, 32768
Z v,88,v,48,v,136
RD v,48,1,768
M v,88,v,52,v,152
RD v,52,1,832
M v,88,v,56,v,168
RD v,56,1,896
M v,88,v,60,v,184
s_waitcnt lgkmcnt(3)
RD v,60,1,960
M v,64,v,32,v,192
M v,64,v,36,v,208
M v,64,v,40,v,224
M v,64,v,44,v,240
M v,68,v,32,v,196
M v,68,v,36,v,212
M v,68,v,40,v,228
M v,68,v,44,v,244
DN 4,24,2,0
M v,72,v,32,v,200
M v,72,v,36,v,216
M v,72,v,40,v,232
v_max3_f32 v24, v64, v65, v66
M v,72,v,44,v,248
s_waitcnt lgkmcnt(0)
s_waitcnt vmcnt(17)
s_mov_b64 exec, 0
s_branch L_pad4
L_ret4:
s_mov_b64 exec, -1
s_barrier
M v,80,v,48,v,192
RD v,32,1,16896
v_max3_f32 v25, v68, v69, v70
M v,80,v,52,v,208
RD v,36,1,16960
v_max3_f32 v26, v72, v73, v74
M v,80,v,56,v,224
RD v,40,1,17024
M v,80,v,60,v,240
RD v,44,1,17088
M v,84,v,48,v,196
M v,84,v,52,v,212
M v,84,v,56,v,228
M v,84,v,60,v,244
M v,88,v,48,v,200
DN 4,28,2,1056
RD v,48,1,17152
M v,88,v,52,v,216
RD v,52,1,17216
v_max3_f32 v24, v24, v67, v80
v_max3_f32 v24, v24, v81, v82
M v,88,v,56,v,232
RD v,56,1,17280
v_max3_f32 v25, v25, v71, v84
v_max3_f32 v25, v25, v85, v86
M v,88,v,60,v,248
s_waitcnt lgkmcnt(3)
RD v,60,1,17344
v_max_f32 v25, v25, v87
Z v,96,v,32,v,128
v_max_f32 v24, v24, v83
v_mov_b32 v27, v25
M v,96,v,36,v,144
M v,96,v,40,v,160
v_max3_f32 v26, v26, v75, v88
v_max3_f32 v26, v26, v89, v90
M v,96,v,44,v,176
v_permlane32_swap_b32 v25, v27
Z v,100,v,32,v,132
v_max_f32 v26, v26, v91
v_max_f32 v25, v25, v27
M v,100,v,36,v,148
v_permlane32_swap_b32 v24, v26
M v,100,v,40,v,164
v_max_f32 v24, v24, v26
M v,100,v,44,v,180
Z v,104,v,32,v,136
v_permlane16_swap_b32 v24, v25
M v,104,v,36,v,152
DN 4,32,2,2112
M v,104,v,40,v,168
RD v,32,1,17408
v_max_f32 v24, v24, v25
M v,104,v,44,v,184
s_waitcnt lgkmcnt(1)
RD v,36,1,17472
M v,96,v,48,v,192
RD v,40,1,17536
v_sub_f32 v24, 0, v24
M v,96,v,52,v,208
RD v,44,1,17600
v_mov_b32 v25, v24
M v,96,v,56,v,224
M v,96,v,60,v,240
v_permlane16_swap_b32 v24, v25
M v,100,v,48,v,196
v_mov_b32 v26, v24
v_mov_b32 v27, v25
M v,100,v,52,v,212
v_permlane32_swap_b32 v24, v26
M v,100,v,56,v,228
v_xor_b32 v2, 81920, v2
AD 64,64,24
M v,100,v,60,v,244
AD 65,65,24
AD 66,66,24
M v,104,v,48,v,200
RD v,48,1,17664
AD 67,67,24
M v,104,v,52,v,216
DN 4,36,2,3168
M v,104,v,56,v,232
RD v,52,1,17728
s_add_u32 m0, s92, 50688
M v,104,v,60,v,248
s_waitcnt lgkmcnt(2)
RD v,56,1,17792
Z v,112,v,32,v,128
RD v,60,1,17856
s_mov_b32 s2, 65536
M v,112,v,36,v,144
v_permlane32_swap_b32 v25, v27
M v,112,v,40,v,160
EX 64
M v,112,v,44,v,176
EX 65
Z v,116,v,32,v,132
AD 68,68,25
AD 69,69,25
M v,116,v,36,v,148
EX 66
M v,116,v,40,v,164
AD 80,80,24
AD 70,70,25
M v,116,v,44,v,180
AD 12,64,65
AD 81,81,24
Z v,120,v,32,v,136
EX 67
M v,120,v,36,v,152
AD 71,71,25
AD 72,72,26
M v,120,v,40,v,168
DN 4,8,2,0
M v,120,v,44,v,184
s_waitcnt lgkmcnt(0)
s_waitcnt vmcnt(17)
M v,112,v,48,v,192
s_barrier
TR v,32,33792
M v,112,v,52,v,208
TR v,34,34304
AD 73,73,26
M v,112,v,56,v,224
TR v,36,33824
AD 12,12,66
M v,112,v,60,v,240
TR v,38,34336
AD 82,82,24
M v,116,v,48,v,196
TR v,40,33856
AD 84,84,25
M v,116,v,52,v,212
TR v,42,34368
AD 74,74,26
M v,116,v,56,v,228
TR v,44,33888
TR v,46,34400
M v,116,v,60,v,244
EX 68
M v,120,v,48,v,200
EX 69
M v,120,v,52,v,216
EX 80
M v,120,v,56,v,232
EX 70
M v,120,v,60,v,248
AD 12,12,67
AD 13,68,69
AD 83,83,24
EX 81
EX 71
AD 85,85,25
AD 75,75,26
EX 72
EX 73
AD 12,12,80
AD 13,13,70
EX 82
v_pk_add_f32 v[86:87], v[86:87], v[24:25] op_sel:[0,1] op_sel_hi:[1,1]
EX 84
EX 74
v_pk_add_f32 v[88:89], v[88:89], v[26:27] op_sel:[0,0] op_sel_hi:[1,0]
AD 12,12,81
AD 13,13,71
AD 14,72,73
EX 83
EX 85
EX 75
AD 12,12,82
AD 13,13,84
AD 14,14,74
EX 86
v_pk_add_f32 v[90:91], v[90:91], v[26:27] op_sel:[0,0] op_sel_hi:[1,0]
EX 88
AD 12,12,83
AD 13,13,85
AD 14,14,75
EX 87
EX 89
AD 13,13,86
AD 14,14,88
CV 83,82
EX 90
AD 13,13,87
AD 14,14,89
CV 82,80
EX 91
AD 14,14,90
CV 81,66
CV 80,64
CV 87,86
AD 14,14,91
CV 86,84
s_waitcnt lgkmcnt(0)
Z a,0,v,32,v,80
CV 85,70
CV 84,68
CV 91,90
CV 90,88
Z a,4,v,32,v,84
CV 89,74
CV 88,72
DN 4,12,2,1056
TR v,48,33920
Z a,8,v,32,v,88
TR v,50,34432
v_mov_b32 v8, 1
Z a,16,v,36,v,80
TR v,52,33952
v_mov_b32 v9, 0
Z a,20,v,36,v,84
TR v,54,34464
AD 96,96,24
Z a,24,v,36,v,88
TR v,56,33984
AD 97,97,24
Z a,32,v,40,v,80
TR v,58,34496
TR v,60,34016
Z a,36,v,40,v,84
TR v,62,34528
AD 100,100,25
Z a,40,v,40,v,88
TR v,32,34048
AD 101,101,25
Z a,48,v,44,v,80
TR v,34,34560
AD 104,104,26
Z a,52,v,44,v,84
TR v,36,34080
AD 105,105,26
Z a,56,v,44,v,88
s_waitcnt lgkmcnt(3)
TR v,38,34592
Z a,64,v,48,v,80
TR v,40,34112
AD 98,98,24
Z a,68,v,48,v,84
TR v,42,34624
AD 102,102,25
Z a,72,v,48,v,88
TR v,44,34144
AD 106,106,26
Z a,80,v,52,v,80
TR v,46,34656
AD 99,99,24
Z a,84,v,52,v,84
DN 4,16,2,2112
Z a,88,v,52,v,88
s_and_b32 s97, s95, 28
s_cbranch_scc1 L_hs
s_mov_b64 exec, 1
global_store_dword v9, v8, s[0:1] sc1
s_mov_b64 exec, -1
L_hs:
Z a,96,v,56,v,80
v_bfe_u32 v8, v4, 8, 2
v_lshrrev_b32 v9, 14, s95
Z a,100,v,56,v,84
TR v,48,34176
v_add_lshl_u32 v8, v8, v9, 7
Z a,104,v,56,v,88
s_getpc_b64 s[100:101]
s_and_b32 s100, s100, 0xfffff000
Z a,112,v,60,v,80
v_add_u32 v8, 4096, v8
v_mov_b32 v9, 0
Z a,116,v,60,v,84
TR v,50,34688
v_lshl_add_u64 v[8:9], v[8:9], 0, s[100:101]
Z a,120,v,60,v,88
s_waitcnt lgkmcnt(2)
TR v,52,34208
Z a,128,v,32,v,80
TR v,54,34720
AD 103,103,25
Z a,132,v,32,v,84
TR v,56,34240
AD 107,107,26
Z a,136,v,32,v,88
TR v,58,34752
AD 112,112,24
Z a,144,v,36,v,80
TR v,60,34272
AD 116,116,25
Z a,148,v,36,v,84
TR v,62,34784
AD 120,120,26
Z a,152,v,36,v,88
DN 4,20,2,3168
Z a,160,v,40,v,80
s_add_u32 m0, s92, 81920
s_mov_b32 s2, 49152
Z a,164,v,40,v,84
global_load_dword v10, v[8:9], off
Z a,168,v,40,v,88
EX 96
Z a,176,v,44,v,80
EX 97
Z a,180,v,44,v,84
EX 100
Z a,184,v,44,v,88
s_waitcnt lgkmcnt(0)
s_waitcnt vmcnt(17)
Z a,192,v,48,v,80
s_barrier
RD v,32,1,50688
Z a,196,v,48,v,84
RD v,36,1,50752
AD 16,96,97
Z a,200,v,48,v,88
RD v,40,1,50816
AD 113,113,24
Z a,208,v,52,v,80
RD v,44,1,50880
AD 117,117,25
Z a,212,v,52,v,84
EX 101
Z a,216,v,52,v,88
EX 104
Z a,224,v,56,v,80
EX 105
Z a,228,v,56,v,84
EX 98
Z a,232,v,56,v,88
EX 102
Z a,240,v,60,v,80
EX 106
Z a,244,v,60,v,84
AD 17,100,101
AD 18,104,105
Z a,248,v,60,v,88
EX 99
EX 103
EX 107
AD 121,121,26
DN 4,24,2,0
AD 16,16,98
AD 17,17,102
AD 18,18,106
v_pk_add_f32 v[114:115], v[114:115], v[24:25] op_sel:[0,0] op_sel_hi:[1,0]
EX 112
v_pk_add_f32 v[118:119], v[118:119], v[24:25] op_sel:[0,1] op_sel_hi:[1,1]
EX 116
v_pk_add_f32 v[122:123], v[122:123], v[26:27] op_sel:[0,0] op_sel_hi:[1,0]
EX 120
AD 16,16,99
AD 17,17,103
AD 18,18,107
EX 113
EX 117
EX 121
AD 16,16,112
AD 17,17,116
AD 18,18,120
EX 114
EX 118
EX 122
AD 16,16,113
AD 17,17,117
AD 18,18,121
EX 115
EX 119
EX 123
AD 16,16,114
AD 17,17,118
AD 18,18,122
AD 16,16,115
AD 17,17,119
AD 18,18,123
v_max3_f32 v20, v16, v17, v18
v_cmp_lt_f32 vcc, 0x4b800000, v20
v_mov_b32 v64, v24
v_mov_b32 v65, v24
v_mov_b32 v66, v24
v_mov_b32 v67, v24
v_mov_b32 v68, v25
v_mov_b32 v69, v25
v_mov_b32 v70, v25
v_mov_b32 v71, v25
v_mov_b32 v72, v26
v_mov_b32 v73, v26
v_mov_b32 v74, v26
v_mov_b32 v75, v26
s_waitcnt lgkmcnt(0)
CV 80,96
CV 81,98
s_cbranch_vccnz L_rsB0
L_rbB0:
MC 96,v,32,128,64
CV 84,100
CV 85,102
M v,96,v,36,v,144
RD v,48,1,50944
CV 88,104
M v,96,v,40,v,160
RD v,52,1,51008
CV 89,106
M v,96,v,44,v,176
RD v,56,1,51072
CV 82,112
MC 100,v,32,132,68
RD v,60,1,51136
CV 83,114
M v,100,v,36,v,148
DN 4,28,2,1056
M v,100,v,40,v,164
CV 86,116
CV 87,118
M v,100,v,44,v,180
CV 90,120
CV 91,122
MC 104,v,32,136,72
RD v,32,1,51200
AD 12,12,16
M v,104,v,36,v,152
RD v,36,1,51264
AD 13,13,17
M v,104,v,40,v,168
RD v,40,1,51328
AD 14,14,18
M v,104,v,44,v,184
s_waitcnt lgkmcnt(3)
RD v,44,1,51392
M v,96,v,48,v,192
M v,96,v,52,v,208
M v,96,v,56,v,224
M v,96,v,60,v,240
DN 4,32,2,2112
M v,100,v,48,v,196
v_xor_b32 v2, 81920, v2
M v,100,v,52,v,212
M v,100,v,56,v,228
M v,100,v,60,v,244
M v,104,v,48,v,200
RD v,48,1,51456
M v,104,v,52,v,216
EX 96
M v,104,v,56,v,232
EX 97
M v,104,v,60,v,248
s_waitcnt lgkmcnt(1)
RD v,52,1,51520
MC 112,v,32,128,64
RD v,56,1,51584
AD 16,96,97
M v,112,v,36,v,144
EX 100
M v,112,v,40,v,160
EX 101
M v,112,v,44,v,176
RD v,60,1,51648
AD 17,100,101
MC 116,v,32,132,68
DN 4,36,2,3168
M v,116,v,36,v,148
s_add_u32 m0, s92, 98816
s_mov_b32 s2, 81920
M v,116,v,40,v,164
EX 104
M v,116,v,44,v,180
EX 105
MC 120,v,32,136,72
EX 98
M v,120,v,36,v,152
EX 102
M v,120,v,40,v,168
EX 106
M v,120,v,44,v,184
s_waitcnt lgkmcnt(0)
s_waitcnt vmcnt(17)
M v,112,v,48,v,192
s_barrier
TR v,32,0
M v,112,v,52,v,208
TR v,34,512
AD 18,104,105
M v,112,v,56,v,224
TR v,36,32
AD 16,16,98
M v,112,v,60,v,240
TR v,38,544
AD 17,17,102
M v,116,v,48,v,196
TR v,40,64
AD 18,18,106
M v,116,v,52,v,212
TR v,42,576
M v,116,v,56,v,228
TR v,44,96
TR v,46,608
M v,116,v,60,v,244
DN 4,8,2,0
M v,120,v,48,v,200
EX 99
M v,120,v,52,v,216
TR v,48,128
AD 16,16,99
M v,120,v,56,v,232
EX 103
M v,120,v,60,v,248
s_waitcnt lgkmcnt(1)
TR v,50,640
M a,0,v,32,v,80
TR v,52,160
AD 17,17,103
M a,4,v,32,v,84
EX 107
M a,8,v,32,v,88
TR v,54,672
AD 18,18,107
M a,16,v,36,v,80
TR v,56,192
M a,20,v,36,v,84
TR v,58,704
M a,24,v,36,v,88
TR v,60,224
M a,32,v,40,v,80
TR v,62,736
M a,36,v,40,v,84
DN 4,12,2,1056
M a,40,v,40,v,88
EX 112
M a,48,v,44,v,80
TR v,32,256
AD 16,16,112
M a,52,v,44,v,84
EX 116
M a,56,v,44,v,88
s_waitcnt lgkmcnt(1)
TR v,34,768
M a,64,v,48,v,80
TR v,36,288
AD 17,17,116
M a,68,v,48,v,84
EX 120
M a,72,v,48,v,88
TR v,38,800
AD 18,18,120
M a,80,v,52,v,80
TR v,40,320
v_xor_b32 v1, 81920, v1
M a,84,v,52,v,84
TR v,42,832
M a,88,v,52,v,88
TR v,44,352
M a,96,v,56,v,80
TR v,46,864
M a,100,v,56,v,84
DN 4,16,2,2112
M a,104,v,56,v,88
EX 113
M a,112,v,60,v,80
TR v,48,384
AD 16,16,113
M a,116,v,60,v,84
EX 117
M a,120,v,60,v,88
s_waitcnt lgkmcnt(1)
TR v,50,896
M a,128,v,32,v,80
TR v,52,416
AD 17,17,117
M a,132,v,32,v,84
EX 121
M a,136,v,32,v,88
TR v,54,928
AD 18,18,121
M a,144,v,36,v,80
TR v,56,448
M a,148,v,36,v,84
TR v,58,960
M a,152,v,36,v,88
TR v,60,480
M a,160,v,40,v,80
TR v,62,992
M a,164,v,40,v,84
DN 4,20,2,3168
M a,168,v,40,v,88
EX 114
M a,176,v,44,v,80
EX 118
M a,180,v,44,v,84
EX 122
M a,184,v,44,v,88
s_waitcnt lgkmcnt(0)
s_waitcnt vmcnt(17)
M a,192,v,48,v,80
s_mov_b64 exec, 0
s_branch L_pad5
L_ret5:
s_mov_b64 exec, -1
s_barrier
RD v,32,1,16896
M a,196,v,48,v,84
RD v,36,1,16960
AD 16,16,114
M a,200,v,48,v,88
RD v,40,1,17024
AD 17,17,118
M a,208,v,52,v,80
RD v,44,1,17088
AD 18,18,122
M a,212,v,52,v,84
EX 115
M a,216,v,52,v,88
EX 119
M a,224,v,56,v,80
EX 123
M a,228,v,56,v,84
AD 16,16,115
AD 17,17,119
M a,232,v,56,v,88
AD 18,18,123
v_max3_f32 v20, v16, v17, v18
M a,240,v,60,v,80
v_cmp_lt_f32 vcc, 0x4b800000, v20
s_add_u32 m0, s92, 115712
M a,244,v,60,v,84
s_waitcnt lgkmcnt(0)
s_mov_b32 s2, 65536
M a,248,v,60,v,88
CV 80,96
CV 81,98
s_cbranch_vccnz L_rsB1
L_rbB1:
MC 96,v,32,128,64
DN 4,24,2,0
M v,96,v,36,v,144
CV 84,100
CV 85,102
M v,96,v,40,v,160
RD v,48,1,17152
CV 88,104
M v,96,v,44,v,176
RD v,52,1,17216
CV 89,106
MC 100,v,32,132,68
RD v,56,1,17280
CV 82,112
M v,100,v,36,v,148
RD v,60,1,17344
CV 83,114
M v,100,v,40,v,164
CV 86,116
CV 87,118
M v,100,v,44,v,180
CV 90,120
CV 91,122
MC 104,v,32,136,72
DN 4,28,2,1056
M v,104,v,36,v,152
RD v,32,1,17408
AD 12,12,16
M v,104,v,40,v,168
RD v,36,1,17472
AD 13,13,17
M v,104,v,44,v,184
s_waitcnt lgkmcnt(2)
RD v,40,1,17536
M v,96,v,48,v,192
RD v,44,1,17600
AD 14,14,18
M v,96,v,52,v,208
M v,96,v,56,v,224
M v,96,v,60,v,240
M v,100,v,48,v,196
M v,100,v,52,v,212
M v,100,v,56,v,228
M v,100,v,60,v,244
M v,104,v,48,v,200
RD v,48,1,17664
M v,104,v,52,v,216
DN 4,32,2,2112
M v,104,v,56,v,232
EX 96
M v,104,v,60,v,248
s_waitcnt lgkmcnt(1)
RD v,52,1,17728
MC 112,v,32,128,64
EX 97
M v,112,v,36,v,144
RD v,56,1,17792
AD 16,96,97
M v,112,v,40,v,160
EX 100
M v,112,v,44,v,176
RD v,60,1,17856
MC 116,v,32,132,68
EX 101
M v,116,v,36,v,148
EX 104
M v,116,v,40,v,164
EX 105
M v,116,v,44,v,180
EX 98
MC 120,v,32,136,72
EX 102
M v,120,v,36,v,152
DN 4,36,2,3168
M v,120,v,40,v,168
s_add_u32 m0, s92, 132608
s_mov_b32 s2, 98304
M v,120,v,44,v,184
s_waitcnt lgkmcnt(0)
s_waitcnt vmcnt(17)
M v,112,v,48,v,192
s_barrier
TR v,32,33792
M v,112,v,52,v,208
TR v,34,34304
AD 17,100,101
M v,112,v,56,v,224
TR v,36,33824
AD 18,104,105
M v,112,v,60,v,240
TR v,38,34336
AD 16,16,98
M v,116,v,48,v,196
TR v,40,33856
AD 17,17,102
M v,116,v,52,v,212
TR v,42,34368
M v,116,v,56,v,228
TR v,44,33888
TR v,46,34400
M v,116,v,60,v,244
EX 106
M v,120,v,48,v,200
TR v,48,33920
AD 18,18,106
M v,120,v,52,v,216
EX 99
M v,120,v,56,v,232
DN 4,8,2,0
M v,120,v,60,v,248
s_waitcnt lgkmcnt(1)
TR v,50,34432
M a,0,v,32,v,80
TR v,52,33952
AD 16,16,99
M a,4,v,32,v,84
EX 103
M a,8,v,32,v,88
TR v,54,34464
AD 17,17,103
M a,16,v,36,v,80
TR v,56,33984
M a,20,v,36,v,84
TR v,58,34496
M a,24,v,36,v,88
TR v,60,34016
M a,32,v,40,v,80
TR v,62,34528
M a,36,v,40,v,84
EX 107
M a,40,v,40,v,88
TR v,32,34048
AD 18,18,107
M a,48,v,44,v,80
EX 112
M a,52,v,44,v,84
TR v,34,34560
AD 16,16,112
M a,56,v,44,v,88
s_waitcnt lgkmcnt(2)
TR v,36,34080
M a,64,v,48,v,80
DN 4,12,2,1056
M a,68,v,48,v,84
EX 116
M a,72,v,48,v,88
TR v,38,34592
AD 17,17,116
M a,80,v,52,v,80
TR v,40,34112
M a,84,v,52,v,84
TR v,42,34624
M a,88,v,52,v,88
TR v,44,34144
M a,96,v,56,v,80
TR v,46,34656
M a,100,v,56,v,84
EX 120
M a,104,v,56,v,88
TR v,48,34176
AD 18,18,120
M a,112,v,60,v,80
EX 113
M a,116,v,60,v,84
TR v,50,34688
AD 16,16,113
M a,120,v,60,v,88
s_waitcnt lgkmcnt(2)
TR v,52,34208
M a,128,v,32,v,80
DN 4,16,2,2112
M a,132,v,32,v,84
EX 117
M a,136,v,32,v,88
TR v,54,34720
AD 17,17,117
M a,144,v,36,v,80
TR v,56,34240
M a,148,v,36,v,84
TR v,58,34752
M a,152,v,36,v,88
TR v,60,34272
M a,160,v,40,v,80
TR v,62,34784
M a,164,v,40,v,84
EX 121
M a,168,v,40,v,88
EX 114
M a,176,v,44,v,80
EX 118
M a,180,v,44,v,84
EX 122
M a,184,v,44,v,88
s_waitcnt lgkmcnt(0)
s_waitcnt vmcnt(16)
M a,192,v,48,v,80
s_barrier
RD v,32,1,50688
M a,196,v,48,v,84
RD v,36,1,50752
AD 18,18,121
M a,200,v,48,v,88
RD v,40,1,50816
AD 16,16,114
M a,208,v,52,v,80
RD v,44,1,50880
AD 17,17,118
M a,212,v,52,v,84
DN 4,20,2,3168
M a,216,v,52,v,88
EX 115
M a,224,v,56,v,80
EX 119
M a,228,v,56,v,84
EX 123
M a,232,v,56,v,88
AD 18,18,122
AD 16,16,115
M a,240,v,60,v,80
AD 17,17,119
AD 18,18,123
M a,244,v,60,v,84
v_max3_f32 v20, v16, v17, v18
v_cmp_lt_f32 vcc, 0x4b800000, v20
M a,248,v,60,v,88
s_waitcnt lgkmcnt(0)
CV 80,96
CV 81,98
s_cbranch_vccnz L_rsB2
L_rbB2:
MC 96,v,32,128,64
CV 84,100
CV 85,102
M v,96,v,36,v,144
RD v,48,1,50944
s_add_u32 m0, s92, 0
M v,96,v,40,v,160
RD v,52,1,51008
s_mov_b32 s2, 81920
M v,96,v,44,v,176
RD v,56,1,51072
CV 88,104
MC 100,v,32,132,68
RD v,60,1,51136
CV 89,106
M v,100,v,36,v,148
DN 4,24,2,0
M v,100,v,40,v,164
CV 82,112
CV 83,114
M v,100,v,44,v,180
CV 86,116
CV 87,118
MC 104,v,32,136,72
RD v,32,1,51200
CV 90,120
M v,104,v,36,v,152
RD v,36,1,51264
CV 91,122
M v,104,v,40,v,168
RD v,40,1,51328
AD 12,12,16
M v,104,v,44,v,184
s_waitcnt lgkmcnt(3)
RD v,44,1,51392
M v,96,v,48,v,192
AD 13,13,17
AD 14,14,18
M v,96,v,52,v,208
M v,96,v,56,v,224
DN 4,28,2,1056
M v,96,v,60,v,240
v_xor_b32 v2, 81920, v2
M v,100,v,48,v,196
M v,100,v,52,v,212
M v,100,v,56,v,228
M v,100,v,60,v,244
M v,104,v,48,v,200
RD v,48,1,51456
M v,104,v,52,v,216
EX 96
M v,104,v,56,v,232
EX 97
M v,104,v,60,v,248
s_waitcnt lgkmcnt(1)
RD v,52,1,51520
MC 112,v,32,128,64
RD v,56,1,51584
AD 16,96,97
M v,112,v,36,v,144
EX 100
M v,112,v,40,v,160
EX 101
M v,112,v,44,v,176
RD v,60,1,51648
AD 17,100,101
MC 116,v,32,132,68
DN 4,32,2,2112
M v,116,v,36,v,148
EX 104
M v,116,v,40,v,164
EX 105
M v,116,v,44,v,180
EX 98
MC 120,v,32,136,72
EX 102
M v,120,v,36,v,152
EX 106
M v,120,v,40,v,168
AD 18,104,105
AD 16,16,98
M v,120,v,44,v,184
s_waitcnt lgkmcnt(0)
s_waitcnt vmcnt(15)
M v,112,v,48,v,192
s_barrier
TR v,32,0
M v,112,v,52,v,208
TR v,34,512
AD 17,17,102
M v,112,v,56,v,224
TR v,36,32
AD 18,18,106
M v,112,v,60,v,240
TR v,38,544
M v,116,v,48,v,196
TR v,40,64
M v,116,v,52,v,212
TR v,42,576
M v,116,v,56,v,228
TR v,44,96
TR v,46,608
M v,116,v,60,v,244
DN 4,36,2,3168
M v,120,v,48,v,200
TR v,48,128
s_add_u32 m0, s92, 16896
M v,120,v,52,v,216
TR v,50,640
s_mov_b32 s2, 114688
M v,120,v,56,v,232
EX 99
M v,120,v,60,v,248
s_waitcnt lgkmcnt(2)
TR v,52,160
M a,0,v,32,v,80
TR v,54,672
AD 16,16,99
M a,4,v,32,v,84
EX 103
M a,8,v,32,v,88
TR v,56,192
AD 17,17,103
M a,16,v,36,v,80
TR v,58,704
M a,20,v,36,v,84
TR v,60,224
M a,24,v,36,v,88
TR v,62,736
M a,32,v,40,v,80
DN 4,8,2,0
M a,36,v,40,v,84
EX 107
M a,40,v,40,v,88
TR v,32,256
AD 18,18,107
M a,48,v,44,v,80
EX 112
M a,52,v,44,v,84
TR v,34,768
AD 16,16,112
M a,56,v,44,v,88
s_waitcnt lgkmcnt(2)
TR v,36,288
M a,64,v,48,v,80
EX 116
M a,68,v,48,v,84
TR v,38,800
AD 17,17,116
M a,72,v,48,v,88
EX 120
M a,80,v,52,v,80
TR v,40,320
v_xor_b32 v1, 81920, v1
M a,84,v,52,v,84
TR v,42,832
AD 18,18,120
M a,88,v,52,v,88
TR v,44,352
M a,96,v,56,v,80
TR v,46,864
M a,100,v,56,v,84
DN 4,12,2,1056
M a,104,v,56,v,88
EX 113
M a,112,v,60,v,80
TR v,48,384
AD 16,16,113
M a,116,v,60,v,84
EX 117
M a,120,v,60,v,88
s_waitcnt lgkmcnt(1)
TR v,50,896
M a,128,v,32,v,80
TR v,52,416
AD 17,17,117
M a,132,v,32,v,84
EX 121
M a,136,v,32,v,88
TR v,54,928
AD 18,18,121
M a,144,v,36,v,80
TR v,56,448
M a,148,v,36,v,84
TR v,58,960
M a,152,v,36,v,88
TR v,60,480
M a,160,v,40,v,80
TR v,62,992
M a,164,v,40,v,84
DN 4,16,2,2112
M a,168,v,40,v,88
EX 114
M a,176,v,44,v,80
EX 118
M a,180,v,44,v,84
EX 122
M a,184,v,44,v,88
s_waitcnt lgkmcnt(0)
s_waitcnt vmcnt(15)
M a,192,v,48,v,80
s_mov_b64 exec, 0
s_branch L_pad6
L_ret6:
s_mov_b64 exec, -1
s_barrier
RD v,32,1,16896
M a,196,v,48,v,84
RD v,36,1,16960
AD 16,16,114
M a,200,v,48,v,88
RD v,40,1,17024
AD 17,17,118
M a,208,v,52,v,80
RD v,44,1,17088
AD 18,18,122
M a,212,v,52,v,84
EX 115
M a,216,v,52,v,88
EX 119
M a,224,v,56,v,80
EX 123
M a,228,v,56,v,84
AD 16,16,115
AD 17,17,119
M a,232,v,56,v,88
RD v,48,1,17152
AD 18,18,123
M a,240,v,60,v,80
v_max3_f32 v20, v16, v17, v18
v_cmp_lt_f32 vcc, 0x4b800000, v20
M a,244,v,60,v,84
s_waitcnt lgkmcnt(1)
CV 80,96
M a,248,v,60,v,88
DN 4,20,2,3168
CV 81,98
s_cbranch_vccnz L_rsB3
L_rbB3:
MC 96,v,32,128,64
CV 84,100
CV 85,102
M v,96,v,36,v,144
RD v,52,1,17216
CV 88,104
M v,96,v,40,v,160
RD v,56,1,17280
CV 89,106
M v,96,v,44,v,176
RD v,60,1,17344
s_add_u32 m0, s92, 33792
MC 100,v,32,132,68
s_mov_b32 s2, 98304
CV 82,112
M v,100,v,36,v,148
CV 83,114
CV 86,116
M v,100,v,40,v,164
CV 87,118
CV 90,120
M v,100,v,44,v,180
DN 4,24,2,0
MC 104,v,32,136,72
RD v,32,1,17408
CV 91,122
M v,104,v,36,v,152
RD v,36,1,17472
AD 12,12,16
M v,104,v,40,v,168
RD v,40,1,17536
AD 13,13,17
M v,104,v,44,v,184
s_waitcnt lgkmcnt(3)
RD v,44,1,17600
M v,96,v,48,v,192
AD 14,14,18
M v,96,v,52,v,208
M v,96,v,56,v,224
M v,96,v,60,v,240
M v,100,v,48,v,196
M v,100,v,52,v,212
M v,100,v,56,v,228
M v,100,v,60,v,244
M v,104,v,48,v,200
DN 4,28,2,1056
M v,104,v,52,v,216
RD v,48,1,17664
M v,104,v,56,v,232
EX 96
M v,104,v,60,v,248
s_waitcnt lgkmcnt(1)
RD v,52,1,17728
MC 112,v,32,128,64
EX 97
M v,112,v,36,v,144
RD v,56,1,17792
AD 16,96,97
M v,112,v,40,v,160
EX 100
M v,112,v,44,v,176
RD v,60,1,17856
MC 116,v,32,132,68
EX 101
M v,116,v,36,v,148
EX 104
M v,116,v,40,v,164
EX 105
M v,116,v,44,v,180
EX 98
MC 120,v,32,136,72
EX 102
M v,120,v,36,v,152
DN 4,32,2,2112
M v,120,v,40,v,168
EX 106
M v,120,v,44,v,184
s_waitcnt lgkmcnt(0)
s_waitcnt vmcnt(15)
M v,112,v,48,v,192
s_barrier
TR v,32,33792
M v,112,v,52,v,208
TR v,34,34304
AD 17,100,101
M v,112,v,56,v,224
TR v,36,33824
AD 18,104,105
M v,112,v,60,v,240
TR v,38,34336
AD 16,16,98
M v,116,v,48,v,196
TR v,40,33856
AD 17,17,102
M v,116,v,52,v,212
TR v,42,34368
AD 18,18,106
M v,116,v,56,v,228
TR v,44,33888
TR v,46,34400
M v,116,v,60,v,244
EX 99
M v,120,v,48,v,200
TR v,48,33920
AD 16,16,99
M v,120,v,52,v,216
DN 4,36,2,3168
M v,120,v,56,v,232
TR v,50,34432
s_add_u32 m0, s92, 50688
M v,120,v,60,v,248
s_waitcnt lgkmcnt(2)
TR v,52,33952
M a,0,v,32,v,80
TR v,54,34464
s_mov_b32 s2, 131072
M a,4,v,32,v,84
EX 103
M a,8,v,32,v,88
TR v,56,33984
AD 17,17,103
M a,16,v,36,v,80
TR v,58,34496
M a,20,v,36,v,84
TR v,60,34016
M a,24,v,36,v,88
TR v,62,34528
M a,32,v,40,v,80
EX 107
M a,36,v,40,v,84
TR v,32,34048
AD 18,18,107
M a,40,v,40,v,88
EX 112
M a,48,v,44,v,80
TR v,34,34560
v_bfe_u32 v8, v4, 8, 2
M a,52,v,44,v,84
DN 4,8,2,0
M a,56,v,44,v,88
s_waitcnt lgkmcnt(2)
TR v,36,34080
M a,64,v,48,v,80
TR v,38,34592
v_lshrrev_b32 v9, 14, s95
M a,68,v,48,v,84
TR v,40,34112
v_add_lshl_u32 v8, v8, v9, 7
M a,72,v,48,v,88
TR v,42,34624
v_mov_b32 v9, 0
M a,80,v,52,v,80
TR v,44,34144
AD 16,16,112
M a,84,v,52,v,84
TR v,46,34656
M a,88,v,52,v,88
s_getpc_b64 s[100:101]
s_add_u32 s100, s100, L_c1B-.
s_addc_u32 s101, s101, 0
M a,96,v,56,v,80
TR v,48,34176
v_lshl_add_u64 v[8:9], v[8:9], 0, s[100:101]
M a,100,v,56,v,84
global_load_dword v10, v[8:9], off
M a,104,v,56,v,88
EX 116
M a,112,v,60,v,80
TR v,50,34688
AD 17,17,116
M a,116,v,60,v,84
EX 120
M a,120,v,60,v,88
s_waitcnt lgkmcnt(2)
TR v,52,34208
M a,128,v,32,v,80
DN 4,12,2,1056
M a,132,v,32,v,84
TR v,54,34720
AD 18,18,120
M a,136,v,32,v,88
EX 113
M a,144,v,36,v,80
TR v,56,34240
AD 16,16,113
M a,148,v,36,v,84
TR v,58,34752
M a,152,v,36,v,88
TR v,60,34272
M a,160,v,40,v,80
TR v,62,34784
M a,164,v,40,v,84
EX 117
M a,168,v,40,v,88
EX 121
M a,176,v,44,v,80
EX 114
M a,180,v,44,v,84
EX 118
M a,184,v,44,v,88
s_waitcnt lgkmcnt(0)
s_waitcnt vmcnt(15)
M a,192,v,48,v,80
s_barrier
RD v,32,1,50688
M a,196,v,48,v,84
RD v,36,1,50752
AD 17,17,117
M a,200,v,48,v,88
RD v,40,1,50816
AD 18,18,121
M a,208,v,52,v,80
RD v,44,1,50880
AD 16,16,114
M a,212,v,52,v,84
DN 4,16,2,2112
M a,216,v,52,v,88
EX 122
M a,224,v,56,v,80
EX 115
M a,228,v,56,v,84
EX 119
M a,232,v,56,v,88
EX 123
M a,240,v,60,v,80
AD 17,17,118
AD 18,18,122
M a,244,v,60,v,84
AD 16,16,115
AD 17,17,119
M a,248,v,60,v,88
AD 18,18,123
v_max3_f32 v20, v16, v17, v18
v_cmp_lt_f32 vcc, 0x4b800000, v20
s_waitcnt lgkmcnt(0)
CV 80,96
CV 81,98
s_cbranch_vccnz L_rsB4
L_rbB4:
MC 96,v,32,128,64
CV 84,100
CV 85,102
M v,96,v,36,v,144
RD v,48,1,50944
CV 88,104
M v,96,v,40,v,160
RD v,52,1,51008
CV 89,106
M v,96,v,44,v,176
RD v,56,1,51072
CV 82,112
MC 100,v,32,132,68
RD v,60,1,51136
CV 83,114
M v,100,v,36,v,148
DN 4,20,2,3168
M v,100,v,40,v,164
s_add_u32 m0, s92, 81920
s_mov_b32 s2, 114688
M v,100,v,44,v,180
CV 86,116
CV 87,118
MC 104,v,32,136,72
RD v,32,1,51200
CV 90,120
M v,104,v,36,v,152
RD v,36,1,51264
CV 91,122
M v,104,v,40,v,168
RD v,40,1,51328
AD 12,12,16
M v,104,v,44,v,184
s_waitcnt lgkmcnt(3)
RD v,44,1,51392
M v,96,v,48,v,192
AD 13,13,17
AD 14,14,18
M v,96,v,52,v,208
DN 4,24,2,0
M v,96,v,56,v,224
M v,96,v,60,v,240
v_xor_b32 v2, 81920, v2
M v,100,v,48,v,196
M v,100,v,52,v,212
M v,100,v,56,v,228
M v,100,v,60,v,244
M v,104,v,48,v,200
RD v,48,1,51456
M v,104,v,52,v,216
EX 96
M v,104,v,56,v,232
EX 97
M v,104,v,60,v,248
s_waitcnt lgkmcnt(1)
RD v,52,1,51520
MC 112,v,32,128,64
RD v,56,1,51584
AD 16,96,97
M v,112,v,36,v,144
EX 100
M v,112,v,40,v,160
EX 101
M v,112,v,44,v,176
RD v,60,1,51648
AD 17,100,101
MC 116,v,32,132,68
DN 4,28,2,1056
M v,116,v,36,v,148
EX 104
M v,116,v,40,v,164
EX 105
M v,116,v,44,v,180
EX 98
MC 120,v,32,136,72
EX 102
M v,120,v,36,v,152
EX 106
M v,120,v,40,v,168
AD 18,104,105
AD 16,16,98
M v,120,v,44,v,184
s_waitcnt lgkmcnt(0)
s_waitcnt vmcnt(15)
M v,112,v,48,v,192
s_barrier
TR v,32,0
M v,112,v,52,v,208
TR v,34,512
AD 17,17,102
M v,112,v,56,v,224
TR v,36,32
AD 18,18,106
M v,112,v,60,v,240
TR v,38,544
M v,116,v,48,v,196
TR v,40,64
M v,116,v,52,v,212
TR v,42,576
M v,116,v,56,v,228
TR v,44,96
TR v,46,608
M v,116,v,60,v,244
DN 4,32,2,2112
M v,120,v,48,v,200
EX 99
M v,120,v,52,v,216
TR v,48,128
AD 16,16,99
M v,120,v,56,v,232
EX 103
M v,120,v,60,v,248
s_waitcnt lgkmcnt(1)
TR v,50,640
M a,0,v,32,v,80
TR v,52,160
AD 17,17,103
M a,4,v,32,v,84
EX 107
M a,8,v,32,v,88
TR v,54,672
AD 18,18,107
M a,16,v,36,v,80
TR v,56,192
M a,20,v,36,v,84
TR v,58,704
M a,24,v,36,v,88
TR v,60,224
M a,32,v,40,v,80
TR v,62,736
M a,36,v,40,v,84
DN 4,36,2,3168
M a,40,v,40,v,88
TR v,32,256
s_add_u32 m0, s92, 98816
M a,48,v,44,v,80
TR v,34,768
s_mov_b32 s2, 147456
M a,52,v,44,v,84
EX 112
M a,56,v,44,v,88
s_waitcnt lgkmcnt(2)
TR v,36,288
M a,64,v,48,v,80
TR v,38,800
AD 16,16,112
M a,68,v,48,v,84
EX 116
M a,72,v,48,v,88
TR v,40,320
AD 17,17,116
M a,80,v,52,v,80
TR v,42,832
v_xor_b32 v1, 81920, v1
M a,84,v,52,v,84
TR v,44,352
M a,88,v,52,v,88
TR v,46,864
M a,96,v,56,v,80
EX 120
M a,100,v,56,v,84
DN 4,8,2,0
M a,104,v,56,v,88
TR v,48,384
AD 18,18,120
M a,112,v,60,v,80
EX 113
M a,116,v,60,v,84
TR v,50,896
AD 16,16,113
M a,120,v,60,v,88
s_waitcnt lgkmcnt(2)
TR v,52,416
M a,128,v,32,v,80
EX 117
M a,132,v,32,v,84
TR v,54,928
AD 17,17,117
M a,136,v,32,v,88
EX 121
M a,144,v,36,v,80
TR v,56,448
AD 18,18,121
M a,148,v,36,v,84
TR v,58,960
M a,152,v,36,v,88
TR v,60,480
M a,160,v,40,v,80
TR v,62,992
M a,164,v,40,v,84
EX 114
M a,168,v,40,v,88
EX 118
M a,176,v,44,v,80
DN 4,12,2,1056
M a,180,v,44,v,84
EX 122
M a,184,v,44,v,88
s_waitcnt lgkmcnt(0)
s_waitcnt vmcnt(15)
M a,192,v,48,v,80
s_barrier
RD v,32,1,16896
M a,196,v,48,v,84
RD v,36,1,16960
AD 16,16,114
M a,200,v,48,v,88
RD v,40,1,17024
AD 17,17,118
M a,208,v,52,v,80
RD v,44,1,17088
AD 18,18,122
M a,212,v,52,v,84
EX 115
M a,216,v,52,v,88
EX 119
M a,224,v,56,v,80
EX 123
M a,228,v,56,v,84
AD 16,16,115
AD 17,17,119
M a,232,v,56,v,88
RD v,48,1,17152
AD 18,18,123
M a,240,v,60,v,80
v_max3_f32 v20, v16, v17, v18
v_cmp_lt_f32 vcc, 0x4b800000, v20
M a,244,v,60,v,84
s_waitcnt lgkmcnt(1)
CV 80,96
M a,248,v,60,v,88
CV 81,98
CV 84,100
s_cbranch_vccnz L_rsB5
L_rbB5:
MC 96,v,32,128,64
DN 4,16,2,2112
M v,96,v,36,v,144
RD v,52,1,17216
CV 85,102
M v,96,v,40,v,160
RD v,56,1,17280
CV 88,104
M v,96,v,44,v,176
RD v,60,1,17344
CV 89,106
MC 100,v,32,132,68
CV 82,112
CV 83,114
M v,100,v,36,v,148
CV 86,116
CV 87,118
M v,100,v,40,v,164
CV 90,120
CV 91,122
M v,100,v,44,v,180
AD 12,12,16
AD 13,13,17
MC 104,v,32,136,72
RD v,32,1,17408
AD 14,14,18
M v,104,v,36,v,152
RD v,36,1,17472
M v,104,v,40,v,168
RD v,40,1,17536
M v,104,v,44,v,184
s_waitcnt lgkmcnt(3)
RD v,44,1,17600
M v,96,v,48,v,192
DN 4,20,2,3168
M v,96,v,52,v,208
s_add_u32 m0, s92, 115712
s_mov_b32 s2, 131072
M v,96,v,56,v,224
M v,96,v,60,v,240
M v,100,v,48,v,196
M v,100,v,52,v,212
M v,100,v,56,v,228
M v,100,v,60,v,244
M v,104,v,48,v,200
RD v,48,1,17664
M v,104,v,52,v,216
RD v,52,1,17728
M v,104,v,56,v,232
EX 96
M v,104,v,60,v,248
s_waitcnt lgkmcnt(2)
RD v,56,1,17792
MC 112,v,32,128,64
EX 97
M v,112,v,36,v,144
RD v,60,1,17856
AD 16,96,97
M v,112,v,40,v,160
DN 4,24,2,0
M v,112,v,44,v,176
EX 100
MC 116,v,32,132,68
EX 101
M v,116,v,36,v,148
EX 104
M v,116,v,40,v,164
EX 105
M v,116,v,44,v,180
EX 98
MC 120,v,32,136,72
EX 102
M v,120,v,36,v,152
EX 106
M v,120,v,40,v,168
AD 17,100,101
AD 18,104,105
M v,120,v,44,v,184
s_waitcnt lgkmcnt(0)
s_waitcnt vmcnt(14)
M v,112,v,48,v,192
s_mov_b64 exec, 0
s_branch L_pad7
L_ret7:
s_branch L_pad8
L_ret8:
s_mov_b64 exec, -1
s_barrier
TR v,32,33792
M v,112,v,52,v,208
TR v,34,34304
AD 16,16,98
M v,112,v,56,v,224
TR v,36,33824
AD 17,17,102
M v,112,v,60,v,240
TR v,38,34336
AD 18,18,106
M v,116,v,48,v,196
TR v,40,33856
M v,116,v,52,v,212
TR v,42,34368
M v,116,v,56,v,228
TR v,44,33888
TR v,46,34400
M v,116,v,60,v,244
DN 4,28,2,1056
M v,120,v,48,v,200
EX 99
M v,120,v,52,v,216
TR v,48,33920
AD 16,16,99
M v,120,v,56,v,232
EX 103
M v,120,v,60,v,248
s_waitcnt lgkmcnt(1)
TR v,50,34432
M a,0,v,32,v,80
TR v,52,33952
AD 17,17,103
M a,4,v,32,v,84
EX 107
M a,8,v,32,v,88
TR v,54,34464
AD 18,18,107
M a,16,v,36,v,80
TR v,56,33984
M a,20,v,36,v,84
TR v,58,34496
M a,24,v,36,v,88
TR v,60,34016
M a,32,v,40,v,80
TR v,62,34528
M a,36,v,40,v,84
DN 4,32,2,2112
M a,40,v,40,v,88
EX 112
M a,48,v,44,v,80
TR v,32,34048
AD 16,16,112
M a,52,v,44,v,84
EX 116
M a,56,v,44,v,88
s_waitcnt lgkmcnt(1)
TR v,34,34560
M a,64,v,48,v,80
TR v,36,34080
AD 17,17,116
M a,68,v,48,v,84
EX 120
M a,72,v,48,v,88
TR v,38,34592
AD 18,18,120
M a,80,v,52,v,80
TR v,40,34112
M a,84,v,52,v,84
TR v,42,34624
M a,88,v,52,v,88
TR v,44,34144
M a,96,v,56,v,80
TR v,46,34656
M a,100,v,56,v,84
DN 4,36,2,3168
M a,104,v,56,v,88
TR v,48,34176
s_add_u32 m0, s92, 132608
M a,112,v,60,v,80
TR v,50,34688
s_mov_b32 s2, 163840
M a,116,v,60,v,84
EX 113
M a,120,v,60,v,88
s_waitcnt lgkmcnt(2)
TR v,52,34208
M a,128,v,32,v,80
TR v,54,34720
AD 16,16,113
M a,132,v,32,v,84
EX 117
M a,136,v,32,v,88
TR v,56,34240
AD 17,17,117
M a,144,v,36,v,80
TR v,58,34752
M a,148,v,36,v,84
TR v,60,34272
M a,152,v,36,v,88
TR v,62,34784
M a,160,v,40,v,80
EX 121
M a,164,v,40,v,84
DN 4,8,2,0
M a,168,v,40,v,88
EX 114
M a,176,v,44,v,80
EX 118
M a,180,v,44,v,84
EX 122
M a,184,v,44,v,88
s_waitcnt lgkmcnt(0)
s_waitcnt vmcnt(13)
M a,192,v,48,v,80
s_barrier
RD v,32,1,50688
M a,196,v,48,v,84
RD v,36,1,50752
AD 18,18,121
M a,200,v,48,v,88
RD v,40,1,50816
AD 16,16,114
M a,208,v,52,v,80
RD v,44,1,50880
AD 17,17,118
M a,212,v,52,v,84
EX 115
M a,216,v,52,v,88
EX 119
M a,224,v,56,v,80
EX 123
M a,228,v,56,v,84
AD 18,18,122
AD 16,16,115
M a,232,v,56,v,88
AD 17,17,119
AD 18,18,123
M a,240,v,60,v,80
v_max3_f32 v20, v16, v17, v18
v_cmp_lt_f32 vcc, 0x4b800000, v20
M a,244,v,60,v,84
s_waitcnt lgkmcnt(0)
CV 80,96
M a,248,v,60,v,88
CV 81,98
CV 84,100
s_cbranch_vccnz L_rsB6
L_rbB6:
MC 96,v,32,128,64
DN 4,12,2,1056
M v,96,v,36,v,144
RD v,48,1,50944
CV 85,102
M v,96,v,40,v,160
RD v,52,1,51008
CV 88,104
M v,96,v,44,v,176
RD v,56,1,51072
CV 89,106
MC 100,v,32,132,68
RD v,60,1,51136
CV 82,112
M v,100,v,36,v,148
CV 83,114
CV 86,116
M v,100,v,40,v,164
s_branch L_c1B
L_rsB0:
s_mov_b32 s100, 16384
s_call_b64 s[98:99], L_rareB
s_branch L_rbB0
L_rsB1:
s_mov_b32 s100, 32768
s_call_b64 s[98:99], L_rareB
s_branch L_rbB1
L_rsB2:
s_mov_b32 s100, 49152
s_call_b64 s[98:99], L_rareB
s_branch L_rbB2
L_rsB3:
s_mov_b32 s100, 65536
s_call_b64 s[98:99], L_rareB
s_branch L_rbB3
L_rsB4:
s_mov_b32 s100, 81920
s_call_b64 s[98:99], L_rareB
s_branch L_rbB4
L_rsB5:
s_mov_b32 s100, 98304
s_call_b64 s[98:99], L_rareB
s_branch L_rbB5
L_rsB6:
s_mov_b32 s100, 114688
s_call_b64 s[98:99], L_rareB
s_branch L_rbB6
.p2align 12
L_c1A:
L_pad8:
s_cbranch_execz L_ret8
M v,104,a,232,v,168
M v,104,a,236,v,184
MC 108,a,224,140,76
RD a,224,1,51200
M v,108,a,228,v,156
RD a,228,1,51264
M v,108,a,232,v,172
DN 4,16,2,2112
M v,108,a,236,v,188
s_waitcnt lgkmcnt(2)
RD a,232,1,51328
M v,96,a,240,v,192
RD a,236,1,51392
M v,96,a,244,v,208
M v,96,a,248,v,224
M v,96,a,252,v,240
M v,100,a,240,v,196
v_xor_b32 v2, 81920, v2
M v,100,a,244,v,212
M v,100,a,248,v,228
M v,100,a,252,v,244
M v,104,a,240,v,200
M v,104,a,244,v,216
M v,104,a,248,v,232
EX 96
M v,104,a,252,v,248
EX 97
M v,108,a,240,v,204
RD a,240,1,51456
AD 16,96,97
M v,108,a,244,v,220
EX 100
M v,108,a,248,v,236
EX 101
M v,108,a,252,v,252
s_waitcnt lgkmcnt(1)
RD a,244,1,51520
MC 112,a,224,128,64
DN 4,20,2,3168
M v,112,a,228,v,144
RD a,248,1,51584
s_add_u32 m0, s92, 0
M v,112,a,232,v,160
RD a,252,1,51648
s_mov_b32 s2, 147456
M v,112,a,236,v,176
EX 104
MC 116,a,224,132,68
EX 105
M v,116,a,228,v,148
EX 98
M v,116,a,232,v,164
EX 102
M v,116,a,236,v,180
EX 106
MC 120,a,224,136,72
EX 108
M v,120,a,228,v,152
EX 109
M v,120,a,232,v,168
AD 17,100,101
AD 18,104,105
M v,120,a,236,v,184
EX 99
MC 124,a,224,140,76
EX 103
M v,124,a,228,v,156
EX 107
M v,124,a,232,v,172
EX 110
M v,124,a,236,v,188
s_waitcnt lgkmcnt(0)
s_waitcnt vmcnt(12)
M v,112,a,240,v,192
s_barrier
TR a,224,0
M v,112,a,244,v,208
TR a,226,512
AD 16,16,98
M v,112,a,248,v,224
DN 4,24,2,0
M v,112,a,252,v,240
TR a,228,32
AD 17,17,102
M v,116,a,240,v,196
TR a,230,544
AD 18,18,106
M v,116,a,244,v,212
TR a,232,64
AD 19,108,109
M v,116,a,248,v,228
TR a,234,576
AD 16,16,99
M v,116,a,252,v,244
TR a,236,96
AD 17,17,103
M v,120,a,240,v,200
TR a,238,608
AD 18,18,107
M v,120,a,244,v,216
EX 111
M v,120,a,248,v,232
EX 112
M v,120,a,252,v,248
EX 116
M v,124,a,240,v,204
TR a,240,128
AD 19,19,110
M v,124,a,244,v,220
TR a,242,640
AD 19,19,111
M v,124,a,248,v,236
TR a,244,160
AD 16,16,112
M v,124,a,252,v,252
s_waitcnt lgkmcnt(3)
TR a,246,672
M a,0,a,224,v,80
TR a,248,192
AD 17,17,116
M a,4,a,224,v,84
EX 120
M a,8,a,224,v,88
TR a,250,704
AD 18,18,120
M a,12,a,224,v,92
EX 113
M a,16,a,228,v,80
TR a,252,224
AD 16,16,113
M a,20,a,228,v,84
DN 4,28,2,1056
M a,24,a,228,v,88
EX 117
M a,28,a,228,v,92
TR a,254,736
AD 17,17,117
M a,32,a,232,v,80
EX 121
M a,36,a,232,v,84
TR a,224,256
AD 18,18,121
M a,40,a,232,v,88
EX 124
M a,44,a,232,v,92
TR a,226,768
AD 19,19,124
M a,48,a,236,v,80
EX 114
M a,52,a,236,v,84
TR a,228,288
AD 16,16,114
M a,56,a,236,v,88
EX 118
M a,60,a,236,v,92
s_waitcnt lgkmcnt(3)
TR a,230,800
M a,64,a,240,v,80
TR a,232,320
AD 17,17,118
M a,68,a,240,v,84
EX 122
M a,72,a,240,v,88
TR a,234,832
AD 18,18,122
M a,76,a,240,v,92
EX 125
M a,80,a,244,v,80
TR a,236,352
v_xor_b32 v1, 81920, v1
M a,84,a,244,v,84
TR a,238,864
AD 19,19,125
M a,88,a,244,v,88
DN 4,32,2,2112
M a,92,a,244,v,92
EX 115
M a,96,a,248,v,80
TR a,240,384
AD 16,16,115
M a,100,a,248,v,84
EX 119
M a,104,a,248,v,88
TR a,242,896
AD 17,17,119
M a,108,a,248,v,92
EX 123
M a,112,a,252,v,80
TR a,244,416
AD 18,18,123
M a,116,a,252,v,84
TR a,246,928
v_max3_f32 v20, v16, v17, v18
M a,120,a,252,v,88
EX 126
M a,124,a,252,v,92
s_waitcnt lgkmcnt(4)
TR a,248,448
M a,128,a,224,v,80
TR a,250,960
AD 19,19,126
M a,132,a,224,v,84
EX 127
M a,136,a,224,v,88
TR a,252,480
AD 19,19,127
M a,140,a,224,v,92
TR a,254,992
v_max_f32 v20, v20, v19
M a,144,a,228,v,80
v_cmp_lt_f32 vcc, 0x4b800000, v20
M a,148,a,228,v,84
M a,152,a,228,v,88
M a,156,a,228,v,92
M a,160,a,232,v,80
DN 4,36,2,3168
M a,164,a,232,v,84
s_add_u32 m0, s92, 16896
s_mov_b32 s2, 180224
M a,168,a,232,v,88
M a,172,a,232,v,92
M a,176,a,236,v,80
M a,180,a,236,v,84
M a,184,a,236,v,88
M a,188,a,236,v,92
s_waitcnt lgkmcnt(0)
s_waitcnt vmcnt(12)
M a,192,a,240,v,80
s_barrier
RD a,224,1,16896
M a,196,a,240,v,84
RD a,228,1,16960
M a,200,a,240,v,88
RD a,232,1,17024
M a,204,a,240,v,92
RD a,236,1,17088
M a,208,a,244,v,80
RD a,240,1,17152
M a,212,a,244,v,84
M a,216,a,244,v,88
M a,220,a,244,v,92
RD a,244,1,17216
M v,32,a,248,v,80
M v,36,a,248,v,84
M v,40,a,248,v,88
DN 4,8,2,0
M v,44,a,248,v,92
RD a,248,1,17280
M v,48,a,252,v,80
CV 80,96
CV 81,98
M v,52,a,252,v,84
CV 84,100
CV 85,102
M v,56,a,252,v,88
s_waitcnt lgkmcnt(3)
CV 88,104
M v,60,a,252,v,92
s_cbranch_vccnz L_rsA7
L_rbA7:
MC 96,a,224,128,64
RD a,252,1,17344
CV 89,106
M v,96,a,228,v,144
CV 92,108
CV 93,110
M v,96,a,232,v,160
CV 82,112
CV 83,114
M v,96,a,236,v,176
CV 86,116
CV 87,118
MC 100,a,224,132,68
CV 90,120
CV 91,122
M v,100,a,228,v,148
CV 94,124
CV 95,126
M v,100,a,232,v,164
AD 12,12,16
AD 13,13,17
M v,100,a,236,v,180
AD 14,14,18
AD 15,15,19
MC 104,a,224,136,72
M v,104,a,228,v,152
M v,104,a,232,v,168
M v,104,a,236,v,184
MC 108,a,224,140,76
DN 4,12,2,1056
M v,108,a,228,v,156
RD a,224,1,17408
M v,108,a,232,v,172
RD a,228,1,17472
M v,108,a,236,v,188
s_waitcnt lgkmcnt(2)
RD a,232,1,17536
M v,96,a,240,v,192
RD a,236,1,17600
M v,96,a,244,v,208
M v,96,a,248,v,224
M v,96,a,252,v,240
M v,100,a,240,v,196
M v,100,a,244,v,212
M v,100,a,248,v,228
M v,100,a,252,v,244
M v,104,a,240,v,200
M v,104,a,244,v,216
M v,104,a,248,v,232
M v,104,a,252,v,248
EX 96
M v,108,a,240,v,204
EX 97
M v,108,a,244,v,220
RD a,240,1,17664
AD 16,96,97
M v,108,a,248,v,236
DN 4,16,2,2112
M v,108,a,252,v,252
s_waitcnt lgkmcnt(1)
RD a,244,1,17728
MC 112,a,224,128,64
EX 100
M v,112,a,228,v,144
EX 101
M v,112,a,232,v,160
RD a,248,1,17792
AD 17,100,101
M v,112,a,236,v,176
EX 104
MC 116,a,224,132,68
EX 105
M v,116,a,228,v,148
RD a,252,1,17856
AD 18,104,105
M v,116,a,232,v,164
EX 98
M v,116,a,236,v,180
EX 102
MC 120,a,224,136,72
EX 106
M v,120,a,228,v,152
EX 108
M v,120,a,232,v,168
EX 109
M v,120,a,236,v,184
EX 99
MC 124,a,224,140,76
EX 103
M v,124,a,228,v,156
EX 107
M v,124,a,232,v,172
EX 110
M v,124,a,236,v,188
s_waitcnt lgkmcnt(0)
s_waitcnt vmcnt(11)
M v,112,a,240,v,192
s_barrier
TR a,224,33792
M v,112,a,244,v,208
DN 4,20,2,3168
M v,112,a,248,v,224
TR a,226,34304
s_add_u32 m0, s92, 33792
M v,112,a,252,v,240
TR a,228,33824
s_mov_b32 s2, 163840
M v,116,a,240,v,196
TR a,230,34336
AD 16,16,98
M v,116,a,244,v,212
TR a,232,33856
AD 17,17,102
M v,116,a,248,v,228
TR a,234,34368
AD 18,18,106
M v,116,a,252,v,244
TR a,236,33888
AD 19,108,109
M v,120,a,240,v,200
TR a,238,34400
AD 16,16,99
M v,120,a,244,v,216
EX 111
M v,120,a,248,v,232
EX 112
M v,120,a,252,v,248
EX 116
M v,124,a,240,v,204
TR a,240,33920
AD 17,17,103
M v,124,a,244,v,220
TR a,242,34432
AD 18,18,107
M v,124,a,248,v,236
TR a,244,33952
AD 19,19,110
M v,124,a,252,v,252
s_waitcnt lgkmcnt(3)
TR a,246,34464
M a,0,a,224,v,80
TR a,248,33984
AD 19,19,111
M a,4,a,224,v,84
TR a,250,34496
AD 16,16,112
M a,8,a,224,v,88
DN 4,24,2,0
M a,12,a,224,v,92
TR a,252,34016
AD 17,17,116
M a,16,a,228,v,80
EX 120
M a,20,a,228,v,84
TR a,254,34528
AD 18,18,120
M a,24,a,228,v,88
EX 113
M a,28,a,228,v,92
TR a,224,34048
AD 16,16,113
M a,32,a,232,v,80
EX 117
M a,36,a,232,v,84
TR a,226,34560
AD 17,17,117
M a,40,a,232,v,88
EX 121
M a,44,a,232,v,92
TR a,228,34080
AD 18,18,121
M a,48,a,236,v,80
EX 124
M a,52,a,236,v,84
TR a,230,34592
AD 19,19,124
M a,56,a,236,v,88
EX 114
M a,60,a,236,v,92
s_waitcnt lgkmcnt(4)
TR a,232,34112
M a,64,a,240,v,80
TR a,234,34624
AD 16,16,114
M a,68,a,240,v,84
EX 118
M a,72,a,240,v,88
TR a,236,34144
AD 17,17,118
M a,76,a,240,v,92
EX 122
M a,80,a,244,v,80
TR a,238,34656
AD 18,18,122
M a,84,a,244,v,84
DN 4,28,2,1056
M a,88,a,244,v,88
EX 125
M a,92,a,244,v,92
TR a,240,34176
AD 19,19,125
M a,96,a,248,v,80
EX 115
M a,100,a,248,v,84
TR a,242,34688
AD 16,16,115
M a,104,a,248,v,88
EX 119
M a,108,a,248,v,92
TR a,244,34208
AD 17,17,119
M a,112,a,252,v,80
EX 123
M a,116,a,252,v,84
TR a,246,34720
AD 18,18,123
M a,120,a,252,v,88
TR a,248,34240
v_max3_f32 v20, v16, v17, v18
M a,124,a,252,v,92
s_waitcnt lgkmcnt(5)
TR a,250,34752
M a,128,a,224,v,80
EX 126
M a,132,a,224,v,84
TR a,252,34272
AD 19,19,126
M a,136,a,224,v,88
EX 127
M a,140,a,224,v,92
TR a,254,34784
AD 19,19,127
M a,144,a,228,v,80
v_max_f32 v20, v20, v19
v_cmp_lt_f32 vcc, 0x4b800000, v20
M a,148,a,228,v,84
M a,152,a,228,v,88
DN 4,32,2,2112
M a,156,a,228,v,92
M a,160,a,232,v,80
M a,164,a,232,v,84
M a,168,a,232,v,88
M a,172,a,232,v,92
M a,176,a,236,v,80
M a,180,a,236,v,84
M a,184,a,236,v,88
M a,188,a,236,v,92
s_waitcnt lgkmcnt(0)
s_waitcnt vmcnt(11)
M a,192,a,240,v,80
s_barrier
RD a,224,1,50688
M a,196,a,240,v,84
RD a,228,1,50752
M a,200,a,240,v,88
RD a,232,1,50816
M a,204,a,240,v,92
RD a,236,1,50880
M a,208,a,244,v,80
RD a,240,1,50944
M a,212,a,244,v,84
M a,216,a,244,v,88
M a,220,a,244,v,92
RD a,244,1,51008
M v,32,a,248,v,80
DN 4,36,2,3168
M v,36,a,248,v,84
s_add_u32 m0, s92, 50688
s_mov_b32 s2, 196608
M v,40,a,248,v,88
M v,44,a,248,v,92
RD a,248,1,51072
M v,48,a,252,v,80
CV 80,96
CV 81,98
M v,52,a,252,v,84
CV 84,100
CV 85,102
M v,56,a,252,v,88
s_waitcnt lgkmcnt(3)
CV 88,104
M v,60,a,252,v,92
s_cbranch_vccnz L_rsA8
L_rbA8:
MC 96,a,224,128,64
RD a,252,1,51136
CV 89,106
M v,96,a,228,v,144
CV 92,108
CV 93,110
M v,96,a,232,v,160
CV 82,112
CV 83,114
M v,96,a,236,v,176
CV 86,116
CV 87,118
MC 100,a,224,132,68
CV 90,120
CV 91,122
M v,100,a,228,v,148
CV 94,124
CV 95,126
M v,100,a,232,v,164
AD 12,12,16
AD 13,13,17
M v,100,a,236,v,180
AD 14,14,18
AD 15,15,19
MC 104,a,224,136,72
M v,104,a,228,v,152
M v,104,a,232,v,168
DN 4,8,2,0
M v,104,a,236,v,184
MC 108,a,224,140,76
RD a,224,1,51200
M v,108,a,228,v,156
RD a,228,1,51264
M v,108,a,232,v,172
RD a,232,1,51328
M v,108,a,236,v,188
s_waitcnt lgkmcnt(3)
RD a,236,1,51392
M v,96,a,240,v,192
M v,96,a,244,v,208
M v,96,a,248,v,224
M v,96,a,252,v,240
M v,100,a,240,v,196
v_xor_b32 v2, 81920, v2
M v,100,a,244,v,212
M v,100,a,248,v,228
M v,100,a,252,v,244
M v,104,a,240,v,200
M v,104,a,244,v,216
L_pad9:
s_cbranch_execz L_ret9
M v,104,a,248,v,232
EX 96
M v,104,a,252,v,248
EX 97
M v,108,a,240,v,204
DN 4,12,2,1056
M v,108,a,244,v,220
RD a,240,1,51456
AD 16,96,97
M v,108,a,248,v,236
EX 100
M v,108,a,252,v,252
s_waitcnt lgkmcnt(1)
RD a,244,1,51520
MC 112,a,224,128,64
EX 101
M v,112,a,228,v,144
RD a,248,1,51584
AD 17,100,101
M v,112,a,232,v,160
EX 104
M v,112,a,236,v,176
EX 105
MC 116,a,224,132,68
RD a,252,1,51648
AD 18,104,105
M v,116,a,228,v,148
EX 98
M v,116,a,232,v,164
EX 102
M v,116,a,236,v,180
EX 106
MC 120,a,224,136,72
EX 108
M v,120,a,228,v,152
EX 109
M v,120,a,232,v,168
EX 99
M v,120,a,236,v,184
EX 103
MC 124,a,224,140,76
EX 107
M v,124,a,228,v,156
EX 110
M v,124,a,232,v,172
DN 4,16,2,2112
M v,124,a,236,v,188
s_waitcnt lgkmcnt(0)
s_waitcnt vmcnt(11)
M v,112,a,240,v,192
s_barrier
TR a,224,0
M v,112,a,244,v,208
TR a,226,512
AD 16,16,98
M v,112,a,248,v,224
TR a,228,32
AD 17,17,102
M v,112,a,252,v,240
TR a,230,544
AD 18,18,106
M v,116,a,240,v,196
TR a,232,64
AD 19,108,109
M v,116,a,244,v,212
TR a,234,576
AD 16,16,99
M v,116,a,248,v,228
TR a,236,96
AD 17,17,103
M v,116,a,252,v,244
TR a,238,608
AD 18,18,107
M v,120,a,240,v,200
EX 111
M v,120,a,244,v,216
EX 112
M v,120,a,248,v,232
AD 19,19,110
AD 19,19,111
M v,120,a,252,v,248
EX 116
M v,124,a,240,v,204
TR a,240,128
AD 16,16,112
M v,124,a,244,v,220
TR a,242,640
AD 17,17,116
M v,124,a,248,v,236
EX 120
M v,124,a,252,v,252
s_waitcnt lgkmcnt(2)
TR a,244,160
M a,0,a,224,v,80
DN 4,20,2,3168
M a,4,a,224,v,84
TR a,246,672
s_add_u32 m0, s92, 81920
M a,8,a,224,v,88
TR a,248,192
s_mov_b32 s2, 180224
M a,12,a,224,v,92
TR a,250,704
AD 18,18,120
M a,16,a,228,v,80
EX 113
M a,20,a,228,v,84
TR a,252,224
AD 16,16,113
M a,24,a,228,v,88
EX 117
M a,28,a,228,v,92
TR a,254,736
AD 17,17,117
M a,32,a,232,v,80
EX 121
M a,36,a,232,v,84
TR a,224,256
AD 18,18,121
M a,40,a,232,v,88
EX 124
M a,44,a,232,v,92
TR a,226,768
AD 19,19,124
M a,48,a,236,v,80
EX 114
M a,52,a,236,v,84
TR a,228,288
AD 16,16,114
M a,56,a,236,v,88
EX 118
M a,60,a,236,v,92
s_waitcnt lgkmcnt(3)
TR a,230,800
M a,64,a,240,v,80
TR a,232,320
AD 17,17,118
M a,68,a,240,v,84
EX 122
M a,72,a,240,v,88
DN 4,24,2,0
M a,76,a,240,v,92
TR a,234,832
AD 18,18,122
M a,80,a,244,v,80
TR a,236,352
v_xor_b32 v1, 81920, v1
M a,84,a,244,v,84
EX 125
M a,88,a,244,v,88
TR a,238,864
AD 19,19,125
M a,92,a,244,v,92
EX 115
M a,96,a,248,v,80
TR a,240,384
AD 16,16,115
M a,100,a,248,v,84
EX 119
M a,104,a,248,v,88
TR a,242,896
AD 17,17,119
M a,108,a,248,v,92
EX 123
M a,112,a,252,v,80
TR a,244,416
AD 18,18,123
M a,116,a,252,v,84
TR a,246,928
v_max3_f32 v20, v16, v17, v18
M a,120,a,252,v,88
EX 126
M a,124,a,252,v,92
s_waitcnt lgkmcnt(4)
TR a,248,448
M a,128,a,224,v,80
TR a,250,960
AD 19,19,126
M a,132,a,224,v,84
EX 127
M a,136,a,224,v,88
TR a,252,480
AD 19,19,127
M a,140,a,224,v,92
TR a,254,992
v_max_f32 v20, v20, v19
M a,144,a,228,v,80
DN 4,28,2,1056
M a,148,a,228,v,84
v_cmp_lt_f32 vcc, 0x4b800000, v20
M a,152,a,228,v,88
M a,156,a,228,v,92
M a,160,a,232,v,80
M a,164,a,232,v,84
M a,168,a,232,v,88
M a,172,a,232,v,92
M a,176,a,236,v,80
M a,180,a,236,v,84
M a,184,a,236,v,88
M a,188,a,236,v,92
s_waitcnt lgkmcnt(0)
s_waitcnt vmcnt(10)
M a,192,a,240,v,80
s_barrier
RD a,224,1,16896
M a,196,a,240,v,84
RD a,228,1,16960
M a,200,a,240,v,88
RD a,232,1,17024
M a,204,a,240,v,92
RD a,236,1,17088
M a,208,a,244,v,80
RD a,240,1,17152
M a,212,a,244,v,84
M a,216,a,244,v,88
DN 4,32,2,2112
M a,220,a,244,v,92
RD a,244,1,17216
M v,32,a,248,v,80
M v,36,a,248,v,84
M v,40,a,248,v,88
M v,44,a,248,v,92
RD a,248,1,17280
M v,48,a,252,v,80
CV 80,96
CV 81,98
M v,52,a,252,v,84
CV 84,100
CV 85,102
M v,56,a,252,v,88
s_waitcnt lgkmcnt(3)
CV 88,104
M v,60,a,252,v,92
s_cbranch_vccnz L_rsA9
L_rbA9:
MC 96,a,224,128,64
RD a,252,1,17344
CV 89,106
M v,96,a,228,v,144
CV 92,108
CV 93,110
M v,96,a,232,v,160
CV 82,112
CV 83,114
M v,96,a,236,v,176
CV 86,116
CV 87,118
MC 100,a,224,132,68
CV 90,120
CV 91,122
M v,100,a,228,v,148
CV 94,124
CV 95,126
M v,100,a,232,v,164
AD 12,12,16
AD 13,13,17
M v,100,a,236,v,180
AD 14,14,18
AD 15,15,19
MC 104,a,224,136,72
DN 4,36,2,3168
M v,104,a,228,v,152
s_add_u32 m0, s92, 98816
s_mov_b32 s2, 212992
M v,104,a,232,v,168
M v,104,a,236,v,184
MC 108,a,224,140,76
RD a,224,1,17408
M v,108,a,228,v,156
RD a,228,1,17472
M v,108,a,232,v,172
RD a,232,1,17536
M v,108,a,236,v,188
s_waitcnt lgkmcnt(3)
RD a,236,1,17600
M v,96,a,240,v,192
M v,96,a,244,v,208
M v,96,a,248,v,224
M v,96,a,252,v,240
M v,100,a,240,v,196
M v,100,a,244,v,212
M v,100,a,248,v,228
M v,100,a,252,v,244
M v,104,a,240,v,200
M v,104,a,244,v,216
M v,104,a,248,v,232
DN 4,8,2,0
M v,104,a,252,v,248
EX 96
M v,108,a,240,v,204
EX 97
M v,108,a,244,v,220
RD a,240,1,17664
AD 16,96,97
M v,108,a,248,v,236
EX 100
M v,108,a,252,v,252
s_waitcnt lgkmcnt(1)
RD a,244,1,17728
MC 112,a,224,128,64
EX 101
M v,112,a,228,v,144
RD a,248,1,17792
AD 17,100,101
M v,112,a,232,v,160
EX 104
M v,112,a,236,v,176
EX 105
MC 116,a,224,132,68
RD a,252,1,17856
AD 18,104,105
M v,116,a,228,v,148
EX 98
M v,116,a,232,v,164
EX 102
M v,116,a,236,v,180
EX 106
MC 120,a,224,136,72
EX 108
M v,120,a,228,v,152
EX 109
M v,120,a,232,v,168
EX 99
M v,120,a,236,v,184
EX 103
MC 124,a,224,140,76
DN 4,12,2,1056
M v,124,a,228,v,156
EX 107
M v,124,a,232,v,172
EX 110
M v,124,a,236,v,188
s_waitcnt lgkmcnt(0)
s_waitcnt vmcnt(10)
M v,112,a,240,v,192
s_barrier
TR a,224,33792
M v,112,a,244,v,208
TR a,226,34304
AD 16,16,98
M v,112,a,248,v,224
TR a,228,33824
AD 17,17,102
M v,112,a,252,v,240
TR a,230,34336
AD 18,18,106
M v,116,a,240,v,196
TR a,232,33856
AD 19,108,109
M v,116,a,244,v,212
TR a,234,34368
AD 16,16,99
M v,116,a,248,v,228
TR a,236,33888
AD 17,17,103
M v,116,a,252,v,244
TR a,238,34400
AD 18,18,107
M v,120,a,240,v,200
EX 111
M v,120,a,244,v,216
EX 112
M v,120,a,248,v,232
AD 19,19,110
AD 19,19,111
M v,120,a,252,v,248
EX 116
M v,124,a,240,v,204
TR a,240,33920
AD 16,16,112
M v,124,a,244,v,220
TR a,242,34432
AD 17,17,116
M v,124,a,248,v,236
DN 4,16,2,2112
M v,124,a,252,v,252
s_waitcnt lgkmcnt(2)
TR a,244,33952
M a,0,a,224,v,80
EX 120
M a,4,a,224,v,84
TR a,246,34464
AD 18,18,120
M a,8,a,224,v,88
EX 113
M a,12,a,224,v,92
TR a,248,33984
AD 16,16,113
M a,16,a,228,v,80
EX 117
M a,20,a,228,v,84
TR a,250,34496
AD 17,17,117
M a,24,a,228,v,88
EX 121
M a,28,a,228,v,92
TR a,252,34016
AD 18,18,121
M a,32,a,232,v,80
TR a,254,34528
M a,36,a,232,v,84
EX 124
M a,40,a,232,v,88
TR a,224,34048
AD 19,19,124
M a,44,a,232,v,92
EX 114
M a,48,a,236,v,80
TR a,226,34560
v_bfe_u32 v8, v4, 8, 2
M a,52,a,236,v,84
TR a,228,34080
v_lshrrev_b32 v9, 14, s95
M a,56,a,236,v,88
TR a,230,34592
v_add_lshl_u32 v8, v8, v9, 7
M a,60,a,236,v,92
s_waitcnt lgkmcnt(4)
TR a,232,34112
M a,64,a,240,v,80
DN 4,20,2,3168
M a,68,a,240,v,84
TR a,234,34624
v_add_u32 v8, 4096, v8
M a,72,a,240,v,88
TR a,236,34144
v_mov_b32 v9, 0
M a,76,a,240,v,92
TR a,238,34656
s_add_u32 m0, s92, 115712
M a,80,a,244,v,80
s_getpc_b64 s[100:101]
s_and_b32 s100, s100, 0xfffff000
M a,84,a,244,v,84
v_lshl_add_u64 v[8:9], v[8:9], 0, s[100:101]
s_mov_b32 s2, 196608
M a,88,a,244,v,88
TR a,240,34176
AD 16,16,114
M a,92,a,244,v,92
global_load_dword v10, v[8:9], off
M a,96,a,248,v,80
EX 118
M a,100,a,248,v,84
TR a,242,34688
AD 17,17,118
M a,104,a,248,v,88
EX 122
M a,108,a,248,v,92
TR a,244,34208
AD 18,18,122
M a,112,a,252,v,80
EX 125
M a,116,a,252,v,84
TR a,246,34720
AD 19,19,125
M a,120,a,252,v,88
EX 115
M a,124,a,252,v,92
s_waitcnt lgkmcnt(4)
TR a,248,34240
M a,128,a,224,v,80
TR a,250,34752
AD 16,16,115
M a,132,a,224,v,84
EX 119
M a,136,a,224,v,88
DN 4,24,2,0
M a,140,a,224,v,92
TR a,252,34272
AD 17,17,119
M a,144,a,228,v,80
EX 123
M a,148,a,228,v,84
TR a,254,34784
AD 18,18,123
M a,152,a,228,v,88
EX 126
M a,156,a,228,v,92
EX 127
M a,160,a,232,v,80
AD 19,19,126
AD 19,19,127
M a,164,a,232,v,84
v_max3_f32 v20, v16, v17, v18
v_max_f32 v20, v20, v19
M a,168,a,232,v,88
v_cmp_lt_f32 vcc, 0x4b800000, v20
M a,172,a,232,v,92
M a,176,a,236,v,80
M a,180,a,236,v,84
M a,184,a,236,v,88
M a,188,a,236,v,92
s_waitcnt lgkmcnt(0)
s_waitcnt vmcnt(10)
M a,192,a,240,v,80
s_barrier
RD a,224,1,50688
M a,196,a,240,v,84
RD a,228,1,50752
M a,200,a,240,v,88
RD a,232,1,50816
M a,204,a,240,v,92
RD a,236,1,50880
M a,208,a,244,v,80
DN 4,28,2,1056
M a,212,a,244,v,84
RD a,240,1,50944
M a,216,a,244,v,88
M a,220,a,244,v,92
RD a,244,1,51008
M v,32,a,248,v,80
M v,36,a,248,v,84
M v,40,a,248,v,88
M v,44,a,248,v,92
RD a,248,1,51072
M v,48,a,252,v,80
CV 80,96
CV 81,98
M v,52,a,252,v,84
CV 84,100
CV 85,102
M v,56,a,252,v,88
s_waitcnt lgkmcnt(3)
CV 88,104
M v,60,a,252,v,92
s_cbranch_vccnz L_rsA10
L_rbA10:
MC 96,a,224,128,64
RD a,252,1,51136
CV 89,106
M v,96,a,228,v,144
CV 92,108
CV 93,110
M v,96,a,232,v,160
CV 82,112
CV 83,114
M v,96,a,236,v,176
CV 86,116
CV 87,118
MC 100,a,224,132,68
CV 90,120
CV 91,122
M v,100,a,228,v,148
CV 94,124
CV 95,126
M v,100,a,232,v,164
DN 4,32,2,2112
M v,100,a,236,v,180
AD 12,12,16
AD 13,13,17
MC 104,a,224,136,72
AD 14,14,18
AD 15,15,19
M v,104,a,228,v,152
M v,104,a,232,v,168
M v,104,a,236,v,184
MC 108,a,224,140,76
RD a,224,1,51200
M v,108,a,228,v,156
RD a,228,1,51264
M v,108,a,232,v,172
RD a,232,1,51328
M v,108,a,236,v,188
s_waitcnt lgkmcnt(3)
RD a,236,1,51392
M v,96,a,240,v,192
M v,96,a,244,v,208
M v,96,a,248,v,224
M v,96,a,252,v,240
M v,100,a,240,v,196
v_xor_b32 v2, 81920, v2
M v,100,a,244,v,212
M v,100,a,248,v,228
M v,100,a,252,v,244
M v,104,a,240,v,200
DN 4,36,2,3168
M v,104,a,244,v,216
s_add_u32 m0, s92, 132608
s_mov_b32 s2, 229376
M v,104,a,248,v,232
EX 96
M v,104,a,252,v,248
EX 97
M v,108,a,240,v,204
RD a,240,1,51456
AD 16,96,97
M v,108,a,244,v,220
EX 100
M v,108,a,248,v,236
EX 101
M v,108,a,252,v,252
s_waitcnt lgkmcnt(1)
RD a,244,1,51520
MC 112,a,224,128,64
RD a,248,1,51584
AD 17,100,101
L_pad10:
s_cbranch_execz L_ret10
M v,112,a,228,v,144
EX 104
M v,112,a,232,v,160
EX 105
M v,112,a,236,v,176
RD a,252,1,51648
AD 18,104,105
MC 116,a,224,132,68
EX 98
M v,116,a,228,v,148
EX 102
M v,116,a,232,v,164
EX 106
M v,116,a,236,v,180
EX 108
MC 120,a,224,136,72
EX 109
M v,120,a,228,v,152
EX 99
M v,120,a,232,v,168
DN 4,8,2,0
M v,120,a,236,v,184
EX 103
MC 124,a,224,140,76
EX 107
M v,124,a,228,v,156
EX 110
M v,124,a,232,v,172
AD 16,16,98
AD 17,17,102
M v,124,a,236,v,188
s_waitcnt lgkmcnt(0)
s_waitcnt vmcnt(10)
M v,112,a,240,v,192
s_barrier
TR a,224,0
M v,112,a,244,v,208
TR a,226,512
AD 18,18,106
M v,112,a,248,v,224
TR a,228,32
AD 19,108,109
M v,112,a,252,v,240
TR a,230,544
AD 16,16,99
M v,116,a,240,v,196
TR a,232,64
AD 17,17,103
M v,116,a,244,v,212
TR a,234,576
AD 18,18,107
M v,116,a,248,v,228
TR a,236,96
AD 19,19,110
M v,116,a,252,v,244
TR a,238,608
M v,120,a,240,v,200
EX 111
M v,120,a,244,v,216
EX 112
M v,120,a,248,v,232
EX 113
M v,120,a,252,v,248
EX 116
M v,124,a,240,v,204
DN 4,12,2,1056
M v,124,a,244,v,220
TR a,240,128
AD 19,19,111
M v,124,a,248,v,236
TR a,242,640
AD 16,16,112
M v,124,a,252,v,252
s_waitcnt lgkmcnt(2)
TR a,244,160
M a,0,a,224,v,80
TR a,246,672
AD 17,17,116
M a,4,a,224,v,84
TR a,248,192
AD 16,16,113
M a,8,a,224,v,88
EX 120
M a,12,a,224,v,92
TR a,250,704
AD 18,18,120
M a,16,a,228,v,80
EX 117
M a,20,a,228,v,84
TR a,252,224
AD 17,17,117
M a,24,a,228,v,88
EX 121
M a,28,a,228,v,92
TR a,254,736
AD 18,18,121
M a,32,a,232,v,80
EX 124
M a,36,a,232,v,84
TR a,224,256
AD 19,19,124
M a,40,a,232,v,88
EX 114
M a,44,a,232,v,92
TR a,226,768
AD 16,16,114
M a,48,a,236,v,80
EX 118
M a,52,a,236,v,84
TR a,228,288
AD 17,17,118
M a,56,a,236,v,88
DN 4,16,2,2112
M a,60,a,236,v,92
s_waitcnt lgkmcnt(3)
TR a,230,800
M a,64,a,240,v,80
EX 122
M a,68,a,240,v,84
TR a,232,320
AD 18,18,122
M a,72,a,240,v,88
EX 125
M a,76,a,240,v,92
TR a,234,832
AD 19,19,125
M a,80,a,244,v,80
TR a,236,352
v_xor_b32 v1, 81920, v1
M a,84,a,244,v,84
EX 115
M a,88,a,244,v,88
TR a,238,864
AD 16,16,115
M a,92,a,244,v,92
EX 119
M a,96,a,248,v,80
TR a,240,384
AD 17,17,119
M a,100,a,248,v,84
EX 123
M a,104,a,248,v,88
TR a,242,896
AD 18,18,123
M a,108,a,248,v,92
TR a,244,416
v_max3_f32 v20, v16, v17, v18
M a,112,a,252,v,80
EX 126
M a,116,a,252,v,84
TR a,246,928
AD 19,19,126
M a,120,a,252,v,88
EX 127
M a,124,a,252,v,92
s_waitcnt lgkmcnt(4)
TR a,248,448
M a,128,a,224,v,80
DN 4,20,2,3168
M a,132,a,224,v,84
TR a,250,960
s_add_u32 m0, s92, 0
M a,136,a,224,v,88
TR a,252,480
s_mov_b32 s2, 212992
M a,140,a,224,v,92
TR a,254,992
AD 19,19,127
M a,144,a,228,v,80
v_max_f32 v20, v20, v19
v_cmp_lt_f32 vcc, 0x4b800000, v20
M a,148,a,228,v,84
M a,152,a,228,v,88
M a,156,a,228,v,92
M a,160,a,232,v,80
M a,164,a,232,v,84
M a,168,a,232,v,88
M a,172,a,232,v,92
M a,176,a,236,v,80
M a,180,a,236,v,84
M a,184,a,236,v,88
M a,188,a,236,v,92
s_waitcnt lgkmcnt(0)
s_waitcnt vmcnt(9)
M a,192,a,240,v,80
s_barrier
RD a,224,1,16896
M a,196,a,240,v,84
RD a,228,1,16960
s_xor_b32 s93, s4, 0
M a,200,a,240,v,88
DN 4,24,2,0
M a,204,a,240,v,92
RD a,232,1,17024
s_add_u32 m0, s92, 81920
M a,208,a,244,v,80
RD a,236,1,17088
M a,212,a,244,v,84
RD a,240,1,17152
M a,216,a,244,v,88
M a,220,a,244,v,92
RD a,244,1,17216
M v,32,a,248,v,80
M v,36,a,248,v,84
M v,40,a,248,v,88
M v,44,a,248,v,92
DL 7,56,93,0
M v,48,a,252,v,80
CV 80,96
CV 81,98
M v,52,a,252,v,84
CV 84,100
CV 85,102
M v,56,a,252,v,88
s_waitcnt lgkmcnt(2)
CV 88,104
M v,60,a,252,v,92
s_cbranch_vccnz L_rsA11
L_rbA11:
MC 96,a,224,128,64
CV 89,106
s_add_u32 m0, s92, 0
M v,96,a,228,v,144
RD a,248,1,17280
CV 92,108
M v,96,a,232,v,160
RD a,252,1,17344
CV 93,110
M v,96,a,236,v,176
CV 82,112
CV 83,114
MC 100,a,224,132,68
DN 4,28,2,1056
M v,100,a,228,v,148
s_add_u32 m0, s92, 81920
CV 86,116
M v,100,a,232,v,164
CV 87,118
CV 90,120
M v,100,a,236,v,180
CV 91,122
CV 94,124
MC 104,a,224,136,72
CV 95,126
AD 12,12,16
M v,104,a,228,v,152
AD 13,13,17
AD 14,14,18
M v,104,a,232,v,168
AD 15,15,19
M v,104,a,236,v,184
DL 7,60,93,1056
MC 108,a,224,140,76
RD a,224,1,17408
s_add_u32 m0, s92, 0
M v,108,a,228,v,156
RD a,228,1,17472
M v,108,a,232,v,172
RD a,232,1,17536
M v,108,a,236,v,188
s_waitcnt lgkmcnt(3)
RD a,236,1,17600
M v,96,a,240,v,192
M v,96,a,244,v,208
M v,96,a,248,v,224
M v,96,a,252,v,240
M v,100,a,240,v,196
M v,100,a,244,v,212
M v,100,a,248,v,228
DN 4,32,2,2112
M v,100,a,252,v,244
s_add_u32 m0, s92, 81920
M v,104,a,240,v,200
M v,104,a,244,v,216
EX 96
M v,104,a,248,v,232
EX 97
M v,104,a,252,v,248
DL 7,64,93,2112
M v,108,a,240,v,204
RD a,240,1,17664
s_add_u32 m0, s92, 0
M v,108,a,244,v,220
RD a,244,1,17728
AD 16,96,97
M v,108,a,248,v,236
EX 100
M v,108,a,252,v,252
s_waitcnt lgkmcnt(2)
RD a,248,1,17792
MC 112,a,224,128,64
EX 101
M v,112,a,228,v,144
RD a,252,1,17856
AD 17,100,101
M v,112,a,232,v,160
EX 104
M v,112,a,236,v,176
EX 105
MC 116,a,224,132,68
EX 98
M v,116,a,228,v,148
EX 102
M v,116,a,232,v,164
EX 106
M v,116,a,236,v,180
EX 108
MC 120,a,224,136,72
DN 4,36,2,3168
M v,120,a,228,v,152
s_add_u32 m0, s92, 81920
s_mov_b32 s2, 245760
M v,120,a,232,v,168
EX 109
M v,120,a,236,v,184
AD 18,104,105
AD 16,16,98
MC 124,a,224,140,76
DL 7,68,93,3168
M v,124,a,228,v,156
s_add_u32 m0, s92, 16896
AD 17,17,102
M v,124,a,232,v,172
EX 99
M v,124,a,236,v,188
s_waitcnt lgkmcnt(0)
s_waitcnt vmcnt(12)
M v,112,a,240,v,192
s_barrier
TR a,224,33792
M v,112,a,244,v,208
TR a,226,34304
s_xor_b32 s93, s4, 28672
M v,112,a,248,v,224
TR a,228,33824
AD 18,18,106
M v,112,a,252,v,240
TR a,230,34336
AD 19,108,109
M v,116,a,240,v,196
TR a,232,33856
AD 16,16,99
M v,116,a,244,v,212
EX 103
M v,116,a,248,v,228
TR a,234,34368
AD 17,17,103
M v,116,a,252,v,244
TR a,236,33888
M v,120,a,240,v,200
TR a,238,34400
M v,120,a,244,v,216
EX 107
M v,120,a,248,v,232
DN 4,8,2,0
M v,120,a,252,v,248
s_add_u32 m0, s92, 98816
AD 18,18,107
M v,124,a,240,v,204
EX 110
M v,124,a,244,v,220
TR a,240,33920
AD 19,19,110
M v,124,a,248,v,236
DL 7,56,93,0
M v,124,a,252,v,252
s_waitcnt lgkmcnt(1)
TR a,242,34432
M a,0,a,224,v,80
EX 111
M a,4,a,224,v,84
TR a,244,33952
AD 19,19,111
M a,8,a,224,v,88
EX 112
M a,12,a,224,v,92
TR a,246,34464
AD 16,16,112
M a,16,a,228,v,80
EX 116
M a,20,a,228,v,84
TR a,248,33984
AD 17,17,116
M a,24,a,228,v,88
EX 120
M a,28,a,228,v,92
TR a,250,34496
AD 18,18,120
M a,32,a,232,v,80
TR a,252,34016
M a,36,a,232,v,84
TR a,254,34528
M a,40,a,232,v,88
EX 113
M a,44,a,232,v,92
DL 7,60,93,1056
M a,48,a,236,v,80
s_add_u32 m0, s92, 16896
TR a,224,34048
M a,52,a,236,v,84
TR a,226,34560
AD 16,16,113
M a,56,a,236,v,88
EX 117
M a,60,a,236,v,92
s_waitcnt lgkmcnt(2)
TR a,228,34080
M a,64,a,240,v,80
DN 4,12,2,1056
M a,68,a,240,v,84
TR a,230,34592
s_add_u32 m0, s92, 98816
M a,72,a,240,v,88
TR a,232,34112
AD 17,17,117
M a,76,a,240,v,92
EX 121
M a,80,a,244,v,80
TR a,234,34624
AD 18,18,121
M a,84,a,244,v,84
EX 124
M a,88,a,244,v,88
TR a,236,34144
AD 19,19,124
M a,92,a,244,v,92
TR a,238,34656
M a,96,a,248,v,80
EX 114
M a,100,a,248,v,84
TR a,240,34176
AD 16,16,114
M a,104,a,248,v,88
EX 118
M a,108,a,248,v,92
DL 7,64,93,2112
M a,112,a,252,v,80
s_add_u32 m0, s92, 16896
TR a,242,34688
M a,116,a,252,v,84
TR a,244,34208
AD 17,17,118
M a,120,a,252,v,88
EX 122
M a,124,a,252,v,92
s_waitcnt lgkmcnt(3)
TR a,246,34720
M a,128,a,224,v,80
DN 4,16,2,2112
M a,132,a,224,v,84
TR a,248,34240
s_add_u32 m0, s92, 98816
M a,136,a,224,v,88
TR a,250,34752
AD 18,18,122
M a,140,a,224,v,92
EX 125
M a,144,a,228,v,80
TR a,252,34272
AD 19,19,125
M a,148,a,228,v,84
EX 115
M a,152,a,228,v,88
TR a,254,34784
AD 16,16,115
M a,156,a,228,v,92
EX 119
M a,160,a,232,v,80
EX 123
M a,164,a,232,v,84
EX 126
M a,168,a,232,v,88
EX 127
M a,172,a,232,v,92
DL 7,68,93,3168
M a,176,a,236,v,80
s_add_u32 m0, s92, 16896
AD 17,17,119
M a,180,a,236,v,84
AD 18,18,123
AD 19,19,126
M a,184,a,236,v,88
AD 19,19,127
v_max3_f32 v20, v16, v17, v18
M a,188,a,236,v,92
s_waitcnt lgkmcnt(0)
s_waitcnt vmcnt(15)
M a,192,a,240,v,80
s_barrier
RD a,224,1,50688
M a,196,a,240,v,84
DN 4,20,2,3168
M a,200,a,240,v,88
RD a,228,1,50752
v_max_f32 v20, v20, v19
M a,204,a,240,v,92
RD a,232,1,50816
v_cmp_lt_f32 vcc, 0x4b800000, v20
M a,208,a,244,v,80
RD a,236,1,50880
s_add_u32 m0, s92, 115712
M a,212,a,244,v,84
s_xor_b32 s93, s4, 128
s_mov_b32 s2, 229376
M a,216,a,244,v,88
RD a,240,1,50944
M a,220,a,244,v,92
RD a,244,1,51008
M v,32,a,248,v,80
M v,36,a,248,v,84
M v,40,a,248,v,88
M v,44,a,248,v,92
DL 7,56,93,0
M v,48,a,252,v,80
CV 80,96
CV 81,98
M v,52,a,252,v,84
CV 84,100
CV 85,102
M v,56,a,252,v,88
s_waitcnt lgkmcnt(2)
s_add_u32 m0, s92, 33792
M v,60,a,252,v,92
s_cbranch_vccnz L_rsA12
L_rbA12:
MC 96,a,224,128,64
CV 88,104
CV 89,106
M v,96,a,228,v,144
RD a,248,1,51072
CV 92,108
M v,96,a,232,v,160
DN 4,24,2,0
M v,96,a,236,v,176
RD a,252,1,51136
CV 93,110
MC 100,a,224,132,68
s_add_u32 m0, s92, 115712
CV 82,112
M v,100,a,228,v,148
CV 83,114
CV 86,116
M v,100,a,232,v,164
CV 87,118
CV 90,120
M v,100,a,236,v,180
CV 91,122
CV 94,124
MC 104,a,224,136,72
CV 95,126
AD 12,12,16
M v,104,a,228,v,152
AD 13,13,17
AD 14,14,18
M v,104,a,232,v,168
AD 15,15,19
M v,104,a,236,v,184
DL 7,60,93,1056
MC 108,a,224,140,76
s_add_u32 m0, s92, 33792
RD a,224,1,51200
M v,108,a,228,v,156
RD a,228,1,51264
M v,108,a,232,v,172
RD a,232,1,51328
M v,108,a,236,v,188
s_waitcnt lgkmcnt(3)
RD a,236,1,51392
M v,96,a,240,v,192
M v,96,a,244,v,208
M v,96,a,248,v,224
M v,96,a,252,v,240
M v,100,a,240,v,196
DN 4,28,2,1056
M v,100,a,244,v,212
s_add_u32 m0, s92, 115712
v_xor_b32 v2, 81920, v2
M v,100,a,248,v,228
M v,100,a,252,v,244
M v,104,a,240,v,200
EX 96
M v,104,a,244,v,216
EX 97
M v,104,a,248,v,232
EX 98
M v,104,a,252,v,248
DL 7,64,93,2112
M v,108,a,240,v,204
RD a,240,1,51456
s_add_u32 m0, s92, 33792
M v,108,a,244,v,220
RD a,244,1,51520
AD 16,96,97
L_pad11:
s_cbranch_execz L_ret11
M v,108,a,248,v,236
RD a,248,1,51584
AD 16,16,98
M v,108,a,252,v,252
s_waitcnt lgkmcnt(3)
RD a,252,1,51648
MC 112,a,224,128,64
EX 100
M v,112,a,228,v,144
EX 101
M v,112,a,232,v,160
EX 104
M v,112,a,236,v,176
EX 105
MC 116,a,224,132,68
EX 102
M v,116,a,228,v,148
EX 106
M v,116,a,232,v,164
DN 4,32,2,2112
M v,116,a,236,v,180
s_add_u32 m0, s92, 115712
AD 17,100,101
MC 120,a,224,136,72
EX 108
M v,120,a,228,v,152
EX 109
M v,120,a,232,v,168
AD 18,104,105
AD 17,17,102
M v,120,a,236,v,184
DL 7,68,93,3168
MC 124,a,224,140,76
s_add_u32 m0, s92, 33792
AD 18,18,106
M v,124,a,228,v,156
EX 99
M v,124,a,232,v,172
EX 103
M v,124,a,236,v,188
s_waitcnt lgkmcnt(0)
s_waitcnt vmcnt(16)
M v,112,a,240,v,192
s_barrier
TR a,224,0
M v,112,a,244,v,208
TR a,226,512
s_xor_b32 s93, s4, 28800
M v,112,a,248,v,224
TR a,228,32
AD 19,108,109
M v,112,a,252,v,240
TR a,230,544
AD 16,16,99
M v,116,a,240,v,196
TR a,232,64
AD 17,17,103
M v,116,a,244,v,212
EX 107
M v,116,a,248,v,228
TR a,234,576
AD 18,18,107
M v,116,a,252,v,244
TR a,236,96
M v,120,a,240,v,200
TR a,238,608
M v,120,a,244,v,216
DN 4,36,2,3168
M v,120,a,248,v,232
s_add_u32 m0, s92, 132608
s_mov_b32 s2, 245760
M v,120,a,252,v,248
EX 110
M v,124,a,240,v,204
DL 7,56,93,0
M v,124,a,244,v,220
TR a,240,128
s_add_u32 m0, s92, 50688
M v,124,a,248,v,236
TR a,242,640
AD 19,19,110
M v,124,a,252,v,252
s_waitcnt lgkmcnt(2)
TR a,244,160
M a,0,a,224,v,80
EX 111
M a,4,a,224,v,84
TR a,246,672
AD 19,19,111
M a,8,a,224,v,88
EX 112
M a,12,a,224,v,92
TR a,248,192
AD 16,16,112
M a,16,a,228,v,80
EX 116
M a,20,a,228,v,84
TR a,250,704
AD 17,17,116
M a,24,a,228,v,88
EX 120
M a,28,a,228,v,92
TR a,252,224
AD 18,18,120
M a,32,a,232,v,80
TR a,254,736
M a,36,a,232,v,84
EX 113
M a,40,a,232,v,88
DN 4,24,2,0
M a,44,a,232,v,92
s_add_u32 m0, s92, 132608
TR a,224,256
M a,48,a,236,v,80
TR a,226,768
AD 16,16,113
M a,52,a,236,v,84
EX 117
M a,56,a,236,v,88
DL 7,60,93,1056
M a,60,a,236,v,92
s_waitcnt lgkmcnt(2)
TR a,228,288
M a,64,a,240,v,80
TR a,230,800
AD 17,17,117
M a,68,a,240,v,84
EX 121
M a,72,a,240,v,88
TR a,232,320
AD 18,18,121
M a,76,a,240,v,92
EX 124
M a,80,a,244,v,80
TR a,234,832
v_xor_b32 v1, 81920, v1
M a,84,a,244,v,84
TR a,236,352
AD 19,19,124
M a,88,a,244,v,88
EX 114
M a,92,a,244,v,92
TR a,238,864
AD 16,16,114
M a,96,a,248,v,80
EX 118
M a,100,a,248,v,84
TR a,240,384
AD 17,17,118
M a,104,a,248,v,88
EX 122
M a,108,a,248,v,92
DL 7,64,93,2112
M a,112,a,252,v,80
s_add_u32 m0, s92, 50688
TR a,242,896
M a,116,a,252,v,84
TR a,244,416
AD 18,18,122
M a,120,a,252,v,88
EX 125
M a,124,a,252,v,92
s_waitcnt lgkmcnt(3)
TR a,246,928
M a,128,a,224,v,80
DN 4,28,2,1056
M a,132,a,224,v,84
TR a,248,448
s_add_u32 m0, s92, 132608
M a,136,a,224,v,88
TR a,250,960
AD 19,19,125
M a,140,a,224,v,92
EX 115
M a,144,a,228,v,80
TR a,252,480
AD 16,16,115
M a,148,a,228,v,84
EX 119
M a,152,a,228,v,88
TR a,254,992
AD 17,17,119
M a,156,a,228,v,92
EX 123
M a,160,a,232,v,80
EX 126
M a,164,a,232,v,84
EX 127
M a,168,a,232,v,88
AD 18,18,123
AD 19,19,126
M a,172,a,232,v,92
DL 7,68,93,3168
M a,176,a,236,v,80
s_add_u32 m0, s92, 50688
AD 19,19,127
M a,180,a,236,v,84
v_max3_f32 v20, v16, v17, v18
v_max_f32 v20, v20, v19
M a,184,a,236,v,88
v_cmp_lt_f32 vcc, 0x4b800000, v20
M a,188,a,236,v,92
s_waitcnt lgkmcnt(0)
s_waitcnt vmcnt(14)
M a,192,a,240,v,80
s_barrier
RD a,224,1,16896
M a,196,a,240,v,84
DN 4,32,2,2112
M a,200,a,240,v,88
RD a,228,1,16960
s_add_u32 m0, s92, 0
M a,204,a,240,v,92
RD a,232,1,17024
s_mov_b32 s93, 512
M a,208,a,244,v,80
RD a,236,1,17088
M a,212,a,244,v,84
RD a,240,1,17152
M a,216,a,244,v,88
M a,220,a,244,v,92
RD a,244,1,17216
M v,32,a,248,v,80
M v,36,a,248,v,84
M v,40,a,248,v,88
M v,44,a,248,v,92
DL 5,40,93,0
M v,48,a,252,v,80
CV 80,96
CV 81,98
M v,52,a,252,v,84
CV 84,100
CV 85,102
M v,56,a,252,v,88
s_waitcnt lgkmcnt(2)
s_add_u32 m0, s92, 50688
M v,60,a,252,v,92
s_cbranch_vccnz L_rsA13
L_rbA13:
MC 96,a,224,128,64
DN 4,36,2,3168
M v,96,a,228,v,144
CV 88,104
CV 89,106
M v,96,a,232,v,160
RD a,248,1,17280
CV 92,108
M v,96,a,236,v,176
RD a,252,1,17344
CV 93,110
MC 100,a,224,132,68
s_add_u32 m0, s92, 0
s_bfe_u32 s94, s95, 0x2000a
M v,100,a,228,v,148
s_bfe_u32 s97, s95, 0x20008
s_lshl_b32 s94, s94, 20
M v,100,a,232,v,164
s_lshl_b32 s97, s97, 7
CV 82,112
M v,100,a,236,v,180
CV 83,114
s_add_u32 s94, s94, s97
MC 104,a,224,136,72
CV 86,116
CV 87,118
M v,104,a,228,v,152
CV 90,120
CV 91,122
M v,104,a,232,v,168
CV 94,124
CV 95,126
M v,104,a,236,v,184
DL 5,44,93,1032
MC 108,a,224,140,76
RD a,224,1,17408
AD 12,12,16
M v,108,a,228,v,156
RD a,228,1,17472
AD 13,13,17
M v,108,a,232,v,172
RD a,232,1,17536
AD 14,14,18
M v,108,a,236,v,188
s_waitcnt lgkmcnt(3)
RD a,236,1,17600
M v,96,a,240,v,192
AD 15,15,19
M v,96,a,244,v,208
buffer_load_dword v10, v5, s[40:43], s94 offen offset:512
M v,96,a,248,v,224
M v,96,a,252,v,240
M v,100,a,240,v,196
M v,100,a,244,v,212
M v,100,a,248,v,228
M v,100,a,252,v,244
M v,104,a,240,v,200
DL 5,48,93,2112
M v,104,a,244,v,216
M v,104,a,248,v,232
EX 96
M v,104,a,252,v,248
EX 97
M v,108,a,240,v,204
RD a,240,1,17664
AD 16,96,97
M v,108,a,244,v,220
EX 100
M v,108,a,248,v,236
EX 101
M v,108,a,252,v,252
s_waitcnt lgkmcnt(1)
RD a,244,1,17728
MC 112,a,224,128,64
RD a,248,1,17792
AD 17,100,101
M v,112,a,228,v,144
EX 104
M v,112,a,232,v,160
EX 105
M v,112,a,236,v,176
RD a,252,1,17856
AD 18,104,105
MC 116,a,224,132,68
EX 98
M v,116,a,228,v,148
DL 5,52,93,3144
M v,116,a,232,v,164
EX 102
M v,116,a,236,v,180
EX 106
MC 120,a,224,136,72
EX 108
M v,120,a,228,v,152
EX 109
M v,120,a,232,v,168
EX 99
M v,120,a,236,v,184
buffer_load_dword v10, v5, s[44:47], s94 offen offset:1544
MC 124,a,224,140,76
EX 103
M v,124,a,228,v,156
EX 107
M v,124,a,232,v,172
EX 110
M v,124,a,236,v,188
s_waitcnt lgkmcnt(0)
s_waitcnt vmcnt(14)
M v,112,a,240,v,192
s_barrier
TR a,224,33792
M v,112,a,244,v,208
TR a,226,34304
s_add_u32 m0, s92, 16896
M v,112,a,248,v,224
TR a,228,33824
s_mov_b32 s93, 640
M v,112,a,252,v,240
TR a,230,34336
AD 16,16,98
M v,116,a,240,v,196
TR a,232,33856
AD 17,17,102
M v,116,a,244,v,212
TR a,234,34368
AD 18,18,106
M v,116,a,248,v,228
TR a,236,33888
AD 19,108,109
M v,116,a,252,v,244
TR a,238,34400
AD 16,16,99
M v,120,a,240,v,200
EX 111
M v,120,a,244,v,216
EX 112
M v,120,a,248,v,232
AD 17,17,103
AD 18,18,107
M v,120,a,252,v,248
DL 5,40,93,0
M v,124,a,240,v,204
TR a,240,33920
AD 19,19,110
M v,124,a,244,v,220
TR a,242,34432
AD 19,19,111
M v,124,a,248,v,236
TR a,244,33952
AD 16,16,112
M v,124,a,252,v,252
s_waitcnt lgkmcnt(3)
TR a,246,34464
M a,0,a,224,v,80
EX 116
M a,4,a,224,v,84
TR a,248,33984
AD 17,17,116
M a,8,a,224,v,88
EX 120
M a,12,a,224,v,92
TR a,250,34496
AD 18,18,120
M a,16,a,228,v,80
EX 113
M a,20,a,228,v,84
TR a,252,34016
AD 16,16,113
M a,24,a,228,v,88
EX 117
M a,28,a,228,v,92
TR a,254,34528
AD 17,17,117
M a,32,a,232,v,80
DL 5,44,93,1032
M a,36,a,232,v,84
EX 121
M a,40,a,232,v,88
TR a,224,34048
AD 18,18,121
M a,44,a,232,v,92
EX 124
M a,48,a,236,v,80
TR a,226,34560
AD 19,19,124
M a,52,a,236,v,84
EX 114
M a,56,a,236,v,88
TR a,228,34080
AD 16,16,114
M a,60,a,236,v,92
s_waitcnt lgkmcnt(3)
TR a,230,34592
M a,64,a,240,v,80
buffer_load_dword v10, v5, s[48:51], s94 offen offset:2624
M a,68,a,240,v,84
EX 118
M a,72,a,240,v,88
TR a,232,34112
AD 17,17,118
M a,76,a,240,v,92
EX 122
M a,80,a,244,v,80
TR a,234,34624
AD 18,18,122
M a,84,a,244,v,84
DL 5,48,93,2112
M a,88,a,244,v,88
EX 125
M a,92,a,244,v,92
TR a,236,34144
AD 19,19,125
M a,96,a,248,v,80
TR a,238,34656
M a,100,a,248,v,84
EX 115
M a,104,a,248,v,88
TR a,240,34176
AD 16,16,115
M a,108,a,248,v,92
EX 119
M a,112,a,252,v,80
TR a,242,34688
AD 17,17,119
M a,116,a,252,v,84
EX 123
M a,120,a,252,v,88
TR a,244,34208
AD 18,18,123
M a,124,a,252,v,92
s_waitcnt lgkmcnt(3)
TR a,246,34720
M a,128,a,224,v,80
TR a,248,34240
v_max3_f32 v20, v16, v17, v18
M a,132,a,224,v,84
EX 126
M a,136,a,224,v,88
DL 5,52,93,3144
M a,140,a,224,v,92
TR a,250,34752
AD 19,19,126
M a,144,a,228,v,80
EX 127
M a,148,a,228,v,84
TR a,252,34272
AD 19,19,127
M a,152,a,228,v,88
TR a,254,34784
v_max_f32 v20, v20, v19
M a,156,a,228,v,92
v_cmp_lt_f32 vcc, 0x4b800000, v20
M a,160,a,232,v,80
buffer_load_dword v10, v5, s[52:55], s94 offen offset:3656
M a,164,a,232,v,84
s_mov_b32 s94, 4194304
M a,168,a,232,v,88
M a,172,a,232,v,92
M a,176,a,236,v,80
M a,180,a,236,v,84
M a,184,a,236,v,88
M a,188,a,236,v,92
s_waitcnt lgkmcnt(0)
s_waitcnt vmcnt(11)
M a,192,a,240,v,80
s_barrier
TR a,224,51136
M a,196,a,240,v,84
TR a,226,51648
s_add_u32 m0, s92, 33792
M a,200,a,240,v,88
TR a,228,51168
s_mov_b32 s93, 768
M a,204,a,240,v,92
TR a,230,51680
M a,208,a,244,v,80
TR a,232,50688
M a,212,a,244,v,84
TR a,234,51200
M a,216,a,244,v,88
TR a,236,50720
M a,220,a,244,v,92
TR a,238,51232
M v,32,a,248,v,80
TR a,240,50752
M v,36,a,248,v,84
TR a,242,51264
M v,40,a,248,v,88
TR a,244,50784
M v,44,a,248,v,92
DL 5,40,93,0
M v,48,a,252,v,80
CV 80,96
CV 81,98
M v,52,a,252,v,84
CV 82,112
CV 83,114
M v,56,a,252,v,88
s_waitcnt lgkmcnt(3)
CV 84,100
M v,60,a,252,v,92
s_cbranch_vccnz L_rsA14
L_rbA14:
M v,32,a,224,v,80
CV 85,102
CV 86,116
CV 87,118
CV 88,104
CV 89,106
M v,36,a,224,v,84
CV 90,120
CV 91,122
CV 92,108
CV 93,110
M v,40,a,224,v,88
CV 94,124
CV 95,126
TR a,246,51296
TR a,248,50816
M v,44,a,224,v,92
TR a,250,51328
CV 32,32
M v,48,a,228,v,80
TR a,252,50848
CV 33,34
M v,52,a,228,v,84
TR a,254,51360
CV 36,36
M v,56,a,228,v,88
RD v,64,3,0
CV 37,38
M v,60,a,228,v,92
RD v,68,3,64
CV 34,48
M a,0,a,232,v,80
DL 5,44,93,1032
M a,4,a,232,v,84
RD v,96,3,512
CV 35,50
M a,8,a,232,v,88
RD v,100,3,576
CV 38,52
M a,12,a,232,v,92
RD v,112,3,16896
CV 39,54
M a,16,a,236,v,80
RD v,116,3,16960
v_bfe_u32 v8, v4, 8, 2
M a,20,a,236,v,84
RD v,240,3,17408
v_lshrrev_b32 v9, 14, s95
L_pad12:
s_cbranch_execz L_ret12
M a,24,a,236,v,88
RD v,244,3,17472
v_add_lshl_u32 v8, v8, v9, 7
M a,28,a,236,v,92
s_waitcnt lgkmcnt(8)
TR a,224,50880
M a,32,a,240,v,80
TR a,226,51392
v_add_u32 v8, 4096, v8
M a,36,a,240,v,84
TR a,228,50912
v_mov_b32 v9, 0
M a,40,a,240,v,88
TR a,230,51424
CV 40,40
M a,44,a,240,v,92
TR a,232,50944
CV 41,42
M a,48,a,244,v,80
TR a,234,51456
CV 42,56
M a,52,a,244,v,84
TR a,236,50976
CV 43,58
M a,56,a,244,v,88
TR a,238,51488
CV 44,44
M a,60,a,244,v,92
DL 5,48,93,2112
M a,64,a,248,v,80
s_getpc_b64 s[100:101]
s_and_b32 s100, s100, 0xfffff000
M a,68,a,248,v,84
RD v,72,3,33792
v_lshl_add_u64 v[8:9], v[8:9], 0, s[100:101]
M a,72,a,248,v,88
RD v,76,3,33856
CV 45,46
M a,76,a,248,v,92
RD v,104,3,34304
CV 46,60
M a,80,a,252,v,80
RD v,108,3,34368
CV 47,62
M a,84,a,252,v,84
RD v,120,3,50688
AR 20,0
M a,88,a,252,v,88
RD v,124,3,50752
AR 21,1
M a,92,a,252,v,92
s_waitcnt lgkmcnt(6)
RD v,248,3,51200
M a,96,a,224,v,80
RD v,252,3,51264
AR 22,2
M a,100,a,224,v,84
TR a,240,51008
AR 23,3
M a,104,a,224,v,88
DL 5,52,93,3144
M a,108,a,224,v,92
TR a,242,51520
AR 24,16
M a,112,a,228,v,80
TR a,244,51040
AR 25,17
M a,116,a,228,v,84
TR a,246,51552
AR 26,18
M a,120,a,228,v,88
TR a,248,51072
AR 27,19
M a,124,a,228,v,92
TR a,250,51584
CV 192,20
M a,128,a,232,v,80
TR a,252,51104
CV 193,22
M a,132,a,232,v,84
TR a,254,51616
CV 194,24
M a,136,a,232,v,88
global_load_dword v10, v[8:9], off
M a,140,a,232,v,92
v_add_u32 v8, 67584, v4
CV 195,26
M a,144,a,236,v,80
ds_write_b128 v8, v[32:35] offset:0
M a,148,a,236,v,84
ds_write_b128 v8, v[36:39] offset:1024
M a,152,a,236,v,88
ds_write_b128 v8, v[40:43] offset:2048
M a,156,a,236,v,92
s_waitcnt lgkmcnt(3)
s_waitcnt vmcnt(12)
M a,160,a,240,v,80
s_barrier
s_add_u32 m0, s92, 50688
M a,164,a,240,v,84
s_xor_b32 s93, s4, 256
TW a,224,0
M a,168,a,240,v,88
DL 7,56,93,0
M a,172,a,240,v,92
TW a,226,128
AR 20,4
M a,176,a,244,v,80
TW a,228,256
AR 21,5
M a,180,a,244,v,84
TW a,230,384
AR 22,6
M a,184,a,244,v,88
TW a,232,512
AR 23,7
M a,188,a,244,v,92
TW a,234,640
AR 24,20
M a,192,a,248,v,80
TW a,236,768
AR 25,21
M a,196,a,248,v,84
TW a,238,896
AR 26,22
M a,200,a,248,v,88
DL 7,60,93,1056
M a,204,a,248,v,92
TW a,240,8
AR 27,23
M a,208,a,252,v,80
TW a,242,136
CV 196,20
M a,212,a,252,v,84
DL 7,64,93,2112
M a,216,a,252,v,88
TW a,244,264
CV 197,22
M a,220,a,252,v,92
s_waitcnt lgkmcnt(3)
TW a,246,392
Z v,128,a,224,v,64
DL 7,68,93,3168
M v,128,a,228,v,68
TW a,248,520
s_add_u32 m0, s92, 81920
M v,128,a,232,v,72
TW a,250,648
s_xor_b32 s93, s4, 28928
M v,128,a,236,v,76
TW a,252,776
CV 198,24
Z v,132,a,224,v,96
TW a,254,904
CV 199,26
M v,132,a,228,v,100
ds_write_b128 v8, v[44:47] offset:3072
M v,132,a,232,v,104
DL 7,56,93,0
M v,132,a,236,v,108
AR 20,8
AR 21,9
Z v,136,a,224,v,112
AR 22,10
AR 23,11
M v,136,a,228,v,116
AR 24,24
AR 25,25
M v,136,a,232,v,120
AR 26,26
AR 27,27
M v,136,a,236,v,124
CV 200,20
CV 201,22
Z v,140,a,224,v,240
DL 7,60,93,1056
M v,140,a,228,v,244
TW a,224,64
CV 202,24
M v,140,a,232,v,248
TW a,226,192
CV 203,26
M v,140,a,236,v,252
s_waitcnt lgkmcnt(3)
TW a,228,320
Z v,32,a,240,v,64
TW a,230,448
AR 20,12
M v,32,a,244,v,68
TW a,232,576
AR 21,13
M v,32,a,248,v,72
DL 7,64,93,2112
M v,32,a,252,v,76
TW a,234,704
AR 22,14
Z v,36,a,240,v,96
TW a,236,832
AR 23,15
M v,36,a,244,v,100
TW a,238,960
AR 24,28
M v,36,a,248,v,104
AR 25,29
AR 26,30
M v,36,a,252,v,108
AR 27,31
CV 204,20
Z v,40,a,240,v,112
DL 7,68,93,3168
M v,40,a,244,v,116
s_add_u32 m0, s92, 98816
s_mov_b32 s93, 1049088
M v,40,a,248,v,120
CV 205,22
CV 206,24
M v,40,a,252,v,124
CV 207,26
AR 20,32
Z v,44,a,240,v,240
TW a,240,72
AR 21,33
M v,44,a,244,v,244
TW a,242,200
AR 22,34
M v,44,a,248,v,248
DL 6,40,93,0
M v,44,a,252,v,252
s_waitcnt lgkmcnt(2)
TW a,244,328
Z v,144,a,224,v,64
TW a,246,456
AR 23,35
M v,144,a,228,v,68
TW a,248,584
AR 24,48
M v,144,a,232,v,72
TW a,250,712
AR 25,49
M v,144,a,236,v,76
TW a,252,840
AR 26,50
Z v,148,a,224,v,96
TW a,254,968
AR 27,51
M v,148,a,228,v,100
DL 6,44,93,1032
M v,148,a,232,v,104
CV 208,20
CV 209,22
M v,148,a,236,v,108
CV 210,24
CV 211,26
Z v,152,a,224,v,112
v_add_u32 v9, 149504, v4
AR 20,36
M v,152,a,228,v,116
ST 208
M v,152,a,232,v,120
ds_write_b128 v9, v[192:195] offset:0
M v,152,a,236,v,124
ds_write_b128 v9, v[196:199] offset:1024
Z v,156,a,224,v,240
DL 6,48,93,2112
M v,156,a,228,v,244
ds_write_b128 v9, v[200:203] offset:2048
M v,156,a,232,v,248
ds_write_b128 v9, v[204:207] offset:3072
M v,156,a,236,v,252
s_waitcnt lgkmcnt(4)
s_waitcnt vmcnt(18)
Z v,48,a,240,v,64
s_barrier
TW a,224,16896
M v,48,a,244,v,68
DL 6,52,93,3144
M v,48,a,248,v,72
TW a,226,17024
s_add_u32 m0, s92, 115712
M v,48,a,252,v,76
TW a,228,17152
s_xor_b32 s93, s4, 384
Z v,52,a,240,v,96
TW a,230,17280
AR 21,37
M v,52,a,244,v,100
TW a,232,17408
AR 22,38
M v,52,a,248,v,104
TW a,234,17536
AR 23,39
M v,52,a,252,v,108
TW a,236,17664
AR 24,52
Z v,56,a,240,v,112
TW a,238,17792
AR 25,53
M v,56,a,244,v,116
DL 7,56,93,0
M v,56,a,248,v,120
AR 26,54
AR 27,55
M v,56,a,252,v,124
CV 212,20
CV 213,22
Z v,60,a,240,v,240
DL 7,60,93,1056
M v,60,a,244,v,244
TW a,240,16904
CV 214,24
M v,60,a,248,v,248
TW a,242,17032
CV 215,26
M v,60,a,252,v,252
s_waitcnt lgkmcnt(2)
TW a,244,17160
Z v,160,a,224,v,64
TW a,246,17288
s_mov_b32 s94, 5242880
M v,160,a,228,v,68
TW a,248,17416
AR 20,40
M v,160,a,232,v,72
DL 7,64,93,2112
M v,160,a,236,v,76
TW a,250,17544
AR 21,41
Z v,164,a,224,v,96
TW a,252,17672
AR 22,42
M v,164,a,228,v,100
TW a,254,17800
AR 23,43
M v,164,a,232,v,104
ST 212
M v,164,a,236,v,108
AR 24,56
AR 25,57
Z v,168,a,224,v,112
AR 26,58
AR 27,59
M v,168,a,228,v,116
DL 7,68,93,3168
M v,168,a,232,v,120
s_add_u32 m0, s92, 132608
s_xor_b32 s93, s4, 29056
M v,168,a,236,v,124
CV 216,20
CV 217,22
Z v,172,a,224,v,240
TW a,224,16960
CV 218,24
M v,172,a,228,v,244
TW a,226,17088
CV 219,26
M v,172,a,232,v,248
DL 7,56,93,0
M v,172,a,236,v,252
s_waitcnt lgkmcnt(2)
TW a,228,17216
Z a,0,a,240,v,64
TW a,230,17344
s_mov_b32 s94, 6291456
M a,0,a,244,v,68
TW a,232,17472
AR 20,44
M a,0,a,248,v,72
TW a,234,17600
AR 21,45
M a,0,a,252,v,76
TW a,236,17728
AR 22,46
Z a,4,a,240,v,96
TW a,238,17856
AR 23,47
M a,4,a,244,v,100
DL 7,60,93,1056
M a,4,a,248,v,104
AR 24,60
AR 25,61
M a,4,a,252,v,108
AR 26,62
AR 27,63
Z a,8,a,240,v,112
ST 216
M a,8,a,244,v,116
CV 220,20
CV 221,22
M a,8,a,248,v,120
CV 222,24
CV 223,26
M a,8,a,252,v,124
DL 7,64,93,2112
Z a,12,a,240,v,240
TW a,240,16968
s_mov_b32 s94, 7340032
M a,12,a,244,v,244
TW a,242,17096
AR 20,64
M a,12,a,248,v,248
TW a,244,17224
AR 21,65
M a,12,a,252,v,252
s_waitcnt lgkmcnt(3)
TW a,246,17352
Z v,176,a,224,v,64
DL 7,68,93,3168
M v,176,a,228,v,68
TW a,248,17480
s_add_u32 m0, s92, 0
M v,176,a,232,v,72
TW a,250,17608
s_mov_b32 s93, 1573376
M v,176,a,236,v,76
TW a,252,17736
AR 22,66
Z v,180,a,224,v,96
TW a,254,17864
AR 23,67
M v,180,a,228,v,100
AR 24,80
AR 25,81
M v,180,a,232,v,104
AR 26,82
AR 27,83
M v,180,a,236,v,108
CV 224,20
CV 225,22
Z v,184,a,224,v,112
DL 6,40,93,0
M v,184,a,228,v,116
CV 226,24
CV 227,26
M v,184,a,232,v,120
AR 20,68
AR 21,69
M v,184,a,236,v,124
ST 220
Z v,188,a,224,v,240
s_mov_b32 s94, 8388608
AR 22,70
M v,188,a,228,v,244
AR 23,71
AR 24,84
M v,188,a,232,v,248
AR 25,85
AR 26,86
M v,188,a,236,v,252
s_waitcnt lgkmcnt(0)
s_waitcnt vmcnt(17)
Z a,16,a,240,v,64
s_barrier
TW a,224,33792
M a,16,a,244,v,68
DL 6,44,93,1032
M a,16,a,248,v,72
TW a,226,33920
AR 27,87
M a,16,a,252,v,76
TW a,228,34048
CV 228,20
Z a,20,a,240,v,96
TW a,230,34176
CV 229,22
M a,20,a,244,v,100
TW a,232,34304
CV 230,24
M a,20,a,248,v,104
TW a,234,34432
CV 231,26
M a,20,a,252,v,108
TW a,236,34560
AR 20,72
Z a,24,a,240,v,112
TW a,238,34688
AR 21,73
M a,24,a,244,v,116
DL 6,48,93,2112
M a,24,a,248,v,120
AR 22,74
AR 23,75
M a,24,a,252,v,124
AR 24,88
AR 25,89
Z a,28,a,240,v,240
ST 224
M a,28,a,244,v,244
TW a,240,33800
s_mov_b32 s94, 9437184
M a,28,a,248,v,248
TW a,242,33928
AR 26,90
M a,28,a,252,v,252
s_waitcnt lgkmcnt(2)
TW a,244,34056
Z v,192,a,224,v,64
DL 6,52,93,3144
M v,192,a,228,v,68
TW a,246,34184
s_add_u32 m0, s92, 16896
M v,192,a,232,v,72
TW a,248,34312
s_mov_b32 s93, 896
M v,192,a,236,v,76
TW a,250,34440
AR 27,91
Z v,196,a,224,v,96
TW a,252,34568
CV 232,20
M v,196,a,228,v,100
TW a,254,34696
CV 233,22
M v,196,a,232,v,104
CV 234,24
CV 235,26
M v,196,a,236,v,108
v_xor_b32 v3, 81920, v3
AR 20,76
Z v,200,a,224,v,112
DL 5,40,93,0
L_pad13:
s_cbranch_execz L_ret13
M v,200,a,228,v,116
RD a,64,3,50688
AR 21,77
M v,200,a,232,v,120
RD a,80,3,50752
AR 22,78
M v,200,a,236,v,124
RD a,68,3,51200
AR 23,79
Z v,204,a,224,v,240
TW a,224,33856
AR 24,92
M v,204,a,228,v,244
ST 228
M v,204,a,232,v,248
TW a,226,33984
s_mov_b32 s94, 10485760
M v,204,a,236,v,252
s_waitcnt lgkmcnt(5)
TW a,228,34112
Z a,32,a,240,v,64
DL 5,44,93,1032
M a,32,a,244,v,68
TW a,230,34240
AR 25,93
M a,32,a,248,v,72
TW a,232,34368
AR 26,94
M a,32,a,252,v,76
TW a,234,34496
AR 27,95
Z a,36,a,240,v,96
TW a,236,34624
CV 236,20
M a,36,a,244,v,100
TW a,238,34752
CV 237,22
M a,36,a,248,v,104
RD a,84,3,51264
v_xor_b32 v3, 81920, v3
M a,36,a,252,v,108
RD a,72,3,0
CV 238,24
Z a,40,a,240,v,112
DL 5,48,93,2112
M a,40,a,244,v,116
RD a,88,3,64
CV 239,26
M a,40,a,248,v,120
RD a,76,3,512
AR 20,96
M a,40,a,252,v,124
RD a,92,3,576
AR 21,97
Z a,44,a,240,v,240
TW a,240,33864
AR 22,98
M a,44,a,244,v,244
TW a,242,33992
AR 23,99
M a,44,a,248,v,248
ST 232
M a,44,a,252,v,252
s_waitcnt lgkmcnt(7)
TW a,244,34120
Z v,208,a,224,v,64
TW a,246,34248
s_mov_b32 s94, 11534336
M v,208,a,228,v,68
DL 5,52,93,3144
M v,208,a,232,v,72
TW a,248,34376
AR 24,112
M v,208,a,236,v,76
TW a,250,34504
AR 25,113
Z v,212,a,224,v,96
TW a,252,34632
AR 26,114
M v,212,a,228,v,100
TW a,254,34760
v_xor_b32 v11, 81920, v11
M v,212,a,232,v,104
AR 27,115
CV 80,20
M v,212,a,236,v,108
CV 81,22
CV 82,24
Z v,216,a,224,v,112
CV 83,26
AR 20,100
M v,216,a,228,v,116
AR 21,101
AR 22,102
M v,216,a,232,v,120
AR 23,103
AR 24,116
M v,216,a,236,v,124
AR 25,117
AR 26,118
Z v,220,a,224,v,240
AR 27,119
CV 84,20
M v,220,a,228,v,244
CV 85,22
CV 86,24
M v,220,a,232,v,248
CV 87,26
AR 20,104
M v,220,a,236,v,252
s_waitcnt lgkmcnt(0)
s_waitcnt vmcnt(12)
Z a,48,a,240,v,64
s_barrier
TW a,224,16896
M a,48,a,244,v,68
TW a,226,17024
s_add_u32 m0, s92, 33792
M a,48,a,248,v,72
TW a,228,17152
s_mov_b32 s93, 1049344
M a,48,a,252,v,76
TW a,230,17280
AR 21,105
Z a,52,a,240,v,96
TW a,232,16904
AR 22,106
M a,52,a,244,v,100
TW a,234,17032
AR 23,107
M a,52,a,248,v,104
TW a,236,17160
AR 24,120
M a,52,a,252,v,108
TW a,238,17288
AR 25,121
Z a,56,a,240,v,112
ST 236
M a,56,a,244,v,116
s_mov_b32 s94, 12582912
AR 26,122
M a,56,a,248,v,120
AR 27,123
CV 88,20
M a,56,a,252,v,124
DL 5,40,93,0
Z a,60,a,240,v,240
TW a,240,16960
CV 89,22
M a,60,a,244,v,244
TW a,242,17088
CV 90,24
M a,60,a,248,v,248
TW a,244,17216
CV 91,26
M a,60,a,252,v,252
s_waitcnt lgkmcnt(3)
TW a,246,17344
M v,128,a,224,a,64
TW a,248,16968
AR 20,108
M v,128,a,228,a,80
TW a,250,17096
AR 21,109
M v,132,a,224,a,68
TW a,252,17224
AR 22,110
M v,132,a,228,a,84
DL 5,44,93,1032
M v,136,a,224,a,72
TW a,254,17352
AR 23,111
M v,136,a,228,a,88
AR 24,124
AR 25,125
M v,140,a,224,a,76
TW a,224,17408
AR 26,126
M v,140,a,228,a,92
TW a,226,17536
AR 27,127
M v,32,a,232,a,64
TW a,228,17664
CV 92,20
M v,32,a,236,a,80
ST 80
M v,36,a,232,a,68
TW a,230,17792
s_mov_b32 s94, 13631488
M v,36,a,236,a,84
RD a,96,3,33792
CV 93,22
M v,40,a,232,a,72
DL 5,48,93,2112
M v,40,a,236,a,88
v_bfe_u32 v8, v4, 8, 2
v_lshrrev_b32 v9, 14, s95
M v,44,a,232,a,76
TW a,232,17416
v_add_lshl_u32 v8, v8, v9, 7
M v,44,a,236,a,92
s_waitcnt lgkmcnt(6)
TW a,234,17544
M v,144,a,240,a,64
TW a,236,17672
v_mov_b32 v9, 0
M v,144,a,244,a,80
TW a,238,17800
CV 94,24
M v,148,a,240,a,68
s_getpc_b64 s[100:101]
s_add_u32 s100, s100, L_c2A-.
s_addc_u32 s101, s101, 0
M v,148,a,244,a,84
DL 5,52,93,3144
M v,152,a,240,a,72
s_add_u32 m0, s92, 50688
s_xor_b32 s93, s4, 640
M v,152,a,244,a,88
RD a,112,3,33856
v_lshl_add_u64 v[8:9], v[8:9], 0, s[100:101]
M v,156,a,240,a,76
TW a,240,17472
CV 95,26
M v,156,a,244,a,92
TW a,242,17600
AR 20,128
M v,48,a,248,a,64
TW a,244,17728
AR 21,129
M v,48,a,252,a,80
TW a,246,17856
AR 22,130
M v,52,a,248,a,68
ST 84
M v,52,a,252,a,84
s_mov_b32 s94, 14680064
RD a,100,3,34304
M v,56,a,248,a,72
RD a,116,3,34368
AR 23,131
M v,56,a,252,a,88
DL 7,56,93,0
M v,60,a,248,a,76
TW a,248,17480
AR 24,144
M v,60,a,252,a,92
s_waitcnt lgkmcnt(8)
TW a,250,17608
M v,160,a,224,a,64
TW a,252,17736
AR 25,145
M v,160,a,228,a,80
TW a,254,17864
v_xor_b32 v11, 81920, v11
M v,164,a,224,a,68
global_load_dword v10, v[8:9], off
M v,164,a,228,a,84
RD a,104,3,50688
AR 26,146
M v,168,a,224,a,72
RD a,120,3,50752
AR 27,147
M v,168,a,228,a,88
DL 7,60,93,1056
M v,172,a,224,a,76
RD a,108,3,51200
CV 224,20
M v,172,a,228,a,92
RD a,124,3,51264
CV 225,22
M a,0,a,232,a,64
CV 226,24
CV 227,26
M a,0,a,236,a,80
AR 20,132
AR 21,133
M a,4,a,232,a,68
AR 22,134
AR 23,135
M a,4,a,236,a,84
DL 7,64,93,2112
M a,8,a,232,a,72
AR 24,148
AR 25,149
M a,8,a,236,a,88
AR 26,150
AR 27,151
M a,12,a,232,a,76
ST 88
M a,12,a,236,a,92
s_waitcnt lgkmcnt(4)
s_waitcnt vmcnt(18)
M v,176,a,240,a,64
s_barrier
TW a,224,0
M v,176,a,244,a,80
TW a,226,128
s_mov_b32 s94, 15728640
M v,180,a,240,a,68
TW a,228,256
CV 228,20
M v,180,a,244,a,84
DL 7,68,93,3168
M v,184,a,240,a,72
TW a,230,384
s_add_u32 m0, s92, 81920
M v,184,a,244,a,88
TW a,232,8
s_xor_b32 s93, s4, 29312
M v,188,a,240,a,76
TW a,234,136
CV 229,22
M v,188,a,244,a,92
TW a,236,264
CV 230,24
M a,16,a,248,a,64
TW a,238,392
CV 231,26
M a,16,a,252,a,80
TW a,240,64
AR 20,136
M a,20,a,248,a,68
TW a,242,192
AR 21,137
M a,20,a,252,a,84
DL 7,56,93,0
M a,24,a,248,a,72
TW a,244,320
AR 22,138
M a,24,a,252,a,88
TW a,246,448
AR 23,139
M a,28,a,248,a,76
TW a,248,72
AR 24,152
M a,28,a,252,a,92
s_waitcnt lgkmcnt(5)
TW a,250,200
M v,128,a,224,a,96
ST 92
M v,128,a,228,a,112
TW a,252,328
s_mov_b32 s94, 16777216
M v,132,a,224,a,100
TW a,254,456
AR 25,153
M v,132,a,228,a,116
DL 7,60,93,1056
M v,136,a,224,a,104
AR 26,154
AR 27,155
M v,136,a,228,a,120
CV 232,20
CV 233,22
M v,140,a,224,a,108
TW a,224,512
CV 234,24
M v,140,a,228,a,124
TW a,226,640
CV 235,26
M v,32,a,232,a,96
TW a,228,768
AR 20,140
M v,32,a,236,a,112
TW a,230,896
AR 21,141
M v,36,a,232,a,100
AR 22,142
AR 23,143
M v,36,a,236,a,116
DL 7,64,93,2112
M v,40,a,232,a,104
AR 24,156
AR 25,157
M v,40,a,236,a,120
AR 26,158
AR 27,159
M v,44,a,232,a,108
TW a,232,520
CV 236,20
M v,44,a,236,a,124
s_waitcnt lgkmcnt(5)
TW a,234,648
M v,144,a,240,a,96
TW a,236,776
CV 237,22
M v,144,a,244,a,112
ST 224
M v,148,a,240,a,100
TW a,238,904
s_mov_b32 s94, 17825792
M v,148,a,244,a,116
CV 238,24
CV 239,26
M v,152,a,240,a,104
DL 7,68,93,3168
M v,152,a,244,a,120
s_add_u32 m0, s92, 98816
s_mov_b32 s93, 1049472
M v,156,a,240,a,108
TW a,240,576
AD 12,12,16
M v,156,a,244,a,124
TW a,242,704
AD 13,13,17
M v,48,a,248,a,96
TW a,244,832
AD 14,14,18
M v,48,a,252,a,112
TW a,246,960
AD 15,15,19
M v,52,a,248,a,100
v_permlane32_swap_b32 v12, v14
M v,52,a,252,a,116
DL 5,40,93,0
M v,56,a,248,a,104
v_permlane32_swap_b32 v13, v15
M v,56,a,252,a,120
v_add_f32 v12, v12, v14
v_add_f32 v13, v13, v15
M v,60,a,248,a,108
TW a,248,584
AR 20,160
M v,60,a,252,a,124
s_waitcnt lgkmcnt(5)
TW a,250,712
M v,160,a,224,a,96
TW a,252,840
AR 21,161
M v,160,a,228,a,112
TW a,254,968
AR 22,162
M v,164,a,224,a,100
ST 228
M v,164,a,228,a,116
s_mov_b32 s94, 18874368
AR 23,163
M v,168,a,224,a,104
v_permlane16_swap_b32 v12, v13
M v,168,a,228,a,120
DL 5,44,93,1032
M v,172,a,224,a,108
AR 24,176
AR 25,177
M v,172,a,228,a,124
AR 26,178
AR 27,179
M a,0,a,232,a,96
v_add_f32 v12, v12, v13
CV 16,20
M a,0,a,236,a,112
CV 17,22
CV 18,24
M a,4,a,232,a,100
DL 5,48,93,2112
M a,4,a,236,a,116
CV 19,26
v_mov_b32 v28, v12
M a,8,a,232,a,104
AR 20,164
AR 21,165
M a,8,a,236,a,120
AR 22,166
AR 23,167
M a,12,a,232,a,108
AR 24,180
AR 25,181
M a,12,a,236,a,124
s_waitcnt lgkmcnt(0)
s_waitcnt vmcnt(23)
M v,176,a,240,a,96
s_barrier
TW a,224,16896
M v,176,a,244,a,112
DL 5,52,93,3144
M v,180,a,240,a,100
TW a,226,17024
s_add_u32 m0, s92, 115712
M v,180,a,244,a,116
TW a,228,17152
s_xor_b32 s93, s4, 768
M v,184,a,240,a,104
ST 232
M v,184,a,244,a,120
TW a,230,17280
s_mov_b32 s94, 19922944
M v,188,a,240,a,108
TW a,232,17408
AR 26,182
M v,188,a,244,a,124
TW a,234,17536
AR 27,183
M a,16,a,248,a,96
TW a,236,17664
CV 12,20
M a,16,a,252,a,112
TW a,238,17792
CV 13,22
M a,20,a,248,a,100
DL 7,56,93,0
M a,20,a,252,a,116
TW a,240,16904
CV 14,24
M a,24,a,248,a,104
TW a,242,17032
CV 15,26
M a,24,a,252,a,120
DL 7,60,93,1056
M a,28,a,248,a,108
TW a,244,17160
AR 20,168
M a,28,a,252,a,124
s_waitcnt lgkmcnt(3)
TW a,246,17288
Z v,224,a,224,v,64
TW a,248,17416
AR 21,169
M v,224,a,228,v,68
TW a,250,17544
AR 22,170
M v,224,a,232,v,72
DL 7,64,93,2112
M v,224,a,236,v,76
TW a,252,17672
AR 23,171
Z v,228,a,224,v,96
TW a,254,17800
AR 24,184
L_pad14:
s_cbranch_execz L_ret14
M v,228,a,228,v,100
ST 236
M v,228,a,232,v,104
AR 25,185
AR 26,186
M v,228,a,236,v,108
AR 27,187
v_mov_b32 v29, v28
Z v,232,a,224,v,112
DL 7,68,93,3168
M v,232,a,228,v,116
s_add_u32 m0, s92, 132608
s_xor_b32 s93, s4, 29440
M v,232,a,232,v,120
v_permlane16_swap_b32 v28, v29
M v,232,a,236,v,124
v_mov_b32 v30, v28
v_mov_b32 v31, v29
Z v,236,a,224,v,240
v_permlane32_swap_b32 v28, v30
M v,236,a,228,v,244
v_permlane32_swap_b32 v29, v31
M v,236,a,232,v,248
DL 7,56,93,0
M v,236,a,236,v,252
s_waitcnt lgkmcnt(0)
TW a,224,16960
Z a,128,a,240,v,64
TW a,226,17088
M a,128,a,244,v,68
TW a,228,17216
M a,128,a,248,v,72
TW a,230,17344
M a,128,a,252,v,76
TW a,232,17472
Z a,132,a,240,v,96
TW a,234,17600
v_xor_b32 v3, 81920, v3
M a,132,a,244,v,100
DL 7,60,93,1056
M a,132,a,248,v,104
TW a,236,17728
M a,132,a,252,v,108
TW a,238,17856
Z a,136,a,240,v,112
M a,136,a,244,v,116
M a,136,a,248,v,120
DL 7,64,93,2112
M a,136,a,252,v,124
Z a,140,a,240,v,240
TW a,240,16968
M a,140,a,244,v,244
TW a,242,17096
M a,140,a,248,v,248
TW a,244,17224
M a,140,a,252,v,252
s_waitcnt lgkmcnt(3)
TW a,246,17352
Z v,80,a,224,v,64
DL 7,68,93,3168
M v,80,a,228,v,68
TW a,248,17480
s_add_u32 m0, s92, 0
M v,80,a,232,v,72
TW a,250,17608
s_mov_b32 s93, 2621952
M v,80,a,236,v,76
TW a,252,17736
Z v,84,a,224,v,96
TW a,254,17864
M v,84,a,228,v,100
M v,84,a,232,v,104
M v,84,a,236,v,108
Z v,88,a,224,v,112
DL 5,40,93,0
M v,88,a,228,v,116
M v,88,a,232,v,120
M v,88,a,236,v,124
Z v,92,a,224,v,240
M v,92,a,228,v,244
M v,92,a,232,v,248
M v,92,a,236,v,252
s_waitcnt lgkmcnt(0)
s_waitcnt vmcnt(16)
Z a,144,a,240,v,64
s_barrier
TW a,224,33792
M a,144,a,244,v,68
DL 5,44,93,1032
M a,144,a,248,v,72
TW a,226,33920
M a,144,a,252,v,76
TW a,228,34048
Z a,148,a,240,v,96
TW a,230,34176
M a,148,a,244,v,100
TW a,232,34304
M a,148,a,248,v,104
TW a,234,34432
M a,148,a,252,v,108
TW a,236,34560
Z a,152,a,240,v,112
TW a,238,34688
M a,152,a,244,v,116
DL 5,48,93,2112
M a,152,a,248,v,120
RD v,64,3,50688
M a,152,a,252,v,124
RD v,68,3,50752
Z a,156,a,240,v,240
TW a,240,33800
M a,156,a,244,v,244
TW a,242,33928
M a,156,a,248,v,248
TW a,244,34056
M a,156,a,252,v,252
s_waitcnt lgkmcnt(5)
TW a,246,34184
M v,192,a,224,a,64
DL 5,52,93,3144
M v,192,a,228,a,80
TW a,248,34312
s_add_u32 m0, s92, 16896
M v,192,a,232,a,96
TW a,250,34440
s_xor_b32 s93, s4, 512
M v,192,a,236,a,112
TW a,252,34568
M v,196,a,224,a,68
TW a,254,34696
M v,196,a,228,a,84
RD v,96,3,51200
M v,196,a,232,a,100
RD v,100,3,51264
v_xor_b32 v3, 81920, v3
M v,196,a,236,a,116
RD v,112,3,0
M v,200,a,224,a,72
DL 7,56,93,0
M v,200,a,228,a,88
RD v,116,3,64
M v,200,a,232,a,104
RD v,240,3,512
M v,200,a,236,a,120
RD v,244,3,576
M v,204,a,224,a,76
TW a,224,33856
M v,204,a,228,a,92
TW a,226,33984
M v,204,a,232,a,108
TW a,228,34112
M v,204,a,236,a,124
s_waitcnt lgkmcnt(9)
TW a,230,34240
M a,32,a,240,a,64
DL 7,60,93,1056
M a,32,a,244,a,80
TW a,232,34368
M a,32,a,248,a,96
TW a,234,34496
M a,32,a,252,a,112
TW a,236,34624
M a,36,a,240,a,68
TW a,238,34752
M a,36,a,244,a,84
M a,36,a,248,a,100
M a,36,a,252,a,116
M a,40,a,240,a,72
DL 7,64,93,2112
M a,40,a,244,a,88
M a,40,a,248,a,104
M a,40,a,252,a,120
M a,44,a,240,a,76
TW a,240,33864
M a,44,a,244,a,92
TW a,242,33992
M a,44,a,248,a,108
TW a,244,34120
M a,44,a,252,a,124
s_waitcnt lgkmcnt(3)
TW a,246,34248
M v,208,a,224,a,64
DL 7,68,93,3168
M v,208,a,228,a,80
TW a,248,34376
M v,208,a,232,a,96
TW a,250,34504
M v,208,a,236,a,112
TW a,252,34632
M v,212,a,224,a,68
TW a,254,34760
v_xor_b32 v11, 81920, v11
M v,212,a,228,a,84
M v,212,a,232,a,100
M v,212,a,236,a,116
M v,216,a,224,a,72
M v,216,a,228,a,88
M v,216,a,232,a,104
M v,216,a,236,a,120
M v,220,a,224,a,76
M v,220,a,228,a,92
M v,220,a,232,a,108
M v,220,a,236,a,124
s_waitcnt lgkmcnt(0)
s_waitcnt vmcnt(8)
M a,48,a,240,a,64
s_barrier
TW a,224,16896
M a,48,a,244,a,80
TW a,226,17024
s_add_u32 m0, s92, 33792
M a,48,a,248,a,96
TW a,228,17152
s_xor_b32 s93, s4, 29184
M a,48,a,252,a,112
TW a,230,17280
M a,52,a,240,a,68
TW a,232,17408
M a,52,a,244,a,84
TW a,234,17536
M a,52,a,248,a,100
DL 7,56,93,0
M a,52,a,252,a,116
TW a,236,17664
M a,56,a,240,a,72
TW a,238,17792
M a,56,a,244,a,88
RD v,72,3,33792
M a,56,a,248,a,104
RD v,76,3,33856
M a,56,a,252,a,120
RD v,104,3,34304
M a,60,a,240,a,76
DL 7,60,93,1056
M a,60,a,244,a,92
TW a,240,16904
M a,60,a,248,a,108
TW a,242,17032
M a,60,a,252,a,124
s_waitcnt lgkmcnt(5)
TW a,244,17160
M v,224,a,224,a,64
TW a,246,17288
v_lshrrev_b32 v8, 12, v4
M v,224,a,228,a,80
TW a,248,17416
v_lshl_add_u32 v8, v8, 7, v4
M v,224,a,232,a,96
DL 7,64,93,2112
M v,224,a,236,a,112
TW a,250,17544
v_xor_b32 v8, 81920, v8
M v,228,a,224,a,68
TW a,252,17672
M v,228,a,228,a,84
TW a,254,17800
M v,228,a,232,a,100
RD v,108,3,34368
M v,228,a,236,a,116
RD v,120,3,50688
M v,232,a,224,a,72
DL 7,68,93,3168
M v,232,a,228,a,88
s_add_u32 m0, s92, 50688
s_mov_b32 s93, 2097664
M v,232,a,232,a,104
RD v,124,3,50752
M v,232,a,236,a,120
RD v,248,3,51200
M v,236,a,224,a,76
RD v,252,3,51264
M v,236,a,228,a,92
TW a,224,16960
M v,236,a,232,a,108
DL 6,40,93,0
M v,236,a,236,a,124
s_waitcnt lgkmcnt(6)
TW a,226,17088
M a,128,a,240,a,64
TW a,228,17216
M a,128,a,244,a,80
TW a,230,17344
M a,128,a,248,a,96
TW a,232,17472
M a,128,a,252,a,112
TW a,234,17600
M a,132,a,240,a,68
TW a,236,17728
v_xor_b32 v3, 81920, v3
M a,132,a,244,a,84
DL 6,44,93,1032
M a,132,a,248,a,100
TW a,238,17856
M a,132,a,252,a,116
M a,136,a,240,a,72
M a,136,a,244,a,88
M a,136,a,248,a,104
DL 6,48,93,2112
M a,136,a,252,a,120
M a,140,a,240,a,76
TW a,240,16968
M a,140,a,244,a,92
TW a,242,17096
M a,140,a,248,a,108
TW a,244,17224
M a,140,a,252,a,124
s_waitcnt lgkmcnt(3)
TW a,246,17352
M v,80,a,224,a,64
DL 6,52,93,3144
M v,80,a,228,a,80
TW a,248,17480
s_add_u32 m0, s92, 81920
M v,80,a,232,a,96
TW a,250,17608
s_mov_b32 s93, 2622080
M v,80,a,236,a,112
TW a,252,17736
M v,84,a,224,a,68
TW a,254,17864
v_xor_b32 v11, 81920, v11
M v,84,a,228,a,84
M v,84,a,232,a,100
M v,84,a,236,a,116
M v,88,a,224,a,72
DL 5,40,93,0
M v,88,a,228,a,88
M v,88,a,232,a,104
M v,88,a,236,a,120
M v,92,a,224,a,76
M v,92,a,228,a,92
M v,92,a,232,a,108
M v,92,a,236,a,124
s_waitcnt lgkmcnt(0)
s_waitcnt vmcnt(13)
M a,144,a,240,a,64
s_barrier
TW a,224,0
M a,144,a,244,a,80
DL 5,44,93,1032
M a,144,a,248,a,96
ds_write_b128 v8, v[16:19] offset:16896
M a,144,a,252,a,112
TW a,226,128
CV 16,20
M a,148,a,240,a,68
TW a,228,256
CV 17,22
M a,148,a,244,a,84
TW a,230,384
CV 18,24
M a,148,a,248,a,100
TW a,232,512
CV 19,26
M a,148,a,252,a,116
TW a,234,640
AR 20,172
M a,152,a,240,a,72
TW a,236,768
AR 21,173
M a,152,a,244,a,88
TW a,238,896
AR 22,174
M a,152,a,248,a,104
DL 5,48,93,2112
M a,152,a,252,a,120
AR 23,175
AR 24,188
M a,156,a,240,a,76
TW a,240,8
AR 25,189
M a,156,a,244,a,92
TW a,242,136
AR 26,190
M a,156,a,248,a,108
TW a,244,264
AR 27,191
M a,156,a,252,a,124
s_waitcnt lgkmcnt(3)
TW a,246,392
M v,128,a,224,v,64
DL 5,52,93,3144
M v,128,a,228,v,68
TW a,248,520
s_add_u32 m0, s92, 132608
M v,128,a,232,v,72
TW a,250,648
s_mov_b32 s93, 2097920
M v,128,a,236,v,76
ds_write_b128 v8, v[12:15] offset:17952
M v,132,a,224,v,96
TW a,252,776
CV 12,20
M v,132,a,228,v,100
TW a,254,904
CV 13,22
M v,132,a,232,v,104
CV 14,24
CV 15,26
M v,132,a,236,v,108
ds_write_b128 v8, v[16:19] offset:19008
M v,136,a,224,v,112
DL 6,40,93,0
M v,136,a,228,v,116
s_branch L_c2A
L_rsA7:
s_mov_b32 s100, 131072
s_call_b64 s[98:99], L_rareA
s_branch L_rbA7
L_rsA8:
s_mov_b32 s100, 147456
s_call_b64 s[98:99], L_rareA
s_branch L_rbA8
L_rsA9:
s_mov_b32 s100, 163840
s_call_b64 s[98:99], L_rareA
s_branch L_rbA9
L_rsA10:
s_mov_b32 s100, 180224
s_call_b64 s[98:99], L_rareA
s_branch L_rbA10
L_rsA11:
s_mov_b32 s100, 196608
s_call_b64 s[98:99], L_rareA
s_branch L_rbA11
L_rsA12:
s_mov_b32 s100, 212992
s_call_b64 s[98:99], L_rareA
s_branch L_rbA12
L_rsA13:
s_mov_b32 s100, 229376
s_call_b64 s[98:99], L_rareA
s_branch L_rbA13
L_rsA14:
s_mov_b32 s100, 245760
s_call_b64 s[98:99], L_rareA
s_branch L_rbA14
.p2align 12
L_c1B:
M v,100,v,44,v,180
CV 87,118
CV 90,120
MC 104,v,32,136,72
RD v,32,1,51200
CV 91,122
M v,104,v,36,v,152
RD v,36,1,51264
AD 12,12,16
M v,104,v,40,v,168
DN 4,16,2,2112
M v,104,v,44,v,184
s_waitcnt lgkmcnt(2)
RD v,40,1,51328
M v,96,v,48,v,192
RD v,44,1,51392
AD 13,13,17
M v,96,v,52,v,208
AD 14,14,18
M v,96,v,56,v,224
M v,96,v,60,v,240
v_xor_b32 v2, 81920, v2
M v,100,v,48,v,196
M v,100,v,52,v,212
M v,100,v,56,v,228
M v,100,v,60,v,244
M v,104,v,48,v,200
RD v,48,1,51456
M v,104,v,52,v,216
EX 96
M v,104,v,56,v,232
EX 97
M v,104,v,60,v,248
s_waitcnt lgkmcnt(1)
RD v,52,1,51520
MC 112,v,32,128,64
RD v,56,1,51584
AD 16,96,97
M v,112,v,36,v,144
DN 4,20,2,3168
M v,112,v,40,v,160
RD v,60,1,51648
s_add_u32 m0, s92, 0
M v,112,v,44,v,176
EX 100
MC 116,v,32,132,68
EX 101
M v,116,v,36,v,148
s_mov_b32 s2, 147456
AD 17,100,101
M v,116,v,40,v,164
EX 104
M v,116,v,44,v,180
EX 105
MC 120,v,32,136,72
EX 98
M v,120,v,36,v,152
EX 102
M v,120,v,40,v,168
EX 106
M v,120,v,44,v,184
s_waitcnt lgkmcnt(0)
s_waitcnt vmcnt(12)
M v,112,v,48,v,192
s_barrier
TR v,32,0
M v,112,v,52,v,208
TR v,34,512
AD 18,104,105
M v,112,v,56,v,224
TR v,36,32
AD 16,16,98
M v,112,v,60,v,240
TR v,38,544
AD 17,17,102
M v,116,v,48,v,196
TR v,40,64
AD 18,18,106
M v,116,v,52,v,212
TR v,42,576
M v,116,v,56,v,228
TR v,44,96
TR v,46,608
M v,116,v,60,v,244
DN 4,24,2,0
M v,120,v,48,v,200
EX 99
M v,120,v,52,v,216
TR v,48,128
AD 16,16,99
M v,120,v,56,v,232
EX 103
M v,120,v,60,v,248
s_waitcnt lgkmcnt(1)
TR v,50,640
M a,0,v,32,v,80
TR v,52,160
AD 17,17,103
M a,4,v,32,v,84
EX 107
M a,8,v,32,v,88
TR v,54,672
AD 18,18,107
M a,16,v,36,v,80
TR v,56,192
M a,20,v,36,v,84
TR v,58,704
M a,24,v,36,v,88
TR v,60,224
M a,32,v,40,v,80
TR v,62,736
M a,36,v,40,v,84
DN 4,28,2,1056
M a,40,v,40,v,88
EX 112
M a,48,v,44,v,80
TR v,32,256
AD 16,16,112
M a,52,v,44,v,84
EX 116
M a,56,v,44,v,88
s_waitcnt lgkmcnt(1)
TR v,34,768
M a,64,v,48,v,80
TR v,36,288
AD 17,17,116
M a,68,v,48,v,84
EX 120
M a,72,v,48,v,88
TR v,38,800
AD 18,18,120
M a,80,v,52,v,80
TR v,40,320
v_xor_b32 v1, 81920, v1
M a,84,v,52,v,84
TR v,42,832
M a,88,v,52,v,88
TR v,44,352
M a,96,v,56,v,80
TR v,46,864
M a,100,v,56,v,84
DN 4,32,2,2112
M a,104,v,56,v,88
EX 113
M a,112,v,60,v,80
TR v,48,384
AD 16,16,113
M a,116,v,60,v,84
EX 117
M a,120,v,60,v,88
s_waitcnt lgkmcnt(1)
TR v,50,896
M a,128,v,32,v,80
TR v,52,416
AD 17,17,117
M a,132,v,32,v,84
EX 121
M a,136,v,32,v,88
TR v,54,928
AD 18,18,121
M a,144,v,36,v,80
TR v,56,448
M a,148,v,36,v,84
TR v,58,960
M a,152,v,36,v,88
TR v,60,480
M a,160,v,40,v,80
TR v,62,992
M a,164,v,40,v,84
DN 4,36,2,3168
M a,168,v,40,v,88
EX 114
M a,176,v,44,v,80
EX 118
M a,180,v,44,v,84
EX 122
M a,184,v,44,v,88
s_waitcnt lgkmcnt(0)
s_waitcnt vmcnt(12)
M a,192,v,48,v,80
s_barrier
RD v,32,1,16896
M a,196,v,48,v,84
RD v,36,1,16960
AD 16,16,114
M a,200,v,48,v,88
RD v,40,1,17024
AD 17,17,118
M a,208,v,52,v,80
RD v,44,1,17088
AD 18,18,122
M a,212,v,52,v,84
EX 115
M a,216,v,52,v,88
EX 119
M a,224,v,56,v,80
EX 123
M a,228,v,56,v,84
AD 16,16,115
AD 17,17,119
M a,232,v,56,v,88
AD 18,18,123
v_max3_f32 v20, v16, v17, v18
M a,240,v,60,v,80
v_cmp_lt_f32 vcc, 0x4b800000, v20
s_add_u32 m0, s92, 16896
M a,244,v,60,v,84
s_waitcnt lgkmcnt(0)
s_mov_b32 s2, 180224
M a,248,v,60,v,88
CV 80,96
CV 81,98
s_cbranch_vccnz L_rsB7
L_rbB7:
MC 96,v,32,128,64
DN 4,8,2,0
M v,96,v,36,v,144
CV 84,100
CV 85,102
M v,96,v,40,v,160
RD v,48,1,17152
CV 88,104
M v,96,v,44,v,176
RD v,52,1,17216
CV 89,106
MC 100,v,32,132,68
RD v,56,1,17280
CV 82,112
M v,100,v,36,v,148
RD v,60,1,17344
CV 83,114
M v,100,v,40,v,164
CV 86,116
CV 87,118
M v,100,v,44,v,180
CV 90,120
CV 91,122
MC 104,v,32,136,72
RD v,32,1,17408
AD 12,12,16
M v,104,v,36,v,152
DN 4,12,2,1056
M v,104,v,40,v,168
RD v,36,1,17472
AD 13,13,17
M v,104,v,44,v,184
s_waitcnt lgkmcnt(2)
RD v,40,1,17536
M v,96,v,48,v,192
RD v,44,1,17600
AD 14,14,18
M v,96,v,52,v,208
M v,96,v,56,v,224
M v,96,v,60,v,240
M v,100,v,48,v,196
M v,100,v,52,v,212
M v,100,v,56,v,228
M v,100,v,60,v,244
M v,104,v,48,v,200
RD v,48,1,17664
M v,104,v,52,v,216
RD v,52,1,17728
M v,104,v,56,v,232
DN 4,16,2,2112
M v,104,v,60,v,248
s_waitcnt lgkmcnt(2)
RD v,56,1,17792
MC 112,v,32,128,64
EX 96
M v,112,v,36,v,144
EX 97
M v,112,v,40,v,160
RD v,60,1,17856
AD 16,96,97
M v,112,v,44,v,176
EX 100
MC 116,v,32,132,68
EX 101
M v,116,v,36,v,148
EX 104
M v,116,v,40,v,164
EX 105
M v,116,v,44,v,180
EX 98
MC 120,v,32,136,72
EX 102
M v,120,v,36,v,152
EX 106
M v,120,v,40,v,168
AD 17,100,101
AD 18,104,105
M v,120,v,44,v,184
s_waitcnt lgkmcnt(0)
s_waitcnt vmcnt(11)
M v,112,v,48,v,192
s_mov_b64 exec, 0
s_branch L_pad9
L_ret9:
s_mov_b64 exec, -1
s_barrier
TR v,32,33792
M v,112,v,52,v,208
TR v,34,34304
AD 16,16,98
M v,112,v,56,v,224
TR v,36,33824
AD 17,17,102
M v,112,v,60,v,240
TR v,38,34336
AD 18,18,106
M v,116,v,48,v,196
TR v,40,33856
M v,116,v,52,v,212
TR v,42,34368
M v,116,v,56,v,228
TR v,44,33888
TR v,46,34400
M v,116,v,60,v,244
DN 4,20,2,3168
M v,120,v,48,v,200
TR v,48,33920
s_add_u32 m0, s92, 33792
M v,120,v,52,v,216
TR v,50,34432
s_mov_b32 s2, 163840
M v,120,v,56,v,232
EX 99
M v,120,v,60,v,248
s_waitcnt lgkmcnt(2)
TR v,52,33952
M a,0,v,32,v,80
TR v,54,34464
AD 16,16,99
M a,4,v,32,v,84
DN 4,24,2,0
M a,8,v,32,v,88
EX 103
M a,16,v,36,v,80
TR v,56,33984
AD 17,17,103
M a,20,v,36,v,84
TR v,58,34496
M a,24,v,36,v,88
TR v,60,34016
M a,32,v,40,v,80
TR v,62,34528
M a,36,v,40,v,84
EX 107
M a,40,v,40,v,88
TR v,32,34048
AD 18,18,107
M a,48,v,44,v,80
EX 112
M a,52,v,44,v,84
TR v,34,34560
AD 16,16,112
M a,56,v,44,v,88
s_waitcnt lgkmcnt(2)
TR v,36,34080
M a,64,v,48,v,80
EX 116
M a,68,v,48,v,84
TR v,38,34592
AD 17,17,116
M a,72,v,48,v,88
EX 120
M a,80,v,52,v,80
TR v,40,34112
AD 18,18,120
M a,84,v,52,v,84
TR v,42,34624
M a,88,v,52,v,88
TR v,44,34144
M a,96,v,56,v,80
TR v,46,34656
M a,100,v,56,v,84
DN 4,28,2,1056
M a,104,v,56,v,88
EX 113
M a,112,v,60,v,80
TR v,48,34176
AD 16,16,113
M a,116,v,60,v,84
EX 117
M a,120,v,60,v,88
s_waitcnt lgkmcnt(1)
TR v,50,34688
M a,128,v,32,v,80
TR v,52,34208
AD 17,17,117
M a,132,v,32,v,84
EX 121
M a,136,v,32,v,88
TR v,54,34720
AD 18,18,121
M a,144,v,36,v,80
TR v,56,34240
M a,148,v,36,v,84
TR v,58,34752
M a,152,v,36,v,88
TR v,60,34272
M a,160,v,40,v,80
TR v,62,34784
M a,164,v,40,v,84
DN 4,32,2,2112
M a,168,v,40,v,88
EX 114
M a,176,v,44,v,80
EX 118
M a,180,v,44,v,84
EX 122
M a,184,v,44,v,88
s_waitcnt lgkmcnt(0)
s_waitcnt vmcnt(11)
M a,192,v,48,v,80
s_barrier
RD v,32,1,50688
M a,196,v,48,v,84
RD v,36,1,50752
AD 16,16,114
M a,200,v,48,v,88
RD v,40,1,50816
AD 17,17,118
M a,208,v,52,v,80
RD v,44,1,50880
AD 18,18,122
M a,212,v,52,v,84
EX 115
M a,216,v,52,v,88
EX 119
M a,224,v,56,v,80
EX 123
M a,228,v,56,v,84
AD 16,16,115
AD 17,17,119
M a,232,v,56,v,88
RD v,48,1,50944
AD 18,18,123
M a,240,v,60,v,80
v_max3_f32 v20, v16, v17, v18
v_cmp_lt_f32 vcc, 0x4b800000, v20
M a,244,v,60,v,84
s_waitcnt lgkmcnt(1)
CV 80,96
M a,248,v,60,v,88
DN 4,36,2,3168
CV 81,98
s_cbranch_vccnz L_rsB8
L_rbB8:
MC 96,v,32,128,64
CV 84,100
CV 85,102
M v,96,v,36,v,144
RD v,52,1,51008
CV 88,104
M v,96,v,40,v,160
RD v,56,1,51072
CV 89,106
M v,96,v,44,v,176
RD v,60,1,51136
s_add_u32 m0, s92, 50688
MC 100,v,32,132,68
s_mov_b32 s2, 196608
CV 82,112
M v,100,v,36,v,148
CV 83,114
CV 86,116
M v,100,v,40,v,164
CV 87,118
CV 90,120
M v,100,v,44,v,180
DN 4,8,2,0
MC 104,v,32,136,72
RD v,32,1,51200
CV 91,122
M v,104,v,36,v,152
RD v,36,1,51264
AD 12,12,16
M v,104,v,40,v,168
RD v,40,1,51328
AD 13,13,17
M v,104,v,44,v,184
s_waitcnt lgkmcnt(3)
RD v,44,1,51392
M v,96,v,48,v,192
AD 14,14,18
M v,96,v,52,v,208
M v,96,v,56,v,224
M v,96,v,60,v,240
v_xor_b32 v2, 81920, v2
M v,100,v,48,v,196
M v,100,v,52,v,212
M v,100,v,56,v,228
M v,100,v,60,v,244
M v,104,v,48,v,200
RD v,48,1,51456
M v,104,v,52,v,216
DN 4,12,2,1056
M v,104,v,56,v,232
EX 96
M v,104,v,60,v,248
s_waitcnt lgkmcnt(1)
RD v,52,1,51520
MC 112,v,32,128,64
EX 97
M v,112,v,36,v,144
RD v,56,1,51584
AD 16,96,97
M v,112,v,40,v,160
EX 100
M v,112,v,44,v,176
RD v,60,1,51648
MC 116,v,32,132,68
EX 101
M v,116,v,36,v,148
EX 104
M v,116,v,40,v,164
EX 105
M v,116,v,44,v,180
EX 98
MC 120,v,32,136,72
EX 102
M v,120,v,36,v,152
EX 106
M v,120,v,40,v,168
DN 4,16,2,2112
M v,120,v,44,v,184
s_waitcnt lgkmcnt(0)
s_waitcnt vmcnt(11)
M v,112,v,48,v,192
s_barrier
TR v,32,0
M v,112,v,52,v,208
TR v,34,512
AD 17,100,101
M v,112,v,56,v,224
TR v,36,32
AD 18,104,105
M v,112,v,60,v,240
TR v,38,544
AD 16,16,98
M v,116,v,48,v,196
TR v,40,64
AD 17,17,102
M v,116,v,52,v,212
TR v,42,576
AD 18,18,106
M v,116,v,56,v,228
TR v,44,96
TR v,46,608
M v,116,v,60,v,244
EX 99
M v,120,v,48,v,200
TR v,48,128
AD 16,16,99
M v,120,v,52,v,216
EX 103
M v,120,v,56,v,232
TR v,50,640
AD 17,17,103
M v,120,v,60,v,248
s_waitcnt lgkmcnt(2)
TR v,52,160
M a,0,v,32,v,80
DN 4,20,2,3168
M a,4,v,32,v,84
TR v,54,672
s_add_u32 m0, s92, 81920
M a,8,v,32,v,88
TR v,56,192
s_mov_b32 s2, 180224
M a,16,v,36,v,80
TR v,58,704
M a,20,v,36,v,84
TR v,60,224
M a,24,v,36,v,88
TR v,62,736
M a,32,v,40,v,80
EX 107
M a,36,v,40,v,84
TR v,32,256
AD 18,18,107
M a,40,v,40,v,88
EX 112
M a,48,v,44,v,80
TR v,34,768
AD 16,16,112
M a,52,v,44,v,84
EX 116
M a,56,v,44,v,88
s_waitcnt lgkmcnt(2)
TR v,36,288
M a,64,v,48,v,80
TR v,38,800
AD 17,17,116
M a,68,v,48,v,84
DN 4,24,2,0
M a,72,v,48,v,88
EX 120
M a,80,v,52,v,80
TR v,40,320
v_xor_b32 v1, 81920, v1
M a,84,v,52,v,84
TR v,42,832
AD 18,18,120
M a,88,v,52,v,88
TR v,44,352
M a,96,v,56,v,80
TR v,46,864
M a,100,v,56,v,84
EX 113
M a,104,v,56,v,88
TR v,48,384
AD 16,16,113
M a,112,v,60,v,80
EX 117
M a,116,v,60,v,84
TR v,50,896
AD 17,17,117
M a,120,v,60,v,88
s_waitcnt lgkmcnt(2)
TR v,52,416
M a,128,v,32,v,80
EX 121
M a,132,v,32,v,84
TR v,54,928
AD 18,18,121
M a,136,v,32,v,88
EX 114
M a,144,v,36,v,80
TR v,56,448
AD 16,16,114
M a,148,v,36,v,84
TR v,58,960
M a,152,v,36,v,88
TR v,60,480
M a,160,v,40,v,80
TR v,62,992
M a,164,v,40,v,84
DN 4,28,2,1056
M a,168,v,40,v,88
EX 118
M a,176,v,44,v,80
EX 122
M a,180,v,44,v,84
EX 115
M a,184,v,44,v,88
s_waitcnt lgkmcnt(0)
s_waitcnt vmcnt(10)
M a,192,v,48,v,80
s_barrier
RD v,32,1,16896
M a,196,v,48,v,84
RD v,36,1,16960
AD 17,17,118
M a,200,v,48,v,88
RD v,40,1,17024
AD 18,18,122
M a,208,v,52,v,80
RD v,44,1,17088
AD 16,16,115
M a,212,v,52,v,84
EX 119
M a,216,v,52,v,88
EX 123
M a,224,v,56,v,80
AD 17,17,119
AD 18,18,123
M a,228,v,56,v,84
DN 4,32,2,2112
M a,232,v,56,v,88
RD v,48,1,17152
v_max3_f32 v20, v16, v17, v18
M a,240,v,60,v,80
v_cmp_lt_f32 vcc, 0x4b800000, v20
CV 80,96
M a,244,v,60,v,84
s_waitcnt lgkmcnt(1)
CV 81,98
M a,248,v,60,v,88
s_cbranch_vccnz L_rsB9
L_rbB9:
MC 96,v,32,128,64
CV 84,100
CV 85,102
M v,96,v,36,v,144
RD v,52,1,17216
CV 88,104
M v,96,v,40,v,160
RD v,56,1,17280
CV 89,106
M v,96,v,44,v,176
RD v,60,1,17344
CV 82,112
MC 100,v,32,132,68
CV 83,114
CV 86,116
M v,100,v,36,v,148
CV 87,118
CV 90,120
M v,100,v,40,v,164
DN 4,36,2,3168
M v,100,v,44,v,180
s_add_u32 m0, s92, 98816
s_mov_b32 s2, 212992
MC 104,v,32,136,72
RD v,32,1,17408
CV 91,122
M v,104,v,36,v,152
RD v,36,1,17472
AD 12,12,16
M v,104,v,40,v,168
RD v,40,1,17536
AD 13,13,17
M v,104,v,44,v,184
s_waitcnt lgkmcnt(3)
RD v,44,1,17600
M v,96,v,48,v,192
AD 14,14,18
M v,96,v,52,v,208
M v,96,v,56,v,224
M v,96,v,60,v,240
M v,100,v,48,v,196
M v,100,v,52,v,212
M v,100,v,56,v,228
M v,100,v,60,v,244
DN 4,8,2,0
M v,104,v,48,v,200
RD v,48,1,17664
M v,104,v,52,v,216
EX 96
M v,104,v,56,v,232
EX 97
M v,104,v,60,v,248
s_waitcnt lgkmcnt(1)
RD v,52,1,17728
MC 112,v,32,128,64
RD v,56,1,17792
AD 16,96,97
M v,112,v,36,v,144
EX 100
M v,112,v,40,v,160
EX 101
M v,112,v,44,v,176
RD v,60,1,17856
AD 17,100,101
MC 116,v,32,132,68
EX 104
M v,116,v,36,v,148
EX 105
M v,116,v,40,v,164
EX 98
M v,116,v,44,v,180
EX 102
MC 120,v,32,136,72
EX 106
M v,120,v,36,v,152
DN 4,12,2,1056
M v,120,v,40,v,168
AD 18,104,105
AD 16,16,98
M v,120,v,44,v,184
s_waitcnt lgkmcnt(0)
s_waitcnt vmcnt(10)
M v,112,v,48,v,192
s_mov_b64 exec, 0
s_branch L_pad10
L_ret10:
s_mov_b64 exec, -1
s_barrier
TR v,32,33792
M v,112,v,52,v,208
TR v,34,34304
AD 17,17,102
M v,112,v,56,v,224
TR v,36,33824
AD 18,18,106
M v,112,v,60,v,240
TR v,38,34336
M v,116,v,48,v,196
TR v,40,33856
M v,116,v,52,v,212
TR v,42,34368
M v,116,v,56,v,228
TR v,44,33888
TR v,46,34400
M v,116,v,60,v,244
EX 99
M v,120,v,48,v,200
TR v,48,33920
AD 16,16,99
M v,120,v,52,v,216
EX 103
M v,120,v,56,v,232
DN 4,16,2,2112
M v,120,v,60,v,248
s_waitcnt lgkmcnt(1)
TR v,50,34432
M a,0,v,32,v,80
TR v,52,33952
AD 17,17,103
M a,4,v,32,v,84
EX 107
M a,8,v,32,v,88
TR v,54,34464
AD 18,18,107
M a,16,v,36,v,80
TR v,56,33984
M a,20,v,36,v,84
TR v,58,34496
M a,24,v,36,v,88
TR v,60,34016
M a,32,v,40,v,80
TR v,62,34528
M a,36,v,40,v,84
EX 112
M a,40,v,40,v,88
TR v,32,34048
AD 16,16,112
M a,48,v,44,v,80
TR v,34,34560
v_bfe_u32 v8, v4, 8, 2
M a,52,v,44,v,84
TR v,36,34080
v_lshrrev_b32 v9, 14, s95
M a,56,v,44,v,88
s_waitcnt lgkmcnt(3)
TR v,38,34592
M a,64,v,48,v,80
TR v,40,34112
v_add_lshl_u32 v8, v8, v9, 7
M a,68,v,48,v,84
TR v,42,34624
v_add_u32 v8, 4096, v8
M a,72,v,48,v,88
TR v,44,34144
v_mov_b32 v9, 0
M a,80,v,52,v,80
TR v,46,34656
M a,84,v,52,v,84
DN 4,20,2,3168
M a,88,v,52,v,88
s_getpc_b64 s[100:101]
s_and_b32 s100, s100, 0xfffff000
M a,96,v,56,v,80
TR v,48,34176
v_lshl_add_u64 v[8:9], v[8:9], 0, s[100:101]
M a,100,v,56,v,84
TR v,50,34688
s_add_u32 m0, s92, 115712
M a,104,v,56,v,88
TR v,52,34208
s_mov_b32 s2, 196608
M a,112,v,60,v,80
global_load_dword v10, v[8:9], off
M a,116,v,60,v,84
EX 116
M a,120,v,60,v,88
s_waitcnt lgkmcnt(3)
TR v,54,34720
M a,128,v,32,v,80
TR v,56,34240
AD 17,17,116
M a,132,v,32,v,84
DN 4,24,2,0
M a,136,v,32,v,88
EX 120
M a,144,v,36,v,80
TR v,58,34752
AD 18,18,120
M a,148,v,36,v,84
TR v,60,34272
M a,152,v,36,v,88
TR v,62,34784
M a,160,v,40,v,80
EX 113
M a,164,v,40,v,84
EX 117
M a,168,v,40,v,88
EX 121
M a,176,v,44,v,80
EX 114
M a,180,v,44,v,84
EX 118
M a,184,v,44,v,88
s_waitcnt lgkmcnt(0)
s_waitcnt vmcnt(10)
M a,192,v,48,v,80
s_barrier
RD v,32,1,50688
M a,196,v,48,v,84
RD v,36,1,50752
AD 16,16,113
M a,200,v,48,v,88
RD v,40,1,50816
AD 17,17,117
M a,208,v,52,v,80
RD v,44,1,50880
AD 18,18,121
M a,212,v,52,v,84
EX 122
M a,216,v,52,v,88
EX 115
M a,224,v,56,v,80
EX 119
M a,228,v,56,v,84
EX 123
M a,232,v,56,v,88
DN 4,28,2,1056
M a,240,v,60,v,80
AD 16,16,114
AD 17,17,118
M a,244,v,60,v,84
AD 18,18,122
AD 16,16,115
M a,248,v,60,v,88
AD 17,17,119
AD 18,18,123
v_max3_f32 v20, v16, v17, v18
v_cmp_lt_f32 vcc, 0x4b800000, v20
s_waitcnt lgkmcnt(0)
CV 80,96
CV 81,98
s_cbranch_vccnz L_rsB10
L_rbB10:
MC 96,v,32,128,64
CV 84,100
CV 85,102
M v,96,v,36,v,144
RD v,48,1,50944
CV 88,104
M v,96,v,40,v,160
RD v,52,1,51008
CV 89,106
M v,96,v,44,v,176
RD v,56,1,51072
CV 82,112
MC 100,v,32,132,68
RD v,60,1,51136
CV 83,114
M v,100,v,36,v,148
DN 4,32,2,2112
M v,100,v,40,v,164
CV 86,116
CV 87,118
M v,100,v,44,v,180
CV 90,120
CV 91,122
MC 104,v,32,136,72
RD v,32,1,51200
AD 12,12,16
M v,104,v,36,v,152
RD v,36,1,51264
AD 13,13,17
M v,104,v,40,v,168
RD v,40,1,51328
AD 14,14,18
M v,104,v,44,v,184
s_waitcnt lgkmcnt(3)
RD v,44,1,51392
M v,96,v,48,v,192
M v,96,v,52,v,208
M v,96,v,56,v,224
M v,96,v,60,v,240
v_xor_b32 v2, 81920, v2
M v,100,v,48,v,196
M v,100,v,52,v,212
M v,100,v,56,v,228
DN 4,36,2,3168
M v,100,v,60,v,244
s_add_u32 m0, s92, 132608
s_mov_b32 s2, 229376
M v,104,v,48,v,200
EX 96
M v,104,v,52,v,216
EX 97
M v,104,v,56,v,232
RD v,48,1,51456
AD 16,96,97
M v,104,v,60,v,248
s_waitcnt lgkmcnt(1)
RD v,52,1,51520
MC 112,v,32,128,64
EX 100
M v,112,v,36,v,144
EX 101
M v,112,v,40,v,160
RD v,56,1,51584
AD 17,100,101
M v,112,v,44,v,176
RD v,60,1,51648
MC 116,v,32,132,68
EX 104
M v,116,v,36,v,148
EX 105
M v,116,v,40,v,164
EX 98
M v,116,v,44,v,180
DN 4,8,2,0
MC 120,v,32,136,72
EX 102
M v,120,v,36,v,152
EX 106
M v,120,v,40,v,168
AD 18,104,105
AD 16,16,98
M v,120,v,44,v,184
s_waitcnt lgkmcnt(0)
s_waitcnt vmcnt(10)
M v,112,v,48,v,192
s_barrier
TR v,32,0
M v,112,v,52,v,208
TR v,34,512
AD 17,17,102
M v,112,v,56,v,224
TR v,36,32
AD 18,18,106
M v,112,v,60,v,240
TR v,38,544
M v,116,v,48,v,196
TR v,40,64
M v,116,v,52,v,212
TR v,42,576
M v,116,v,56,v,228
TR v,44,96
TR v,46,608
M v,116,v,60,v,244
EX 99
M v,120,v,48,v,200
TR v,48,128
AD 16,16,99
M v,120,v,52,v,216
DN 4,12,2,1056
M v,120,v,56,v,232
EX 103
M v,120,v,60,v,248
s_waitcnt lgkmcnt(1)
TR v,50,640
M a,0,v,32,v,80
TR v,52,160
AD 17,17,103
M a,4,v,32,v,84
EX 107
M a,8,v,32,v,88
TR v,54,672
AD 18,18,107
M a,16,v,36,v,80
TR v,56,192
M a,20,v,36,v,84
TR v,58,704
M a,24,v,36,v,88
TR v,60,224
M a,32,v,40,v,80
TR v,62,736
M a,36,v,40,v,84
EX 112
M a,40,v,40,v,88
TR v,32,256
AD 16,16,112
M a,48,v,44,v,80
EX 116
M a,52,v,44,v,84
DN 4,16,2,2112
M a,56,v,44,v,88
s_waitcnt lgkmcnt(1)
TR v,34,768
M a,64,v,48,v,80
TR v,36,288
AD 17,17,116
M a,68,v,48,v,84
EX 120
M a,72,v,48,v,88
TR v,38,800
AD 18,18,120
M a,80,v,52,v,80
TR v,40,320
v_xor_b32 v1, 81920, v1
M a,84,v,52,v,84
TR v,42,832
M a,88,v,52,v,88
TR v,44,352
M a,96,v,56,v,80
TR v,46,864
M a,100,v,56,v,84
EX 113
M a,104,v,56,v,88
TR v,48,384
AD 16,16,113
M a,112,v,60,v,80
EX 117
M a,116,v,60,v,84
TR v,50,896
AD 17,17,117
M a,120,v,60,v,88
s_waitcnt lgkmcnt(2)
TR v,52,416
M a,128,v,32,v,80
DN 4,20,2,3168
M a,132,v,32,v,84
TR v,54,928
s_add_u32 m0, s92, 0
M a,136,v,32,v,88
TR v,56,448
s_mov_b32 s2, 212992
M a,144,v,36,v,80
TR v,58,960
M a,148,v,36,v,84
TR v,60,480
M a,152,v,36,v,88
TR v,62,992
M a,160,v,40,v,80
EX 121
M a,164,v,40,v,84
EX 114
M a,168,v,40,v,88
EX 118
M a,176,v,44,v,80
EX 122
M a,180,v,44,v,84
AD 18,18,121
AD 16,16,114
M a,184,v,44,v,88
s_waitcnt lgkmcnt(0)
s_waitcnt vmcnt(9)
M a,192,v,48,v,80
s_barrier
RD v,32,1,16896
M a,196,v,48,v,84
RD v,36,1,16960
AD 17,17,118
M a,200,v,48,v,88
RD v,40,1,17024
AD 18,18,122
M a,208,v,52,v,80
RD v,44,1,17088
s_xor_b32 s93, s4, 0
M a,212,v,52,v,84
DN 4,24,2,0
M a,216,v,52,v,88
EX 115
M a,224,v,56,v,80
EX 119
M a,228,v,56,v,84
EX 123
M a,232,v,56,v,88
AD 16,16,115
AD 17,17,119
M a,240,v,60,v,80
AD 18,18,123
v_max3_f32 v20, v16, v17, v18
M a,244,v,60,v,84
v_cmp_lt_f32 vcc, 0x4b800000, v20
s_waitcnt lgkmcnt(0)
M a,248,v,60,v,88
CV 80,96
CV 81,98
s_cbranch_vccnz L_rsB11
L_rbB11:
MC 96,v,32,128,64
s_add_u32 m0, s92, 81920
CV 84,100
M v,96,v,36,v,144
RD v,48,1,17152
CV 85,102
M v,96,v,40,v,160
DL 7,56,93,0
M v,96,v,44,v,176
RD v,52,1,17216
s_add_u32 m0, s92, 0
MC 100,v,32,132,68
RD v,56,1,17280
CV 88,104
M v,100,v,36,v,148
RD v,60,1,17344
CV 89,106
M v,100,v,40,v,164
DN 4,28,2,1056
M v,100,v,44,v,180
s_add_u32 m0, s92, 81920
CV 82,112
MC 104,v,32,136,72
RD v,32,1,17408
CV 83,114
M v,104,v,36,v,152
RD v,36,1,17472
CV 86,116
M v,104,v,40,v,168
RD v,40,1,17536
CV 87,118
M v,104,v,44,v,184
s_waitcnt lgkmcnt(3)
RD v,44,1,17600
M v,96,v,48,v,192
DL 7,60,93,1056
M v,96,v,52,v,208
s_add_u32 m0, s92, 0
CV 90,120
M v,96,v,56,v,224
CV 91,122
AD 12,12,16
M v,96,v,60,v,240
AD 13,13,17
AD 14,14,18
M v,100,v,48,v,196
DN 4,32,2,2112
M v,100,v,52,v,212
s_add_u32 m0, s92, 81920
M v,100,v,56,v,228
M v,100,v,60,v,244
EX 96
M v,104,v,48,v,200
EX 97
M v,104,v,52,v,216
RD v,48,1,17664
AD 16,96,97
M v,104,v,56,v,232
EX 98
M v,104,v,60,v,248
s_waitcnt lgkmcnt(1)
RD v,52,1,17728
MC 112,v,32,128,64
DL 7,64,93,2112
M v,112,v,36,v,144
RD v,56,1,17792
s_add_u32 m0, s92, 0
M v,112,v,40,v,160
RD v,60,1,17856
AD 16,16,98
M v,112,v,44,v,176
EX 100
MC 116,v,32,132,68
EX 101
M v,116,v,36,v,148
EX 104
M v,116,v,40,v,164
DN 4,36,2,3168
M v,116,v,44,v,180
s_add_u32 m0, s92, 81920
s_mov_b32 s2, 245760
MC 120,v,32,136,72
EX 105
M v,120,v,36,v,152
EX 102
M v,120,v,40,v,168
EX 106
M v,120,v,44,v,184
s_waitcnt lgkmcnt(0)
s_waitcnt vmcnt(11)
M v,112,v,48,v,192
s_mov_b64 exec, 0
s_branch L_pad11
L_ret11:
s_mov_b64 exec, -1
s_barrier
TR v,32,33792
M v,112,v,52,v,208
DL 7,68,93,3168
M v,112,v,56,v,224
TR v,34,34304
s_add_u32 m0, s92, 16896
M v,112,v,60,v,240
TR v,36,33824
s_xor_b32 s93, s4, 28672
M v,116,v,48,v,196
TR v,38,34336
AD 17,100,101
M v,116,v,52,v,212
TR v,40,33856
AD 18,104,105
M v,116,v,56,v,228
TR v,42,34368
TR v,44,33888
M v,116,v,60,v,244
TR v,46,34400
AD 17,17,102
M v,120,v,48,v,200
DN 4,8,2,0
M v,120,v,52,v,216
s_add_u32 m0, s92, 98816
TR v,48,33920
M v,120,v,56,v,232
TR v,50,34432
AD 18,18,106
M v,120,v,60,v,248
s_waitcnt lgkmcnt(2)
TR v,52,33952
M a,0,v,32,v,80
DL 7,56,93,0
M a,4,v,32,v,84
TR v,54,34464
s_add_u32 m0, s92, 16896
M a,8,v,32,v,88
EX 99
M a,16,v,36,v,80
TR v,56,33984
AD 16,16,99
M a,20,v,36,v,84
TR v,58,34496
M a,24,v,36,v,88
TR v,60,34016
M a,32,v,40,v,80
TR v,62,34528
M a,36,v,40,v,84
EX 103
M a,40,v,40,v,88
TR v,32,34048
AD 17,17,103
M a,48,v,44,v,80
DN 4,12,2,1056
M a,52,v,44,v,84
TR v,34,34560
s_add_u32 m0, s92, 98816
M a,56,v,44,v,88
s_waitcnt lgkmcnt(2)
TR v,36,34080
M a,64,v,48,v,80
EX 107
M a,68,v,48,v,84
TR v,38,34592
AD 18,18,107
M a,72,v,48,v,88
DL 7,60,93,1056
M a,80,v,52,v,80
TR v,40,34112
s_add_u32 m0, s92, 16896
M a,84,v,52,v,84
TR v,42,34624
M a,88,v,52,v,88
TR v,44,34144
M a,96,v,56,v,80
TR v,46,34656
M a,100,v,56,v,84
EX 112
M a,104,v,56,v,88
TR v,48,34176
AD 16,16,112
M a,112,v,60,v,80
EX 116
M a,116,v,60,v,84
DN 4,16,2,2112
M a,120,v,60,v,88
s_waitcnt lgkmcnt(1)
TR v,50,34688
M a,128,v,32,v,80
TR v,52,34208
s_add_u32 m0, s92, 98816
M a,132,v,32,v,84
TR v,54,34720
AD 17,17,116
M a,136,v,32,v,88
DL 7,64,93,2112
M a,144,v,36,v,80
TR v,56,34240
M a,148,v,36,v,84
TR v,58,34752
M a,152,v,36,v,88
TR v,60,34272
M a,160,v,40,v,80
TR v,62,34784
M a,164,v,40,v,84
EX 120
M a,168,v,40,v,88
EX 113
M a,176,v,44,v,80
EX 117
M a,180,v,44,v,84
EX 121
M a,184,v,44,v,88
s_waitcnt lgkmcnt(0)
s_waitcnt vmcnt(14)
M a,192,v,48,v,80
s_barrier
RD v,32,1,50688
M a,196,v,48,v,84
RD v,36,1,50752
AD 18,18,120
M a,200,v,48,v,88
RD v,40,1,50816
AD 16,16,113
M a,208,v,52,v,80
RD v,44,1,50880
AD 17,17,117
M a,212,v,52,v,84
DL 7,68,93,3168
M a,216,v,52,v,88
s_add_u32 m0, s92, 16896
AD 18,18,121
M a,224,v,56,v,80
EX 114
M a,228,v,56,v,84
EX 118
M a,232,v,56,v,88
EX 122
M a,240,v,60,v,80
EX 115
M a,244,v,60,v,84
EX 119
M a,248,v,60,v,88
EX 123
DN 4,20,2,3168
AD 16,16,114
AD 17,17,118
AD 18,18,122
AD 16,16,115
AD 17,17,119
AD 18,18,123
v_max3_f32 v20, v16, v17, v18
v_cmp_lt_f32 vcc, 0x4b800000, v20
s_waitcnt lgkmcnt(0)
CV 80,96
CV 81,98
s_cbranch_vccnz L_rsB12
L_rbB12:
MC 96,v,32,128,64
s_add_u32 m0, s92, 115712
s_xor_b32 s93, s4, 128
M v,96,v,36,v,144
CV 84,100
CV 85,102
M v,96,v,40,v,160
DL 7,56,93,0
M v,96,v,44,v,176
RD v,48,1,50944
s_add_u32 m0, s92, 33792
MC 100,v,32,132,68
RD v,52,1,51008
s_mov_b32 s2, 229376
M v,100,v,36,v,148
RD v,56,1,51072
CV 88,104
M v,100,v,40,v,164
RD v,60,1,51136
CV 89,106
M v,100,v,44,v,180
DN 4,24,2,0
MC 104,v,32,136,72
s_add_u32 m0, s92, 115712
RD v,32,1,51200
M v,104,v,36,v,152
RD v,36,1,51264
CV 82,112
M v,104,v,40,v,168
RD v,40,1,51328
CV 83,114
M v,104,v,44,v,184
s_waitcnt lgkmcnt(3)
RD v,44,1,51392
M v,96,v,48,v,192
DL 7,60,93,1056
M v,96,v,52,v,208
s_add_u32 m0, s92, 33792
CV 86,116
M v,96,v,56,v,224
CV 87,118
CV 90,120
M v,96,v,60,v,240
DN 4,28,2,1056
M v,100,v,48,v,196
s_add_u32 m0, s92, 115712
CV 91,122
M v,100,v,52,v,212
v_xor_b32 v2, 81920, v2
AD 12,12,16
M v,100,v,56,v,228
EX 96
M v,100,v,60,v,244
EX 97
M v,104,v,48,v,200
RD v,48,1,51456
AD 13,13,17
M v,104,v,52,v,216
RD v,52,1,51520
AD 14,14,18
M v,104,v,56,v,232
RD v,56,1,51584
AD 16,96,97
M v,104,v,60,v,248
s_waitcnt lgkmcnt(3)
RD v,60,1,51648
MC 112,v,32,128,64
DL 7,64,93,2112
M v,112,v,36,v,144
EX 100
M v,112,v,40,v,160
EX 101
M v,112,v,44,v,176
s_add_u32 m0, s92, 33792
AD 17,100,101
MC 116,v,32,132,68
DN 4,32,2,2112
M v,116,v,36,v,148
EX 104
M v,116,v,40,v,164
EX 105
M v,116,v,44,v,180
s_add_u32 m0, s92, 115712
AD 18,104,105
MC 120,v,32,136,72
EX 98
M v,120,v,36,v,152
EX 102
M v,120,v,40,v,168
EX 106
M v,120,v,44,v,184
s_waitcnt lgkmcnt(0)
s_waitcnt vmcnt(15)
M v,112,v,48,v,192
s_barrier
TR v,32,0
M v,112,v,52,v,208
DL 7,68,93,3168
M v,112,v,56,v,224
TR v,34,512
s_add_u32 m0, s92, 33792
M v,112,v,60,v,240
TR v,36,32
s_xor_b32 s93, s4, 28800
M v,116,v,48,v,196
TR v,38,544
AD 16,16,98
M v,116,v,52,v,212
TR v,40,64
AD 17,17,102
M v,116,v,56,v,228
TR v,42,576
TR v,44,96
M v,116,v,60,v,244
TR v,46,608
AD 18,18,106
M v,120,v,48,v,200
DN 4,36,2,3168
M v,120,v,52,v,216
s_add_u32 m0, s92, 132608
TR v,48,128
M v,120,v,56,v,232
TR v,50,640
s_mov_b32 s2, 245760
M v,120,v,60,v,248
s_waitcnt lgkmcnt(2)
TR v,52,160
M a,0,v,32,v,80
DL 7,56,93,0
M a,4,v,32,v,84
TR v,54,672
s_add_u32 m0, s92, 50688
M a,8,v,32,v,88
EX 99
M a,16,v,36,v,80
TR v,56,192
AD 16,16,99
M a,20,v,36,v,84
TR v,58,704
M a,24,v,36,v,88
TR v,60,224
M a,32,v,40,v,80
TR v,62,736
M a,36,v,40,v,84
DN 4,24,2,0
M a,40,v,40,v,88
s_add_u32 m0, s92, 132608
TR v,32,256
M a,48,v,44,v,80
EX 103
M a,52,v,44,v,84
TR v,34,768
AD 17,17,103
M a,56,v,44,v,88
s_waitcnt lgkmcnt(2)
TR v,36,288
M a,64,v,48,v,80
DL 7,60,93,1056
M a,68,v,48,v,84
TR v,38,800
s_add_u32 m0, s92, 50688
M a,72,v,48,v,88
EX 107
M a,80,v,52,v,80
TR v,40,320
v_xor_b32 v1, 81920, v1
M a,84,v,52,v,84
TR v,42,832
AD 18,18,107
M a,88,v,52,v,88
TR v,44,352
M a,96,v,56,v,80
TR v,46,864
M a,100,v,56,v,84
EX 112
M a,104,v,56,v,88
TR v,48,384
AD 16,16,112
M a,112,v,60,v,80
DN 4,28,2,1056
M a,116,v,60,v,84
TR v,50,896
s_add_u32 m0, s92, 132608
M a,120,v,60,v,88
s_waitcnt lgkmcnt(2)
TR v,52,416
M a,128,v,32,v,80
EX 116
M a,132,v,32,v,84
TR v,54,928
AD 17,17,116
M a,136,v,32,v,88
DL 7,64,93,2112
M a,144,v,36,v,80
TR v,56,448
s_add_u32 m0, s92, 50688
M a,148,v,36,v,84
TR v,58,960
M a,152,v,36,v,88
TR v,60,480
M a,160,v,40,v,80
TR v,62,992
M a,164,v,40,v,84
EX 120
M a,168,v,40,v,88
EX 113
M a,176,v,44,v,80
EX 117
M a,180,v,44,v,84
DN 4,32,2,2112
M a,184,v,44,v,88
s_waitcnt lgkmcnt(0)
s_waitcnt vmcnt(14)
M a,192,v,48,v,80
s_barrier
RD v,32,1,16896
M a,196,v,48,v,84
RD v,36,1,16960
s_add_u32 m0, s92, 132608
M a,200,v,48,v,88
RD v,40,1,17024
AD 18,18,120
M a,208,v,52,v,80
RD v,44,1,17088
AD 16,16,113
M a,212,v,52,v,84
EX 121
M a,216,v,52,v,88
DL 7,68,93,3168
M a,224,v,56,v,80
EX 114
M a,228,v,56,v,84
EX 118
M a,232,v,56,v,88
EX 122
M a,240,v,60,v,80
AD 17,17,117
AD 18,18,121
M a,244,v,60,v,84
EX 115
M a,248,v,60,v,88
EX 119
EX 123
AD 16,16,114
AD 17,17,118
AD 18,18,122
AD 16,16,115
AD 17,17,119
AD 18,18,123
v_max3_f32 v20, v16, v17, v18
v_cmp_lt_f32 vcc, 0x4b800000, v20
s_waitcnt lgkmcnt(0)
CV 80,96
CV 81,98
s_cbranch_vccnz L_rsB13
L_rbB13:
MC 96,v,32,128,64
s_add_u32 m0, s92, 0
s_mov_b32 s93, 512
M v,96,v,36,v,144
CV 84,100
CV 85,102
M v,96,v,40,v,160
DL 5,40,93,0
M v,96,v,44,v,176
RD v,48,1,17152
s_add_u32 m0, s92, 50688
MC 100,v,32,132,68
RD v,52,1,17216
CV 88,104
M v,100,v,36,v,148
RD v,56,1,17280
CV 89,106
M v,100,v,40,v,164
RD v,60,1,17344
s_bfe_u32 s94, s95, 0x2000a
M v,100,v,44,v,180
DN 4,36,2,3168
MC 104,v,32,136,72
s_add_u32 m0, s92, 0
RD v,32,1,17408
M v,104,v,36,v,152
RD v,36,1,17472
s_bfe_u32 s97, s95, 0x20008
M v,104,v,40,v,168
RD v,40,1,17536
s_lshl_b32 s94, s94, 20
M v,104,v,44,v,184
s_waitcnt lgkmcnt(3)
RD v,44,1,17600
M v,96,v,48,v,192
DL 5,44,93,1032
M v,96,v,52,v,208
s_lshl_b32 s97, s97, 7
CV 82,112
M v,96,v,56,v,224
CV 83,114
s_add_u32 s94, s94, s97
M v,96,v,60,v,240
CV 86,116
CV 87,118
M v,100,v,48,v,196
CV 90,120
CV 91,122
M v,100,v,52,v,212
buffer_load_dword v10, v5, s[40:43], s94 offen offset:512
M v,100,v,56,v,228
EX 96
M v,100,v,60,v,244
EX 97
M v,104,v,48,v,200
DL 5,48,93,2112
M v,104,v,52,v,216
RD v,48,1,17664
AD 12,12,16
M v,104,v,56,v,232
RD v,52,1,17728
AD 13,13,17
M v,104,v,60,v,248
s_waitcnt lgkmcnt(2)
RD v,56,1,17792
MC 112,v,32,128,64
RD v,60,1,17856
AD 14,14,18
M v,112,v,36,v,144
EX 100
M v,112,v,40,v,160
EX 101
M v,112,v,44,v,176
EX 104
MC 116,v,32,132,68
EX 105
M v,116,v,36,v,148
EX 98
M v,116,v,40,v,164
DL 5,52,93,3144
M v,116,v,44,v,180
EX 102
MC 120,v,32,136,72
EX 106
M v,120,v,36,v,152
AD 16,96,97
AD 17,100,101
M v,120,v,40,v,168
AD 18,104,105
AD 16,16,98
M v,120,v,44,v,184
s_waitcnt lgkmcnt(0)
s_waitcnt vmcnt(13)
M v,112,v,48,v,192
s_mov_b64 exec, 0
s_branch L_pad12
L_ret12:
s_mov_b64 exec, -1
s_barrier
TR v,32,33792
M v,112,v,52,v,208
TR v,34,34304
s_add_u32 m0, s92, 16896
M v,112,v,56,v,224
TR v,36,33824
s_mov_b32 s93, 640
M v,112,v,60,v,240
TR v,38,34336
AD 17,17,102
M v,116,v,48,v,196
TR v,40,33856
AD 18,18,106
M v,116,v,52,v,212
TR v,42,34368
M v,116,v,56,v,228
TR v,44,33888
TR v,46,34400
M v,116,v,60,v,244
buffer_load_dword v10, v5, s[44:47], s94 offen offset:1544
M v,120,v,48,v,200
EX 99
M v,120,v,52,v,216
TR v,48,33920
AD 16,16,99
M v,120,v,56,v,232
EX 103
M v,120,v,60,v,248
s_waitcnt lgkmcnt(1)
TR v,50,34432
M a,0,v,32,v,80
DL 5,40,93,0
M a,4,v,32,v,84
TR v,52,33952
AD 17,17,103
M a,8,v,32,v,88
EX 107
M a,16,v,36,v,80
TR v,54,34464
AD 18,18,107
M a,20,v,36,v,84
TR v,56,33984
M a,24,v,36,v,88
TR v,58,34496
M a,32,v,40,v,80
TR v,60,34016
TR v,62,34528
M a,36,v,40,v,84
EX 112
M a,40,v,40,v,88
DL 5,44,93,1032
M a,48,v,44,v,80
TR v,32,34048
AD 16,16,112
M a,52,v,44,v,84
EX 116
M a,56,v,44,v,88
s_waitcnt lgkmcnt(1)
TR v,34,34560
M a,64,v,48,v,80
TR v,36,34080
AD 17,17,116
M a,68,v,48,v,84
buffer_load_dword v10, v5, s[48:51], s94 offen offset:2624
M a,72,v,48,v,88
EX 120
M a,80,v,52,v,80
TR v,38,34592
AD 18,18,120
M a,84,v,52,v,84
TR v,40,34112
M a,88,v,52,v,88
TR v,42,34624
M a,96,v,56,v,80
TR v,44,34144
TR v,46,34656
M a,100,v,56,v,84
DL 5,48,93,2112
M a,104,v,56,v,88
EX 113
M a,112,v,60,v,80
TR v,48,34176
AD 16,16,113
M a,116,v,60,v,84
EX 117
M a,120,v,60,v,88
s_waitcnt lgkmcnt(1)
TR v,50,34688
M a,128,v,32,v,80
TR v,52,34208
AD 17,17,117
M a,132,v,32,v,84
EX 121
M a,136,v,32,v,88
TR v,54,34720
AD 18,18,121
M a,144,v,36,v,80
TR v,56,34240
M a,148,v,36,v,84
TR v,58,34752
M a,152,v,36,v,88
TR v,60,34272
M a,160,v,40,v,80
TR v,62,34784
M a,164,v,40,v,84
DL 5,52,93,3144
M a,168,v,40,v,88
EX 114
M a,176,v,44,v,80
EX 118
M a,180,v,44,v,84
EX 122
M a,184,v,44,v,88
s_waitcnt lgkmcnt(0)
s_waitcnt vmcnt(10)
M a,192,v,48,v,80
s_barrier
TR v,32,50688
M a,196,v,48,v,84
TR v,34,51200
AD 16,16,114
M a,200,v,48,v,88
TR v,36,50720
AD 17,17,118
M a,208,v,52,v,80
TR v,38,51232
AD 18,18,122
M a,212,v,52,v,84
TR v,40,50752
s_add_u32 m0, s92, 33792
M a,216,v,52,v,88
TR v,42,51264
TR v,44,50784
M a,224,v,56,v,80
TR v,46,51296
s_mov_b32 s93, 768
M a,228,v,56,v,84
EX 115
M a,232,v,56,v,88
EX 119
M a,240,v,60,v,80
EX 123
M a,244,v,60,v,84
AD 16,16,115
AD 17,17,119
M a,248,v,60,v,88
AD 18,18,123
v_max3_f32 v20, v16, v17, v18
buffer_load_dword v10, v5, s[52:55], s94 offen offset:3656
v_cmp_lt_f32 vcc, 0x4b800000, v20
CV 80,96
s_waitcnt lgkmcnt(0)
CV 81,98
CV 82,112
CV 83,114
s_cbranch_vccnz L_rsB14
L_rbB14:
CV 84,100
M a,0,v,32,v,80
CV 85,102
CV 86,116
CV 87,118
CV 88,104
CV 89,106
M a,4,v,32,v,84
CV 90,120
CV 91,122
DL 5,40,93,0
TR v,48,50816
M a,8,v,32,v,88
TR v,50,51328
AR 20,0
M a,16,v,36,v,80
TR v,52,50848
AR 21,1
M a,20,v,36,v,84
TR v,54,51360
AR 22,2
M a,24,v,36,v,88
TR v,56,50880
AR 23,3
M a,32,v,40,v,80
TR v,58,51392
TR v,60,50912
M a,36,v,40,v,84
TR v,62,51424
CV 140,20
M a,40,v,40,v,88
DL 5,44,93,1032
M a,48,v,44,v,80
RD v,64,3,0
v_bfe_u32 v8, v4, 8, 2
M a,52,v,44,v,84
RD v,68,3,64
v_lshrrev_b32 v9, 14, s95
M a,56,v,44,v,88
s_waitcnt lgkmcnt(2)
RD v,96,3,512
M a,64,v,48,v,80
RD v,100,3,576
v_add_lshl_u32 v8, v8, v9, 7
M a,68,v,48,v,84
RD v,112,3,16896
v_add_u32 v8, 4096, v8
M a,72,v,48,v,88
RD v,116,3,16960
v_mov_b32 v9, 0
M a,80,v,52,v,80
TR v,32,50944
CV 141,22
M a,84,v,52,v,84
TR v,34,51456
AR 20,4
M a,88,v,52,v,88
TR v,36,50976
AR 21,5
M a,96,v,56,v,80
TR v,38,51488
TR v,40,51008
M a,100,v,56,v,84
TR v,42,51520
TR v,44,51040
M a,104,v,56,v,88
TR v,46,51552
AR 22,6
M a,112,v,60,v,80
DL 5,48,93,2112
M a,116,v,60,v,84
s_getpc_b64 s[100:101]
s_and_b32 s100, s100, 0xfffff000
M a,120,v,60,v,88
s_waitcnt lgkmcnt(0)
v_lshl_add_u64 v[8:9], v[8:9], 0, s[100:101]
M a,128,v,32,v,80
RD v,72,3,33792
AR 23,7
M a,132,v,32,v,84
RD v,76,3,33856
CV 228,20
M a,136,v,32,v,88
RD v,104,3,34304
CV 229,22
M a,144,v,36,v,80
RD v,108,3,34368
AR 20,8
M a,148,v,36,v,84
RD v,120,3,50688
AR 21,9
M a,152,v,36,v,88
RD v,124,3,50752
AR 22,10
M a,160,v,40,v,80
TR v,48,51072
TR v,50,51584
M a,164,v,40,v,84
TR v,52,51104
TR v,54,51616
M a,168,v,40,v,88
TR v,56,51136
TR v,58,51648
M a,176,v,44,v,80
TR v,60,51168
TR v,62,51680
M a,180,v,44,v,84
global_load_dword v10, v[8:9], off
M a,184,v,44,v,88
DL 5,52,93,3144
s_waitcnt vmcnt(12)
AR 23,11
AR 24,16
AR 25,17
AR 26,18
AR 27,19
CV 142,24
CV 143,26
AR 24,20
AR 25,21
AR 26,22
AR 27,23
CV 230,24
CV 231,26
AR 24,24
AR 25,25
AR 26,26
AR 27,27
CV 232,20
s_waitcnt lgkmcnt(0)
M a,192,v,48,v,80
s_barrier
TW v,32,0
M a,196,v,48,v,84
TW v,34,128
s_add_u32 m0, s92, 50688
M a,200,v,48,v,88
TW v,36,256
s_xor_b32 s93, s4, 256
M a,208,v,52,v,80
TW v,38,384
CV 233,22
M a,212,v,52,v,84
TW v,40,512
AR 20,32
M a,216,v,52,v,88
TW v,42,640
AR 21,33
M a,224,v,56,v,80
TW v,44,768
TW v,46,896
M a,228,v,56,v,84
DL 7,56,93,0
M a,232,v,56,v,88
TW v,48,8
AR 22,34
M a,240,v,60,v,80
TW v,50,136
AR 23,35
M a,244,v,60,v,84
DL 7,60,93,1056
M a,248,v,60,v,88
s_waitcnt lgkmcnt(2)
TW v,52,264
Z a,0,v,32,v,64
TW v,54,392
CV 156,20
M a,0,v,36,v,68
DL 7,64,93,2112
M a,0,v,40,v,72
TW v,56,520
CV 157,22
M a,0,v,44,v,76
TW v,58,648
AR 20,36
Z a,4,v,32,v,96
TW v,60,776
AR 21,37
M a,4,v,36,v,100
TW v,62,904
AR 22,38
M a,4,v,40,v,104
DL 7,68,93,3168
M a,4,v,44,v,108
s_add_u32 m0, s92, 81920
s_xor_b32 s93, s4, 28928
Z a,8,v,32,v,112
TW v,32,64
AR 23,39
M a,8,v,36,v,116
DL 7,56,93,0
M a,8,v,40,v,120
TW v,34,192
CV 244,20
M a,8,v,44,v,124
s_waitcnt lgkmcnt(2)
TW v,36,320
Z a,16,v,48,v,64
DL 7,60,93,1056
M a,16,v,52,v,68
TW v,38,448
CV 245,22
M a,16,v,56,v,72
TW v,40,576
AR 20,40
M a,16,v,60,v,76
TW v,42,704
AR 21,41
Z a,20,v,48,v,96
TW v,44,832
AR 22,42
M a,20,v,52,v,100
TW v,46,960
AR 23,43
M a,20,v,56,v,104
DL 7,64,93,2112
M a,20,v,60,v,108
CV 234,24
CV 235,26
Z a,24,v,48,v,112
TW v,48,72
AR 24,48
M a,24,v,52,v,116
DL 7,68,93,3168
M a,24,v,56,v,120
s_add_u32 m0, s92, 98816
s_mov_b32 s93, 1049088
M a,24,v,60,v,124
s_waitcnt lgkmcnt(1)
TW v,50,200
Z a,32,v,32,v,64
DL 6,40,93,0
M a,32,v,36,v,68
TW v,52,328
AR 25,49
M a,32,v,40,v,72
TW v,54,456
AR 26,50
M a,32,v,44,v,76
TW v,56,584
AR 27,51
Z a,36,v,32,v,96
TW v,58,712
CV 158,24
M a,36,v,36,v,100
TW v,60,840
CV 159,26
M a,36,v,40,v,104
TW v,62,968
AR 24,52
M a,36,v,44,v,108
DL 6,44,93,1032
Z a,40,v,32,v,112
AR 25,53
AR 26,54
M a,40,v,36,v,116
AR 27,55
CV 246,24
M a,40,v,40,v,120
DL 6,48,93,2112
M a,40,v,44,v,124
s_waitcnt lgkmcnt(0)
s_waitcnt vmcnt(17)
Z a,48,v,48,v,64
s_mov_b64 exec, 0
s_branch L_pad13
L_ret13:
s_mov_b64 exec, -1
s_barrier
TW v,32,16896
M a,48,v,52,v,68
TW v,34,17024
CV 247,26
M a,48,v,56,v,72
TW v,36,17152
AR 24,56
M a,48,v,60,v,76
TW v,38,17280
AR 25,57
Z a,52,v,48,v,96
TW v,40,17408
AR 26,58
M a,52,v,52,v,100
TW v,42,17536
AR 27,59
M a,52,v,56,v,104
TW v,44,17664
TW v,46,17792
M a,52,v,60,v,108
DL 6,52,93,3144
Z a,56,v,48,v,112
s_add_u32 m0, s92, 115712
s_xor_b32 s93, s4, 384
M a,56,v,52,v,116
DL 7,56,93,0
M a,56,v,56,v,120
CV 248,20
CV 249,22
M a,56,v,60,v,124
AR 20,64
AR 21,65
AR 22,66
AR 23,67
DL 7,60,93,1056
CV 172,20
s_waitcnt lgkmcnt(0)
Z a,64,v,32,v,64
CV 173,22
AR 20,68
M a,64,v,36,v,68
AR 21,69
AR 22,70
M a,64,v,40,v,72
TW v,48,16904
AR 23,71
M a,64,v,44,v,76
TW v,50,17032
CV 196,20
Z a,68,v,32,v,96
TW v,52,17160
CV 197,22
M a,68,v,36,v,100
TW v,54,17288
AR 20,72
M a,68,v,40,v,104
TW v,56,17416
TW v,58,17544
M a,68,v,44,v,108
TW v,60,17672
TW v,62,17800
DL 7,64,93,2112
AR 21,73
AR 22,74
AR 23,75
Z a,72,v,32,v,112
CV 250,24
CV 251,26
M a,72,v,36,v,116
AR 24,80
AR 25,81
M a,72,v,40,v,120
DL 7,68,93,3168
M a,72,v,44,v,124
AR 26,82
AR 27,83
s_add_u32 m0, s92, 132608
s_xor_b32 s93, s4, 29056
CV 174,24
CV 175,26
DL 7,56,93,0
s_waitcnt lgkmcnt(0)
Z a,80,v,48,v,64
AR 24,84
AR 25,85
M a,80,v,52,v,68
AR 26,86
AR 27,87
M a,80,v,56,v,72
TW v,32,16960
CV 198,24
M a,80,v,60,v,76
TW v,34,17088
CV 199,26
Z a,84,v,48,v,96
TW v,36,17216
AR 24,88
M a,84,v,52,v,100
TW v,38,17344
AR 25,89
M a,84,v,56,v,104
TW v,40,17472
TW v,42,17600
M a,84,v,60,v,108
TW v,44,17728
TW v,46,17856
AR 26,90
AR 27,91
Z a,88,v,48,v,112
DL 7,60,93,1056
M a,88,v,52,v,116
CV 200,20
CV 201,22
M a,88,v,56,v,120
AR 20,96
AR 21,97
M a,88,v,60,v,124
AR 22,98
AR 23,99
DL 7,64,93,2112
CV 188,20
CV 189,22
AR 20,100
AR 21,101
AR 22,102
s_waitcnt lgkmcnt(0)
Z a,96,v,32,v,64
TW v,48,16968
AR 23,103
M a,96,v,36,v,68
TW v,50,17096
CV 212,20
M a,96,v,40,v,72
TW v,52,17224
CV 213,22
M a,96,v,44,v,76
TW v,54,17352
AR 20,104
Z a,100,v,32,v,96
TW v,56,17480
AR 21,105
M a,100,v,36,v,100
TW v,58,17608
AR 22,106
M a,100,v,40,v,104
TW v,60,17736
TW v,62,17864
M a,100,v,44,v,108
DL 7,68,93,3168
AR 23,107
Z a,104,v,32,v,112
s_add_u32 m0, s92, 0
s_mov_b32 s93, 1573376
M a,104,v,36,v,116
CV 202,24
CV 203,26
M a,104,v,40,v,120
DL 6,40,93,0
M a,104,v,44,v,124
AR 24,112
AR 25,113
AR 26,114
AR 27,115
s_waitcnt vmcnt(13)
CV 190,24
CV 191,26
AR 24,116
s_waitcnt lgkmcnt(0)
Z a,112,v,48,v,64
s_barrier
AR 25,117
M a,112,v,52,v,68
AR 26,118
AR 27,119
M a,112,v,56,v,72
TW v,32,33792
CV 214,24
M a,112,v,60,v,76
TW v,34,33920
CV 215,26
Z a,116,v,48,v,96
TW v,36,34048
AR 24,120
M a,116,v,52,v,100
TW v,38,34176
AR 25,121
M a,116,v,56,v,104
TW v,40,34304
TW v,42,34432
M a,116,v,60,v,108
TW v,44,34560
TW v,46,34688
DL 6,44,93,1032
AR 26,122
AR 27,123
Z a,120,v,48,v,112
CV 216,20
CV 217,22
M a,120,v,52,v,116
AR 20,128
AR 21,129
M a,120,v,56,v,120
DL 6,48,93,2112
M a,120,v,60,v,124
AR 22,130
AR 23,131
CV 204,20
CV 205,22
AR 20,132
AR 21,133
AR 22,134
AR 23,135
TW v,48,33800
s_waitcnt lgkmcnt(1)
Z a,128,v,32,v,64
TW v,50,33928
AW 12,228
M a,128,v,36,v,68
TW v,52,34056
AW 13,229
M a,128,v,40,v,72
TW v,54,34184
CV 228,20
M a,128,v,44,v,76
TW v,56,34312
CV 229,22
Z a,132,v,32,v,96
TW v,58,34440
AR 20,136
M a,132,v,36,v,100
TW v,60,34568
AR 21,137
M a,132,v,40,v,104
TW v,62,34696
AR 22,138
M a,132,v,44,v,108
DL 6,52,93,3144
AR 23,139
Z a,136,v,32,v,112
s_add_u32 m0, s92, 16896
s_mov_b32 s93, 896
M a,136,v,36,v,116
CV 218,24
CV 219,26
M a,136,v,40,v,120
DL 5,40,93,0
M a,136,v,44,v,124
AR 24,144
AR 25,145
AR 26,146
AR 27,147
CV 206,24
CV 207,26
AR 24,148
s_waitcnt lgkmcnt(0)
Z a,144,v,48,v,64
AR 25,149
AR 26,150
M a,144,v,52,v,68
TW v,32,33856
AR 27,151
M a,144,v,56,v,72
TW v,34,33984
AW 14,230
M a,144,v,60,v,76
TW v,36,34112
AW 15,231
Z a,148,v,48,v,96
TW v,38,34240
CV 230,24
M a,148,v,52,v,100
TW v,40,34368
CV 231,26
M a,148,v,56,v,104
TW v,42,34496
TW v,44,34624
M a,148,v,60,v,108
TW v,46,34752
AR 24,152
DL 5,44,93,1032
AR 25,153
AR 26,154
AR 27,155
Z a,152,v,48,v,112
AW 28,232
AW 29,233
M a,152,v,52,v,116
CV 232,20
CV 233,22
M a,152,v,56,v,120
DL 5,48,93,2112
M a,152,v,60,v,124
AR 20,160
AR 21,161
AR 22,162
AR 23,163
CV 220,20
s_waitcnt lgkmcnt(0)
Z a,160,v,32,v,64
CV 221,22
AR 20,164
M a,160,v,36,v,68
AR 21,165
AR 22,166
M a,160,v,40,v,72
TW v,48,33864
AR 23,167
M a,160,v,44,v,76
TW v,50,33992
AW 44,244
Z a,164,v,32,v,96
TW v,52,34120
AW 45,245
M a,164,v,36,v,100
TW v,54,34248
CV 244,20
M a,164,v,40,v,104
TW v,56,34376
TW v,58,34504
M a,164,v,44,v,108
TW v,60,34632
TW v,62,34760
DL 5,52,93,3144
CV 245,22
AR 20,168
AR 21,169
AR 22,170
AR 23,171
Z a,168,v,32,v,112
AW 30,234
AW 31,235
M a,168,v,36,v,116
CV 234,24
CV 235,26
M a,168,v,40,v,120
AR 24,176
AR 25,177
M a,168,v,44,v,124
AR 26,178
AR 27,179
s_waitcnt vmcnt(8)
CV 222,24
CV 223,26
v_xor_b32 v3, 81920, v3
s_waitcnt lgkmcnt(0)
Z a,176,v,48,v,64
s_barrier
AR 24,180
M a,176,v,52,v,68
AR 25,181
AR 26,182
M a,176,v,56,v,72
RD v,128,3,50688
AR 27,183
M a,176,v,60,v,76
RD v,144,3,50752
v_xor_b32 v11, 81920, v11
Z a,180,v,48,v,96
RD v,132,3,51200
AW 46,246
M a,180,v,52,v,100
RD v,148,3,51264
v_xor_b32 v3, 81920, v3
M a,180,v,56,v,104
RD v,136,3,0
RD v,152,3,64
M a,180,v,60,v,108
TW v,32,16896
TW v,34,17024
TW v,36,17152
TW v,38,17280
TW v,40,16904
TW v,42,17032
TW v,44,17160
TW v,46,17288
AW 47,247
CV 246,24
CV 247,26
AR 24,184
AR 25,185
AR 26,186
AR 27,187
Z a,184,v,48,v,112
s_add_u32 m0, s92, 33792
s_mov_b32 s93, 1049344
M a,184,v,52,v,116
TW v,48,16960
AW 60,248
M a,184,v,56,v,120
TW v,50,17088
AW 61,249
M a,184,v,60,v,124
s_waitcnt lgkmcnt(2)
TW v,52,17216
M a,0,v,32,v,128
DL 5,40,93,0
M a,0,v,36,v,144
TW v,54,17344
CV 248,20
M a,4,v,32,v,132
TW v,56,16968
CV 249,22
M a,4,v,36,v,148
TW v,58,17096
AR 20,192
M a,8,v,32,v,136
TW v,60,17224
AR 21,193
M a,8,v,36,v,152
TW v,62,17352
AR 22,194
M a,16,v,40,v,128
DL 5,44,93,1032
M a,16,v,44,v,144
TW v,32,17408
AR 23,195
M a,20,v,40,v,132
TW v,34,17536
CV 236,20
M a,20,v,44,v,148
TW v,36,17664
v_bfe_u32 v8, v4, 8, 2
M a,24,v,40,v,136
TW v,38,17792
v_lshrrev_b32 v9, 14, s95
M a,24,v,44,v,152
s_waitcnt lgkmcnt(4)
TW v,40,17416
M a,32,v,48,v,128
DL 5,48,93,2112
M a,32,v,52,v,144
TW v,42,17544
v_add_lshl_u32 v8, v8, v9, 7
M a,36,v,48,v,132
TW v,44,17672
v_mov_b32 v9, 0
M a,36,v,52,v,148
TW v,46,17800
CV 237,22
M a,40,v,48,v,136
s_getpc_b64 s[100:101]
s_add_u32 s100, s100, L_c2B-.
s_addc_u32 s101, s101, 0
M a,40,v,52,v,152
DL 5,52,93,3144
M a,48,v,56,v,128
v_lshl_add_u64 v[8:9], v[8:9], 0, s[100:101]
s_add_u32 m0, s92, 50688
M a,48,v,60,v,144
s_xor_b32 s93, s4, 640
TW v,48,17472
M a,52,v,56,v,132
TW v,50,17600
AR 20,196
M a,52,v,60,v,148
TW v,52,17728
AR 21,197
M a,56,v,56,v,136
TW v,54,17856
AR 22,198
M a,56,v,60,v,152
s_waitcnt lgkmcnt(4)
TW v,56,17480
M a,64,v,32,v,128
DL 7,56,93,0
M a,64,v,36,v,144
TW v,58,17608
AR 23,199
M a,68,v,32,v,132
TW v,60,17736
AW 76,196
M a,68,v,36,v,148
TW v,62,17864
v_xor_b32 v11, 81920, v11
M a,72,v,32,v,136
global_load_dword v10, v[8:9], off
M a,72,v,36,v,152
RD v,160,3,33792
AW 77,197
M a,80,v,40,v,128
RD v,176,3,33856
CV 196,20
M a,80,v,44,v,144
DL 7,60,93,1056
M a,84,v,40,v,132
RD v,164,3,34304
CV 197,22
M a,84,v,44,v,148
RD v,180,3,34368
AR 20,200
M a,88,v,40,v,136
RD v,168,3,50688
AR 21,201
M a,88,v,44,v,152
s_waitcnt lgkmcnt(5)
s_waitcnt vmcnt(11)
M a,96,v,48,v,128
s_mov_b64 exec, 0
s_branch L_pad14
L_ret14:
s_mov_b64 exec, -1
s_barrier
RD v,184,3,50752
M a,96,v,52,v,144
DL 7,64,93,2112
M a,100,v,48,v,132
TW v,32,0
AR 22,202
M a,100,v,52,v,148
TW v,34,128
AR 23,203
M a,104,v,48,v,136
TW v,36,256
AW 62,250
M a,104,v,52,v,152
TW v,38,384
AW 63,251
M a,112,v,56,v,128
TW v,40,8
TW v,42,136
M a,112,v,60,v,144
TW v,44,264
TW v,46,392
M a,116,v,56,v,132
DL 7,68,93,3168
M a,116,v,60,v,148
s_add_u32 m0, s92, 81920
s_xor_b32 s93, s4, 29312
M a,120,v,56,v,136
TW v,48,64
CV 250,24
M a,120,v,60,v,152
s_waitcnt lgkmcnt(1)
TW v,50,192
M a,0,v,32,v,160
DL 7,56,93,0
M a,0,v,36,v,176
TW v,52,320
CV 251,26
M a,4,v,32,v,164
TW v,54,448
AR 24,208
M a,4,v,36,v,180
TW v,56,72
AR 25,209
M a,8,v,32,v,168
TW v,58,200
AR 26,210
M a,8,v,36,v,184
TW v,60,328
AR 27,211
M a,16,v,40,v,160
TW v,62,456
CV 238,24
M a,16,v,44,v,176
DL 7,60,93,1056
M a,20,v,40,v,164
TW v,32,512
CV 239,26
M a,20,v,44,v,180
TW v,34,640
AR 24,212
M a,24,v,40,v,168
TW v,36,768
AR 25,213
M a,24,v,44,v,184
s_waitcnt lgkmcnt(3)
TW v,38,896
M a,32,v,48,v,160
DL 7,64,93,2112
M a,32,v,52,v,176
TW v,40,520
AR 26,214
M a,36,v,48,v,164
TW v,42,648
AR 27,215
M a,36,v,52,v,180
TW v,44,776
AW 78,198
M a,40,v,48,v,168
TW v,46,904
AW 79,199
M a,40,v,52,v,184
DL 7,68,93,3168
M a,48,v,56,v,160
s_add_u32 m0, s92, 98816
s_mov_b32 s93, 1049472
M a,48,v,60,v,176
TW v,48,576
CV 198,24
M a,52,v,56,v,164
TW v,50,704
CV 199,26
M a,52,v,60,v,180
TW v,52,832
AR 24,216
M a,56,v,56,v,168
DL 5,40,93,0
M a,56,v,60,v,184
s_waitcnt lgkmcnt(3)
TW v,54,960
M a,64,v,32,v,160
TW v,56,584
AR 25,217
M a,64,v,36,v,176
TW v,58,712
AR 26,218
M a,68,v,32,v,164
TW v,60,840
AR 27,219
M a,68,v,36,v,180
TW v,62,968
AW 92,200
M a,72,v,32,v,168
DL 5,44,93,1032
M a,72,v,36,v,184
AW 93,201
CV 200,20
M a,80,v,40,v,160
CV 201,22
AR 20,224
M a,80,v,44,v,176
DL 5,48,93,2112
M a,84,v,40,v,164
AR 21,225
AR 22,226
M a,84,v,44,v,180
AR 23,227
CV 252,20
M a,88,v,40,v,168
CV 253,22
AR 20,228
M a,88,v,44,v,184
s_waitcnt lgkmcnt(0)
s_waitcnt vmcnt(16)
M a,96,v,48,v,160
s_barrier
TW v,32,16896
M a,96,v,52,v,176
TW v,34,17024
AR 21,229
M a,100,v,48,v,164
TW v,36,17152
AR 22,230
M a,100,v,52,v,180
TW v,38,17280
AR 23,231
M a,104,v,48,v,168
TW v,40,17408
AW 108,212
M a,104,v,52,v,184
TW v,42,17536
AW 109,213
M a,112,v,56,v,160
TW v,44,17664
TW v,46,17792
M a,112,v,60,v,176
DL 5,52,93,3144
M a,116,v,56,v,164
s_add_u32 m0, s92, 115712
s_xor_b32 s93, s4, 768
M a,116,v,60,v,180
DL 7,56,93,0
M a,120,v,56,v,168
TW v,48,16904
CV 212,20
M a,120,v,60,v,184
s_waitcnt lgkmcnt(1)
TW v,50,17032
Z a,192,v,32,v,64
DL 7,60,93,1056
M a,192,v,36,v,68
TW v,52,17160
CV 213,22
M a,192,v,40,v,72
TW v,54,17288
AR 20,232
M a,192,v,44,v,76
TW v,56,17416
AR 21,233
Z a,196,v,32,v,96
TW v,58,17544
AR 22,234
M a,196,v,36,v,100
TW v,60,17672
AR 23,235
M a,196,v,40,v,104
TW v,62,17800
AW 94,202
M a,196,v,44,v,108
DL 7,64,93,2112
Z a,200,v,32,v,112
TW v,32,16960
AW 95,203
M a,200,v,36,v,116
TW v,34,17088
CV 202,24
M a,200,v,40,v,120
DL 7,68,93,3168
M a,200,v,44,v,124
s_waitcnt lgkmcnt(2)
s_add_u32 m0, s92, 132608
Z a,208,v,48,v,64
s_xor_b32 s93, s4, 29440
TW v,36,17216
M a,208,v,52,v,68
DL 7,56,93,0
M a,208,v,56,v,72
TW v,38,17344
CV 203,26
M a,208,v,60,v,76
TW v,40,17472
AR 24,240
Z a,212,v,48,v,96
TW v,42,17600
AR 25,241
M a,212,v,52,v,100
TW v,44,17728
AR 26,242
M a,212,v,56,v,104
TW v,46,17856
AR 27,243
M a,212,v,60,v,108
DL 7,60,93,1056
Z a,216,v,48,v,112
TW v,48,16968
CV 254,24
M a,216,v,52,v,116
TW v,50,17096
CV 255,26
M a,216,v,56,v,120
DL 7,64,93,2112
M a,216,v,60,v,124
s_waitcnt lgkmcnt(2)
TW v,52,17224
Z a,224,v,32,v,64
TW v,54,17352
AR 24,244
M a,224,v,36,v,68
TW v,56,17480
AR 25,245
M a,224,v,40,v,72
TW v,58,17608
AR 26,246
M a,224,v,44,v,76
TW v,60,17736
AR 27,247
Z a,228,v,32,v,96
TW v,62,17864
AW 110,214
M a,228,v,36,v,100
DL 7,68,93,3168
M a,228,v,40,v,104
s_add_u32 m0, s92, 0
s_mov_b32 s93, 2621952
M a,228,v,44,v,108
AW 111,215
CV 214,24
Z a,232,v,32,v,112
DL 5,40,93,0
M a,232,v,36,v,116
CV 215,26
AR 24,248
M a,232,v,40,v,120
AR 25,249
AR 26,250
M a,232,v,44,v,124
s_waitcnt lgkmcnt(0)
s_waitcnt vmcnt(13)
Z a,240,v,48,v,64
s_barrier
TW v,32,33792
M a,240,v,52,v,68
TW v,34,33920
AR 27,251
M a,240,v,56,v,72
TW v,36,34048
v_xor_b32 v3, 81920, v3
M a,240,v,60,v,76
TW v,38,34176
AW 140,228
Z a,244,v,48,v,96
TW v,40,34304
AW 141,229
M a,244,v,52,v,100
TW v,42,34432
AW 142,230
M a,244,v,56,v,104
TW v,44,34560
TW v,46,34688
M a,244,v,60,v,108
DL 5,44,93,1032
Z a,248,v,48,v,112
TW v,48,33800
AW 143,231
M a,248,v,52,v,116
TW v,50,33928
AW 156,232
M a,248,v,56,v,120
DL 5,48,93,2112
M a,248,v,60,v,124
s_waitcnt lgkmcnt(2)
TW v,52,34056
M a,128,v,32,v,128
TW v,54,34184
AW 157,233
M a,128,v,36,v,144
TW v,56,34312
AW 158,234
M a,128,v,40,v,160
TW v,58,34440
AW 159,235
M a,128,v,44,v,176
TW v,60,34568
AW 172,244
M a,132,v,32,v,132
TW v,62,34696
AW 173,245
M a,132,v,36,v,148
DL 5,52,93,3144
M a,132,v,40,v,164
s_add_u32 m0, s92, 16896
s_xor_b32 s93, s4, 512
M a,132,v,44,v,180
RD v,64,3,50688
AW 174,246
M a,136,v,32,v,136
DL 7,56,93,0
M a,136,v,36,v,152
RD v,68,3,50752
AW 175,247
M a,136,v,40,v,168
RD v,96,3,51200
AW 188,248
M a,136,v,44,v,184
s_waitcnt lgkmcnt(3)
RD v,100,3,51264
M a,144,v,48,v,128
TW v,32,33856
v_xor_b32 v3, 81920, v3
M a,144,v,52,v,144
RD v,112,3,0
AW 189,249
M a,144,v,56,v,160
RD v,116,3,64
AW 190,250
M a,144,v,60,v,176
TW v,34,33984
AW 191,251
M a,148,v,48,v,132
TW v,36,34112
AW 126,218
M a,148,v,52,v,148
TW v,38,34240
AW 127,219
M a,148,v,56,v,164
TW v,40,34368
TW v,42,34496
M a,148,v,60,v,180
TW v,44,34624
TW v,46,34752
M a,152,v,48,v,136
DL 7,60,93,1056
M a,152,v,52,v,152
TW v,48,33864
CV 218,24
M a,152,v,56,v,168
DL 7,64,93,2112
M a,152,v,60,v,184
s_waitcnt lgkmcnt(1)
TW v,50,33992
M a,160,v,32,v,128
TW v,52,34120
CV 219,26
M a,160,v,36,v,144
TW v,54,34248
AW 124,216
M a,160,v,40,v,160
TW v,56,34376
AW 125,217
M a,160,v,44,v,176
TW v,58,34504
CV 216,20
M a,164,v,32,v,132
TW v,60,34632
CV 217,22
M a,164,v,36,v,148
TW v,62,34760
v_xor_b32 v11, 81920, v11
M a,164,v,40,v,164
DL 7,68,93,3168
M a,164,v,44,v,180
AW 204,196
AW 205,197
M a,168,v,32,v,136
AW 220,200
AW 221,201
M a,168,v,36,v,152
AW 222,202
AW 223,203
M a,168,v,40,v,168
AW 206,198
AW 207,199
M a,168,v,44,v,184
s_waitcnt lgkmcnt(0)
s_waitcnt vmcnt(8)
M a,176,v,48,v,128
s_mov_b64 exec, 0
s_branch L_pad15
L_ret15:
s_mov_b64 exec, -1
s_barrier
TW v,32,16896
M a,176,v,52,v,144
TW v,34,17024
s_add_u32 m0, s92, 33792
M a,176,v,56,v,160
TW v,36,17152
s_xor_b32 s93, s4, 29184
M a,176,v,60,v,176
TW v,38,17280
AW 236,212
M a,180,v,48,v,132
TW v,40,17408
AW 237,213
M a,180,v,52,v,148
TW v,42,17536
AW 252,216
M a,180,v,56,v,164
TW v,44,17664
TW v,46,17792
M a,180,v,60,v,180
DL 7,56,93,0
M a,184,v,48,v,136
TW v,48,16904
AW 253,217
M a,184,v,52,v,152
TW v,50,17032
AW 254,218
M a,184,v,56,v,168
DL 7,60,93,1056
M a,184,v,60,v,184
s_waitcnt lgkmcnt(2)
TW v,52,17160
M a,192,v,32,v,128
TW v,54,17288
AW 255,219
M a,192,v,36,v,144
TW v,56,17416
AW 238,214
M a,192,v,40,v,160
TW v,58,17544
v_mov_b32 v8, 0
M a,192,v,44,v,176
TW v,60,17672
AW 239,215
M a,196,v,32,v,132
TW v,62,17800
AD 13,13,17
M a,196,v,36,v,148
DL 7,64,93,2112
M a,196,v,40,v,164
RD v,72,3,33792
AD 12,12,16
M a,196,v,44,v,180
global_load_dword v8, v8, s[0:1] sc1
M a,200,v,32,v,136
RD v,76,3,33856
AD 14,14,18
M a,200,v,36,v,152
RD v,104,3,34304
v_mov_b32 v15, v13
M a,200,v,40,v,168
DL 7,68,93,3168
M a,200,v,44,v,184
s_waitcnt lgkmcnt(3)
s_add_u32 m0, s92, 50688
M a,208,v,48,v,128
s_mov_b32 s93, 2097664
RD v,108,3,34368
M a,208,v,52,v,144
DL 6,40,93,0
M a,208,v,56,v,160
v_permlane32_swap_b32 v12, v14
M a,208,v,60,v,176
RD v,120,3,50688
v_add_f32 v12, v12, v14
M a,212,v,48,v,132
RD v,124,3,50752
v_xor_b32 v3, 81920, v3
M a,212,v,52,v,148
TW v,32,16960
M a,212,v,56,v,164
TW v,34,17088
TW v,36,17216
M a,212,v,60,v,180
TW v,38,17344
TW v,40,17472
M a,216,v,48,v,136
TW v,42,17600
TW v,44,17728
M a,216,v,52,v,152
TW v,46,17856
M a,216,v,56,v,168
DL 6,44,93,1032
M a,216,v,60,v,184
s_waitcnt lgkmcnt(0)
TW v,48,16968
M a,224,v,32,v,128
DL 6,48,93,2112
M a,224,v,36,v,144
v_permlane32_swap_b32 v13, v15
M a,224,v,40,v,160
TW v,50,17096
v_add_f32 v13, v13, v15
M a,224,v,44,v,176
TW v,52,17224
M a,228,v,32,v,132
TW v,54,17352
M a,228,v,36,v,148
TW v,56,17480
M a,228,v,40,v,164
TW v,58,17608
TW v,60,17736
M a,228,v,44,v,180
TW v,62,17864
v_xor_b32 v11, 81920, v11
M a,232,v,32,v,136
DL 6,52,93,3144
M a,232,v,36,v,152
s_add_u32 m0, s92, 81920
s_mov_b32 s93, 2622080
M a,232,v,40,v,168
DL 5,40,93,0
M a,232,v,44,v,184
s_waitcnt lgkmcnt(0)
s_waitcnt vmcnt(14)
M a,240,v,48,v,128
s_barrier
TW v,32,0
M a,240,v,52,v,144
DL 5,44,93,1032
M a,240,v,56,v,160
v_permlane16_swap_b32 v12, v13
M a,240,v,60,v,176
TW v,34,128
v_add_f32 v12, v12, v13
M a,244,v,48,v,132
TW v,36,256
v_mov_b32 v28, v12
M a,244,v,52,v,148
TW v,38,384
v_mov_b32 v29, v28
M a,244,v,56,v,164
TW v,40,512
TW v,42,640
M a,244,v,60,v,180
TW v,44,768
TW v,46,896
M a,248,v,48,v,136
DL 5,48,93,2112
M a,248,v,52,v,152
v_permlane16_swap_b32 v28, v29
M a,248,v,56,v,168
TW v,48,8
v_mov_b32 v30, v28
M a,248,v,60,v,184
s_waitcnt lgkmcnt(1)
TW v,50,136
M a,0,v,32,v,64
TW v,52,264
v_mov_b32 v31, v29
M a,0,v,36,v,68
DL 5,52,93,3144
M a,0,v,40,v,72
TW v,54,392
s_add_u32 m0, s92, 132608
M a,0,v,44,v,76
TW v,56,520
s_mov_b32 s93, 2097920
M a,4,v,32,v,96
TW v,58,648
M a,4,v,36,v,100
TW v,60,776
M a,4,v,40,v,104
s_branch L_c2B
L_rsB7:
s_mov_b32 s100, 131072
s_call_b64 s[98:99], L_rareB
s_branch L_rbB7
L_rsB8:
s_mov_b32 s100, 147456
s_call_b64 s[98:99], L_rareB
s_branch L_rbB8
L_rsB9:
s_mov_b32 s100, 163840
s_call_b64 s[98:99], L_rareB
s_branch L_rbB9
L_rsB10:
s_mov_b32 s100, 180224
s_call_b64 s[98:99], L_rareB
s_branch L_rbB10
L_rsB11:
s_mov_b32 s100, 196608
s_call_b64 s[98:99], L_rareB
s_branch L_rbB11
L_rsB12:
s_mov_b32 s100, 212992
s_call_b64 s[98:99], L_rareB
s_branch L_rbB12
L_rsB13:
s_mov_b32 s100, 229376
s_call_b64 s[98:99], L_rareB
s_branch L_rbB13
L_rsB14:
s_mov_b32 s100, 245760
s_call_b64 s[98:99], L_rareB
s_branch L_rbB14
L_rareA:
s_nop 15
v_bfe_u32 v20, v4, 4, 4
v_lshlrev_b32 v20, 10, v20
v_bfe_u32 v21, v4, 8, 2
v_lshl_add_u32 v20, v21, 4, v20
buffer_load_dwordx4 v[80:83], v20, s[8:11], s100 offen offset:0
buffer_load_dwordx4 v[84:87], v20, s[8:11], s100 offen offset:64
buffer_load_dwordx4 v[88:91], v20, s[8:11], s100 offen offset:128
buffer_load_dwordx4 v[92:95], v20, s[8:11], s100 offen offset:192
s_waitcnt vmcnt(0)
MC 96,v,80,128,64
M v,96,v,84,v,144
M v,96,v,88,v,160
M v,96,v,92,v,176
MC 100,v,80,132,68
M v,100,v,84,v,148
M v,100,v,88,v,164
M v,100,v,92,v,180
MC 104,v,80,136,72
M v,104,v,84,v,152
M v,104,v,88,v,168
M v,104,v,92,v,184
MC 108,v,80,140,76
M v,108,v,84,v,156
M v,108,v,88,v,172
M v,108,v,92,v,188
s_nop 7
buffer_load_dwordx4 v[80:83], v20, s[8:11], s100 offen offset:256
buffer_load_dwordx4 v[84:87], v20, s[8:11], s100 offen offset:320
buffer_load_dwordx4 v[88:91], v20, s[8:11], s100 offen offset:384
buffer_load_dwordx4 v[92:95], v20, s[8:11], s100 offen offset:448
s_waitcnt vmcnt(0)
M v,96,v,80,v,192
M v,96,v,84,v,208
M v,96,v,88,v,224
M v,96,v,92,v,240
M v,100,v,80,v,196
M v,100,v,84,v,212
M v,100,v,88,v,228
M v,100,v,92,v,244
M v,104,v,80,v,200
M v,104,v,84,v,216
M v,104,v,88,v,232
M v,104,v,92,v,248
M v,108,v,80,v,204
M v,108,v,84,v,220
M v,108,v,88,v,236
M v,108,v,92,v,252
s_nop 7
buffer_load_dwordx4 v[80:83], v20, s[8:11], s100 offen offset:512
buffer_load_dwordx4 v[84:87], v20, s[8:11], s100 offen offset:576
buffer_load_dwordx4 v[88:91], v20, s[8:11], s100 offen offset:640
buffer_load_dwordx4 v[92:95], v20, s[8:11], s100 offen offset:704
s_waitcnt vmcnt(0)
MC 112,v,80,128,64
M v,112,v,84,v,144
M v,112,v,88,v,160
M v,112,v,92,v,176
MC 116,v,80,132,68
M v,116,v,84,v,148
M v,116,v,88,v,164
M v,116,v,92,v,180
MC 120,v,80,136,72
M v,120,v,84,v,152
M v,120,v,88,v,168
M v,120,v,92,v,184
MC 124,v,80,140,76
M v,124,v,84,v,156
M v,124,v,88,v,172
M v,124,v,92,v,188
s_nop 7
buffer_load_dwordx4 v[80:83], v20, s[8:11], s100 offen offset:768
buffer_load_dwordx4 v[84:87], v20, s[8:11], s100 offen offset:832
buffer_load_dwordx4 v[88:91], v20, s[8:11], s100 offen offset:896
buffer_load_dwordx4 v[92:95], v20, s[8:11], s100 offen offset:960
s_waitcnt vmcnt(0)
M v,112,v,80,v,192
M v,112,v,84,v,208
M v,112,v,88,v,224
M v,112,v,92,v,240
M v,116,v,80,v,196
M v,116,v,84,v,212
M v,116,v,88,v,228
M v,116,v,92,v,244
M v,120,v,80,v,200
M v,120,v,84,v,216
M v,120,v,88,v,232
M v,120,v,92,v,248
M v,124,v,80,v,204
M v,124,v,84,v,220
M v,124,v,88,v,236
M v,124,v,92,v,252
s_nop 7
s_nop 15
v_max3_f32 v20, v96, v97, v98
v_max3_f32 v20, v20, v99, v112
v_max3_f32 v20, v20, v113, v114
v_max3_f32 v20, v20, v115, 0
v_mov_b32 v21, v20
s_nop 1
v_permlane32_swap_b32 v20, v21
s_nop 1
v_max_f32 v20, v20, v21
v_mov_b32 v21, v20
s_nop 1
v_permlane16_swap_b32 v20, v21
s_nop 1
v_max_f32 v20, v20, v21
v_sub_f32 v64, v64, v20
v_sub_f32 v65, v65, v20
v_sub_f32 v66, v66, v20
v_sub_f32 v67, v67, v20
v_sub_f32 v96, v96, v20
EX 96
v_sub_f32 v97, v97, v20
EX 97
v_sub_f32 v98, v98, v20
EX 98
v_sub_f32 v99, v99, v20
EX 99
v_sub_f32 v112, v112, v20
EX 112
v_sub_f32 v113, v113, v20
EX 113
v_sub_f32 v114, v114, v20
EX 114
v_sub_f32 v115, v115, v20
EX 115
v_exp_f32 v21, -v20
AD 16,96,97
AD 16,16,98
AD 16,16,99
AD 16,16,112
AD 16,16,113
AD 16,16,114
AD 16,16,115
MU 12,21
CV 80,96
CV 81,98
CV 82,112
CV 83,114
AR 24,0
AR 25,1
AR 26,2
AR 27,3
v_pk_mul_f32 v[24:25], v[24:25], v[20:21] op_sel:[0,1] op_sel_hi:[1,1]
v_pk_mul_f32 v[26:27], v[26:27], v[20:21] op_sel:[0,1] op_sel_hi:[1,1]
AW 0,24
AW 1,25
AW 2,26
AW 3,27
AR 24,16
AR 25,17
AR 26,18
AR 27,19
v_pk_mul_f32 v[24:25], v[24:25], v[20:21] op_sel:[0,1] op_sel_hi:[1,1]
v_pk_mul_f32 v[26:27], v[26:27], v[20:21] op_sel:[0,1] op_sel_hi:[1,1]
AW 16,24
AW 17,25
AW 18,26
AW 19,27
AR 24,32
AR 25,33
AR 26,34
AR 27,35
v_pk_mul_f32 v[24:25], v[24:25], v[20:21] op_sel:[0,1] op_sel_hi:[1,1]
v_pk_mul_f32 v[26:27], v[26:27], v[20:21] op_sel:[0,1] op_sel_hi:[1,1]
AW 32,24
AW 33,25
AW 34,26
AW 35,27
AR 24,48
AR 25,49
AR 26,50
AR 27,51
v_pk_mul_f32 v[24:25], v[24:25], v[20:21] op_sel:[0,1] op_sel_hi:[1,1]
v_pk_mul_f32 v[26:27], v[26:27], v[20:21] op_sel:[0,1] op_sel_hi:[1,1]
AW 48,24
AW 49,25
AW 50,26
AW 51,27
AR 24,64
AR 25,65
AR 26,66
AR 27,67
v_pk_mul_f32 v[24:25], v[24:25], v[20:21] op_sel:[0,1] op_sel_hi:[1,1]
v_pk_mul_f32 v[26:27], v[26:27], v[20:21] op_sel:[0,1] op_sel_hi:[1,1]
AW 64,24
AW 65,25
AW 66,26
AW 67,27
AR 24,80
AR 25,81
AR 26,82
AR 27,83
v_pk_mul_f32 v[24:25], v[24:25], v[20:21] op_sel:[0,1] op_sel_hi:[1,1]
v_pk_mul_f32 v[26:27], v[26:27], v[20:21] op_sel:[0,1] op_sel_hi:[1,1]
AW 80,24
AW 81,25
AW 82,26
AW 83,27
AR 24,96
AR 25,97
AR 26,98
AR 27,99
v_pk_mul_f32 v[24:25], v[24:25], v[20:21] op_sel:[0,1] op_sel_hi:[1,1]
v_pk_mul_f32 v[26:27], v[26:27], v[20:21] op_sel:[0,1] op_sel_hi:[1,1]
AW 96,24
AW 97,25
AW 98,26
AW 99,27
AR 24,112
AR 25,113
AR 26,114
AR 27,115
v_pk_mul_f32 v[24:25], v[24:25], v[20:21] op_sel:[0,1] op_sel_hi:[1,1]
v_pk_mul_f32 v[26:27], v[26:27], v[20:21] op_sel:[0,1] op_sel_hi:[1,1]
AW 112,24
AW 113,25
AW 114,26
AW 115,27
AR 24,128
AR 25,129
AR 26,130
AR 27,131
v_pk_mul_f32 v[24:25], v[24:25], v[20:21] op_sel:[0,1] op_sel_hi:[1,1]
v_pk_mul_f32 v[26:27], v[26:27], v[20:21] op_sel:[0,1] op_sel_hi:[1,1]
AW 128,24
AW 129,25
AW 130,26
AW 131,27
AR 24,144
AR 25,145
AR 26,146
AR 27,147
v_pk_mul_f32 v[24:25], v[24:25], v[20:21] op_sel:[0,1] op_sel_hi:[1,1]
v_pk_mul_f32 v[26:27], v[26:27], v[20:21] op_sel:[0,1] op_sel_hi:[1,1]
AW 144,24
AW 145,25
AW 146,26
AW 147,27
AR 24,160
AR 25,161
AR 26,162
AR 27,163
v_pk_mul_f32 v[24:25], v[24:25], v[20:21] op_sel:[0,1] op_sel_hi:[1,1]
v_pk_mul_f32 v[26:27], v[26:27], v[20:21] op_sel:[0,1] op_sel_hi:[1,1]
AW 160,24
AW 161,25
AW 162,26
AW 163,27
AR 24,176
AR 25,177
AR 26,178
AR 27,179
v_pk_mul_f32 v[24:25], v[24:25], v[20:21] op_sel:[0,1] op_sel_hi:[1,1]
v_pk_mul_f32 v[26:27], v[26:27], v[20:21] op_sel:[0,1] op_sel_hi:[1,1]
AW 176,24
AW 177,25
AW 178,26
AW 179,27
AR 24,192
AR 25,193
AR 26,194
AR 27,195
v_pk_mul_f32 v[24:25], v[24:25], v[20:21] op_sel:[0,1] op_sel_hi:[1,1]
v_pk_mul_f32 v[26:27], v[26:27], v[20:21] op_sel:[0,1] op_sel_hi:[1,1]
AW 192,24
AW 193,25
AW 194,26
AW 195,27
AR 24,208
AR 25,209
AR 26,210
AR 27,211
v_pk_mul_f32 v[24:25], v[24:25], v[20:21] op_sel:[0,1] op_sel_hi:[1,1]
v_pk_mul_f32 v[26:27], v[26:27], v[20:21] op_sel:[0,1] op_sel_hi:[1,1]
AW 208,24
AW 209,25
AW 210,26
AW 211,27
v_pk_mul_f32 v[32:33], v[32:33], v[20:21] op_sel:[0,1] op_sel_hi:[1,1]
v_pk_mul_f32 v[34:35], v[34:35], v[20:21] op_sel:[0,1] op_sel_hi:[1,1]
v_pk_mul_f32 v[48:49], v[48:49], v[20:21] op_sel:[0,1] op_sel_hi:[1,1]
v_pk_mul_f32 v[50:51], v[50:51], v[20:21] op_sel:[0,1] op_sel_hi:[1,1]
v_max3_f32 v20, v100, v101, v102
v_max3_f32 v20, v20, v103, v116
v_max3_f32 v20, v20, v117, v118
v_max3_f32 v20, v20, v119, 0
v_mov_b32 v21, v20
s_nop 1
v_permlane32_swap_b32 v20, v21
s_nop 1
v_max_f32 v20, v20, v21
v_mov_b32 v21, v20
s_nop 1
v_permlane16_swap_b32 v20, v21
s_nop 1
v_max_f32 v20, v20, v21
v_sub_f32 v68, v68, v20
v_sub_f32 v69, v69, v20
v_sub_f32 v70, v70, v20
v_sub_f32 v71, v71, v20
v_sub_f32 v100, v100, v20
EX 100
v_sub_f32 v101, v101, v20
EX 101
v_sub_f32 v102, v102, v20
EX 102
v_sub_f32 v103, v103, v20
EX 103
v_sub_f32 v116, v116, v20
EX 116
v_sub_f32 v117, v117, v20
EX 117
v_sub_f32 v118, v118, v20
EX 118
v_sub_f32 v119, v119, v20
EX 119
v_exp_f32 v21, -v20
AD 17,100,101
AD 17,17,102
AD 17,17,103
AD 17,17,116
AD 17,17,117
AD 17,17,118
AD 17,17,119
MU 13,21
CV 84,100
CV 85,102
CV 86,116
CV 87,118
AR 24,4
AR 25,5
AR 26,6
AR 27,7
v_pk_mul_f32 v[24:25], v[24:25], v[20:21] op_sel:[0,1] op_sel_hi:[1,1]
v_pk_mul_f32 v[26:27], v[26:27], v[20:21] op_sel:[0,1] op_sel_hi:[1,1]
AW 4,24
AW 5,25
AW 6,26
AW 7,27
AR 24,20
AR 25,21
AR 26,22
AR 27,23
v_pk_mul_f32 v[24:25], v[24:25], v[20:21] op_sel:[0,1] op_sel_hi:[1,1]
v_pk_mul_f32 v[26:27], v[26:27], v[20:21] op_sel:[0,1] op_sel_hi:[1,1]
AW 20,24
AW 21,25
AW 22,26
AW 23,27
AR 24,36
AR 25,37
AR 26,38
AR 27,39
v_pk_mul_f32 v[24:25], v[24:25], v[20:21] op_sel:[0,1] op_sel_hi:[1,1]
v_pk_mul_f32 v[26:27], v[26:27], v[20:21] op_sel:[0,1] op_sel_hi:[1,1]
AW 36,24
AW 37,25
AW 38,26
AW 39,27
AR 24,52
AR 25,53
AR 26,54
AR 27,55
v_pk_mul_f32 v[24:25], v[24:25], v[20:21] op_sel:[0,1] op_sel_hi:[1,1]
v_pk_mul_f32 v[26:27], v[26:27], v[20:21] op_sel:[0,1] op_sel_hi:[1,1]
AW 52,24
AW 53,25
AW 54,26
AW 55,27
AR 24,68
AR 25,69
AR 26,70
AR 27,71
v_pk_mul_f32 v[24:25], v[24:25], v[20:21] op_sel:[0,1] op_sel_hi:[1,1]
v_pk_mul_f32 v[26:27], v[26:27], v[20:21] op_sel:[0,1] op_sel_hi:[1,1]
AW 68,24
AW 69,25
AW 70,26
AW 71,27
AR 24,84
AR 25,85
AR 26,86
AR 27,87
v_pk_mul_f32 v[24:25], v[24:25], v[20:21] op_sel:[0,1] op_sel_hi:[1,1]
v_pk_mul_f32 v[26:27], v[26:27], v[20:21] op_sel:[0,1] op_sel_hi:[1,1]
AW 84,24
AW 85,25
AW 86,26
AW 87,27
AR 24,100
AR 25,101
AR 26,102
AR 27,103
v_pk_mul_f32 v[24:25], v[24:25], v[20:21] op_sel:[0,1] op_sel_hi:[1,1]
v_pk_mul_f32 v[26:27], v[26:27], v[20:21] op_sel:[0,1] op_sel_hi:[1,1]
AW 100,24
AW 101,25
AW 102,26
AW 103,27
AR 24,116
AR 25,117
AR 26,118
AR 27,119
v_pk_mul_f32 v[24:25], v[24:25], v[20:21] op_sel:[0,1] op_sel_hi:[1,1]
v_pk_mul_f32 v[26:27], v[26:27], v[20:21] op_sel:[0,1] op_sel_hi:[1,1]
AW 116,24
AW 117,25
AW 118,26
AW 119,27
AR 24,132
AR 25,133
AR 26,134
AR 27,135
v_pk_mul_f32 v[24:25], v[24:25], v[20:21] op_sel:[0,1] op_sel_hi:[1,1]
v_pk_mul_f32 v[26:27], v[26:27], v[20:21] op_sel:[0,1] op_sel_hi:[1,1]
AW 132,24
AW 133,25
AW 134,26
AW 135,27
AR 24,148
AR 25,149
AR 26,150
AR 27,151
v_pk_mul_f32 v[24:25], v[24:25], v[20:21] op_sel:[0,1] op_sel_hi:[1,1]
v_pk_mul_f32 v[26:27], v[26:27], v[20:21] op_sel:[0,1] op_sel_hi:[1,1]
AW 148,24
AW 149,25
AW 150,26
AW 151,27
AR 24,164
AR 25,165
AR 26,166
AR 27,167
v_pk_mul_f32 v[24:25], v[24:25], v[20:21] op_sel:[0,1] op_sel_hi:[1,1]
v_pk_mul_f32 v[26:27], v[26:27], v[20:21] op_sel:[0,1] op_sel_hi:[1,1]
AW 164,24
AW 165,25
AW 166,26
AW 167,27
AR 24,180
AR 25,181
AR 26,182
AR 27,183
v_pk_mul_f32 v[24:25], v[24:25], v[20:21] op_sel:[0,1] op_sel_hi:[1,1]
v_pk_mul_f32 v[26:27], v[26:27], v[20:21] op_sel:[0,1] op_sel_hi:[1,1]
AW 180,24
AW 181,25
AW 182,26
AW 183,27
AR 24,196
AR 25,197
AR 26,198
AR 27,199
v_pk_mul_f32 v[24:25], v[24:25], v[20:21] op_sel:[0,1] op_sel_hi:[1,1]
v_pk_mul_f32 v[26:27], v[26:27], v[20:21] op_sel:[0,1] op_sel_hi:[1,1]
AW 196,24
AW 197,25
AW 198,26
AW 199,27
AR 24,212
AR 25,213
AR 26,214
AR 27,215
v_pk_mul_f32 v[24:25], v[24:25], v[20:21] op_sel:[0,1] op_sel_hi:[1,1]
v_pk_mul_f32 v[26:27], v[26:27], v[20:21] op_sel:[0,1] op_sel_hi:[1,1]
AW 212,24
AW 213,25
AW 214,26
AW 215,27
v_pk_mul_f32 v[36:37], v[36:37], v[20:21] op_sel:[0,1] op_sel_hi:[1,1]
v_pk_mul_f32 v[38:39], v[38:39], v[20:21] op_sel:[0,1] op_sel_hi:[1,1]
v_pk_mul_f32 v[52:53], v[52:53], v[20:21] op_sel:[0,1] op_sel_hi:[1,1]
v_pk_mul_f32 v[54:55], v[54:55], v[20:21] op_sel:[0,1] op_sel_hi:[1,1]
v_max3_f32 v20, v104, v105, v106
v_max3_f32 v20, v20, v107, v120
v_max3_f32 v20, v20, v121, v122
v_max3_f32 v20, v20, v123, 0
v_mov_b32 v21, v20
s_nop 1
v_permlane32_swap_b32 v20, v21
s_nop 1
v_max_f32 v20, v20, v21
v_mov_b32 v21, v20
s_nop 1
v_permlane16_swap_b32 v20, v21
s_nop 1
v_max_f32 v20, v20, v21
v_sub_f32 v72, v72, v20
v_sub_f32 v73, v73, v20
v_sub_f32 v74, v74, v20
v_sub_f32 v75, v75, v20
v_sub_f32 v104, v104, v20
EX 104
v_sub_f32 v105, v105, v20
EX 105
v_sub_f32 v106, v106, v20
EX 106
v_sub_f32 v107, v107, v20
EX 107
v_sub_f32 v120, v120, v20
EX 120
v_sub_f32 v121, v121, v20
EX 121
v_sub_f32 v122, v122, v20
EX 122
v_sub_f32 v123, v123, v20
EX 123
v_exp_f32 v21, -v20
AD 18,104,105
AD 18,18,106
AD 18,18,107
AD 18,18,120
AD 18,18,121
AD 18,18,122
AD 18,18,123
MU 14,21
CV 88,104
CV 89,106
CV 90,120
CV 91,122
AR 24,8
AR 25,9
AR 26,10
AR 27,11
v_pk_mul_f32 v[24:25], v[24:25], v[20:21] op_sel:[0,1] op_sel_hi:[1,1]
v_pk_mul_f32 v[26:27], v[26:27], v[20:21] op_sel:[0,1] op_sel_hi:[1,1]
AW 8,24
AW 9,25
AW 10,26
AW 11,27
AR 24,24
AR 25,25
AR 26,26
AR 27,27
v_pk_mul_f32 v[24:25], v[24:25], v[20:21] op_sel:[0,1] op_sel_hi:[1,1]
v_pk_mul_f32 v[26:27], v[26:27], v[20:21] op_sel:[0,1] op_sel_hi:[1,1]
AW 24,24
AW 25,25
AW 26,26
AW 27,27
AR 24,40
AR 25,41
AR 26,42
AR 27,43
v_pk_mul_f32 v[24:25], v[24:25], v[20:21] op_sel:[0,1] op_sel_hi:[1,1]
v_pk_mul_f32 v[26:27], v[26:27], v[20:21] op_sel:[0,1] op_sel_hi:[1,1]
AW 40,24
AW 41,25
AW 42,26
AW 43,27
AR 24,56
AR 25,57
AR 26,58
AR 27,59
v_pk_mul_f32 v[24:25], v[24:25], v[20:21] op_sel:[0,1] op_sel_hi:[1,1]
v_pk_mul_f32 v[26:27], v[26:27], v[20:21] op_sel:[0,1] op_sel_hi:[1,1]
AW 56,24
AW 57,25
AW 58,26
AW 59,27
AR 24,72
AR 25,73
AR 26,74
AR 27,75
v_pk_mul_f32 v[24:25], v[24:25], v[20:21] op_sel:[0,1] op_sel_hi:[1,1]
v_pk_mul_f32 v[26:27], v[26:27], v[20:21] op_sel:[0,1] op_sel_hi:[1,1]
AW 72,24
AW 73,25
AW 74,26
AW 75,27
AR 24,88
AR 25,89
AR 26,90
AR 27,91
v_pk_mul_f32 v[24:25], v[24:25], v[20:21] op_sel:[0,1] op_sel_hi:[1,1]
v_pk_mul_f32 v[26:27], v[26:27], v[20:21] op_sel:[0,1] op_sel_hi:[1,1]
AW 88,24
AW 89,25
AW 90,26
AW 91,27
AR 24,104
AR 25,105
AR 26,106
AR 27,107
v_pk_mul_f32 v[24:25], v[24:25], v[20:21] op_sel:[0,1] op_sel_hi:[1,1]
v_pk_mul_f32 v[26:27], v[26:27], v[20:21] op_sel:[0,1] op_sel_hi:[1,1]
AW 104,24
AW 105,25
AW 106,26
AW 107,27
AR 24,120
AR 25,121
AR 26,122
AR 27,123
v_pk_mul_f32 v[24:25], v[24:25], v[20:21] op_sel:[0,1] op_sel_hi:[1,1]
v_pk_mul_f32 v[26:27], v[26:27], v[20:21] op_sel:[0,1] op_sel_hi:[1,1]
AW 120,24
AW 121,25
AW 122,26
AW 123,27
AR 24,136
AR 25,137
AR 26,138
AR 27,139
v_pk_mul_f32 v[24:25], v[24:25], v[20:21] op_sel:[0,1] op_sel_hi:[1,1]
v_pk_mul_f32 v[26:27], v[26:27], v[20:21] op_sel:[0,1] op_sel_hi:[1,1]
AW 136,24
AW 137,25
AW 138,26
AW 139,27
AR 24,152
AR 25,153
AR 26,154
AR 27,155
v_pk_mul_f32 v[24:25], v[24:25], v[20:21] op_sel:[0,1] op_sel_hi:[1,1]
v_pk_mul_f32 v[26:27], v[26:27], v[20:21] op_sel:[0,1] op_sel_hi:[1,1]
AW 152,24
AW 153,25
AW 154,26
AW 155,27
AR 24,168
AR 25,169
AR 26,170
AR 27,171
v_pk_mul_f32 v[24:25], v[24:25], v[20:21] op_sel:[0,1] op_sel_hi:[1,1]
v_pk_mul_f32 v[26:27], v[26:27], v[20:21] op_sel:[0,1] op_sel_hi:[1,1]
AW 168,24
AW 169,25
AW 170,26
AW 171,27
AR 24,184
AR 25,185
AR 26,186
AR 27,187
v_pk_mul_f32 v[24:25], v[24:25], v[20:21] op_sel:[0,1] op_sel_hi:[1,1]
v_pk_mul_f32 v[26:27], v[26:27], v[20:21] op_sel:[0,1] op_sel_hi:[1,1]
AW 184,24
AW 185,25
AW 186,26
AW 187,27
AR 24,200
AR 25,201
AR 26,202
AR 27,203
v_pk_mul_f32 v[24:25], v[24:25], v[20:21] op_sel:[0,1] op_sel_hi:[1,1]
v_pk_mul_f32 v[26:27], v[26:27], v[20:21] op_sel:[0,1] op_sel_hi:[1,1]
AW 200,24
AW 201,25
AW 202,26
AW 203,27
AR 24,216
AR 25,217
AR 26,218
AR 27,219
v_pk_mul_f32 v[24:25], v[24:25], v[20:21] op_sel:[0,1] op_sel_hi:[1,1]
v_pk_mul_f32 v[26:27], v[26:27], v[20:21] op_sel:[0,1] op_sel_hi:[1,1]
AW 216,24
AW 217,25
AW 218,26
AW 219,27
v_pk_mul_f32 v[40:41], v[40:41], v[20:21] op_sel:[0,1] op_sel_hi:[1,1]
v_pk_mul_f32 v[42:43], v[42:43], v[20:21] op_sel:[0,1] op_sel_hi:[1,1]
v_pk_mul_f32 v[56:57], v[56:57], v[20:21] op_sel:[0,1] op_sel_hi:[1,1]
v_pk_mul_f32 v[58:59], v[58:59], v[20:21] op_sel:[0,1] op_sel_hi:[1,1]
v_max3_f32 v20, v108, v109, v110
v_max3_f32 v20, v20, v111, v124
v_max3_f32 v20, v20, v125, v126
v_max3_f32 v20, v20, v127, 0
v_mov_b32 v21, v20
s_nop 1
v_permlane32_swap_b32 v20, v21
s_nop 1
v_max_f32 v20, v20, v21
v_mov_b32 v21, v20
s_nop 1
v_permlane16_swap_b32 v20, v21
s_nop 1
v_max_f32 v20, v20, v21
v_sub_f32 v76, v76, v20
v_sub_f32 v77, v77, v20
v_sub_f32 v78, v78, v20
v_sub_f32 v79, v79, v20
v_sub_f32 v108, v108, v20
EX 108
v_sub_f32 v109, v109, v20
EX 109
v_sub_f32 v110, v110, v20
EX 110
v_sub_f32 v111, v111, v20
EX 111
v_sub_f32 v124, v124, v20
EX 124
v_sub_f32 v125, v125, v20
EX 125
v_sub_f32 v126, v126, v20
EX 126
v_sub_f32 v127, v127, v20
EX 127
v_exp_f32 v21, -v20
AD 19,108,109
AD 19,19,110
AD 19,19,111
AD 19,19,124
AD 19,19,125
AD 19,19,126
AD 19,19,127
MU 15,21
CV 92,108
CV 93,110
CV 94,124
CV 95,126
AR 24,12
AR 25,13
AR 26,14
AR 27,15
v_pk_mul_f32 v[24:25], v[24:25], v[20:21] op_sel:[0,1] op_sel_hi:[1,1]
v_pk_mul_f32 v[26:27], v[26:27], v[20:21] op_sel:[0,1] op_sel_hi:[1,1]
AW 12,24
AW 13,25
AW 14,26
AW 15,27
AR 24,28
AR 25,29
AR 26,30
AR 27,31
v_pk_mul_f32 v[24:25], v[24:25], v[20:21] op_sel:[0,1] op_sel_hi:[1,1]
v_pk_mul_f32 v[26:27], v[26:27], v[20:21] op_sel:[0,1] op_sel_hi:[1,1]
AW 28,24
AW 29,25
AW 30,26
AW 31,27
AR 24,44
AR 25,45
AR 26,46
AR 27,47
v_pk_mul_f32 v[24:25], v[24:25], v[20:21] op_sel:[0,1] op_sel_hi:[1,1]
v_pk_mul_f32 v[26:27], v[26:27], v[20:21] op_sel:[0,1] op_sel_hi:[1,1]
AW 44,24
AW 45,25
AW 46,26
AW 47,27
AR 24,60
AR 25,61
AR 26,62
AR 27,63
v_pk_mul_f32 v[24:25], v[24:25], v[20:21] op_sel:[0,1] op_sel_hi:[1,1]
v_pk_mul_f32 v[26:27], v[26:27], v[20:21] op_sel:[0,1] op_sel_hi:[1,1]
AW 60,24
AW 61,25
AW 62,26
AW 63,27
AR 24,76
AR 25,77
AR 26,78
AR 27,79
v_pk_mul_f32 v[24:25], v[24:25], v[20:21] op_sel:[0,1] op_sel_hi:[1,1]
v_pk_mul_f32 v[26:27], v[26:27], v[20:21] op_sel:[0,1] op_sel_hi:[1,1]
AW 76,24
AW 77,25
AW 78,26
AW 79,27
AR 24,92
AR 25,93
AR 26,94
AR 27,95
v_pk_mul_f32 v[24:25], v[24:25], v[20:21] op_sel:[0,1] op_sel_hi:[1,1]
v_pk_mul_f32 v[26:27], v[26:27], v[20:21] op_sel:[0,1] op_sel_hi:[1,1]
AW 92,24
AW 93,25
AW 94,26
AW 95,27
AR 24,108
AR 25,109
AR 26,110
AR 27,111
v_pk_mul_f32 v[24:25], v[24:25], v[20:21] op_sel:[0,1] op_sel_hi:[1,1]
v_pk_mul_f32 v[26:27], v[26:27], v[20:21] op_sel:[0,1] op_sel_hi:[1,1]
AW 108,24
AW 109,25
AW 110,26
AW 111,27
AR 24,124
AR 25,125
AR 26,126
AR 27,127
v_pk_mul_f32 v[24:25], v[24:25], v[20:21] op_sel:[0,1] op_sel_hi:[1,1]
v_pk_mul_f32 v[26:27], v[26:27], v[20:21] op_sel:[0,1] op_sel_hi:[1,1]
AW 124,24
AW 125,25
AW 126,26
AW 127,27
AR 24,140
AR 25,141
AR 26,142
AR 27,143
v_pk_mul_f32 v[24:25], v[24:25], v[20:21] op_sel:[0,1] op_sel_hi:[1,1]
v_pk_mul_f32 v[26:27], v[26:27], v[20:21] op_sel:[0,1] op_sel_hi:[1,1]
AW 140,24
AW 141,25
AW 142,26
AW 143,27
AR 24,156
AR 25,157
AR 26,158
AR 27,159
v_pk_mul_f32 v[24:25], v[24:25], v[20:21] op_sel:[0,1] op_sel_hi:[1,1]
v_pk_mul_f32 v[26:27], v[26:27], v[20:21] op_sel:[0,1] op_sel_hi:[1,1]
AW 156,24
AW 157,25
AW 158,26
AW 159,27
AR 24,172
AR 25,173
AR 26,174
AR 27,175
v_pk_mul_f32 v[24:25], v[24:25], v[20:21] op_sel:[0,1] op_sel_hi:[1,1]
v_pk_mul_f32 v[26:27], v[26:27], v[20:21] op_sel:[0,1] op_sel_hi:[1,1]
AW 172,24
AW 173,25
AW 174,26
AW 175,27
AR 24,188
AR 25,189
AR 26,190
AR 27,191
v_pk_mul_f32 v[24:25], v[24:25], v[20:21] op_sel:[0,1] op_sel_hi:[1,1]
v_pk_mul_f32 v[26:27], v[26:27], v[20:21] op_sel:[0,1] op_sel_hi:[1,1]
AW 188,24
AW 189,25
AW 190,26
AW 191,27
AR 24,204
AR 25,205
AR 26,206
AR 27,207
v_pk_mul_f32 v[24:25], v[24:25], v[20:21] op_sel:[0,1] op_sel_hi:[1,1]
v_pk_mul_f32 v[26:27], v[26:27], v[20:21] op_sel:[0,1] op_sel_hi:[1,1]
AW 204,24
AW 205,25
AW 206,26
AW 207,27
AR 24,220
AR 25,221
AR 26,222
AR 27,223
v_pk_mul_f32 v[24:25], v[24:25], v[20:21] op_sel:[0,1] op_sel_hi:[1,1]
v_pk_mul_f32 v[26:27], v[26:27], v[20:21] op_sel:[0,1] op_sel_hi:[1,1]
AW 220,24
AW 221,25
AW 222,26
AW 223,27
v_pk_mul_f32 v[44:45], v[44:45], v[20:21] op_sel:[0,1] op_sel_hi:[1,1]
v_pk_mul_f32 v[46:47], v[46:47], v[20:21] op_sel:[0,1] op_sel_hi:[1,1]
v_pk_mul_f32 v[60:61], v[60:61], v[20:21] op_sel:[0,1] op_sel_hi:[1,1]
v_pk_mul_f32 v[62:63], v[62:63], v[20:21] op_sel:[0,1] op_sel_hi:[1,1]
s_nop 3
s_setpc_b64 s[98:99]
L_rareB:
s_nop 15
v_bfe_u32 v20, v4, 4, 4
v_lshlrev_b32 v20, 10, v20
v_bfe_u32 v21, v4, 8, 2
v_lshl_add_u32 v20, v21, 4, v20
buffer_load_dwordx4 v[80:83], v20, s[8:11], s100 offen offset:0
buffer_load_dwordx4 v[84:87], v20, s[8:11], s100 offen offset:64
buffer_load_dwordx4 v[88:91], v20, s[8:11], s100 offen offset:128
buffer_load_dwordx4 v[92:95], v20, s[8:11], s100 offen offset:192
s_waitcnt vmcnt(0)
MC 96,v,80,128,64
M v,96,v,84,v,144
M v,96,v,88,v,160
M v,96,v,92,v,176
MC 100,v,80,132,68
M v,100,v,84,v,148
M v,100,v,88,v,164
M v,100,v,92,v,180
MC 104,v,80,136,72
M v,104,v,84,v,152
M v,104,v,88,v,168
M v,104,v,92,v,184
s_nop 7
buffer_load_dwordx4 v[80:83], v20, s[8:11], s100 offen offset:256
buffer_load_dwordx4 v[84:87], v20, s[8:11], s100 offen offset:320
buffer_load_dwordx4 v[88:91], v20, s[8:11], s100 offen offset:384
buffer_load_dwordx4 v[92:95], v20, s[8:11], s100 offen offset:448
s_waitcnt vmcnt(0)
M v,96,v,80,v,192
M v,96,v,84,v,208
M v,96,v,88,v,224
M v,96,v,92,v,240
M v,100,v,80,v,196
M v,100,v,84,v,212
M v,100,v,88,v,228
M v,100,v,92,v,244
M v,104,v,80,v,200
M v,104,v,84,v,216
M v,104,v,88,v,232
M v,104,v,92,v,248
s_nop 7
buffer_load_dwordx4 v[80:83], v20, s[8:11], s100 offen offset:512
buffer_load_dwordx4 v[84:87], v20, s[8:11], s100 offen offset:576
buffer_load_dwordx4 v[88:91], v20, s[8:11], s100 offen offset:640
buffer_load_dwordx4 v[92:95], v20, s[8:11], s100 offen offset:704
s_waitcnt vmcnt(0)
MC 112,v,80,128,64
M v,112,v,84,v,144
M v,112,v,88,v,160
M v,112,v,92,v,176
MC 116,v,80,132,68
M v,116,v,84,v,148
M v,116,v,88,v,164
M v,116,v,92,v,180
MC 120,v,80,136,72
M v,120,v,84,v,152
M v,120,v,88,v,168
M v,120,v,92,v,184
s_nop 7
buffer_load_dwordx4 v[80:83], v20, s[8:11], s100 offen offset:768
buffer_load_dwordx4 v[84:87], v20, s[8:11], s100 offen offset:832
buffer_load_dwordx4 v[88:91], v20, s[8:11], s100 offen offset:896
buffer_load_dwordx4 v[92:95], v20, s[8:11], s100 offen offset:960
s_waitcnt vmcnt(0)
M v,112,v,80,v,192
M v,112,v,84,v,208
M v,112,v,88,v,224
M v,112,v,92,v,240
M v,116,v,80,v,196
M v,116,v,84,v,212
M v,116,v,88,v,228
M v,116,v,92,v,244
M v,120,v,80,v,200
M v,120,v,84,v,216
M v,120,v,88,v,232
M v,120,v,92,v,248
s_nop 7
s_nop 15
v_max3_f32 v20, v96, v97, v98
v_max3_f32 v20, v20, v99, v112
v_max3_f32 v20, v20, v113, v114
v_max3_f32 v20, v20, v115, 0
v_mov_b32 v21, v20
s_nop 1
v_permlane32_swap_b32 v20, v21
s_nop 1
v_max_f32 v20, v20, v21
v_mov_b32 v21, v20
s_nop 1
v_permlane16_swap_b32 v20, v21
s_nop 1
v_max_f32 v20, v20, v21
v_sub_f32 v64, v64, v20
v_sub_f32 v65, v65, v20
v_sub_f32 v66, v66, v20
v_sub_f32 v67, v67, v20
v_sub_f32 v96, v96, v20
EX 96
v_sub_f32 v97, v97, v20
EX 97
v_sub_f32 v98, v98, v20
EX 98
v_sub_f32 v99, v99, v20
EX 99
v_sub_f32 v112, v112, v20
EX 112
v_sub_f32 v113, v113, v20
EX 113
v_sub_f32 v114, v114, v20
EX 114
v_sub_f32 v115, v115, v20
EX 115
v_exp_f32 v21, -v20
AD 16,96,97
AD 16,16,98
AD 16,16,99
AD 16,16,112
AD 16,16,113
AD 16,16,114
AD 16,16,115
MU 12,21
CV 80,96
CV 81,98
CV 82,112
CV 83,114
AR 24,0
AR 25,1
AR 26,2
AR 27,3
v_pk_mul_f32 v[24:25], v[24:25], v[20:21] op_sel:[0,1] op_sel_hi:[1,1]
v_pk_mul_f32 v[26:27], v[26:27], v[20:21] op_sel:[0,1] op_sel_hi:[1,1]
AW 0,24
AW 1,25
AW 2,26
AW 3,27
AR 24,16
AR 25,17
AR 26,18
AR 27,19
v_pk_mul_f32 v[24:25], v[24:25], v[20:21] op_sel:[0,1] op_sel_hi:[1,1]
v_pk_mul_f32 v[26:27], v[26:27], v[20:21] op_sel:[0,1] op_sel_hi:[1,1]
AW 16,24
AW 17,25
AW 18,26
AW 19,27
AR 24,32
AR 25,33
AR 26,34
AR 27,35
v_pk_mul_f32 v[24:25], v[24:25], v[20:21] op_sel:[0,1] op_sel_hi:[1,1]
v_pk_mul_f32 v[26:27], v[26:27], v[20:21] op_sel:[0,1] op_sel_hi:[1,1]
AW 32,24
AW 33,25
AW 34,26
AW 35,27
AR 24,48
AR 25,49
AR 26,50
AR 27,51
v_pk_mul_f32 v[24:25], v[24:25], v[20:21] op_sel:[0,1] op_sel_hi:[1,1]
v_pk_mul_f32 v[26:27], v[26:27], v[20:21] op_sel:[0,1] op_sel_hi:[1,1]
AW 48,24
AW 49,25
AW 50,26
AW 51,27
AR 24,64
AR 25,65
AR 26,66
AR 27,67
v_pk_mul_f32 v[24:25], v[24:25], v[20:21] op_sel:[0,1] op_sel_hi:[1,1]
v_pk_mul_f32 v[26:27], v[26:27], v[20:21] op_sel:[0,1] op_sel_hi:[1,1]
AW 64,24
AW 65,25
AW 66,26
AW 67,27
AR 24,80
AR 25,81
AR 26,82
AR 27,83
v_pk_mul_f32 v[24:25], v[24:25], v[20:21] op_sel:[0,1] op_sel_hi:[1,1]
v_pk_mul_f32 v[26:27], v[26:27], v[20:21] op_sel:[0,1] op_sel_hi:[1,1]
AW 80,24
AW 81,25
AW 82,26
AW 83,27
AR 24,96
AR 25,97
AR 26,98
AR 27,99
v_pk_mul_f32 v[24:25], v[24:25], v[20:21] op_sel:[0,1] op_sel_hi:[1,1]
v_pk_mul_f32 v[26:27], v[26:27], v[20:21] op_sel:[0,1] op_sel_hi:[1,1]
AW 96,24
AW 97,25
AW 98,26
AW 99,27
AR 24,112
AR 25,113
AR 26,114
AR 27,115
v_pk_mul_f32 v[24:25], v[24:25], v[20:21] op_sel:[0,1] op_sel_hi:[1,1]
v_pk_mul_f32 v[26:27], v[26:27], v[20:21] op_sel:[0,1] op_sel_hi:[1,1]
AW 112,24
AW 113,25
AW 114,26
AW 115,27
AR 24,128
AR 25,129
AR 26,130
AR 27,131
v_pk_mul_f32 v[24:25], v[24:25], v[20:21] op_sel:[0,1] op_sel_hi:[1,1]
v_pk_mul_f32 v[26:27], v[26:27], v[20:21] op_sel:[0,1] op_sel_hi:[1,1]
AW 128,24
AW 129,25
AW 130,26
AW 131,27
AR 24,144
AR 25,145
AR 26,146
AR 27,147
v_pk_mul_f32 v[24:25], v[24:25], v[20:21] op_sel:[0,1] op_sel_hi:[1,1]
v_pk_mul_f32 v[26:27], v[26:27], v[20:21] op_sel:[0,1] op_sel_hi:[1,1]
AW 144,24
AW 145,25
AW 146,26
AW 147,27
AR 24,160
AR 25,161
AR 26,162
AR 27,163
v_pk_mul_f32 v[24:25], v[24:25], v[20:21] op_sel:[0,1] op_sel_hi:[1,1]
v_pk_mul_f32 v[26:27], v[26:27], v[20:21] op_sel:[0,1] op_sel_hi:[1,1]
AW 160,24
AW 161,25
AW 162,26
AW 163,27
AR 24,176
AR 25,177
AR 26,178
AR 27,179
v_pk_mul_f32 v[24:25], v[24:25], v[20:21] op_sel:[0,1] op_sel_hi:[1,1]
v_pk_mul_f32 v[26:27], v[26:27], v[20:21] op_sel:[0,1] op_sel_hi:[1,1]
AW 176,24
AW 177,25
AW 178,26
AW 179,27
AR 24,192
AR 25,193
AR 26,194
AR 27,195
v_pk_mul_f32 v[24:25], v[24:25], v[20:21] op_sel:[0,1] op_sel_hi:[1,1]
v_pk_mul_f32 v[26:27], v[26:27], v[20:21] op_sel:[0,1] op_sel_hi:[1,1]
AW 192,24
AW 193,25
AW 194,26
AW 195,27
AR 24,208
AR 25,209
AR 26,210
AR 27,211
v_pk_mul_f32 v[24:25], v[24:25], v[20:21] op_sel:[0,1] op_sel_hi:[1,1]
v_pk_mul_f32 v[26:27], v[26:27], v[20:21] op_sel:[0,1] op_sel_hi:[1,1]
AW 208,24
AW 209,25
AW 210,26
AW 211,27
AR 24,224
AR 25,225
AR 26,226
AR 27,227
v_pk_mul_f32 v[24:25], v[24:25], v[20:21] op_sel:[0,1] op_sel_hi:[1,1]
v_pk_mul_f32 v[26:27], v[26:27], v[20:21] op_sel:[0,1] op_sel_hi:[1,1]
AW 224,24
AW 225,25
AW 226,26
AW 227,27
AR 24,240
AR 25,241
AR 26,242
AR 27,243
v_pk_mul_f32 v[24:25], v[24:25], v[20:21] op_sel:[0,1] op_sel_hi:[1,1]
v_pk_mul_f32 v[26:27], v[26:27], v[20:21] op_sel:[0,1] op_sel_hi:[1,1]
AW 240,24
AW 241,25
AW 242,26
AW 243,27
v_max3_f32 v20, v100, v101, v102
v_max3_f32 v20, v20, v103, v116
v_max3_f32 v20, v20, v117, v118
v_max3_f32 v20, v20, v119, 0
v_mov_b32 v21, v20
s_nop 1
v_permlane32_swap_b32 v20, v21
s_nop 1
v_max_f32 v20, v20, v21
v_mov_b32 v21, v20
s_nop 1
v_permlane16_swap_b32 v20, v21
s_nop 1
v_max_f32 v20, v20, v21
v_sub_f32 v68, v68, v20
v_sub_f32 v69, v69, v20
v_sub_f32 v70, v70, v20
v_sub_f32 v71, v71, v20
v_sub_f32 v100, v100, v20
EX 100
v_sub_f32 v101, v101, v20
EX 101
v_sub_f32 v102, v102, v20
EX 102
v_sub_f32 v103, v103, v20
EX 103
v_sub_f32 v116, v116, v20
EX 116
v_sub_f32 v117, v117, v20
EX 117
v_sub_f32 v118, v118, v20
EX 118
v_sub_f32 v119, v119, v20
EX 119
v_exp_f32 v21, -v20
AD 17,100,101
AD 17,17,102
AD 17,17,103
AD 17,17,116
AD 17,17,117
AD 17,17,118
AD 17,17,119
MU 13,21
CV 84,100
CV 85,102
CV 86,116
CV 87,118
AR 24,4
AR 25,5
AR 26,6
AR 27,7
v_pk_mul_f32 v[24:25], v[24:25], v[20:21] op_sel:[0,1] op_sel_hi:[1,1]
v_pk_mul_f32 v[26:27], v[26:27], v[20:21] op_sel:[0,1] op_sel_hi:[1,1]
AW 4,24
AW 5,25
AW 6,26
AW 7,27
AR 24,20
AR 25,21
AR 26,22
AR 27,23
v_pk_mul_f32 v[24:25], v[24:25], v[20:21] op_sel:[0,1] op_sel_hi:[1,1]
v_pk_mul_f32 v[26:27], v[26:27], v[20:21] op_sel:[0,1] op_sel_hi:[1,1]
AW 20,24
AW 21,25
AW 22,26
AW 23,27
AR 24,36
AR 25,37
AR 26,38
AR 27,39
v_pk_mul_f32 v[24:25], v[24:25], v[20:21] op_sel:[0,1] op_sel_hi:[1,1]
v_pk_mul_f32 v[26:27], v[26:27], v[20:21] op_sel:[0,1] op_sel_hi:[1,1]
AW 36,24
AW 37,25
AW 38,26
AW 39,27
AR 24,52
AR 25,53
AR 26,54
AR 27,55
v_pk_mul_f32 v[24:25], v[24:25], v[20:21] op_sel:[0,1] op_sel_hi:[1,1]
v_pk_mul_f32 v[26:27], v[26:27], v[20:21] op_sel:[0,1] op_sel_hi:[1,1]
AW 52,24
AW 53,25
AW 54,26
AW 55,27
AR 24,68
AR 25,69
AR 26,70
AR 27,71
v_pk_mul_f32 v[24:25], v[24:25], v[20:21] op_sel:[0,1] op_sel_hi:[1,1]
v_pk_mul_f32 v[26:27], v[26:27], v[20:21] op_sel:[0,1] op_sel_hi:[1,1]
AW 68,24
AW 69,25
AW 70,26
AW 71,27
AR 24,84
AR 25,85
AR 26,86
AR 27,87
v_pk_mul_f32 v[24:25], v[24:25], v[20:21] op_sel:[0,1] op_sel_hi:[1,1]
v_pk_mul_f32 v[26:27], v[26:27], v[20:21] op_sel:[0,1] op_sel_hi:[1,1]
AW 84,24
AW 85,25
AW 86,26
AW 87,27
AR 24,100
AR 25,101
AR 26,102
AR 27,103
v_pk_mul_f32 v[24:25], v[24:25], v[20:21] op_sel:[0,1] op_sel_hi:[1,1]
v_pk_mul_f32 v[26:27], v[26:27], v[20:21] op_sel:[0,1] op_sel_hi:[1,1]
AW 100,24
AW 101,25
AW 102,26
AW 103,27
AR 24,116
AR 25,117
AR 26,118
AR 27,119
v_pk_mul_f32 v[24:25], v[24:25], v[20:21] op_sel:[0,1] op_sel_hi:[1,1]
v_pk_mul_f32 v[26:27], v[26:27], v[20:21] op_sel:[0,1] op_sel_hi:[1,1]
AW 116,24
AW 117,25
AW 118,26
AW 119,27
AR 24,132
AR 25,133
AR 26,134
AR 27,135
v_pk_mul_f32 v[24:25], v[24:25], v[20:21] op_sel:[0,1] op_sel_hi:[1,1]
v_pk_mul_f32 v[26:27], v[26:27], v[20:21] op_sel:[0,1] op_sel_hi:[1,1]
AW 132,24
AW 133,25
AW 134,26
AW 135,27
AR 24,148
AR 25,149
AR 26,150
AR 27,151
v_pk_mul_f32 v[24:25], v[24:25], v[20:21] op_sel:[0,1] op_sel_hi:[1,1]
v_pk_mul_f32 v[26:27], v[26:27], v[20:21] op_sel:[0,1] op_sel_hi:[1,1]
AW 148,24
AW 149,25
AW 150,26
AW 151,27
AR 24,164
AR 25,165
AR 26,166
AR 27,167
v_pk_mul_f32 v[24:25], v[24:25], v[20:21] op_sel:[0,1] op_sel_hi:[1,1]
v_pk_mul_f32 v[26:27], v[26:27], v[20:21] op_sel:[0,1] op_sel_hi:[1,1]
AW 164,24
AW 165,25
AW 166,26
AW 167,27
AR 24,180
AR 25,181
AR 26,182
AR 27,183
v_pk_mul_f32 v[24:25], v[24:25], v[20:21] op_sel:[0,1] op_sel_hi:[1,1]
v_pk_mul_f32 v[26:27], v[26:27], v[20:21] op_sel:[0,1] op_sel_hi:[1,1]
AW 180,24
AW 181,25
AW 182,26
AW 183,27
AR 24,196
AR 25,197
AR 26,198
AR 27,199
v_pk_mul_f32 v[24:25], v[24:25], v[20:21] op_sel:[0,1] op_sel_hi:[1,1]
v_pk_mul_f32 v[26:27], v[26:27], v[20:21] op_sel:[0,1] op_sel_hi:[1,1]
AW 196,24
AW 197,25
AW 198,26
AW 199,27
AR 24,212
AR 25,213
AR 26,214
AR 27,215
v_pk_mul_f32 v[24:25], v[24:25], v[20:21] op_sel:[0,1] op_sel_hi:[1,1]
v_pk_mul_f32 v[26:27], v[26:27], v[20:21] op_sel:[0,1] op_sel_hi:[1,1]
AW 212,24
AW 213,25
AW 214,26
AW 215,27
AR 24,228
AR 25,229
AR 26,230
AR 27,231
v_pk_mul_f32 v[24:25], v[24:25], v[20:21] op_sel:[0,1] op_sel_hi:[1,1]
v_pk_mul_f32 v[26:27], v[26:27], v[20:21] op_sel:[0,1] op_sel_hi:[1,1]
AW 228,24
AW 229,25
AW 230,26
AW 231,27
AR 24,244
AR 25,245
AR 26,246
AR 27,247
v_pk_mul_f32 v[24:25], v[24:25], v[20:21] op_sel:[0,1] op_sel_hi:[1,1]
v_pk_mul_f32 v[26:27], v[26:27], v[20:21] op_sel:[0,1] op_sel_hi:[1,1]
AW 244,24
AW 245,25
AW 246,26
AW 247,27
v_max3_f32 v20, v104, v105, v106
v_max3_f32 v20, v20, v107, v120
v_max3_f32 v20, v20, v121, v122
v_max3_f32 v20, v20, v123, 0
v_mov_b32 v21, v20
s_nop 1
v_permlane32_swap_b32 v20, v21
s_nop 1
v_max_f32 v20, v20, v21
v_mov_b32 v21, v20
s_nop 1
v_permlane16_swap_b32 v20, v21
s_nop 1
v_max_f32 v20, v20, v21
v_sub_f32 v72, v72, v20
v_sub_f32 v73, v73, v20
v_sub_f32 v74, v74, v20
v_sub_f32 v75, v75, v20
v_sub_f32 v104, v104, v20
EX 104
v_sub_f32 v105, v105, v20
EX 105
v_sub_f32 v106, v106, v20
EX 106
v_sub_f32 v107, v107, v20
EX 107
v_sub_f32 v120, v120, v20
EX 120
v_sub_f32 v121, v121, v20
EX 121
v_sub_f32 v122, v122, v20
EX 122
v_sub_f32 v123, v123, v20
EX 123
v_exp_f32 v21, -v20
AD 18,104,105
AD 18,18,106
AD 18,18,107
AD 18,18,120
AD 18,18,121
AD 18,18,122
AD 18,18,123
MU 14,21
CV 88,104
CV 89,106
CV 90,120
CV 91,122
AR 24,8
AR 25,9
AR 26,10
AR 27,11
v_pk_mul_f32 v[24:25], v[24:25], v[20:21] op_sel:[0,1] op_sel_hi:[1,1]
v_pk_mul_f32 v[26:27], v[26:27], v[20:21] op_sel:[0,1] op_sel_hi:[1,1]
AW 8,24
AW 9,25
AW 10,26
AW 11,27
AR 24,24
AR 25,25
AR 26,26
AR 27,27
v_pk_mul_f32 v[24:25], v[24:25], v[20:21] op_sel:[0,1] op_sel_hi:[1,1]
v_pk_mul_f32 v[26:27], v[26:27], v[20:21] op_sel:[0,1] op_sel_hi:[1,1]
AW 24,24
AW 25,25
AW 26,26
AW 27,27
AR 24,40
AR 25,41
AR 26,42
AR 27,43
v_pk_mul_f32 v[24:25], v[24:25], v[20:21] op_sel:[0,1] op_sel_hi:[1,1]
v_pk_mul_f32 v[26:27], v[26:27], v[20:21] op_sel:[0,1] op_sel_hi:[1,1]
AW 40,24
AW 41,25
AW 42,26
AW 43,27
AR 24,56
AR 25,57
AR 26,58
AR 27,59
v_pk_mul_f32 v[24:25], v[24:25], v[20:21] op_sel:[0,1] op_sel_hi:[1,1]
v_pk_mul_f32 v[26:27], v[26:27], v[20:21] op_sel:[0,1] op_sel_hi:[1,1]
AW 56,24
AW 57,25
AW 58,26
AW 59,27
AR 24,72
AR 25,73
AR 26,74
AR 27,75
v_pk_mul_f32 v[24:25], v[24:25], v[20:21] op_sel:[0,1] op_sel_hi:[1,1]
v_pk_mul_f32 v[26:27], v[26:27], v[20:21] op_sel:[0,1] op_sel_hi:[1,1]
AW 72,24
AW 73,25
AW 74,26
AW 75,27
AR 24,88
AR 25,89
AR 26,90
AR 27,91
v_pk_mul_f32 v[24:25], v[24:25], v[20:21] op_sel:[0,1] op_sel_hi:[1,1]
v_pk_mul_f32 v[26:27], v[26:27], v[20:21] op_sel:[0,1] op_sel_hi:[1,1]
AW 88,24
AW 89,25
AW 90,26
AW 91,27
AR 24,104
AR 25,105
AR 26,106
AR 27,107
v_pk_mul_f32 v[24:25], v[24:25], v[20:21] op_sel:[0,1] op_sel_hi:[1,1]
v_pk_mul_f32 v[26:27], v[26:27], v[20:21] op_sel:[0,1] op_sel_hi:[1,1]
AW 104,24
AW 105,25
AW 106,26
AW 107,27
AR 24,120
AR 25,121
AR 26,122
AR 27,123
v_pk_mul_f32 v[24:25], v[24:25], v[20:21] op_sel:[0,1] op_sel_hi:[1,1]
v_pk_mul_f32 v[26:27], v[26:27], v[20:21] op_sel:[0,1] op_sel_hi:[1,1]
AW 120,24
AW 121,25
AW 122,26
AW 123,27
AR 24,136
AR 25,137
AR 26,138
AR 27,139
v_pk_mul_f32 v[24:25], v[24:25], v[20:21] op_sel:[0,1] op_sel_hi:[1,1]
v_pk_mul_f32 v[26:27], v[26:27], v[20:21] op_sel:[0,1] op_sel_hi:[1,1]
AW 136,24
AW 137,25
AW 138,26
AW 139,27
AR 24,152
AR 25,153
AR 26,154
AR 27,155
v_pk_mul_f32 v[24:25], v[24:25], v[20:21] op_sel:[0,1] op_sel_hi:[1,1]
v_pk_mul_f32 v[26:27], v[26:27], v[20:21] op_sel:[0,1] op_sel_hi:[1,1]
AW 152,24
AW 153,25
AW 154,26
AW 155,27
AR 24,168
AR 25,169
AR 26,170
AR 27,171
v_pk_mul_f32 v[24:25], v[24:25], v[20:21] op_sel:[0,1] op_sel_hi:[1,1]
v_pk_mul_f32 v[26:27], v[26:27], v[20:21] op_sel:[0,1] op_sel_hi:[1,1]
AW 168,24
AW 169,25
AW 170,26
AW 171,27
AR 24,184
AR 25,185
AR 26,186
AR 27,187
v_pk_mul_f32 v[24:25], v[24:25], v[20:21] op_sel:[0,1] op_sel_hi:[1,1]
v_pk_mul_f32 v[26:27], v[26:27], v[20:21] op_sel:[0,1] op_sel_hi:[1,1]
AW 184,24
AW 185,25
AW 186,26
AW 187,27
AR 24,200
AR 25,201
AR 26,202
AR 27,203
v_pk_mul_f32 v[24:25], v[24:25], v[20:21] op_sel:[0,1] op_sel_hi:[1,1]
v_pk_mul_f32 v[26:27], v[26:27], v[20:21] op_sel:[0,1] op_sel_hi:[1,1]
AW 200,24
AW 201,25
AW 202,26
AW 203,27
AR 24,216
AR 25,217
AR 26,218
AR 27,219
v_pk_mul_f32 v[24:25], v[24:25], v[20:21] op_sel:[0,1] op_sel_hi:[1,1]
v_pk_mul_f32 v[26:27], v[26:27], v[20:21] op_sel:[0,1] op_sel_hi:[1,1]
AW 216,24
AW 217,25
AW 218,26
AW 219,27
AR 24,232
AR 25,233
AR 26,234
AR 27,235
v_pk_mul_f32 v[24:25], v[24:25], v[20:21] op_sel:[0,1] op_sel_hi:[1,1]
v_pk_mul_f32 v[26:27], v[26:27], v[20:21] op_sel:[0,1] op_sel_hi:[1,1]
AW 232,24
AW 233,25
AW 234,26
AW 235,27
AR 24,248
AR 25,249
AR 26,250
AR 27,251
v_pk_mul_f32 v[24:25], v[24:25], v[20:21] op_sel:[0,1] op_sel_hi:[1,1]
v_pk_mul_f32 v[26:27], v[26:27], v[20:21] op_sel:[0,1] op_sel_hi:[1,1]
AW 248,24
AW 249,25
AW 250,26
AW 251,27
s_nop 3
s_setpc_b64 s[98:99]
L_rsA15:
s_mov_b32 s100, 278528
s_call_b64 s[98:99], L_rareA
s_branch L_rbA15
L_rsA16:
s_mov_b32 s100, 294912
s_call_b64 s[98:99], L_rareA
s_branch L_rbA16
L_rsA17:
s_mov_b32 s100, 311296
s_call_b64 s[98:99], L_rareA
s_branch L_rbA17
L_rsA18:
s_mov_b32 s100, 327680
s_call_b64 s[98:99], L_rareA
s_branch L_rbA18
L_rsA19:
s_mov_b32 s100, 344064
s_call_b64 s[98:99], L_rareA
s_branch L_rbA19
L_rsA20:
s_mov_b32 s100, 360448
s_call_b64 s[98:99], L_rareA
s_branch L_rbA20
L_rsA21:
s_mov_b32 s100, 376832
s_call_b64 s[98:99], L_rareA
s_branch L_rbA21
L_rsA22:
s_mov_b32 s100, 393216
s_call_b64 s[98:99], L_rareA
s_branch L_rbA22
L_rsA23:
s_mov_b32 s100, 409600
s_call_b64 s[98:99], L_rareA
s_branch L_rbA23
L_rsA24:
s_mov_b32 s100, 425984
s_call_b64 s[98:99], L_rareA
s_branch L_rbA24
L_rsA25:
s_mov_b32 s100, 442368
s_call_b64 s[98:99], L_rareA
s_branch L_rbA25
.p2align 12
L_c2A:
L_pad15:
s_cbranch_execz L_ret15
M v,136,a,232,v,120
AR 20,192
AR 21,193
M v,136,a,236,v,124
AR 22,194
AR 23,195
M v,140,a,224,v,240
TW a,224,64
AR 24,208
M v,140,a,228,v,244
TW a,226,192
AR 25,209
M v,140,a,232,v,248
TW a,228,320
AR 26,210
M v,140,a,236,v,252
s_waitcnt lgkmcnt(4)
TW a,230,448
M v,32,a,240,v,64
DL 6,44,93,1032
M v,32,a,244,v,68
TW a,232,576
AR 27,211
M v,32,a,248,v,72
TW a,234,704
CV 16,20
M v,32,a,252,v,76
TW a,236,832
CV 17,22
M v,36,a,240,v,96
TW a,238,960
CV 18,24
M v,36,a,244,v,100
CV 19,26
AR 20,196
M v,36,a,248,v,104
ds_write_b128 v8, v[12:15] offset:20064
M v,36,a,252,v,108
AR 21,197
AR 22,198
M v,40,a,240,v,112
DL 6,48,93,2112
M v,40,a,244,v,116
AR 23,199
AR 24,212
M v,40,a,248,v,120
AR 25,213
AR 26,214
M v,40,a,252,v,124
AR 27,215
CV 12,20
M v,44,a,240,v,240
TW a,240,72
CV 13,22
M v,44,a,244,v,244
TW a,242,200
CV 14,24
M v,44,a,248,v,248
TW a,244,328
CV 15,26
M v,44,a,252,v,252
s_waitcnt lgkmcnt(4)
TW a,246,456
M v,144,a,224,v,64
s_waitcnt vmcnt(11)
TW a,248,584
M v,144,a,228,v,68
DL 6,52,93,3144
M v,144,a,232,v,72
TW a,250,712
AR 20,200
M v,144,a,236,v,76
TW a,252,840
AR 21,201
M v,148,a,224,v,96
TW a,254,968
AR 22,202
M v,148,a,228,v,100
RD a,160,3,16896
AR 23,203
M v,148,a,232,v,104
RD a,176,3,16960
AR 24,216
M v,148,a,236,v,108
RD a,164,3,17408
AR 25,217
M v,152,a,224,v,112
RD a,180,3,17472
AR 26,218
M v,152,a,228,v,116
RD a,168,3,33792
AR 27,219
M v,152,a,232,v,120
ds_write_b128 v8, v[16:19] offset:33792
M v,152,a,236,v,124
RD a,184,3,33856
CV 16,20
M v,156,a,224,v,240
RD a,172,3,34304
CV 17,22
M v,156,a,228,v,244
RD a,188,3,34368
CV 18,24
M v,156,a,232,v,248
CV 19,26
AR 20,204
M v,156,a,236,v,252
s_waitcnt lgkmcnt(9)
s_waitcnt vmcnt(8)
M v,48,a,240,v,64
s_barrier
TW a,224,50688
M v,48,a,244,v,68
TW a,226,50816
s_add_u32 m0, s92, 0
M v,48,a,248,v,72
TW a,228,50944
s_mov_b32 s2, 262144
M v,48,a,252,v,76
TW a,230,51072
AR 21,205
M v,52,a,240,v,96
TW a,232,50696
AR 22,206
M v,52,a,244,v,100
TW a,234,50824
AR 23,207
M v,52,a,248,v,104
TW a,236,50952
AR 24,220
M v,52,a,252,v,108
TW a,238,51080
AR 25,221
M v,56,a,240,v,112
DN 4,8,2,0
M v,56,a,244,v,116
ds_write_b128 v8, v[12:15] offset:34848
M v,56,a,248,v,120
AR 26,222
AR 27,223
M v,56,a,252,v,124
CV 12,20
CV 13,22
M v,60,a,240,v,240
TW a,240,50752
CV 14,24
M v,60,a,244,v,244
TW a,242,50880
CV 15,26
M v,60,a,248,v,248
TW a,244,51008
v_lshrrev_b32 v3, 12, v4
M v,60,a,252,v,252
s_waitcnt lgkmcnt(4)
s_add_u32 m0, s92, 16896
M v,128,a,224,a,160
s_mov_b32 s93, 2622208
TW a,246,51136
M v,128,a,228,a,176
TW a,248,50760
v_lshl_add_u32 v3, v3, 7, v4
M v,132,a,224,a,164
DL 5,40,93,0
M v,132,a,228,a,180
TW a,250,50888
s_add_u32 m0, s92, 0
M v,136,a,224,a,168
TW a,252,51016
v_mul_f32 v128, 0x3db8aa3b, v128
M v,136,a,228,a,184
TW a,254,51144
v_mul_f32 v129, 0x3db8aa3b, v129
M v,140,a,224,a,172
ds_write_b128 v8, v[16:19] offset:35904
M v,140,a,228,a,188
ds_write_b128 v8, v[12:15] offset:36960
M v,32,a,232,a,160
TW a,224,51200
v_mul_f32 v130, 0x3db8aa3b, v130
M v,32,a,236,a,176
DN 4,12,2,1056
M v,36,a,232,a,164
s_add_u32 m0, s92, 16896
TW a,226,51328
M v,36,a,236,a,180
TW a,228,51456
v_mul_f32 v131, 0x3db8aa3b, v131
M v,40,a,232,a,168
TW a,230,51584
CV 128,128
M v,40,a,236,a,184
CV 129,130
v_mul_f32 v32, 0x3db8aa3b, v32
M v,44,a,232,a,172
TW a,232,51208
v_mul_f32 v33, 0x3db8aa3b, v33
M v,44,a,236,a,188
s_waitcnt lgkmcnt(7)
TW a,234,51336
M v,144,a,240,a,160
TW a,236,51464
v_mul_f32 v34, 0x3db8aa3b, v34
M v,144,a,244,a,176
TW a,238,51592
v_mul_f32 v35, 0x3db8aa3b, v35
M v,148,a,240,a,164
DL 5,44,93,1032
M v,148,a,244,a,180
s_add_u32 m0, s92, 0
CV 130,32
M v,152,a,240,a,168
v_mul_f32 v144, 0x3db8aa3b, v144
v_mul_f32 v145, 0x3db8aa3b, v145
M v,152,a,244,a,184
CV 131,34
v_mul_f32 v146, 0x3db8aa3b, v146
M v,156,a,240,a,172
TW a,240,51264
v_mul_f32 v147, 0x3db8aa3b, v147
M v,156,a,244,a,188
TW a,242,51392
CV 144,144
M v,48,a,248,a,160
TW a,244,51520
CV 145,146
M v,48,a,252,a,176
TW a,246,51648
v_mul_f32 v132, 0x3db8aa3b, v132
M v,52,a,248,a,164
v_mul_f32 v133, 0x3db8aa3b, v133
v_mul_f32 v134, 0x3db8aa3b, v134
M v,52,a,252,a,180
v_mul_f32 v135, 0x3db8aa3b, v135
CV 132,132
M v,56,a,248,a,168
v_mul_f32 v48, 0x3db8aa3b, v48
v_mul_f32 v49, 0x3db8aa3b, v49
M v,56,a,252,a,184
DN 4,16,2,2112
M v,60,a,248,a,172
s_add_u32 m0, s92, 16896
TW a,248,51272
M v,60,a,252,a,188
s_waitcnt lgkmcnt(5)
TW a,250,51400
M v,160,a,224,a,160
TW a,252,51528
v_mul_f32 v50, 0x3db8aa3b, v50
M v,160,a,228,a,176
TW a,254,51656
v_xor_b32 v11, 81920, v11
M v,164,a,224,a,164
DL 5,48,93,2112
M v,164,a,228,a,180
s_add_u32 m0, s92, 0
v_mul_f32 v51, 0x3db8aa3b, v51
M v,168,a,224,a,168
CV 146,48
CV 147,50
M v,168,a,228,a,184
CV 133,134
v_mul_f32 v36, 0x3db8aa3b, v36
M v,172,a,224,a,172
v_mul_f32 v37, 0x3db8aa3b, v37
v_mul_f32 v38, 0x3db8aa3b, v38
M v,172,a,228,a,188
v_mul_f32 v39, 0x3db8aa3b, v39
v_mul_f32 v148, 0x3db8aa3b, v148
M a,0,a,232,a,160
v_mul_f32 v149, 0x3db8aa3b, v149
CV 134,36
M a,0,a,236,a,176
CV 135,38
v_mul_f32 v150, 0x3db8aa3b, v150
M a,4,a,232,a,164
v_mul_f32 v151, 0x3db8aa3b, v151
CV 148,148
M a,4,a,236,a,180
CV 149,150
v_mul_f32 v52, 0x3db8aa3b, v52
M a,8,a,232,a,168
v_mul_f32 v53, 0x3db8aa3b, v53
v_mul_f32 v54, 0x3db8aa3b, v54
M a,8,a,236,a,184
v_mul_f32 v55, 0x3db8aa3b, v55
CV 150,52
M a,12,a,232,a,172
CV 151,54
v_mul_f32 v136, 0x3db8aa3b, v136
M a,12,a,236,a,188
s_waitcnt lgkmcnt(0)
s_waitcnt vmcnt(10)
M v,176,a,240,a,160
s_barrier
TW a,224,0
M v,176,a,244,a,176
DN 4,20,2,3168
M v,180,a,240,a,164
TW a,226,128
s_add_u32 m0, s92, 16896
M v,180,a,244,a,180
TW a,228,256
s_mov_b32 s2, 278528
M v,184,a,240,a,168
TW a,230,384
v_mul_f32 v137, 0x3db8aa3b, v137
M v,184,a,244,a,184
TW a,232,512
v_mul_f32 v138, 0x3db8aa3b, v138
M v,188,a,240,a,172
TW a,234,640
v_mul_f32 v139, 0x3db8aa3b, v139
M v,188,a,244,a,188
TW a,236,768
CV 136,136
M a,16,a,248,a,160
TW a,238,896
CV 137,138
M a,16,a,252,a,176
DL 5,52,93,3144
M a,20,a,248,a,164
s_add_u32 m0, s92, 33792
s_mov_b32 s93, 2622336
M a,20,a,252,a,180
TW a,240,8
v_mul_f32 v40, 0x3db8aa3b, v40
M a,24,a,248,a,168
TW a,242,136
v_mul_f32 v41, 0x3db8aa3b, v41
M a,24,a,252,a,184
TW a,244,264
v_mul_f32 v42, 0x3db8aa3b, v42
M a,28,a,248,a,172
TW a,246,392
v_mul_f32 v43, 0x3db8aa3b, v43
M a,28,a,252,a,188
s_waitcnt lgkmcnt(4)
TW a,248,520
M v,160,a,224,v,64
TW a,250,648
v_mul_f32 v152, 0x3db8aa3b, v152
M v,160,a,228,v,68
TW a,252,776
v_mul_f32 v153, 0x3db8aa3b, v153
M v,160,a,232,v,72
DL 5,40,93,0
M v,160,a,236,v,76
TW a,254,904
s_add_u32 m0, s92, 50688
M v,164,a,224,v,96
CV 138,40
CV 139,42
M v,164,a,228,v,100
v_mul_f32 v154, 0x3db8aa3b, v154
v_mul_f32 v155, 0x3db8aa3b, v155
M v,164,a,232,v,104
DN 4,8,2,0
M v,164,a,236,v,108
s_add_u32 m0, s92, 33792
v_mul_f32 v160, 0x3db8aa3b, v160
M v,168,a,224,v,112
v_mul_f32 v161, 0x3db8aa3b, v161
v_mul_f32 v162, 0x3db8aa3b, v162
M v,168,a,228,v,116
v_mul_f32 v163, 0x3db8aa3b, v163
CV 160,160
M v,168,a,232,v,120
CV 161,162
v_mul_f32 v164, 0x3db8aa3b, v164
M v,168,a,236,v,124
v_mul_f32 v165, 0x3db8aa3b, v165
v_mul_f32 v166, 0x3db8aa3b, v166
M v,172,a,224,v,240
TW a,224,64
v_mul_f32 v167, 0x3db8aa3b, v167
M v,172,a,228,v,244
TW a,226,192
CV 164,164
M v,172,a,232,v,248
TW a,228,320
v_mul_f32 v168, 0x3db8aa3b, v168
M v,172,a,236,v,252
s_waitcnt lgkmcnt(3)
TW a,230,448
M a,0,a,240,v,64
TW a,232,576
v_mul_f32 v169, 0x3db8aa3b, v169
M a,0,a,244,v,68
TW a,234,704
v_mul_f32 v170, 0x3db8aa3b, v170
M a,0,a,248,v,72
DL 5,44,93,1032
M a,0,a,252,v,76
TW a,236,832
s_add_u32 m0, s92, 50688
M a,4,a,240,v,96
TW a,238,960
v_mul_f32 v171, 0x3db8aa3b, v171
M a,4,a,244,v,100
CV 168,168
CV 169,170
M a,4,a,248,v,104
AR 20,0
AR 21,1
M a,4,a,252,v,108
AR 22,2
AR 23,3
M a,8,a,240,v,112
v_mul_f32 v20, 0x3db8aa3b, v20
v_mul_f32 v21, 0x3db8aa3b, v21
M a,8,a,244,v,116
DN 4,12,2,1056
M a,8,a,248,v,120
s_add_u32 m0, s92, 33792
v_mul_f32 v22, 0x3db8aa3b, v22
M a,8,a,252,v,124
v_mul_f32 v23, 0x3db8aa3b, v23
CV 162,20
M a,12,a,240,v,240
TW a,240,72
CV 163,22
M a,12,a,244,v,244
TW a,242,200
AR 24,4
M a,12,a,248,v,248
TW a,244,328
AR 20,8
M a,12,a,252,v,252
s_waitcnt lgkmcnt(3)
TW a,246,456
M v,176,a,224,v,64
TW a,248,584
AR 21,9
M v,176,a,228,v,68
TW a,250,712
AR 22,10
M v,176,a,232,v,72
DL 5,48,93,2112
M v,176,a,236,v,76
TW a,252,840
s_add_u32 m0, s92, 50688
M v,180,a,224,v,96
TW a,254,968
AR 23,11
M v,180,a,228,v,100
v_mul_f32 v20, 0x3db8aa3b, v20
v_mul_f32 v21, 0x3db8aa3b, v21
M v,180,a,232,v,104
v_mul_f32 v22, 0x3db8aa3b, v22
v_mul_f32 v23, 0x3db8aa3b, v23
M v,180,a,236,v,108
CV 170,20
CV 171,22
M v,184,a,224,v,112
v_mul_f32 v176, 0x3db8aa3b, v176
v_mul_f32 v177, 0x3db8aa3b, v177
M v,184,a,228,v,116
v_mul_f32 v178, 0x3db8aa3b, v178
v_mul_f32 v179, 0x3db8aa3b, v179
M v,184,a,232,v,120
CV 176,176
CV 177,178
M v,184,a,236,v,124
AR 25,5
AR 26,6
M v,188,a,224,v,240
AR 27,7
CV 165,166
M v,188,a,228,v,244
DN 4,16,2,2112
M v,188,a,232,v,248
s_add_u32 m0, s92, 33792
v_mul_f32 v24, 0x3db8aa3b, v24
M v,188,a,236,v,252
s_waitcnt lgkmcnt(0)
s_waitcnt vmcnt(14)
M a,16,a,240,v,64
s_barrier
TW a,224,50688
M a,16,a,244,v,68
TW a,226,50816
v_mul_f32 v25, 0x3db8aa3b, v25
M a,16,a,248,v,72
DL 5,52,93,3144
M a,16,a,252,v,76
TW a,228,50944
s_add_u32 m0, s92, 50688
M a,20,a,240,v,96
TW a,230,51072
v_mul_f32 v26, 0x3db8aa3b, v26
M a,20,a,244,v,100
TW a,232,50696
v_mul_f32 v27, 0x3db8aa3b, v27
M a,20,a,248,v,104
TW a,234,50824
AR 20,16
M a,20,a,252,v,108
TW a,236,50952
AR 21,17
M a,24,a,240,v,112
TW a,238,51080
AR 22,18
M a,24,a,244,v,116
AR 23,19
v_mul_f32 v20, 0x3db8aa3b, v20
M a,24,a,248,v,120
v_mul_f32 v21, 0x3db8aa3b, v21
v_mul_f32 v22, 0x3db8aa3b, v22
M a,24,a,252,v,124
v_mul_f32 v23, 0x3db8aa3b, v23
CV 178,20
M a,28,a,240,v,240
TW a,240,50752
CV 179,22
M a,28,a,244,v,244
TW a,242,50880
v_mul_f32 v172, 0x3db8aa3b, v172
M a,28,a,248,v,248
TW a,244,51008
v_mul_f32 v173, 0x3db8aa3b, v173
M a,28,a,252,v,252
s_waitcnt lgkmcnt(3)
TW a,246,51136
M v,192,a,224,a,160
TW a,248,50760
CV 166,24
L_pad16:
s_cbranch_execz L_ret16
M v,192,a,228,a,176
DN 4,20,2,3168
M v,196,a,224,a,164
TW a,250,50888
s_add_u32 m0, s92, 81920
M v,196,a,228,a,180
TW a,252,51016
s_mov_b32 s2, 262144
M v,200,a,224,a,168
TW a,254,51144
CV 167,26
M v,200,a,228,a,184
v_mul_f32 v174, 0x3db8aa3b, v174
v_mul_f32 v175, 0x3db8aa3b, v175
M v,204,a,224,a,172
TW a,224,51200
CV 172,172
M v,204,a,228,a,188
TW a,226,51328
AR 24,12
M a,32,a,232,a,160
TW a,228,51456
AR 25,13
M a,32,a,236,a,176
TW a,230,51584
AR 26,14
M a,36,a,232,a,164
AR 27,15
CV 173,174
M a,36,a,236,a,180
v_mul_f32 v24, 0x3db8aa3b, v24
v_mul_f32 v25, 0x3db8aa3b, v25
M a,40,a,232,a,168
v_mul_f32 v26, 0x3db8aa3b, v26
v_mul_f32 v27, 0x3db8aa3b, v27
M a,40,a,236,a,184
CV 174,24
CV 175,26
M a,44,a,232,a,172
TW a,232,51208
v_mul_f32 v180, 0x3db8aa3b, v180
M a,44,a,236,a,188
s_waitcnt lgkmcnt(5)
TW a,234,51336
M v,208,a,240,a,160
TW a,236,51464
v_mul_f32 v181, 0x3db8aa3b, v181
M v,208,a,244,a,176
TW a,238,51592
v_mul_f32 v182, 0x3db8aa3b, v182
M v,212,a,240,a,164
v_mul_f32 v183, 0x3db8aa3b, v183
CV 180,180
M v,212,a,244,a,180
AR 24,20
AR 25,21
M v,216,a,240,a,168
AR 26,22
AR 27,23
M v,216,a,244,a,184
DN 4,24,2,0
M v,220,a,240,a,172
TW a,240,51264
CV 181,182
M v,220,a,244,a,188
TW a,242,51392
v_mul_f32 v24, 0x3db8aa3b, v24
M a,48,a,248,a,160
TW a,244,51520
v_mul_f32 v25, 0x3db8aa3b, v25
M a,48,a,252,a,176
TW a,246,51648
v_mul_f32 v26, 0x3db8aa3b, v26
M a,52,a,248,a,164
v_mul_f32 v27, 0x3db8aa3b, v27
CV 182,24
M a,52,a,252,a,180
CV 183,26
CV 152,152
M a,56,a,248,a,168
CV 153,154
v_mul_f32 v56, 0x3db8aa3b, v56
M a,56,a,252,a,184
v_mul_f32 v57, 0x3db8aa3b, v57
v_mul_f32 v58, 0x3db8aa3b, v58
M a,60,a,248,a,172
TW a,248,51272
v_mul_f32 v59, 0x3db8aa3b, v59
M a,60,a,252,a,188
s_waitcnt lgkmcnt(5)
TW a,250,51400
M v,224,a,224,a,160
TW a,252,51528
CV 154,56
M v,224,a,228,a,176
TW a,254,51656
v_xor_b32 v11, 81920, v11
M v,228,a,224,a,164
CV 155,58
v_mul_f32 v184, 0x3db8aa3b, v184
M v,228,a,228,a,180
v_mul_f32 v185, 0x3db8aa3b, v185
v_mul_f32 v186, 0x3db8aa3b, v186
M v,232,a,224,a,168
v_mul_f32 v187, 0x3db8aa3b, v187
CV 184,184
M v,232,a,228,a,184
AR 20,24
AR 21,25
M v,236,a,224,a,172
AR 22,26
AR 23,27
M v,236,a,228,a,188
v_mul_f32 v140, 0x3db8aa3b, v140
v_mul_f32 v141, 0x3db8aa3b, v141
M a,128,a,232,a,160
CV 185,186
v_mul_f32 v20, 0x3db8aa3b, v20
M a,128,a,236,a,176
DN 4,28,2,1056
M a,132,a,232,a,164
v_mul_f32 v21, 0x3db8aa3b, v21
v_mul_f32 v22, 0x3db8aa3b, v22
M a,132,a,236,a,180
v_mul_f32 v23, 0x3db8aa3b, v23
v_mul_f32 v142, 0x3db8aa3b, v142
M a,136,a,232,a,168
v_mul_f32 v143, 0x3db8aa3b, v143
CV 140,140
M a,136,a,236,a,184
CV 186,20
CV 187,22
M a,140,a,232,a,172
CV 141,142
v_mul_f32 v44, 0x3db8aa3b, v44
M a,140,a,236,a,188
s_waitcnt lgkmcnt(0)
s_waitcnt vmcnt(10)
M v,80,a,240,a,160
s_barrier
TW a,224,16896
M v,80,a,244,a,176
TW a,226,17024
v_mul_f32 v45, 0x3db8aa3b, v45
M v,84,a,240,a,164
TW a,228,17152
v_mul_f32 v46, 0x3db8aa3b, v46
M v,84,a,244,a,180
TW a,230,17280
v_mul_f32 v47, 0x3db8aa3b, v47
M v,88,a,240,a,168
TW a,232,17408
v_mul_f32 v156, 0x3db8aa3b, v156
M v,88,a,244,a,184
TW a,234,17536
v_mul_f32 v157, 0x3db8aa3b, v157
M v,92,a,240,a,172
TW a,236,17664
CV 142,44
M v,92,a,244,a,188
TW a,238,17792
CV 143,46
M a,144,a,248,a,160
TW a,240,16904
v_mul_f32 v158, 0x3db8aa3b, v158
M a,144,a,252,a,176
TW a,242,17032
v_mul_f32 v159, 0x3db8aa3b, v159
M a,148,a,248,a,164
TW a,244,17160
CV 156,156
M a,148,a,252,a,180
TW a,246,17288
CV 157,158
M a,152,a,248,a,168
v_mul_f32 v60, 0x3db8aa3b, v60
v_mul_f32 v61, 0x3db8aa3b, v61
M a,152,a,252,a,184
DN 4,32,2,2112
M a,156,a,248,a,172
TW a,248,17416
v_mul_f32 v62, 0x3db8aa3b, v62
M a,156,a,252,a,188
s_waitcnt lgkmcnt(5)
TW a,250,17544
M v,192,a,224,v,64
TW a,252,17672
v_mul_f32 v63, 0x3db8aa3b, v63
M v,192,a,228,v,68
TW a,254,17800
CV 158,60
M v,192,a,232,v,72
CV 159,62
v_mul_f32 v188, 0x3db8aa3b, v188
M v,192,a,236,v,76
v_mul_f32 v189, 0x3db8aa3b, v189
v_mul_f32 v190, 0x3db8aa3b, v190
M v,196,a,224,v,96
v_mul_f32 v191, 0x3db8aa3b, v191
CV 188,188
M v,196,a,228,v,100
AR 24,28
AR 25,29
M v,196,a,232,v,104
AR 26,30
AR 27,31
M v,196,a,236,v,108
CV 189,190
v_mul_f32 v24, 0x3db8aa3b, v24
M v,200,a,224,v,112
v_mul_f32 v25, 0x3db8aa3b, v25
v_mul_f32 v26, 0x3db8aa3b, v26
M v,200,a,228,v,116
v_mul_f32 v27, 0x3db8aa3b, v27
CV 190,24
M v,200,a,232,v,120
CV 191,26
v_mul_f32 v192, 0x3db8aa3b, v192
M v,200,a,236,v,124
v_mul_f32 v193, 0x3db8aa3b, v193
v_mul_f32 v194, 0x3db8aa3b, v194
M v,204,a,224,v,240
TW a,224,16960
v_mul_f32 v195, 0x3db8aa3b, v195
M v,204,a,228,v,244
TW a,226,17088
CV 192,192
M v,204,a,232,v,248
TW a,228,17216
CV 193,194
M v,204,a,236,v,252
s_waitcnt lgkmcnt(3)
TW a,230,17344
M a,32,a,240,v,64
TW a,232,17472
v_mul_f32 v200, 0x3db8aa3b, v200
M a,32,a,244,v,68
DN 4,36,2,3168
M a,32,a,248,v,72
TW a,234,17600
s_add_u32 m0, s92, 132608
M a,32,a,252,v,76
TW a,236,17728
s_mov_b32 s2, 294912
M a,36,a,240,v,96
TW a,238,17856
v_mul_f32 v201, 0x3db8aa3b, v201
M a,36,a,244,v,100
v_mul_f32 v202, 0x3db8aa3b, v202
v_mul_f32 v203, 0x3db8aa3b, v203
M a,36,a,248,v,104
AR 20,32
AR 21,33
M a,36,a,252,v,108
AR 22,34
AR 23,35
M a,40,a,240,v,112
v_mul_f32 v20, 0x3db8aa3b, v20
v_mul_f32 v21, 0x3db8aa3b, v21
M a,40,a,244,v,116
v_mul_f32 v22, 0x3db8aa3b, v22
v_mul_f32 v23, 0x3db8aa3b, v23
M a,40,a,248,v,120
CV 194,20
CV 195,22
M a,40,a,252,v,124
CV 200,200
CV 201,202
M a,44,a,240,v,240
TW a,240,16968
v_mul_f32 v196, 0x3db8aa3b, v196
M a,44,a,244,v,244
TW a,242,17096
v_mul_f32 v197, 0x3db8aa3b, v197
M a,44,a,248,v,248
TW a,244,17224
AR 20,40
M a,44,a,252,v,252
s_waitcnt lgkmcnt(3)
TW a,246,17352
M v,208,a,224,v,64
TW a,248,17480
AR 21,41
M v,208,a,228,v,68
TW a,250,17608
AR 22,42
M v,208,a,232,v,72
TW a,252,17736
AR 23,43
M v,208,a,236,v,76
TW a,254,17864
v_mul_f32 v20, 0x3db8aa3b, v20
M v,212,a,224,v,96
v_mul_f32 v21, 0x3db8aa3b, v21
v_mul_f32 v22, 0x3db8aa3b, v22
M v,212,a,228,v,100
DN 4,8,2,0
M v,212,a,232,v,104
v_mul_f32 v23, 0x3db8aa3b, v23
CV 202,20
M v,212,a,236,v,108
CV 203,22
v_mul_f32 v208, 0x3db8aa3b, v208
M v,216,a,224,v,112
v_mul_f32 v209, 0x3db8aa3b, v209
v_mul_f32 v210, 0x3db8aa3b, v210
M v,216,a,228,v,116
v_mul_f32 v211, 0x3db8aa3b, v211
CV 208,208
M v,216,a,232,v,120
CV 209,210
v_mul_f32 v198, 0x3db8aa3b, v198
M v,216,a,236,v,124
v_mul_f32 v199, 0x3db8aa3b, v199
CV 196,196
M v,220,a,224,v,240
AR 24,36
AR 25,37
M v,220,a,228,v,244
AR 26,38
AR 27,39
M v,220,a,232,v,248
v_mul_f32 v216, 0x3db8aa3b, v216
v_mul_f32 v217, 0x3db8aa3b, v217
M v,220,a,236,v,252
s_waitcnt lgkmcnt(0)
s_waitcnt vmcnt(6)
M a,48,a,240,v,64
s_barrier
TW a,224,33792
M a,48,a,244,v,68
TW a,226,33920
CV 197,198
M a,48,a,248,v,72
TW a,228,34048
v_mul_f32 v24, 0x3db8aa3b, v24
M a,48,a,252,v,76
TW a,230,34176
v_mul_f32 v25, 0x3db8aa3b, v25
M a,52,a,240,v,96
TW a,232,34304
v_mul_f32 v26, 0x3db8aa3b, v26
M a,52,a,244,v,100
TW a,234,34432
v_mul_f32 v27, 0x3db8aa3b, v27
M a,52,a,248,v,104
TW a,236,34560
AR 20,48
M a,52,a,252,v,108
TW a,238,34688
AR 21,49
M a,56,a,240,v,112
DN 4,12,2,1056
M a,56,a,244,v,116
AR 22,50
AR 23,51
M a,56,a,248,v,120
v_mul_f32 v20, 0x3db8aa3b, v20
v_mul_f32 v21, 0x3db8aa3b, v21
M a,56,a,252,v,124
v_mul_f32 v22, 0x3db8aa3b, v22
v_mul_f32 v23, 0x3db8aa3b, v23
M a,60,a,240,v,240
TW a,240,33800
CV 210,20
M a,60,a,244,v,244
TW a,242,33928
CV 211,22
M a,60,a,248,v,248
TW a,244,34056
v_mul_f32 v218, 0x3db8aa3b, v218
M a,60,a,252,v,252
s_waitcnt lgkmcnt(3)
TW a,246,34184
M v,224,a,224,v,64
TW a,248,34312
v_mul_f32 v219, 0x3db8aa3b, v219
M v,224,a,228,v,68
TW a,250,34440
CV 216,216
M v,224,a,232,v,72
TW a,252,34568
AR 20,56
M v,224,a,236,v,76
TW a,254,34696
AR 21,57
M v,228,a,224,v,96
AR 22,58
AR 23,59
M v,228,a,228,v,100
v_mul_f32 v204, 0x3db8aa3b, v204
v_mul_f32 v205, 0x3db8aa3b, v205
M v,228,a,232,v,104
CV 198,24
CV 199,26
M v,228,a,236,v,108
CV 217,218
v_mul_f32 v20, 0x3db8aa3b, v20
M v,232,a,224,v,112
v_mul_f32 v21, 0x3db8aa3b, v21
v_mul_f32 v22, 0x3db8aa3b, v22
M v,232,a,228,v,116
DN 4,16,2,2112
M v,232,a,232,v,120
v_mul_f32 v23, 0x3db8aa3b, v23
v_mul_f32 v206, 0x3db8aa3b, v206
M v,232,a,236,v,124
v_mul_f32 v207, 0x3db8aa3b, v207
CV 204,204
M v,236,a,224,v,240
TW a,224,33856
AR 24,44
M v,236,a,228,v,244
TW a,226,33984
AR 25,45
M v,236,a,232,v,248
TW a,228,34112
AR 26,46
M v,236,a,236,v,252
s_waitcnt lgkmcnt(3)
TW a,230,34240
M a,128,a,240,v,64
TW a,232,34368
AR 27,47
M a,128,a,244,v,68
TW a,234,34496
CV 218,20
M a,128,a,248,v,72
TW a,236,34624
CV 219,22
M a,128,a,252,v,76
TW a,238,34752
v_mul_f32 v224, 0x3db8aa3b, v224
M a,132,a,240,v,96
v_mul_f32 v225, 0x3db8aa3b, v225
CV 205,206
M a,132,a,244,v,100
v_mul_f32 v24, 0x3db8aa3b, v24
v_mul_f32 v25, 0x3db8aa3b, v25
M a,132,a,248,v,104
v_mul_f32 v26, 0x3db8aa3b, v26
v_mul_f32 v27, 0x3db8aa3b, v27
M a,132,a,252,v,108
v_mul_f32 v226, 0x3db8aa3b, v226
v_mul_f32 v227, 0x3db8aa3b, v227
M a,136,a,240,v,112
CV 224,224
AR 20,128
M a,136,a,244,v,116
AR 21,129
AR 22,130
M a,136,a,248,v,120
AR 23,131
CV 206,24
M a,136,a,252,v,124
DN 4,20,2,3168
M a,140,a,240,v,240
TW a,240,33864
s_add_u32 m0, s92, 16896
M a,140,a,244,v,244
TW a,242,33992
s_mov_b32 s2, 278528
M a,140,a,248,v,248
TW a,244,34120
CV 207,26
M a,140,a,252,v,252
s_waitcnt lgkmcnt(3)
TW a,246,34248
M v,80,a,224,v,64
TW a,248,34376
v_mul_f32 v212, 0x3db8aa3b, v212
M v,80,a,228,v,68
TW a,250,34504
v_mul_f32 v213, 0x3db8aa3b, v213
M v,80,a,232,v,72
TW a,252,34632
CV 225,226
M v,80,a,236,v,76
TW a,254,34760
v_mul_f32 v20, 0x3db8aa3b, v20
M v,84,a,224,v,96
v_mul_f32 v21, 0x3db8aa3b, v21
v_mul_f32 v22, 0x3db8aa3b, v22
M v,84,a,228,v,100
v_mul_f32 v23, 0x3db8aa3b, v23
v_mul_f32 v214, 0x3db8aa3b, v214
M v,84,a,232,v,104
v_mul_f32 v80, 0x3db8aa3b, v80
v_mul_f32 v81, 0x3db8aa3b, v81
M v,84,a,236,v,108
v_mul_f32 v82, 0x3db8aa3b, v82
v_mul_f32 v83, 0x3db8aa3b, v83
M v,88,a,224,v,112
v_mul_f32 v215, 0x3db8aa3b, v215
CV 212,212
M v,88,a,228,v,116
AR 24,52
AR 25,53
M v,88,a,232,v,120
v_mul_f32 v84, 0x3db8aa3b, v84
v_mul_f32 v85, 0x3db8aa3b, v85
M v,88,a,236,v,124
v_mul_f32 v86, 0x3db8aa3b, v86
v_mul_f32 v87, 0x3db8aa3b, v87
M v,92,a,224,v,240
AR 26,54
AR 27,55
M v,92,a,228,v,244
DN 4,24,2,0
M v,92,a,232,v,248
v_mul_f32 v88, 0x3db8aa3b, v88
v_mul_f32 v89, 0x3db8aa3b, v89
M v,92,a,236,v,252
s_waitcnt lgkmcnt(0)
s_waitcnt vmcnt(10)
M a,144,a,240,v,64
s_barrier
RD a,224,1,0
L_pad17:
s_cbranch_execz L_ret17
M a,144,a,244,v,68
RD a,228,1,64
v_mul_f32 v90, 0x3db8aa3b, v90
M a,144,a,248,v,72
RD a,232,1,128
v_mul_f32 v91, 0x3db8aa3b, v91
M a,144,a,252,v,76
RD a,236,1,192
v_mul_f32 v92, 0x3db8aa3b, v92
M a,148,a,240,v,96
v_mul_f32 v93, 0x3db8aa3b, v93
v_mul_f32 v94, 0x3db8aa3b, v94
M a,148,a,244,v,100
v_mul_f32 v95, 0x3db8aa3b, v95
v_mul_f32 v232, 0x3db8aa3b, v232
M a,148,a,248,v,104
v_mul_f32 v233, 0x3db8aa3b, v233
CV 226,20
M a,148,a,252,v,108
CV 227,22
CV 213,214
M a,152,a,240,v,112
v_mul_f32 v24, 0x3db8aa3b, v24
v_mul_f32 v25, 0x3db8aa3b, v25
M a,152,a,244,v,116
v_mul_f32 v26, 0x3db8aa3b, v26
v_mul_f32 v27, 0x3db8aa3b, v27
M a,152,a,248,v,120
v_mul_f32 v234, 0x3db8aa3b, v234
v_mul_f32 v235, 0x3db8aa3b, v235
M a,152,a,252,v,124
CV 232,232
AR 20,136
M a,156,a,240,v,240
RD a,240,1,512
CV 240,80
M a,156,a,244,v,244
RD a,244,1,576
CV 241,82
M a,156,a,248,v,248
RD a,248,1,640
CV 244,84
M a,156,a,252,v,252
s_waitcnt lgkmcnt(3)
RD a,252,1,704
Z v,64,a,224,v,128
DN 4,28,2,1056
M v,64,a,228,v,144
CV 245,86
CV 248,88
M v,64,a,232,v,160
CV 249,90
CV 252,92
M v,64,a,236,v,176
CV 253,94
AR 21,137
Z v,68,a,224,v,132
AR 22,138
AR 23,139
M v,68,a,228,v,148
v_mul_f32 v220, 0x3db8aa3b, v220
v_mul_f32 v221, 0x3db8aa3b, v221
M v,68,a,232,v,164
CV 214,24
CV 215,26
M v,68,a,236,v,180
CV 233,234
v_mul_f32 v20, 0x3db8aa3b, v20
Z v,72,a,224,v,136
v_mul_f32 v21, 0x3db8aa3b, v21
v_mul_f32 v22, 0x3db8aa3b, v22
M v,72,a,228,v,152
v_mul_f32 v23, 0x3db8aa3b, v23
v_mul_f32 v222, 0x3db8aa3b, v222
M v,72,a,232,v,168
v_mul_f32 v223, 0x3db8aa3b, v223
CV 220,220
M v,72,a,236,v,184
AR 24,60
AR 25,61
Z v,76,a,224,v,140
RD a,224,1,256
v_bfe_u32 v8, v4, 8, 2
M v,76,a,228,v,156
RD a,228,1,320
v_lshrrev_b32 v9, 14, s95
M v,76,a,232,v,172
RD a,232,1,384
v_add_lshl_u32 v8, v8, v9, 7
M v,76,a,236,v,188
s_waitcnt lgkmcnt(3)
RD a,236,1,448
Z v,80,a,240,v,128
s_getpc_b64 s[100:101]
s_and_b32 s100, s100, 0xfffff000
M v,80,a,244,v,144
v_add_u32 v8, 4096, v8
v_mov_b32 v9, 0
M v,80,a,248,v,160
DN 4,32,2,2112
M v,80,a,252,v,176
AR 26,62
AR 27,63
Z v,84,a,240,v,132
CV 234,20
CV 235,22
M v,84,a,244,v,148
v_lshl_add_u64 v[8:9], v[8:9], 0, s[100:101]
CV 221,222
M v,84,a,248,v,164
v_mul_f32 v24, 0x3db8aa3b, v24
v_mul_f32 v25, 0x3db8aa3b, v25
M v,84,a,252,v,180
v_mul_f32 v26, 0x3db8aa3b, v26
v_mul_f32 v27, 0x3db8aa3b, v27
Z v,88,a,240,v,136
AR 20,144
AR 21,145
M v,88,a,244,v,152
AR 22,146
AR 23,147
M v,88,a,248,v,168
CV 222,24
CV 223,26
M v,88,a,252,v,184
v_mul_f32 v228, 0x3db8aa3b, v228
v_mul_f32 v229, 0x3db8aa3b, v229
Z v,92,a,240,v,140
v_mul_f32 v20, 0x3db8aa3b, v20
v_mul_f32 v21, 0x3db8aa3b, v21
M v,92,a,244,v,156
v_mul_f32 v22, 0x3db8aa3b, v22
v_mul_f32 v23, 0x3db8aa3b, v23
M v,92,a,248,v,172
v_mul_f32 v230, 0x3db8aa3b, v230
v_mul_f32 v231, 0x3db8aa3b, v231
M v,92,a,252,v,188
s_waitcnt lgkmcnt(0)
CV 228,228
M v,64,a,224,v,192
AR 24,132
AR 25,133
M v,64,a,228,v,208
AR 26,134
AR 27,135
M v,64,a,232,v,224
CV 242,20
CV 243,22
CV 229,230
v_mul_f32 v24, 0x3db8aa3b, v24
M v,64,a,236,v,240
v_mul_f32 v25, 0x3db8aa3b, v25
v_mul_f32 v26, 0x3db8aa3b, v26
M v,68,a,224,v,196
v_mul_f32 v27, 0x3db8aa3b, v27
v_mul_f32 v236, 0x3db8aa3b, v236
M v,68,a,228,v,212
v_mul_f32 v237, 0x3db8aa3b, v237
CV 230,24
CV 231,26
v_mul_f32 v238, 0x3db8aa3b, v238
v_mul_f32 v239, 0x3db8aa3b, v239
M v,68,a,232,v,228
CV 236,236
AR 24,140
AR 25,141
AR 26,142
AR 27,143
CV 237,238
v_mul_f32 v24, 0x3db8aa3b, v24
v_mul_f32 v25, 0x3db8aa3b, v25
v_mul_f32 v26, 0x3db8aa3b, v26
v_mul_f32 v27, 0x3db8aa3b, v27
CV 238,24
CV 239,26
AR 24,148
AR 25,149
AR 26,150
AR 27,151
v_mul_f32 v24, 0x3db8aa3b, v24
v_mul_f32 v25, 0x3db8aa3b, v25
v_mul_f32 v26, 0x3db8aa3b, v26
v_mul_f32 v27, 0x3db8aa3b, v27
CV 246,24
CV 247,26
RD a,240,1,768
RD a,244,1,832
M v,68,a,236,v,244
RD a,248,1,896
AR 20,152
M v,72,a,224,v,200
RD a,252,1,960
AR 21,153
M v,72,a,228,v,216
AR 22,154
AR 23,155
M v,72,a,232,v,232
v_mul_f32 v20, 0x3db8aa3b, v20
v_mul_f32 v21, 0x3db8aa3b, v21
v_mul_f32 v22, 0x3db8aa3b, v22
v_mul_f32 v23, 0x3db8aa3b, v23
DN 4,36,2,3168
CV 250,20
CV 251,22
global_load_dword v10, v[8:9], off
AR 24,156
M v,72,a,236,v,248
AR 25,157
AR 26,158
M v,76,a,224,v,204
AR 27,159
v_mul_f32 v24, 0x3db8aa3b, v24
M v,76,a,228,v,220
v_mul_f32 v25, 0x3db8aa3b, v25
v_mul_f32 v26, 0x3db8aa3b, v26
M v,76,a,232,v,236
v_mul_f32 v27, 0x3db8aa3b, v27
CV 254,24
CV 255,26
s_add_u32 m0, s92, 33792
s_mov_b32 s2, 311296
M v,76,a,236,v,252
s_waitcnt lgkmcnt(0)
s_waitcnt vmcnt(13)
M v,80,a,240,v,192
s_barrier
RD a,224,1,50688
M v,80,a,244,v,208
RD a,228,1,50752
v_max3_f32 v24, v64, v65, v66
M v,80,a,248,v,224
RD a,232,1,50816
v_max3_f32 v25, v68, v69, v70
M v,80,a,252,v,240
RD a,236,1,50880
v_max3_f32 v26, v72, v73, v74
M v,84,a,240,v,196
v_max3_f32 v27, v76, v77, v78
M v,84,a,244,v,212
M v,84,a,248,v,228
DN 4,8,2,0
M v,84,a,252,v,244
v_max3_f32 v24, v24, v67, v80
v_max3_f32 v24, v24, v81, v82
M v,88,a,240,v,200
v_max_f32 v24, v24, v83
M v,88,a,244,v,216
M v,88,a,248,v,232
M v,88,a,252,v,248
M v,92,a,240,v,204
RD a,240,1,50944
v_max3_f32 v25, v25, v71, v84
M v,92,a,244,v,220
RD a,244,1,51008
v_max3_f32 v25, v25, v85, v86
M v,92,a,248,v,236
RD a,248,1,51072
v_max3_f32 v26, v26, v75, v88
M v,92,a,252,v,252
s_waitcnt lgkmcnt(3)
RD a,252,1,51136
Z v,96,a,224,v,128
v_max3_f32 v26, v26, v89, v90
v_max_f32 v25, v25, v87
M v,96,a,228,v,144
v_max_f32 v26, v26, v91
M v,96,a,232,v,160
v_max3_f32 v27, v27, v79, v92
v_max3_f32 v27, v27, v93, v94
M v,96,a,236,v,176
v_permlane32_swap_b32 v24, v26
Z v,100,a,224,v,132
v_max_f32 v27, v27, v95
v_max_f32 v24, v24, v26
M v,100,a,228,v,148
v_permlane32_swap_b32 v25, v27
M v,100,a,232,v,164
v_max_f32 v25, v25, v27
M v,100,a,236,v,180
Z v,104,a,224,v,136
DN 4,12,2,1056
M v,104,a,228,v,152
v_permlane16_swap_b32 v24, v25
M v,104,a,232,v,168
v_max_f32 v24, v24, v25
v_sub_f32 v24, 0, v24
M v,104,a,236,v,184
v_mov_b32 v25, v24
Z v,108,a,224,v,140
RD a,224,1,51200
M v,108,a,228,v,156
v_permlane16_swap_b32 v24, v25
M v,108,a,232,v,172
RD a,228,1,51264
v_mov_b32 v26, v24
M v,108,a,236,v,188
s_waitcnt lgkmcnt(2)
RD a,232,1,51328
M v,96,a,240,v,192
RD a,236,1,51392
v_mov_b32 v27, v25
M v,96,a,244,v,208
v_permlane32_swap_b32 v24, v26
M v,96,a,248,v,224
AD 64,64,24
AD 65,65,24
M v,96,a,252,v,240
v_permlane32_swap_b32 v25, v27
M v,100,a,240,v,196
v_xor_b32 v2, 81920, v2
AD 66,66,24
M v,100,a,244,v,212
AD 67,67,24
AD 68,68,25
M v,100,a,248,v,228
EX 64
M v,100,a,252,v,244
EX 65
M v,104,a,240,v,200
AD 69,69,25
AD 80,80,24
M v,104,a,244,v,216
EX 66
M v,104,a,248,v,232
AD 70,70,25
AD 12,64,65
M v,104,a,252,v,248
DN 4,16,2,2112
M v,108,a,240,v,204
RD a,240,1,51456
AD 81,81,24
M v,108,a,244,v,220
RD a,244,1,51520
AD 71,71,25
M v,108,a,248,v,236
RD a,248,1,51584
AD 72,72,26
M v,108,a,252,v,252
s_waitcnt lgkmcnt(3)
RD a,252,1,51648
Z v,112,a,224,v,128
EX 67
M v,112,a,228,v,144
EX 68
M v,112,a,232,v,160
EX 69
M v,112,a,236,v,176
AD 73,73,26
AD 12,12,66
Z v,116,a,224,v,132
AD 82,82,24
AD 84,84,25
M v,116,a,228,v,148
EX 80
M v,116,a,232,v,164
EX 70
M v,116,a,236,v,180
AD 74,74,26
AD 12,12,67
Z v,120,a,224,v,136
AD 13,68,69
AD 83,83,24
M v,120,a,228,v,152
EX 81
M v,120,a,232,v,168
EX 71
M v,120,a,236,v,184
AD 85,85,25
AD 75,75,26
Z v,124,a,224,v,140
EX 72
M v,124,a,228,v,156
DN 4,20,2,3168
M v,124,a,232,v,172
EX 73
M v,124,a,236,v,188
s_waitcnt lgkmcnt(0)
s_waitcnt vmcnt(13)
M v,112,a,240,v,192
s_barrier
TR a,224,0
M v,112,a,244,v,208
TR a,226,512
AD 76,76,27
M v,112,a,248,v,224
TR a,228,32
AD 77,77,27
M v,112,a,252,v,240
TR a,230,544
AD 12,12,80
M v,116,a,240,v,196
TR a,232,64
AD 13,13,70
M v,116,a,244,v,212
TR a,234,576
AD 86,86,25
M v,116,a,248,v,228
TR a,236,96
AD 88,88,26
M v,116,a,252,v,244
TR a,238,608
AD 78,78,27
M v,120,a,240,v,200
EX 82
M v,120,a,244,v,216
EX 84
M v,120,a,248,v,232
EX 74
M v,120,a,252,v,248
AD 12,12,81
AD 13,13,71
M v,124,a,240,v,204
AD 14,72,73
AD 87,87,25
M v,124,a,244,v,220
EX 83
M v,124,a,248,v,236
EX 85
M v,124,a,252,v,252
EX 75
AD 89,89,26
AD 79,79,27
EX 76
EX 77
AD 12,12,82
AD 13,13,84
AD 14,14,74
EX 86
v_pk_add_f32 v[90:91], v[90:91], v[26:27] op_sel:[0,0] op_sel_hi:[1,0]
EX 88
EX 78
v_pk_add_f32 v[92:93], v[92:93], v[26:27] op_sel:[0,1] op_sel_hi:[1,1]
AD 12,12,83
AD 13,13,85
AD 14,14,75
AD 15,76,77
EX 87
EX 89
EX 79
AD 13,13,86
AD 14,14,88
AD 15,15,78
CV 83,82
EX 90
v_pk_add_f32 v[94:95], v[94:95], v[26:27] op_sel:[0,1] op_sel_hi:[1,1]
EX 92
AD 13,13,87
AD 14,14,89
AD 15,15,79
CV 82,80
EX 91
EX 93
AD 14,14,90
AD 15,15,92
CV 81,66
CV 80,64
CV 87,86
EX 94
AD 14,14,91
AD 15,15,93
CV 86,84
EX 95
s_waitcnt lgkmcnt(0)
Z a,0,a,224,v,80
AD 15,15,94
CV 85,70
CV 84,68
CV 91,90
AD 15,15,95
Z a,4,a,224,v,84
CV 90,88
CV 89,74
CV 88,72
CV 95,94
CV 94,92
Z a,8,a,224,v,88
CV 93,78
CV 92,76
s_add_u32 m0, s92, 0
s_mov_b32 s2, 294912
Z a,12,a,224,v,92
DN 4,24,2,0
Z a,16,a,228,v,80
TR a,240,128
AD 96,96,24
Z a,20,a,228,v,84
TR a,242,640
AD 97,97,24
Z a,24,a,228,v,88
TR a,244,160
AD 100,100,25
Z a,28,a,228,v,92
TR a,246,672
AD 101,101,25
Z a,32,a,232,v,80
TR a,248,192
AD 104,104,26
Z a,36,a,232,v,84
TR a,250,704
AD 105,105,26
Z a,40,a,232,v,88
TR a,252,224
TR a,254,736
Z a,44,a,232,v,92
TR a,224,256
AD 98,98,24
Z a,48,a,236,v,80
TR a,226,768
AD 102,102,25
Z a,52,a,236,v,84
TR a,228,288
AD 106,106,26
Z a,56,a,236,v,88
TR a,230,800
AD 108,108,27
Z a,60,a,236,v,92
s_waitcnt lgkmcnt(4)
TR a,232,320
Z a,64,a,240,v,80
TR a,234,832
AD 109,109,27
Z a,68,a,240,v,84
DN 4,28,2,1056
Z a,72,a,240,v,88
TR a,236,352
AD 99,99,24
Z a,76,a,240,v,92
TR a,238,864
AD 103,103,25
Z a,80,a,244,v,80
TR a,240,384
v_xor_b32 v1, 81920, v1
Z a,84,a,244,v,84
TR a,242,896
AD 107,107,26
Z a,88,a,244,v,88
EX 96
Z a,92,a,244,v,92
TR a,244,416
AD 110,110,27
Z a,96,a,248,v,80
TR a,246,928
AD 111,111,27
Z a,100,a,248,v,84
EX 97
Z a,104,a,248,v,88
EX 100
Z a,108,a,248,v,92
TR a,248,448
AD 112,112,24
Z a,112,a,252,v,80
TR a,250,960
AD 116,116,25
Z a,116,a,252,v,84
EX 101
Z a,120,a,252,v,88
EX 104
Z a,124,a,252,v,92
s_waitcnt lgkmcnt(6)
TR a,252,480
Z a,128,a,224,v,80
TR a,254,992
AD 120,120,26
Z a,132,a,224,v,84
EX 105
Z a,136,a,224,v,88
EX 98
Z a,140,a,224,v,92
DN 4,32,2,2112
Z a,144,a,228,v,80
EX 102
Z a,148,a,228,v,84
EX 106
Z a,152,a,228,v,88
EX 108
Z a,156,a,228,v,92
EX 109
Z a,160,a,232,v,80
AD 16,96,97
AD 17,100,101
Z a,164,a,232,v,84
AD 18,104,105
AD 113,113,24
Z a,168,a,232,v,88
EX 99
Z a,172,a,232,v,92
EX 103
Z a,176,a,236,v,80
EX 107
Z a,180,a,236,v,84
EX 110
L_pad18:
s_cbranch_execz L_ret18
Z a,184,a,236,v,88
AD 117,117,25
AD 121,121,26
Z a,188,a,236,v,92
s_waitcnt lgkmcnt(0)
s_waitcnt vmcnt(12)
Z a,192,a,240,v,80
s_barrier
RD a,224,1,50688
Z a,196,a,240,v,84
RD a,228,1,50752
AD 124,124,27
Z a,200,a,240,v,88
RD a,232,1,50816
AD 16,16,98
Z a,204,a,240,v,92
RD a,236,1,50880
AD 17,17,102
Z a,208,a,244,v,80
AD 18,18,106
AD 19,108,109
Z a,212,a,244,v,84
EX 111
Z a,216,a,244,v,88
AD 114,114,24
AD 118,118,25
Z a,220,a,244,v,92
EX 112
Z v,32,a,248,v,80
EX 116
Z v,36,a,248,v,84
AD 122,122,26
AD 125,125,27
Z v,40,a,248,v,88
EX 120
Z v,44,a,248,v,92
AD 16,16,99
AD 17,17,103
Z v,48,a,252,v,80
AD 18,18,107
AD 19,19,110
Z v,52,a,252,v,84
AD 115,115,24
AD 119,119,25
Z v,56,a,252,v,88
EX 113
Z v,60,a,252,v,92
EX 117
AD 123,123,26
EX 121
v_pk_add_f32 v[126:127], v[126:127], v[26:27] op_sel:[0,1] op_sel_hi:[1,1]
EX 124
AD 19,19,111
AD 16,16,112
AD 17,17,116
AD 18,18,120
EX 114
EX 118
EX 122
EX 125
DN 4,36,2,3168
AD 16,16,113
AD 17,17,117
AD 18,18,121
AD 19,19,124
EX 115
EX 119
EX 123
EX 126
AD 16,16,114
AD 17,17,118
AD 18,18,122
AD 19,19,125
EX 127
AD 16,16,115
AD 17,17,119
AD 18,18,123
AD 19,19,126
AD 19,19,127
v_max3_f32 v20, v16, v17, v18
v_max_f32 v20, v20, v19
v_cmp_lt_f32 vcc, 0x4b800000, v20
v_mov_b32 v64, v24
v_mov_b32 v65, v24
v_mov_b32 v66, v24
v_mov_b32 v67, v24
v_mov_b32 v68, v25
v_mov_b32 v69, v25
v_mov_b32 v70, v25
v_mov_b32 v71, v25
v_mov_b32 v72, v26
v_mov_b32 v73, v26
v_mov_b32 v74, v26
v_mov_b32 v75, v26
v_mov_b32 v76, v27
v_mov_b32 v77, v27
v_mov_b32 v78, v27
v_mov_b32 v79, v27
s_waitcnt lgkmcnt(0)
CV 80,96
CV 81,98
s_cbranch_vccnz L_rsA15
L_rbA15:
MC 96,a,224,128,64
CV 84,100
CV 85,102
M v,96,a,228,v,144
CV 88,104
CV 89,106
M v,96,a,232,v,160
RD a,240,1,50944
CV 92,108
M v,96,a,236,v,176
RD a,244,1,51008
CV 93,110
MC 100,a,224,132,68
RD a,248,1,51072
s_add_u32 m0, s92, 50688
M v,100,a,228,v,148
RD a,252,1,51136
s_mov_b32 s2, 327680
M v,100,a,232,v,164
CV 82,112
CV 83,114
M v,100,a,236,v,180
CV 86,116
CV 87,118
MC 104,a,224,136,72
DN 4,8,2,0
M v,104,a,228,v,152
CV 90,120
CV 91,122
M v,104,a,232,v,168
CV 94,124
CV 95,126
M v,104,a,236,v,184
AD 12,12,16
AD 13,13,17
MC 108,a,224,140,76
RD a,224,1,51200
AD 14,14,18
M v,108,a,228,v,156
RD a,228,1,51264
AD 15,15,19
M v,108,a,232,v,172
RD a,232,1,51328
M v,108,a,236,v,188
s_waitcnt lgkmcnt(3)
RD a,236,1,51392
M v,96,a,240,v,192
M v,96,a,244,v,208
M v,96,a,248,v,224
M v,96,a,252,v,240
M v,100,a,240,v,196
v_xor_b32 v2, 81920, v2
M v,100,a,244,v,212
M v,100,a,248,v,228
M v,100,a,252,v,244
M v,104,a,240,v,200
M v,104,a,244,v,216
M v,104,a,248,v,232
DN 4,12,2,1056
M v,104,a,252,v,248
EX 96
M v,108,a,240,v,204
EX 97
M v,108,a,244,v,220
RD a,240,1,51456
AD 16,96,97
M v,108,a,248,v,236
EX 100
M v,108,a,252,v,252
s_waitcnt lgkmcnt(1)
RD a,244,1,51520
MC 112,a,224,128,64
EX 101
M v,112,a,228,v,144
RD a,248,1,51584
AD 17,100,101
M v,112,a,232,v,160
EX 104
M v,112,a,236,v,176
EX 105
MC 116,a,224,132,68
RD a,252,1,51648
AD 18,104,105
M v,116,a,228,v,148
EX 98
M v,116,a,232,v,164
EX 102
M v,116,a,236,v,180
EX 106
MC 120,a,224,136,72
EX 108
M v,120,a,228,v,152
EX 109
M v,120,a,232,v,168
EX 99
M v,120,a,236,v,184
EX 103
MC 124,a,224,140,76
DN 4,16,2,2112
M v,124,a,228,v,156
EX 107
M v,124,a,232,v,172
EX 110
M v,124,a,236,v,188
s_waitcnt lgkmcnt(0)
s_waitcnt vmcnt(12)
M v,112,a,240,v,192
s_barrier
TR a,224,16896
M v,112,a,244,v,208
TR a,226,17408
AD 16,16,98
M v,112,a,248,v,224
TR a,228,16928
AD 17,17,102
M v,112,a,252,v,240
TR a,230,17440
AD 18,18,106
M v,116,a,240,v,196
TR a,232,16960
AD 19,108,109
M v,116,a,244,v,212
TR a,234,17472
AD 16,16,99
M v,116,a,248,v,228
TR a,236,16992
AD 17,17,103
M v,116,a,252,v,244
TR a,238,17504
AD 18,18,107
M v,120,a,240,v,200
EX 111
M v,120,a,244,v,216
EX 112
M v,120,a,248,v,232
AD 19,19,110
AD 19,19,111
M v,120,a,252,v,248
EX 116
M v,124,a,240,v,204
TR a,240,17024
AD 16,16,112
M v,124,a,244,v,220
TR a,242,17536
AD 17,17,116
M v,124,a,248,v,236
DN 4,20,2,3168
M v,124,a,252,v,252
s_waitcnt lgkmcnt(2)
TR a,244,17056
M a,0,a,224,v,80
TR a,246,17568
s_add_u32 m0, s92, 81920
M a,4,a,224,v,84
TR a,248,17088
s_mov_b32 s2, 311296
M a,8,a,224,v,88
EX 120
M a,12,a,224,v,92
TR a,250,17600
AD 18,18,120
M a,16,a,228,v,80
EX 113
M a,20,a,228,v,84
TR a,252,17120
AD 16,16,113
M a,24,a,228,v,88
EX 117
M a,28,a,228,v,92
TR a,254,17632
AD 17,17,117
M a,32,a,232,v,80
EX 121
M a,36,a,232,v,84
TR a,224,17152
AD 18,18,121
M a,40,a,232,v,88
EX 124
M a,44,a,232,v,92
TR a,226,17664
AD 19,19,124
M a,48,a,236,v,80
EX 114
M a,52,a,236,v,84
TR a,228,17184
AD 16,16,114
M a,56,a,236,v,88
EX 118
M a,60,a,236,v,92
s_waitcnt lgkmcnt(3)
TR a,230,17696
M a,64,a,240,v,80
TR a,232,17216
AD 17,17,118
M a,68,a,240,v,84
DN 4,24,2,0
M a,72,a,240,v,88
EX 122
M a,76,a,240,v,92
TR a,234,17728
AD 18,18,122
M a,80,a,244,v,80
TR a,236,17248
v_xor_b32 v1, 81920, v1
M a,84,a,244,v,84
EX 125
M a,88,a,244,v,88
TR a,238,17760
AD 19,19,125
M a,92,a,244,v,92
EX 115
M a,96,a,248,v,80
TR a,240,17280
AD 16,16,115
M a,100,a,248,v,84
EX 119
M a,104,a,248,v,88
TR a,242,17792
AD 17,17,119
M a,108,a,248,v,92
EX 123
M a,112,a,252,v,80
TR a,244,17312
AD 18,18,123
M a,116,a,252,v,84
TR a,246,17824
v_max3_f32 v20, v16, v17, v18
M a,120,a,252,v,88
EX 126
M a,124,a,252,v,92
s_waitcnt lgkmcnt(4)
TR a,248,17344
M a,128,a,224,v,80
TR a,250,17856
AD 19,19,126
M a,132,a,224,v,84
EX 127
M a,136,a,224,v,88
TR a,252,17376
AD 19,19,127
M a,140,a,224,v,92
DN 4,28,2,1056
M a,144,a,228,v,80
TR a,254,17888
v_max_f32 v20, v20, v19
M a,148,a,228,v,84
v_cmp_lt_f32 vcc, 0x4b800000, v20
M a,152,a,228,v,88
M a,156,a,228,v,92
M a,160,a,232,v,80
M a,164,a,232,v,84
M a,168,a,232,v,88
M a,172,a,232,v,92
M a,176,a,236,v,80
M a,180,a,236,v,84
M a,184,a,236,v,88
M a,188,a,236,v,92
s_waitcnt lgkmcnt(0)
s_waitcnt vmcnt(10)
M a,192,a,240,v,80
s_barrier
RD a,224,1,33792
M a,196,a,240,v,84
RD a,228,1,33856
M a,200,a,240,v,88
RD a,232,1,33920
M a,204,a,240,v,92
RD a,236,1,33984
M a,208,a,244,v,80
RD a,240,1,34048
M a,212,a,244,v,84
DN 4,32,2,2112
M a,216,a,244,v,88
M a,220,a,244,v,92
RD a,244,1,34112
M v,32,a,248,v,80
M v,36,a,248,v,84
M v,40,a,248,v,88
M v,44,a,248,v,92
RD a,248,1,34176
M v,48,a,252,v,80
CV 80,96
CV 81,98
M v,52,a,252,v,84
CV 84,100
CV 85,102
M v,56,a,252,v,88
s_waitcnt lgkmcnt(3)
CV 88,104
M v,60,a,252,v,92
s_cbranch_vccnz L_rsA16
L_rbA16:
MC 96,a,224,128,64
RD a,252,1,34240
CV 89,106
M v,96,a,228,v,144
CV 92,108
CV 93,110
M v,96,a,232,v,160
CV 82,112
CV 83,114
M v,96,a,236,v,176
CV 86,116
CV 87,118
MC 100,a,224,132,68
CV 90,120
CV 91,122
M v,100,a,228,v,148
CV 94,124
CV 95,126
M v,100,a,232,v,164
AD 12,12,16
AD 13,13,17
M v,100,a,236,v,180
DN 4,36,2,3168
MC 104,a,224,136,72
s_add_u32 m0, s92, 132608
s_mov_b32 s2, 344064
M v,104,a,228,v,152
AD 14,14,18
AD 15,15,19
M v,104,a,232,v,168
M v,104,a,236,v,184
MC 108,a,224,140,76
RD a,224,1,34304
M v,108,a,228,v,156
RD a,228,1,34368
M v,108,a,232,v,172
RD a,232,1,34432
M v,108,a,236,v,188
s_waitcnt lgkmcnt(3)
RD a,236,1,34496
M v,96,a,240,v,192
M v,96,a,244,v,208
M v,96,a,248,v,224
M v,96,a,252,v,240
M v,100,a,240,v,196
M v,100,a,244,v,212
M v,100,a,248,v,228
M v,100,a,252,v,244
M v,104,a,240,v,200
M v,104,a,244,v,216
DN 4,8,2,0
M v,104,a,248,v,232
EX 96
M v,104,a,252,v,248
EX 97
M v,108,a,240,v,204
RD a,240,1,34560
AD 16,96,97
M v,108,a,244,v,220
EX 100
M v,108,a,248,v,236
EX 101
M v,108,a,252,v,252
s_waitcnt lgkmcnt(1)
RD a,244,1,34624
MC 112,a,224,128,64
RD a,248,1,34688
AD 17,100,101
M v,112,a,228,v,144
EX 104
M v,112,a,232,v,160
EX 105
M v,112,a,236,v,176
RD a,252,1,34752
AD 18,104,105
MC 116,a,224,132,68
EX 98
M v,116,a,228,v,148
EX 102
M v,116,a,232,v,164
EX 106
M v,116,a,236,v,180
EX 108
MC 120,a,224,136,72
EX 109
M v,120,a,228,v,152
EX 99
M v,120,a,232,v,168
EX 103
M v,120,a,236,v,184
EX 107
MC 124,a,224,140,76
DN 4,12,2,1056
M v,124,a,228,v,156
EX 110
M v,124,a,232,v,172
AD 16,16,98
AD 17,17,102
M v,124,a,236,v,188
s_waitcnt lgkmcnt(0)
s_waitcnt vmcnt(10)
M v,112,a,240,v,192
s_barrier
TR a,224,0
M v,112,a,244,v,208
TR a,226,512
AD 18,18,106
M v,112,a,248,v,224
TR a,228,32
AD 19,108,109
M v,112,a,252,v,240
TR a,230,544
AD 16,16,99
M v,116,a,240,v,196
TR a,232,64
AD 17,17,103
M v,116,a,244,v,212
TR a,234,576
AD 18,18,107
M v,116,a,248,v,228
TR a,236,96
AD 19,19,110
M v,116,a,252,v,244
TR a,238,608
M v,120,a,240,v,200
EX 111
M v,120,a,244,v,216
EX 112
M v,120,a,248,v,232
EX 113
M v,120,a,252,v,248
EX 116
M v,124,a,240,v,204
TR a,240,128
AD 19,19,111
M v,124,a,244,v,220
TR a,242,640
AD 16,16,112
M v,124,a,248,v,236
DN 4,16,2,2112
M v,124,a,252,v,252
s_waitcnt lgkmcnt(2)
TR a,244,160
M a,0,a,224,v,80
TR a,246,672
AD 17,17,116
M a,4,a,224,v,84
TR a,248,192
AD 16,16,113
M a,8,a,224,v,88
EX 120
M a,12,a,224,v,92
TR a,250,704
AD 18,18,120
M a,16,a,228,v,80
EX 117
M a,20,a,228,v,84
TR a,252,224
AD 17,17,117
M a,24,a,228,v,88
EX 121
M a,28,a,228,v,92
TR a,254,736
AD 18,18,121
M a,32,a,232,v,80
EX 124
M a,36,a,232,v,84
TR a,224,256
AD 19,19,124
M a,40,a,232,v,88
EX 114
M a,44,a,232,v,92
TR a,226,768
AD 16,16,114
M a,48,a,236,v,80
EX 118
M a,52,a,236,v,84
TR a,228,288
AD 17,17,118
M a,56,a,236,v,88
EX 122
M a,60,a,236,v,92
s_waitcnt lgkmcnt(3)
TR a,230,800
M a,64,a,240,v,80
DN 4,20,2,3168
M a,68,a,240,v,84
TR a,232,320
s_add_u32 m0, s92, 16896
M a,72,a,240,v,88
TR a,234,832
s_mov_b32 s2, 327680
M a,76,a,240,v,92
TR a,236,352
AD 18,18,122
M a,80,a,244,v,80
EX 125
M a,84,a,244,v,84
TR a,238,864
AD 19,19,125
M a,88,a,244,v,88
EX 115
M a,92,a,244,v,92
TR a,240,384
AD 16,16,115
M a,96,a,248,v,80
EX 119
M a,100,a,248,v,84
TR a,242,896
AD 17,17,119
M a,104,a,248,v,88
EX 123
M a,108,a,248,v,92
TR a,244,416
AD 18,18,123
M a,112,a,252,v,80
TR a,246,928
v_max3_f32 v20, v16, v17, v18
M a,116,a,252,v,84
EX 126
M a,120,a,252,v,88
TR a,248,448
AD 19,19,126
M a,124,a,252,v,92
s_waitcnt lgkmcnt(5)
TR a,250,960
M a,128,a,224,v,80
EX 127
M a,132,a,224,v,84
TR a,252,480
AD 19,19,127
L_pad19:
s_cbranch_execz L_ret19
M a,136,a,224,v,88
DN 4,24,2,0
M a,140,a,224,v,92
TR a,254,992
v_max_f32 v20, v20, v19
M a,144,a,228,v,80
v_cmp_lt_f32 vcc, 0x4b800000, v20
M a,148,a,228,v,84
M a,152,a,228,v,88
M a,156,a,228,v,92
M a,160,a,232,v,80
M a,164,a,232,v,84
M a,168,a,232,v,88
M a,172,a,232,v,92
M a,176,a,236,v,80
M a,180,a,236,v,84
M a,184,a,236,v,88
M a,188,a,236,v,92
s_waitcnt lgkmcnt(0)
s_waitcnt vmcnt(9)
M a,192,a,240,v,80
s_barrier
RD a,224,1,50688
M a,196,a,240,v,84
RD a,228,1,50752
M a,200,a,240,v,88
RD a,232,1,50816
M a,204,a,240,v,92
RD a,236,1,50880
M a,208,a,244,v,80
DN 4,28,2,1056
M a,212,a,244,v,84
RD a,240,1,50944
M a,216,a,244,v,88
M a,220,a,244,v,92
RD a,244,1,51008
M v,32,a,248,v,80
M v,36,a,248,v,84
M v,40,a,248,v,88
M v,44,a,248,v,92
RD a,248,1,51072
M v,48,a,252,v,80
CV 80,96
CV 81,98
M v,52,a,252,v,84
CV 84,100
CV 85,102
M v,56,a,252,v,88
s_waitcnt lgkmcnt(3)
CV 88,104
M v,60,a,252,v,92
s_cbranch_vccnz L_rsA17
L_rbA17:
MC 96,a,224,128,64
RD a,252,1,51136
CV 89,106
M v,96,a,228,v,144
CV 92,108
CV 93,110
M v,96,a,232,v,160
CV 82,112
CV 83,114
M v,96,a,236,v,176
CV 86,116
CV 87,118
MC 100,a,224,132,68
CV 90,120
CV 91,122
M v,100,a,228,v,148
CV 94,124
CV 95,126
M v,100,a,232,v,164
AD 12,12,16
AD 13,13,17
M v,100,a,236,v,180
DN 4,32,2,2112
MC 104,a,224,136,72
AD 14,14,18
AD 15,15,19
M v,104,a,228,v,152
M v,104,a,232,v,168
M v,104,a,236,v,184
MC 108,a,224,140,76
RD a,224,1,51200
M v,108,a,228,v,156
RD a,228,1,51264
M v,108,a,232,v,172
RD a,232,1,51328
M v,108,a,236,v,188
s_waitcnt lgkmcnt(3)
RD a,236,1,51392
M v,96,a,240,v,192
M v,96,a,244,v,208
M v,96,a,248,v,224
M v,96,a,252,v,240
M v,100,a,240,v,196
v_xor_b32 v2, 81920, v2
M v,100,a,244,v,212
M v,100,a,248,v,228
M v,100,a,252,v,244
M v,104,a,240,v,200
M v,104,a,244,v,216
DN 4,36,2,3168
M v,104,a,248,v,232
s_add_u32 m0, s92, 33792
s_mov_b32 s2, 360448
M v,104,a,252,v,248
EX 96
M v,108,a,240,v,204
EX 97
M v,108,a,244,v,220
RD a,240,1,51456
AD 16,96,97
M v,108,a,248,v,236
EX 100
M v,108,a,252,v,252
s_waitcnt lgkmcnt(1)
RD a,244,1,51520
MC 112,a,224,128,64
EX 101
M v,112,a,228,v,144
RD a,248,1,51584
AD 17,100,101
M v,112,a,232,v,160
EX 104
M v,112,a,236,v,176
EX 105
MC 116,a,224,132,68
RD a,252,1,51648
AD 18,104,105
M v,116,a,228,v,148
EX 98
M v,116,a,232,v,164
EX 102
M v,116,a,236,v,180
EX 106
MC 120,a,224,136,72
EX 108
M v,120,a,228,v,152
EX 109
M v,120,a,232,v,168
EX 99
M v,120,a,236,v,184
DN 4,8,2,0
MC 124,a,224,140,76
EX 103
M v,124,a,228,v,156
EX 107
M v,124,a,232,v,172
EX 110
M v,124,a,236,v,188
s_waitcnt lgkmcnt(0)
s_waitcnt vmcnt(9)
M v,112,a,240,v,192
s_barrier
TR a,224,0
M v,112,a,244,v,208
TR a,226,512
AD 16,16,98
M v,112,a,248,v,224
TR a,228,32
AD 17,17,102
M v,112,a,252,v,240
TR a,230,544
AD 18,18,106
M v,116,a,240,v,196
TR a,232,64
AD 19,108,109
M v,116,a,244,v,212
TR a,234,576
AD 16,16,99
M v,116,a,248,v,228
TR a,236,96
AD 17,17,103
M v,116,a,252,v,244
TR a,238,608
AD 18,18,107
M v,120,a,240,v,200
EX 111
M v,120,a,244,v,216
EX 112
M v,120,a,248,v,232
AD 19,19,110
AD 19,19,111
M v,120,a,252,v,248
EX 116
M v,124,a,240,v,204
TR a,240,128
AD 16,16,112
M v,124,a,244,v,220
DN 4,12,2,1056
M v,124,a,248,v,236
TR a,242,640
AD 17,17,116
M v,124,a,252,v,252
s_waitcnt lgkmcnt(2)
TR a,244,160
M a,0,a,224,v,80
EX 120
M a,4,a,224,v,84
TR a,246,672
AD 18,18,120
M a,8,a,224,v,88
EX 113
M a,12,a,224,v,92
TR a,248,192
AD 16,16,113
M a,16,a,228,v,80
EX 117
M a,20,a,228,v,84
TR a,250,704
AD 17,17,117
M a,24,a,228,v,88
EX 121
M a,28,a,228,v,92
TR a,252,224
AD 18,18,121
M a,32,a,232,v,80
TR a,254,736
M a,36,a,232,v,84
EX 124
M a,40,a,232,v,88
TR a,224,256
AD 19,19,124
M a,44,a,232,v,92
EX 114
M a,48,a,236,v,80
TR a,226,768
AD 16,16,114
M a,52,a,236,v,84
EX 118
M a,56,a,236,v,88
TR a,228,288
AD 17,17,118
M a,60,a,236,v,92
s_waitcnt lgkmcnt(3)
TR a,230,800
M a,64,a,240,v,80
DN 4,16,2,2112
M a,68,a,240,v,84
EX 122
M a,72,a,240,v,88
TR a,232,320
AD 18,18,122
M a,76,a,240,v,92
EX 125
M a,80,a,244,v,80
TR a,234,832
v_xor_b32 v1, 81920, v1
M a,84,a,244,v,84
TR a,236,352
AD 19,19,125
M a,88,a,244,v,88
EX 115
M a,92,a,244,v,92
TR a,238,864
AD 16,16,115
M a,96,a,248,v,80
EX 119
M a,100,a,248,v,84
TR a,240,384
AD 17,17,119
M a,104,a,248,v,88
EX 123
M a,108,a,248,v,92
TR a,242,896
AD 18,18,123
M a,112,a,252,v,80
TR a,244,416
v_max3_f32 v20, v16, v17, v18
M a,116,a,252,v,84
EX 126
M a,120,a,252,v,88
TR a,246,928
AD 19,19,126
M a,124,a,252,v,92
s_waitcnt lgkmcnt(4)
TR a,248,448
M a,128,a,224,v,80
EX 127
M a,132,a,224,v,84
TR a,250,960
AD 19,19,127
M a,136,a,224,v,88
DN 4,20,2,3168
M a,140,a,224,v,92
TR a,252,480
s_add_u32 m0, s92, 0
M a,144,a,228,v,80
TR a,254,992
s_mov_b32 s2, 344064
M a,148,a,228,v,84
v_max_f32 v20, v20, v19
v_cmp_lt_f32 vcc, 0x4b800000, v20
M a,152,a,228,v,88
M a,156,a,228,v,92
M a,160,a,232,v,80
M a,164,a,232,v,84
M a,168,a,232,v,88
M a,172,a,232,v,92
M a,176,a,236,v,80
M a,180,a,236,v,84
M a,184,a,236,v,88
M a,188,a,236,v,92
s_waitcnt lgkmcnt(0)
s_waitcnt vmcnt(8)
M a,192,a,240,v,80
s_barrier
RD a,224,1,50688
M a,196,a,240,v,84
RD a,228,1,50752
M a,200,a,240,v,88
RD a,232,1,50816
M a,204,a,240,v,92
RD a,236,1,50880
M a,208,a,244,v,80
DN 4,24,2,0
M a,212,a,244,v,84
RD a,240,1,50944
M a,216,a,244,v,88
M a,220,a,244,v,92
RD a,244,1,51008
M v,32,a,248,v,80
M v,36,a,248,v,84
M v,40,a,248,v,88
M v,44,a,248,v,92
RD a,248,1,51072
M v,48,a,252,v,80
CV 80,96
CV 81,98
M v,52,a,252,v,84
CV 84,100
CV 85,102
M v,56,a,252,v,88
s_waitcnt lgkmcnt(3)
CV 88,104
M v,60,a,252,v,92
s_cbranch_vccnz L_rsA18
L_rbA18:
MC 96,a,224,128,64
RD a,252,1,51136
CV 89,106
M v,96,a,228,v,144
CV 92,108
CV 93,110
M v,96,a,232,v,160
CV 82,112
CV 83,114
M v,96,a,236,v,176
CV 86,116
CV 87,118
MC 100,a,224,132,68
CV 90,120
CV 91,122
M v,100,a,228,v,148
CV 94,124
CV 95,126
M v,100,a,232,v,164
DN 4,28,2,1056
M v,100,a,236,v,180
AD 12,12,16
AD 13,13,17
MC 104,a,224,136,72
AD 14,14,18
AD 15,15,19
M v,104,a,228,v,152
M v,104,a,232,v,168
M v,104,a,236,v,184
MC 108,a,224,140,76
RD a,224,1,51200
M v,108,a,228,v,156
RD a,228,1,51264
M v,108,a,232,v,172
RD a,232,1,51328
M v,108,a,236,v,188
s_waitcnt lgkmcnt(3)
RD a,236,1,51392
M v,96,a,240,v,192
M v,96,a,244,v,208
M v,96,a,248,v,224
M v,96,a,252,v,240
M v,100,a,240,v,196
v_xor_b32 v2, 81920, v2
M v,100,a,244,v,212
M v,100,a,248,v,228
M v,100,a,252,v,244
M v,104,a,240,v,200
DN 4,32,2,2112
M v,104,a,244,v,216
EX 96
M v,104,a,248,v,232
EX 97
M v,104,a,252,v,248
EX 98
M v,108,a,240,v,204
RD a,240,1,51456
AD 16,96,97
M v,108,a,244,v,220
RD a,244,1,51520
AD 16,16,98
M v,108,a,248,v,236
EX 100
M v,108,a,252,v,252
s_waitcnt lgkmcnt(2)
RD a,248,1,51584
MC 112,a,224,128,64
EX 101
M v,112,a,228,v,144
RD a,252,1,51648
AD 17,100,101
M v,112,a,232,v,160
EX 104
M v,112,a,236,v,176
EX 105
MC 116,a,224,132,68
EX 102
M v,116,a,228,v,148
EX 106
M v,116,a,232,v,164
EX 108
M v,116,a,236,v,180
EX 109
MC 120,a,224,136,72
AD 18,104,105
AD 17,17,102
M v,120,a,228,v,152
EX 99
M v,120,a,232,v,168
DN 4,36,2,3168
M v,120,a,236,v,184
s_add_u32 m0, s92, 50688
s_mov_b32 s2, 376832
MC 124,a,224,140,76
EX 103
M v,124,a,228,v,156
EX 107
M v,124,a,232,v,172
EX 110
M v,124,a,236,v,188
s_waitcnt lgkmcnt(0)
s_waitcnt vmcnt(8)
M v,112,a,240,v,192
s_barrier
TR a,224,16896
M v,112,a,244,v,208
TR a,226,17408
AD 18,18,106
M v,112,a,248,v,224
TR a,228,16928
AD 19,108,109
M v,112,a,252,v,240
TR a,230,17440
AD 16,16,99
M v,116,a,240,v,196
TR a,232,16960
AD 17,17,103
M v,116,a,244,v,212
TR a,234,17472
AD 18,18,107
M v,116,a,248,v,228
TR a,236,16992
AD 19,19,110
M v,116,a,252,v,244
TR a,238,17504
M v,120,a,240,v,200
EX 111
M v,120,a,244,v,216
EX 112
M v,120,a,248,v,232
EX 113
M v,120,a,252,v,248
EX 116
M v,124,a,240,v,204
TR a,240,17024
AD 19,19,111
M v,124,a,244,v,220
DN 4,8,2,0
M v,124,a,248,v,236
TR a,242,17536
AD 16,16,112
M v,124,a,252,v,252
s_waitcnt lgkmcnt(2)
TR a,244,17056
M a,0,a,224,v,80
TR a,246,17568
AD 17,17,116
M a,4,a,224,v,84
TR a,248,17088
AD 16,16,113
M a,8,a,224,v,88
EX 120
M a,12,a,224,v,92
TR a,250,17600
AD 18,18,120
M a,16,a,228,v,80
EX 117
M a,20,a,228,v,84
TR a,252,17120
AD 17,17,117
M a,24,a,228,v,88
EX 121
M a,28,a,228,v,92
TR a,254,17632
AD 18,18,121
M a,32,a,232,v,80
EX 124
M a,36,a,232,v,84
TR a,224,17152
AD 19,19,124
M a,40,a,232,v,88
EX 114
M a,44,a,232,v,92
TR a,226,17664
AD 16,16,114
M a,48,a,236,v,80
DN 4,12,2,1056
M a,52,a,236,v,84
TR a,228,17184
v_bfe_u32 v8, v4, 8, 2
M a,56,a,236,v,88
TR a,230,17696
v_lshrrev_b32 v9, 14, s95
M a,60,a,236,v,92
s_waitcnt lgkmcnt(4)
TR a,232,17216
M a,64,a,240,v,80
TR a,234,17728
v_add_lshl_u32 v8, v8, v9, 7
M a,68,a,240,v,84
TR a,236,17248
v_add_u32 v8, 4096, v8
M a,72,a,240,v,88
TR a,238,17760
v_mov_b32 v9, 0
M a,76,a,240,v,92
s_getpc_b64 s[100:101]
s_and_b32 s100, s100, 0xfffff000
M a,80,a,244,v,80
TR a,240,17280
v_lshl_add_u64 v[8:9], v[8:9], 0, s[100:101]
M a,84,a,244,v,84
TR a,242,17792
v_xor_b32 v1, 81920, v1
M a,88,a,244,v,88
global_load_dword v10, v[8:9], off
M a,92,a,244,v,92
EX 118
M a,96,a,248,v,80
TR a,244,17312
AD 17,17,118
M a,100,a,248,v,84
EX 122
M a,104,a,248,v,88
TR a,246,17824
AD 18,18,122
M a,108,a,248,v,92
DN 4,16,2,2112
M a,112,a,252,v,80
EX 125
M a,116,a,252,v,84
TR a,248,17344
AD 19,19,125
M a,120,a,252,v,88
EX 115
M a,124,a,252,v,92
s_waitcnt lgkmcnt(5)
TR a,250,17856
M a,128,a,224,v,80
TR a,252,17376
AD 16,16,115
M a,132,a,224,v,84
EX 119
M a,136,a,224,v,88
TR a,254,17888
AD 17,17,119
M a,140,a,224,v,92
EX 123
M a,144,a,228,v,80
EX 126
M a,148,a,228,v,84
EX 127
M a,152,a,228,v,88
AD 18,18,123
AD 19,19,126
M a,156,a,228,v,92
AD 19,19,127
v_max3_f32 v20, v16, v17, v18
M a,160,a,232,v,80
v_max_f32 v20, v20, v19
v_cmp_lt_f32 vcc, 0x4b800000, v20
M a,164,a,232,v,84
M a,168,a,232,v,88
DN 4,20,2,3168
M a,172,a,232,v,92
s_add_u32 m0, s92, 81920
s_mov_b32 s2, 360448
M a,176,a,236,v,80
L_pad20:
s_cbranch_execz L_ret20
M a,180,a,236,v,84
M a,184,a,236,v,88
M a,188,a,236,v,92
s_waitcnt lgkmcnt(0)
s_waitcnt vmcnt(9)
M a,192,a,240,v,80
s_barrier
RD a,224,1,33792
M a,196,a,240,v,84
RD a,228,1,33856
M a,200,a,240,v,88
RD a,232,1,33920
M a,204,a,240,v,92
RD a,236,1,33984
M a,208,a,244,v,80
RD a,240,1,34048
M a,212,a,244,v,84
M a,216,a,244,v,88
M a,220,a,244,v,92
RD a,244,1,34112
M v,32,a,248,v,80
M v,36,a,248,v,84
DN 4,24,2,0
M v,40,a,248,v,88
M v,44,a,248,v,92
RD a,248,1,34176
M v,48,a,252,v,80
CV 80,96
CV 81,98
M v,52,a,252,v,84
CV 84,100
CV 85,102
M v,56,a,252,v,88
s_waitcnt lgkmcnt(3)
CV 88,104
M v,60,a,252,v,92
s_cbranch_vccnz L_rsA19
L_rbA19:
MC 96,a,224,128,64
RD a,252,1,34240
CV 89,106
M v,96,a,228,v,144
CV 92,108
CV 93,110
M v,96,a,232,v,160
CV 82,112
CV 83,114
M v,96,a,236,v,176
CV 86,116
CV 87,118
MC 100,a,224,132,68
CV 90,120
CV 91,122
M v,100,a,228,v,148
CV 94,124
CV 95,126
M v,100,a,232,v,164
AD 12,12,16
AD 13,13,17
M v,100,a,236,v,180
AD 14,14,18
AD 15,15,19
MC 104,a,224,136,72
M v,104,a,228,v,152
DN 4,28,2,1056
M v,104,a,232,v,168
M v,104,a,236,v,184
MC 108,a,224,140,76
RD a,224,1,34304
M v,108,a,228,v,156
RD a,228,1,34368
M v,108,a,232,v,172
RD a,232,1,34432
M v,108,a,236,v,188
s_waitcnt lgkmcnt(3)
RD a,236,1,34496
M v,96,a,240,v,192
M v,96,a,244,v,208
M v,96,a,248,v,224
M v,96,a,252,v,240
M v,100,a,240,v,196
M v,100,a,244,v,212
M v,100,a,248,v,228
M v,100,a,252,v,244
M v,104,a,240,v,200
DN 4,32,2,2112
M v,104,a,244,v,216
M v,104,a,248,v,232
EX 96
M v,104,a,252,v,248
EX 97
M v,108,a,240,v,204
RD a,240,1,34560
AD 16,96,97
M v,108,a,244,v,220
EX 100
M v,108,a,248,v,236
EX 101
M v,108,a,252,v,252
s_waitcnt lgkmcnt(1)
RD a,244,1,34624
MC 112,a,224,128,64
RD a,248,1,34688
AD 17,100,101
M v,112,a,228,v,144
EX 104
M v,112,a,232,v,160
EX 105
M v,112,a,236,v,176
RD a,252,1,34752
AD 18,104,105
MC 116,a,224,132,68
EX 98
M v,116,a,228,v,148
EX 102
M v,116,a,232,v,164
EX 106
M v,116,a,236,v,180
DN 4,36,2,3168
MC 120,a,224,136,72
s_add_u32 m0, s92, 132608
s_mov_b32 s2, 393216
M v,120,a,228,v,152
EX 108
M v,120,a,232,v,168
EX 109
M v,120,a,236,v,184
EX 99
MC 124,a,224,140,76
EX 103
M v,124,a,228,v,156
EX 107
M v,124,a,232,v,172
EX 110
M v,124,a,236,v,188
s_waitcnt lgkmcnt(0)
s_waitcnt vmcnt(9)
M v,112,a,240,v,192
s_barrier
TR a,224,0
M v,112,a,244,v,208
TR a,226,512
AD 16,16,98
M v,112,a,248,v,224
TR a,228,32
AD 17,17,102
M v,112,a,252,v,240
TR a,230,544
AD 18,18,106
M v,116,a,240,v,196
TR a,232,64
AD 19,108,109
M v,116,a,244,v,212
TR a,234,576
AD 16,16,99
M v,116,a,248,v,228
TR a,236,96
AD 17,17,103
M v,116,a,252,v,244
TR a,238,608
AD 18,18,107
M v,120,a,240,v,200
DN 4,8,2,0
M v,120,a,244,v,216
EX 111
M v,120,a,248,v,232
EX 112
M v,120,a,252,v,248
EX 116
M v,124,a,240,v,204
TR a,240,128
AD 19,19,110
M v,124,a,244,v,220
TR a,242,640
AD 19,19,111
M v,124,a,248,v,236
TR a,244,160
AD 16,16,112
M v,124,a,252,v,252
s_waitcnt lgkmcnt(3)
TR a,246,672
M a,0,a,224,v,80
TR a,248,192
AD 17,17,116
M a,4,a,224,v,84
EX 120
M a,8,a,224,v,88
TR a,250,704
AD 18,18,120
M a,12,a,224,v,92
EX 113
M a,16,a,228,v,80
TR a,252,224
AD 16,16,113
M a,20,a,228,v,84
DN 4,12,2,1056
M a,24,a,228,v,88
EX 117
M a,28,a,228,v,92
TR a,254,736
AD 17,17,117
M a,32,a,232,v,80
EX 121
M a,36,a,232,v,84
TR a,224,256
AD 18,18,121
M a,40,a,232,v,88
EX 124
M a,44,a,232,v,92
TR a,226,768
AD 19,19,124
M a,48,a,236,v,80
EX 114
M a,52,a,236,v,84
TR a,228,288
AD 16,16,114
M a,56,a,236,v,88
EX 118
M a,60,a,236,v,92
s_waitcnt lgkmcnt(3)
TR a,230,800
M a,64,a,240,v,80
TR a,232,320
AD 17,17,118
M a,68,a,240,v,84
EX 122
M a,72,a,240,v,88
TR a,234,832
AD 18,18,122
M a,76,a,240,v,92
EX 125
M a,80,a,244,v,80
TR a,236,352
AD 19,19,125
M a,84,a,244,v,84
DN 4,16,2,2112
M a,88,a,244,v,88
EX 115
M a,92,a,244,v,92
TR a,238,864
AD 16,16,115
M a,96,a,248,v,80
EX 119
M a,100,a,248,v,84
TR a,240,384
AD 17,17,119
M a,104,a,248,v,88
EX 123
M a,108,a,248,v,92
TR a,242,896
AD 18,18,123
M a,112,a,252,v,80
TR a,244,416
v_max3_f32 v20, v16, v17, v18
M a,116,a,252,v,84
EX 126
M a,120,a,252,v,88
TR a,246,928
AD 19,19,126
M a,124,a,252,v,92
s_waitcnt lgkmcnt(4)
TR a,248,448
M a,128,a,224,v,80
EX 127
M a,132,a,224,v,84
TR a,250,960
AD 19,19,127
M a,136,a,224,v,88
TR a,252,480
v_max_f32 v20, v20, v19
M a,140,a,224,v,92
TR a,254,992
v_cmp_lt_f32 vcc, 0x4b800000, v20
M a,144,a,228,v,80
DN 4,20,2,3168
M a,148,a,228,v,84
s_add_u32 m0, s92, 16896
s_mov_b32 s2, 376832
M a,152,a,228,v,88
M a,156,a,228,v,92
M a,160,a,232,v,80
M a,164,a,232,v,84
M a,168,a,232,v,88
M a,172,a,232,v,92
M a,176,a,236,v,80
M a,180,a,236,v,84
M a,184,a,236,v,88
M a,188,a,236,v,92
s_waitcnt lgkmcnt(0)
s_waitcnt vmcnt(8)
M a,192,a,240,v,80
s_barrier
RD a,224,1,50688
M a,196,a,240,v,84
RD a,228,1,50752
M a,200,a,240,v,88
RD a,232,1,50816
M a,204,a,240,v,92
DN 4,24,2,0
M a,208,a,244,v,80
RD a,236,1,50880
M a,212,a,244,v,84
RD a,240,1,50944
M a,216,a,244,v,88
M a,220,a,244,v,92
RD a,244,1,51008
M v,32,a,248,v,80
M v,36,a,248,v,84
M v,40,a,248,v,88
M v,44,a,248,v,92
RD a,248,1,51072
M v,48,a,252,v,80
CV 80,96
CV 81,98
M v,52,a,252,v,84
CV 84,100
CV 85,102
M v,56,a,252,v,88
s_waitcnt lgkmcnt(3)
CV 88,104
M v,60,a,252,v,92
s_cbranch_vccnz L_rsA20
L_rbA20:
MC 96,a,224,128,64
RD a,252,1,51136
CV 89,106
M v,96,a,228,v,144
CV 92,108
CV 93,110
M v,96,a,232,v,160
DN 4,28,2,1056
M v,96,a,236,v,176
CV 82,112
CV 83,114
MC 100,a,224,132,68
CV 86,116
CV 87,118
M v,100,a,228,v,148
CV 90,120
CV 91,122
M v,100,a,232,v,164
CV 94,124
CV 95,126
M v,100,a,236,v,180
AD 12,12,16
AD 13,13,17
MC 104,a,224,136,72
AD 14,14,18
AD 15,15,19
M v,104,a,228,v,152
M v,104,a,232,v,168
M v,104,a,236,v,184
MC 108,a,224,140,76
RD a,224,1,51200
M v,108,a,228,v,156
RD a,228,1,51264
M v,108,a,232,v,172
RD a,232,1,51328
M v,108,a,236,v,188
s_waitcnt lgkmcnt(3)
RD a,236,1,51392
M v,96,a,240,v,192
M v,96,a,244,v,208
DN 4,32,2,2112
M v,96,a,248,v,224
M v,96,a,252,v,240
M v,100,a,240,v,196
v_xor_b32 v2, 81920, v2
M v,100,a,244,v,212
M v,100,a,248,v,228
M v,100,a,252,v,244
M v,104,a,240,v,200
M v,104,a,244,v,216
M v,104,a,248,v,232
EX 96
M v,104,a,252,v,248
EX 97
M v,108,a,240,v,204
RD a,240,1,51456
AD 16,96,97
M v,108,a,244,v,220
EX 100
M v,108,a,248,v,236
EX 101
M v,108,a,252,v,252
s_waitcnt lgkmcnt(1)
RD a,244,1,51520
MC 112,a,224,128,64
RD a,248,1,51584
AD 17,100,101
M v,112,a,228,v,144
DN 4,36,2,3168
M v,112,a,232,v,160
RD a,252,1,51648
s_add_u32 m0, s92, 33792
M v,112,a,236,v,176
EX 104
MC 116,a,224,132,68
EX 105
M v,116,a,228,v,148
s_mov_b32 s2, 409600
AD 18,104,105
M v,116,a,232,v,164
EX 98
M v,116,a,236,v,180
EX 102
MC 120,a,224,136,72
EX 106
M v,120,a,228,v,152
EX 108
M v,120,a,232,v,168
EX 109
M v,120,a,236,v,184
EX 99
MC 124,a,224,140,76
EX 103
M v,124,a,228,v,156
EX 107
M v,124,a,232,v,172
EX 110
M v,124,a,236,v,188
s_waitcnt lgkmcnt(0)
s_waitcnt vmcnt(8)
M v,112,a,240,v,192
s_barrier
TR a,224,0
M v,112,a,244,v,208
DN 4,8,2,0
M v,112,a,248,v,224
TR a,226,512
AD 16,16,98
M v,112,a,252,v,240
TR a,228,32
AD 17,17,102
M v,116,a,240,v,196
TR a,230,544
AD 18,18,106
M v,116,a,244,v,212
TR a,232,64
AD 19,108,109
M v,116,a,248,v,228
TR a,234,576
AD 16,16,99
M v,116,a,252,v,244
TR a,236,96
AD 17,17,103
M v,120,a,240,v,200
TR a,238,608
AD 18,18,107
M v,120,a,244,v,216
EX 111
M v,120,a,248,v,232
EX 112
M v,120,a,252,v,248
EX 116
M v,124,a,240,v,204
TR a,240,128
AD 19,19,110
M v,124,a,244,v,220
TR a,242,640
AD 19,19,111
M v,124,a,248,v,236
TR a,244,160
AD 16,16,112
M v,124,a,252,v,252
s_waitcnt lgkmcnt(3)
TR a,246,672
M a,0,a,224,v,80
DN 4,12,2,1056
M a,4,a,224,v,84
TR a,248,192
AD 17,17,116
M a,8,a,224,v,88
EX 120
M a,12,a,224,v,92
TR a,250,704
AD 18,18,120
M a,16,a,228,v,80
EX 113
M a,20,a,228,v,84
TR a,252,224
AD 16,16,113
M a,24,a,228,v,88
EX 117
M a,28,a,228,v,92
TR a,254,736
AD 17,17,117
M a,32,a,232,v,80
EX 121
M a,36,a,232,v,84
TR a,224,256
AD 18,18,121
M a,40,a,232,v,88
EX 124
M a,44,a,232,v,92
TR a,226,768
AD 19,19,124
M a,48,a,236,v,80
EX 114
M a,52,a,236,v,84
TR a,228,288
AD 16,16,114
M a,56,a,236,v,88
DN 4,16,2,2112
M a,60,a,236,v,92
s_waitcnt lgkmcnt(3)
TR a,230,800
M a,64,a,240,v,80
EX 118
M a,68,a,240,v,84
TR a,232,320
AD 17,17,118
M a,72,a,240,v,88
EX 122
M a,76,a,240,v,92
TR a,234,832
AD 18,18,122
M a,80,a,244,v,80
TR a,236,352
v_xor_b32 v1, 81920, v1
M a,84,a,244,v,84
EX 125
M a,88,a,244,v,88
TR a,238,864
AD 19,19,125
M a,92,a,244,v,92
EX 115
M a,96,a,248,v,80
TR a,240,384
AD 16,16,115
M a,100,a,248,v,84
EX 119
M a,104,a,248,v,88
TR a,242,896
AD 17,17,119
M a,108,a,248,v,92
EX 123
M a,112,a,252,v,80
TR a,244,416
AD 18,18,123
M a,116,a,252,v,84
DN 4,20,2,3168
M a,120,a,252,v,88
TR a,246,928
s_add_u32 m0, s92, 0
M a,124,a,252,v,92
s_waitcnt lgkmcnt(4)
TR a,248,448
M a,128,a,224,v,80
TR a,250,960
s_mov_b32 s2, 393216
M a,132,a,224,v,84
TR a,252,480
v_max3_f32 v20, v16, v17, v18
M a,136,a,224,v,88
EX 126
M a,140,a,224,v,92
TR a,254,992
AD 19,19,126
M a,144,a,228,v,80
EX 127
M a,148,a,228,v,84
AD 19,19,127
v_max_f32 v20, v20, v19
M a,152,a,228,v,88
v_cmp_lt_f32 vcc, 0x4b800000, v20
M a,156,a,228,v,92
M a,160,a,232,v,80
M a,164,a,232,v,84
M a,168,a,232,v,88
M a,172,a,232,v,92
M a,176,a,236,v,80
M a,180,a,236,v,84
DN 4,24,2,0
M a,184,a,236,v,88
M a,188,a,236,v,92
s_waitcnt lgkmcnt(0)
s_waitcnt vmcnt(9)
M a,192,a,240,v,80
s_barrier
RD a,224,1,50688
M a,196,a,240,v,84
RD a,228,1,50752
M a,200,a,240,v,88
RD a,232,1,50816
M a,204,a,240,v,92
RD a,236,1,50880
M a,208,a,244,v,80
RD a,240,1,50944
M a,212,a,244,v,84
L_pad21:
s_cbranch_execz L_ret21
M a,216,a,244,v,88
M a,220,a,244,v,92
RD a,244,1,51008
M v,32,a,248,v,80
M v,36,a,248,v,84
M v,40,a,248,v,88
M v,44,a,248,v,92
RD a,248,1,51072
M v,48,a,252,v,80
CV 80,96
CV 81,98
M v,52,a,252,v,84
DN 4,28,2,1056
M v,56,a,252,v,88
s_waitcnt lgkmcnt(3)
CV 84,100
M v,60,a,252,v,92
s_cbranch_vccnz L_rsA21
L_rbA21:
MC 96,a,224,128,64
CV 85,102
CV 88,104
M v,96,a,228,v,144
RD a,252,1,51136
CV 89,106
M v,96,a,232,v,160
CV 92,108
CV 93,110
M v,96,a,236,v,176
CV 82,112
CV 83,114
MC 100,a,224,132,68
CV 86,116
CV 87,118
M v,100,a,228,v,148
CV 90,120
CV 91,122
M v,100,a,232,v,164
CV 94,124
CV 95,126
M v,100,a,236,v,180
AD 12,12,16
AD 13,13,17
MC 104,a,224,136,72
AD 14,14,18
AD 15,15,19
M v,104,a,228,v,152
M v,104,a,232,v,168
M v,104,a,236,v,184
DN 4,32,2,2112
MC 108,a,224,140,76
RD a,224,1,51200
M v,108,a,228,v,156
RD a,228,1,51264
M v,108,a,232,v,172
RD a,232,1,51328
M v,108,a,236,v,188
s_waitcnt lgkmcnt(3)
RD a,236,1,51392
M v,96,a,240,v,192
M v,96,a,244,v,208
M v,96,a,248,v,224
M v,96,a,252,v,240
M v,100,a,240,v,196
v_xor_b32 v2, 81920, v2
M v,100,a,244,v,212
M v,100,a,248,v,228
M v,100,a,252,v,244
M v,104,a,240,v,200
M v,104,a,244,v,216
M v,104,a,248,v,232
DN 4,36,2,3168
M v,104,a,252,v,248
s_add_u32 m0, s92, 50688
s_mov_b32 s2, 425984
M v,108,a,240,v,204
EX 96
M v,108,a,244,v,220
EX 97
M v,108,a,248,v,236
RD a,240,1,51456
AD 16,96,97
M v,108,a,252,v,252
s_waitcnt lgkmcnt(1)
RD a,244,1,51520
MC 112,a,224,128,64
EX 100
M v,112,a,228,v,144
EX 101
M v,112,a,232,v,160
RD a,248,1,51584
AD 17,100,101
M v,112,a,236,v,176
EX 104
MC 116,a,224,132,68
EX 105
M v,116,a,228,v,148
RD a,252,1,51648
AD 18,104,105
M v,116,a,232,v,164
EX 98
M v,116,a,236,v,180
EX 102
MC 120,a,224,136,72
EX 106
M v,120,a,228,v,152
DN 4,8,2,0
M v,120,a,232,v,168
EX 108
M v,120,a,236,v,184
EX 109
MC 124,a,224,140,76
EX 99
M v,124,a,228,v,156
EX 103
M v,124,a,232,v,172
EX 107
M v,124,a,236,v,188
s_waitcnt lgkmcnt(0)
s_waitcnt vmcnt(9)
M v,112,a,240,v,192
s_barrier
TR a,224,16896
M v,112,a,244,v,208
TR a,226,17408
AD 16,16,98
M v,112,a,248,v,224
TR a,228,16928
AD 17,17,102
M v,112,a,252,v,240
TR a,230,17440
AD 18,18,106
M v,116,a,240,v,196
TR a,232,16960
AD 19,108,109
M v,116,a,244,v,212
TR a,234,17472
AD 16,16,99
M v,116,a,248,v,228
TR a,236,16992
AD 17,17,103
M v,116,a,252,v,244
TR a,238,17504
AD 18,18,107
M v,120,a,240,v,200
EX 110
M v,120,a,244,v,216
DN 4,12,2,1056
M v,120,a,248,v,232
EX 111
M v,120,a,252,v,248
EX 112
M v,124,a,240,v,204
TR a,240,17024
AD 19,19,110
M v,124,a,244,v,220
TR a,242,17536
AD 19,19,111
M v,124,a,248,v,236
TR a,244,17056
AD 16,16,112
M v,124,a,252,v,252
s_waitcnt lgkmcnt(3)
TR a,246,17568
M a,0,a,224,v,80
TR a,248,17088
v_bfe_u32 v6, v4, 7, 3
M a,4,a,224,v,84
TR a,250,17600
v_mul_u32_u24 v7, 14336, v6
M a,8,a,224,v,88
TR a,252,17120
v_lshlrev_b32 v6, 4, s95
M a,12,a,224,v,92
TR a,254,17632
v_and_b32 v6, 64, v6
M a,16,a,228,v,80
TR a,224,17152
v_xor_b32 v6, v6, v4
M a,20,a,228,v,84
TR a,226,17664
v_xor_b32 v6, 64, v6
M a,24,a,228,v,88
EX 116
M a,28,a,228,v,92
TR a,228,17184
AD 17,17,116
M a,32,a,232,v,80
DN 4,16,2,2112
M a,36,a,232,v,84
TR a,230,17696
v_and_b32 v6, 0x70, v6
M a,40,a,232,v,88
EX 120
M a,44,a,232,v,92
TR a,232,17216
AD 18,18,120
M a,48,a,236,v,80
TR a,234,17728
v_add_u32 v7, v6, v7
M a,52,a,236,v,84
EX 113
M a,56,a,236,v,88
EX 117
M a,60,a,236,v,92
s_waitcnt lgkmcnt(6)
TR a,236,17248
M a,64,a,240,v,80
TR a,238,17760
AD 16,16,113
M a,68,a,240,v,84
EX 121
M a,72,a,240,v,88
EX 124
M a,76,a,240,v,92
TR a,240,17280
AD 17,17,117
M a,80,a,244,v,80
TR a,242,17792
v_xor_b32 v1, 81920, v1
M a,84,a,244,v,84
EX 114
M a,88,a,244,v,88
EX 118
M a,92,a,244,v,92
DN 4,20,2,3168
M a,96,a,248,v,80
TR a,244,17312
s_add_u32 m0, s92, 81920
M a,100,a,248,v,84
TR a,246,17824
s_mov_b32 s2, 409600
M a,104,a,248,v,88
EX 122
M a,108,a,248,v,92
TR a,248,17344
AD 18,18,121
M a,112,a,252,v,80
TR a,250,17856
AD 19,19,124
M a,116,a,252,v,84
EX 125
M a,120,a,252,v,88
EX 115
M a,124,a,252,v,92
s_waitcnt lgkmcnt(6)
TR a,252,17376
M a,128,a,224,v,80
TR a,254,17888
AD 16,16,114
M a,132,a,224,v,84
EX 119
M a,136,a,224,v,88
EX 123
M a,140,a,224,v,92
EX 126
M a,144,a,228,v,80
AD 17,17,118
AD 18,18,122
M a,148,a,228,v,84
AD 19,19,125
AD 16,16,115
M a,152,a,228,v,88
DN 4,24,2,0
M a,156,a,228,v,92
EX 127
M a,160,a,232,v,80
AD 17,17,119
AD 18,18,123
M a,164,a,232,v,84
AD 19,19,126
AD 19,19,127
M a,168,a,232,v,88
v_max3_f32 v20, v16, v17, v18
v_max_f32 v20, v20, v19
M a,172,a,232,v,92
v_cmp_lt_f32 vcc, 0x4b800000, v20
v_bfe_u32 v6, v4, 12, 1
M a,176,a,236,v,80
v_mul_u32_u24 v6, 7168, v6
v_add_u32 v7, v6, v7
M a,180,a,236,v,84
v_lshrrev_b32 v6, 13, v4
v_mul_u32_u24 v6, 3584, v6
M a,184,a,236,v,88
v_add_u32 v7, v6, v7
M a,188,a,236,v,92
s_waitcnt lgkmcnt(0)
s_waitcnt vmcnt(9)
M a,192,a,240,v,80
s_barrier
RD a,224,1,33792
M a,196,a,240,v,84
RD a,228,1,33856
M a,200,a,240,v,88
RD a,232,1,33920
M a,204,a,240,v,92
RD a,236,1,33984
M a,208,a,244,v,80
RD a,240,1,34048
M a,212,a,244,v,84
DN 4,28,2,1056
M a,216,a,244,v,88
M a,220,a,244,v,92
RD a,244,1,34112
M v,32,a,248,v,80
M v,36,a,248,v,84
M v,40,a,248,v,88
M v,44,a,248,v,92
RD a,248,1,34176
M v,48,a,252,v,80
CV 80,96
CV 81,98
M v,52,a,252,v,84
CV 84,100
CV 85,102
M v,56,a,252,v,88
s_waitcnt lgkmcnt(3)
CV 88,104
M v,60,a,252,v,92
s_cbranch_vccnz L_rsA22
L_rbA22:
MC 96,a,224,128,64
RD a,252,1,34240
CV 89,106
M v,96,a,228,v,144
CV 92,108
CV 93,110
M v,96,a,232,v,160
CV 82,112
CV 83,114
M v,96,a,236,v,176
CV 86,116
CV 87,118
MC 100,a,224,132,68
CV 90,120
CV 91,122
M v,100,a,228,v,148
DN 4,32,2,2112
M v,100,a,232,v,164
CV 94,124
CV 95,126
M v,100,a,236,v,180
AD 12,12,16
AD 13,13,17
MC 104,a,224,136,72
AD 14,14,18
AD 15,15,19
M v,104,a,228,v,152
M v,104,a,232,v,168
M v,104,a,236,v,184
MC 108,a,224,140,76
RD a,224,1,34304
M v,108,a,228,v,156
RD a,228,1,34368
M v,108,a,232,v,172
RD a,232,1,34432
M v,108,a,236,v,188
s_waitcnt lgkmcnt(3)
RD a,236,1,34496
M v,96,a,240,v,192
M v,96,a,244,v,208
M v,96,a,248,v,224
M v,96,a,252,v,240
M v,100,a,240,v,196
DN 4,36,2,3168
M v,100,a,244,v,212
s_add_u32 m0, s92, 132608
s_mov_b32 s2, 442368
M v,100,a,248,v,228
M v,100,a,252,v,244
M v,104,a,240,v,200
EX 96
M v,104,a,244,v,216
EX 97
M v,104,a,248,v,232
EX 98
M v,104,a,252,v,248
AD 16,96,97
AD 16,16,98
M v,108,a,240,v,204
EX 100
M v,108,a,244,v,220
EX 101
M v,108,a,248,v,236
RD a,240,1,34560
AD 17,100,101
M v,108,a,252,v,252
s_waitcnt lgkmcnt(1)
RD a,244,1,34624
MC 112,a,224,128,64
EX 104
M v,112,a,228,v,144
EX 105
M v,112,a,232,v,160
RD a,248,1,34688
AD 18,104,105
M v,112,a,236,v,176
DN 4,8,2,0
MC 116,a,224,132,68
EX 102
M v,116,a,228,v,148
RD a,252,1,34752
AD 17,17,102
M v,116,a,232,v,164
EX 106
M v,116,a,236,v,180
EX 108
MC 120,a,224,136,72
EX 109
M v,120,a,228,v,152
EX 99
M v,120,a,232,v,168
EX 103
M v,120,a,236,v,184
EX 107
MC 124,a,224,140,76
EX 110
M v,124,a,228,v,156
AD 18,18,106
AD 19,108,109
M v,124,a,232,v,172
EX 111
M v,124,a,236,v,188
s_waitcnt lgkmcnt(0)
s_waitcnt vmcnt(9)
M v,112,a,240,v,192
s_barrier
TR a,224,0
M v,112,a,244,v,208
TR a,226,512
AD 16,16,99
M v,112,a,248,v,224
DN 4,12,2,1056
M v,112,a,252,v,240
TR a,228,32
AD 17,17,103
M v,116,a,240,v,196
TR a,230,544
AD 18,18,107
M v,116,a,244,v,212
TR a,232,64
AD 19,19,110
M v,116,a,248,v,228
TR a,234,576
AD 19,19,111
M v,116,a,252,v,244
TR a,236,96
M v,120,a,240,v,200
TR a,238,608
M v,120,a,244,v,216
EX 112
M v,120,a,248,v,232
EX 113
M v,120,a,252,v,248
EX 116
M v,124,a,240,v,204
TR a,240,128
AD 16,16,112
M v,124,a,244,v,220
TR a,242,640
AD 17,17,116
M v,124,a,248,v,236
TR a,244,160
AD 16,16,113
M v,124,a,252,v,252
s_waitcnt lgkmcnt(3)
TR a,246,672
M a,0,a,224,v,80
EX 120
M a,4,a,224,v,84
DN 4,16,2,2112
M a,8,a,224,v,88
TR a,248,192
AD 18,18,120
M a,12,a,224,v,92
EX 117
M a,16,a,228,v,80
TR a,250,704
AD 17,17,117
M a,20,a,228,v,84
EX 121
M a,24,a,228,v,88
TR a,252,224
AD 18,18,121
M a,28,a,228,v,92
TR a,254,736
M a,32,a,232,v,80
EX 124
M a,36,a,232,v,84
TR a,224,256
AD 19,19,124
M a,40,a,232,v,88
EX 114
M a,44,a,232,v,92
TR a,226,768
AD 16,16,114
M a,48,a,236,v,80
TR a,228,288
v_bfe_u32 v8, v4, 8, 2
M a,52,a,236,v,84
TR a,230,800
v_lshrrev_b32 v9, 14, s95
M a,56,a,236,v,88
TR a,232,320
v_add_lshl_u32 v8, v8, v9, 7
M a,60,a,236,v,92
s_waitcnt lgkmcnt(5)
TR a,234,832
M a,64,a,240,v,80
TR a,236,352
v_mov_b32 v9, 0
M a,68,a,240,v,84
DN 4,20,2,3168
M a,72,a,240,v,88
TR a,238,864
s_add_u32 m0, s92, 16896
M a,76,a,240,v,92
s_getpc_b64 s[100:101]
s_add_u32 s100, s100, L_c3A-.
s_addc_u32 s101, s101, 0
M a,80,a,244,v,80
v_lshl_add_u64 v[8:9], v[8:9], 0, s[100:101]
s_mov_b32 s2, 425984
M a,84,a,244,v,84
global_load_dword v10, v[8:9], off
M a,88,a,244,v,88
EX 118
M a,92,a,244,v,92
TR a,240,384
AD 17,17,118
M a,96,a,248,v,80
EX 122
M a,100,a,248,v,84
TR a,242,896
AD 18,18,122
M a,104,a,248,v,88
EX 125
M a,108,a,248,v,92
TR a,244,416
AD 19,19,125
M a,112,a,252,v,80
EX 115
M a,116,a,252,v,84
TR a,246,928
AD 16,16,115
M a,120,a,252,v,88
EX 119
M a,124,a,252,v,92
s_waitcnt lgkmcnt(4)
TR a,248,448
M a,128,a,224,v,80
DN 4,24,2,0
M a,132,a,224,v,84
TR a,250,960
AD 17,17,119
M a,136,a,224,v,88
EX 123
M a,140,a,224,v,92
TR a,252,480
AD 18,18,123
M a,144,a,228,v,80
TR a,254,992
v_max3_f32 v20, v16, v17, v18
M a,148,a,228,v,84
EX 126
M a,152,a,228,v,88
EX 127
M a,156,a,228,v,92
AD 19,19,126
AD 19,19,127
M a,160,a,232,v,80
v_max_f32 v20, v20, v19
v_cmp_lt_f32 vcc, 0x4b800000, v20
M a,164,a,232,v,84
M a,168,a,232,v,88
M a,172,a,232,v,92
M a,176,a,236,v,80
M a,180,a,236,v,84
M a,184,a,236,v,88
M a,188,a,236,v,92
s_waitcnt lgkmcnt(0)
s_waitcnt vmcnt(10)
M a,192,a,240,v,80
s_barrier
RD a,224,1,50688
M a,196,a,240,v,84
DN 4,28,2,1056
M a,200,a,240,v,88
RD a,228,1,50752
M a,204,a,240,v,92
RD a,232,1,50816
M a,208,a,244,v,80
RD a,236,1,50880
M a,212,a,244,v,84
RD a,240,1,50944
M a,216,a,244,v,88
L_pad22:
s_cbranch_execz L_ret22
M a,220,a,244,v,92
RD a,244,1,51008
M v,32,a,248,v,80
M v,36,a,248,v,84
M v,40,a,248,v,88
M v,44,a,248,v,92
RD a,248,1,51072
M v,48,a,252,v,80
CV 80,96
CV 81,98
M v,52,a,252,v,84
CV 84,100
CV 85,102
M v,56,a,252,v,88
s_waitcnt lgkmcnt(3)
CV 88,104
M v,60,a,252,v,92
s_cbranch_vccnz L_rsA23
L_rbA23:
MC 96,a,224,128,64
DN 4,32,2,2112
M v,96,a,228,v,144
RD a,252,1,51136
CV 89,106
M v,96,a,232,v,160
CV 92,108
CV 93,110
M v,96,a,236,v,176
CV 82,112
CV 83,114
MC 100,a,224,132,68
CV 86,116
CV 87,118
M v,100,a,228,v,148
CV 90,120
CV 91,122
M v,100,a,232,v,164
CV 94,124
CV 95,126
M v,100,a,236,v,180
AD 12,12,16
AD 13,13,17
MC 104,a,224,136,72
AD 14,14,18
AD 15,15,19
M v,104,a,228,v,152
M v,104,a,232,v,168
M v,104,a,236,v,184
MC 108,a,224,140,76
RD a,224,1,51200
M v,108,a,228,v,156
DN 4,36,2,3168
M v,108,a,232,v,172
RD a,228,1,51264
s_add_u32 m0, s92, 33792
M v,108,a,236,v,188
s_waitcnt lgkmcnt(2)
RD a,232,1,51328
M v,96,a,240,v,192
RD a,236,1,51392
s_mov_b32 s2, 458752
M v,96,a,244,v,208
M v,96,a,248,v,224
M v,96,a,252,v,240
M v,100,a,240,v,196
v_xor_b32 v2, 81920, v2
M v,100,a,244,v,212
M v,100,a,248,v,228
M v,100,a,252,v,244
M v,104,a,240,v,200
M v,104,a,244,v,216
M v,104,a,248,v,232
EX 96
M v,104,a,252,v,248
EX 97
M v,108,a,240,v,204
RD a,240,1,51456
AD 16,96,97
M v,108,a,244,v,220
DN 4,8,2,0
M v,108,a,248,v,236
EX 100
M v,108,a,252,v,252
s_waitcnt lgkmcnt(1)
RD a,244,1,51520
MC 112,a,224,128,64
EX 101
M v,112,a,228,v,144
RD a,248,1,51584
AD 17,100,101
M v,112,a,232,v,160
EX 104
M v,112,a,236,v,176
EX 105
MC 116,a,224,132,68
RD a,252,1,51648
AD 18,104,105
M v,116,a,228,v,148
EX 98
M v,116,a,232,v,164
EX 102
M v,116,a,236,v,180
EX 106
MC 120,a,224,136,72
EX 108
M v,120,a,228,v,152
EX 109
M v,120,a,232,v,168
EX 99
M v,120,a,236,v,184
EX 103
MC 124,a,224,140,76
DN 4,12,2,1056
M v,124,a,228,v,156
EX 107
M v,124,a,232,v,172
EX 110
M v,124,a,236,v,188
s_waitcnt lgkmcnt(0)
s_waitcnt vmcnt(11)
M v,112,a,240,v,192
s_barrier
TR a,224,0
M v,112,a,244,v,208
TR a,226,512
AD 16,16,98
M v,112,a,248,v,224
TR a,228,32
AD 17,17,102
M v,112,a,252,v,240
TR a,230,544
AD 18,18,106
M v,116,a,240,v,196
TR a,232,64
AD 19,108,109
M v,116,a,244,v,212
TR a,234,576
AD 16,16,99
M v,116,a,248,v,228
TR a,236,96
AD 17,17,103
M v,116,a,252,v,244
TR a,238,608
AD 18,18,107
M v,120,a,240,v,200
EX 111
M v,120,a,244,v,216
EX 112
M v,120,a,248,v,232
AD 19,19,110
AD 19,19,111
M v,120,a,252,v,248
DN 4,16,2,2112
M v,124,a,240,v,204
TR a,240,128
AD 16,16,112
M v,124,a,244,v,220
EX 116
M v,124,a,248,v,236
TR a,242,640
AD 17,17,116
M v,124,a,252,v,252
s_waitcnt lgkmcnt(2)
TR a,244,160
M a,0,a,224,v,80
EX 120
M a,4,a,224,v,84
TR a,246,672
AD 18,18,120
M a,8,a,224,v,88
EX 113
M a,12,a,224,v,92
TR a,248,192
AD 16,16,113
M a,16,a,228,v,80
EX 117
M a,20,a,228,v,84
TR a,250,704
AD 17,17,117
M a,24,a,228,v,88
EX 121
M a,28,a,228,v,92
TR a,252,224
AD 18,18,121
M a,32,a,232,v,80
TR a,254,736
M a,36,a,232,v,84
EX 124
M a,40,a,232,v,88
DN 4,20,2,3168
M a,44,a,232,v,92
TR a,224,256
s_add_u32 m0, s92, 0
M a,48,a,236,v,80
TR a,226,768
s_mov_b32 s2, 442368
M a,52,a,236,v,84
TR a,228,288
AD 19,19,124
M a,56,a,236,v,88
EX 114
M a,60,a,236,v,92
s_waitcnt lgkmcnt(3)
TR a,230,800
M a,64,a,240,v,80
TR a,232,320
AD 16,16,114
M a,68,a,240,v,84
EX 118
M a,72,a,240,v,88
TR a,234,832
AD 17,17,118
M a,76,a,240,v,92
EX 122
M a,80,a,244,v,80
TR a,236,352
v_xor_b32 v1, 81920, v1
M a,84,a,244,v,84
TR a,238,864
AD 18,18,122
M a,88,a,244,v,88
EX 125
M a,92,a,244,v,92
TR a,240,384
AD 19,19,125
M a,96,a,248,v,80
EX 115
M a,100,a,248,v,84
DN 4,24,2,0
M a,104,a,248,v,88
TR a,242,896
AD 16,16,115
M a,108,a,248,v,92
EX 119
M a,112,a,252,v,80
TR a,244,416
AD 17,17,119
M a,116,a,252,v,84
EX 123
M a,120,a,252,v,88
TR a,246,928
AD 18,18,123
M a,124,a,252,v,92
s_waitcnt lgkmcnt(4)
TR a,248,448
M a,128,a,224,v,80
TR a,250,960
v_max3_f32 v20, v16, v17, v18
M a,132,a,224,v,84
EX 126
M a,136,a,224,v,88
TR a,252,480
AD 19,19,126
M a,140,a,224,v,92
EX 127
M a,144,a,228,v,80
TR a,254,992
AD 19,19,127
M a,148,a,228,v,84
v_max_f32 v20, v20, v19
v_cmp_lt_f32 vcc, 0x4b800000, v20
M a,152,a,228,v,88
M a,156,a,228,v,92
M a,160,a,232,v,80
M a,164,a,232,v,84
DN 4,28,2,1056
M a,168,a,232,v,88
M a,172,a,232,v,92
M a,176,a,236,v,80
M a,180,a,236,v,84
M a,184,a,236,v,88
M a,188,a,236,v,92
s_waitcnt lgkmcnt(0)
s_waitcnt vmcnt(11)
M a,192,a,240,v,80
s_barrier
RD a,224,1,50688
M a,196,a,240,v,84
RD a,228,1,50752
M a,200,a,240,v,88
RD a,232,1,50816
M a,204,a,240,v,92
RD a,236,1,50880
M a,208,a,244,v,80
RD a,240,1,50944
M a,212,a,244,v,84
M a,216,a,244,v,88
M a,220,a,244,v,92
RD a,244,1,51008
M v,32,a,248,v,80
DN 4,32,2,2112
M v,36,a,248,v,84
M v,40,a,248,v,88
M v,44,a,248,v,92
RD a,248,1,51072
M v,48,a,252,v,80
CV 80,96
CV 81,98
M v,52,a,252,v,84
CV 84,100
CV 85,102
M v,56,a,252,v,88
s_waitcnt lgkmcnt(3)
CV 88,104
M v,60,a,252,v,92
s_cbranch_vccnz L_rsA24
L_rbA24:
MC 96,a,224,128,64
RD a,252,1,51136
CV 89,106
M v,96,a,228,v,144
CV 92,108
CV 93,110
M v,96,a,232,v,160
CV 82,112
CV 83,114
M v,96,a,236,v,176
CV 86,116
CV 87,118
MC 100,a,224,132,68
CV 90,120
CV 91,122
M v,100,a,228,v,148
CV 94,124
CV 95,126
M v,100,a,232,v,164
AD 12,12,16
AD 13,13,17
M v,100,a,236,v,180
DN 4,36,2,3168
MC 104,a,224,136,72
s_add_u32 m0, s92, 50688
s_mov_b32 s2, 475136
M v,104,a,228,v,152
AD 14,14,18
AD 15,15,19
M v,104,a,232,v,168
M v,104,a,236,v,184
MC 108,a,224,140,76
RD a,224,1,51200
M v,108,a,228,v,156
RD a,228,1,51264
M v,108,a,232,v,172
RD a,232,1,51328
M v,108,a,236,v,188
s_waitcnt lgkmcnt(3)
RD a,236,1,51392
M v,96,a,240,v,192
M v,96,a,244,v,208
M v,96,a,248,v,224
M v,96,a,252,v,240
M v,100,a,240,v,196
v_xor_b32 v2, 81920, v2
M v,100,a,244,v,212
M v,100,a,248,v,228
DN 4,8,2,0
M v,100,a,252,v,244
M v,104,a,240,v,200
M v,104,a,244,v,216
EX 96
M v,104,a,248,v,232
EX 97
M v,104,a,252,v,248
EX 98
M v,108,a,240,v,204
RD a,240,1,51456
AD 16,96,97
M v,108,a,244,v,220
RD a,244,1,51520
AD 16,16,98
M v,108,a,248,v,236
EX 100
M v,108,a,252,v,252
s_waitcnt lgkmcnt(2)
RD a,248,1,51584
MC 112,a,224,128,64
EX 101
M v,112,a,228,v,144
RD a,252,1,51648
AD 17,100,101
M v,112,a,232,v,160
EX 104
M v,112,a,236,v,176
EX 105
MC 116,a,224,132,68
EX 102
M v,116,a,228,v,148
DN 4,12,2,1056
M v,116,a,232,v,164
EX 106
M v,116,a,236,v,180
EX 108
MC 120,a,224,136,72
EX 109
M v,120,a,228,v,152
AD 18,104,105
AD 17,17,102
M v,120,a,232,v,168
EX 99
M v,120,a,236,v,184
EX 103
MC 124,a,224,140,76
EX 107
M v,124,a,228,v,156
EX 110
M v,124,a,232,v,172
AD 18,18,106
AD 19,108,109
M v,124,a,236,v,188
s_waitcnt lgkmcnt(0)
s_waitcnt vmcnt(10)
M v,112,a,240,v,192
s_barrier
TR a,224,16896
M v,112,a,244,v,208
TR a,226,17408
AD 16,16,99
M v,112,a,248,v,224
TR a,228,16928
AD 17,17,103
M v,112,a,252,v,240
TR a,230,17440
AD 18,18,107
M v,116,a,240,v,196
TR a,232,16960
AD 19,19,110
M v,116,a,244,v,212
DN 4,16,2,2112
M v,116,a,248,v,228
EX 111
M v,116,a,252,v,244
TR a,234,17472
AD 19,19,111
M v,120,a,240,v,200
TR a,236,16992
M v,120,a,244,v,216
TR a,238,17504
M v,120,a,248,v,232
EX 112
M v,120,a,252,v,248
EX 116
M v,124,a,240,v,204
TR a,240,17024
AD 16,16,112
M v,124,a,244,v,220
TR a,242,17536
AD 17,17,116
M v,124,a,248,v,236
EX 120
M v,124,a,252,v,252
s_waitcnt lgkmcnt(2)
TR a,244,17056
M a,0,a,224,v,80
TR a,246,17568
AD 18,18,120
M a,4,a,224,v,84
EX 113
M a,8,a,224,v,88
TR a,248,17088
AD 16,16,113
M a,12,a,224,v,92
EX 117
M a,16,a,228,v,80
TR a,250,17600
AD 17,17,117
M a,20,a,228,v,84
DN 4,20,2,3168
M a,24,a,228,v,88
TR a,252,17120
s_add_u32 m0, s92, 81920
M a,28,a,228,v,92
TR a,254,17632
s_mov_b32 s2, 458752
M a,32,a,232,v,80
EX 121
M a,36,a,232,v,84
TR a,224,17152
AD 18,18,121
M a,40,a,232,v,88
EX 124
M a,44,a,232,v,92
TR a,226,17664
AD 19,19,124
M a,48,a,236,v,80
EX 114
M a,52,a,236,v,84
TR a,228,17184
AD 16,16,114
M a,56,a,236,v,88
EX 118
M a,60,a,236,v,92
s_waitcnt lgkmcnt(3)
TR a,230,17696
M a,64,a,240,v,80
TR a,232,17216
AD 17,17,118
M a,68,a,240,v,84
EX 122
M a,72,a,240,v,88
TR a,234,17728
AD 18,18,122
M a,76,a,240,v,92
DN 4,24,2,0
M a,80,a,244,v,80
TR a,236,17248
v_xor_b32 v1, 81920, v1
M a,84,a,244,v,84
EX 125
M a,88,a,244,v,88
TR a,238,17760
AD 19,19,125
M a,92,a,244,v,92
EX 115
M a,96,a,248,v,80
TR a,240,17280
AD 16,16,115
M a,100,a,248,v,84
EX 119
M a,104,a,248,v,88
TR a,242,17792
AD 17,17,119
M a,108,a,248,v,92
EX 123
M a,112,a,252,v,80
TR a,244,17312
AD 18,18,123
M a,116,a,252,v,84
TR a,246,17824
v_max3_f32 v20, v16, v17, v18
M a,120,a,252,v,88
EX 126
M a,124,a,252,v,92
s_waitcnt lgkmcnt(4)
TR a,248,17344
M a,128,a,224,v,80
TR a,250,17856
AD 19,19,126
M a,132,a,224,v,84
EX 127
M a,136,a,224,v,88
DN 4,28,2,1056
M a,140,a,224,v,92
TR a,252,17376
AD 19,19,127
M a,144,a,228,v,80
TR a,254,17888
v_max_f32 v20, v20, v19
M a,148,a,228,v,84
v_cmp_lt_f32 vcc, 0x4b800000, v20
M a,152,a,228,v,88
M a,156,a,228,v,92
M a,160,a,232,v,80
M a,164,a,232,v,84
M a,168,a,232,v,88
M a,172,a,232,v,92
M a,176,a,236,v,80
M a,180,a,236,v,84
M a,184,a,236,v,88
M a,188,a,236,v,92
s_waitcnt lgkmcnt(0)
s_waitcnt vmcnt(10)
M a,192,a,240,v,80
s_barrier
RD a,224,1,33792
M a,196,a,240,v,84
DN 4,32,2,2112
M a,200,a,240,v,88
RD a,228,1,33856
M a,204,a,240,v,92
RD a,232,1,33920
M a,208,a,244,v,80
RD a,236,1,33984
M a,212,a,244,v,84
RD a,240,1,34048
M a,216,a,244,v,88
M a,220,a,244,v,92
RD a,244,1,34112
M v,32,a,248,v,80
M v,36,a,248,v,84
M v,40,a,248,v,88
M v,44,a,248,v,92
RD a,248,1,34176
M v,48,a,252,v,80
CV 80,96
CV 81,98
M v,52,a,252,v,84
CV 84,100
CV 85,102
M v,56,a,252,v,88
s_waitcnt lgkmcnt(3)
CV 88,104
L_pad23:
s_cbranch_execz L_ret23
M v,60,a,252,v,92
s_cbranch_vccnz L_rsA25
L_rbA25:
MC 96,a,224,128,64
RD a,252,1,34240
CV 89,106
M v,96,a,228,v,144
DN 4,36,2,3168
M v,96,a,232,v,160
CV 92,108
CV 93,110
M v,96,a,236,v,176
s_add_u32 m0, s92, 132608
s_mov_b32 s2, 491520
MC 100,a,224,132,68
CV 82,112
CV 83,114
M v,100,a,228,v,148
CV 86,116
CV 87,118
M v,100,a,232,v,164
CV 90,120
CV 91,122
M v,100,a,236,v,180
CV 94,124
CV 95,126
MC 104,a,224,136,72
AD 12,12,16
AD 13,13,17
M v,104,a,228,v,152
s_branch L_c3A
L_rsB15:
s_mov_b32 s100, 278528
s_call_b64 s[98:99], L_rareB
s_branch L_rbB15
L_rsB16:
s_mov_b32 s100, 294912
s_call_b64 s[98:99], L_rareB
s_branch L_rbB16
L_rsB17:
s_mov_b32 s100, 311296
s_call_b64 s[98:99], L_rareB
s_branch L_rbB17
L_rsB18:
s_mov_b32 s100, 327680
s_call_b64 s[98:99], L_rareB
s_branch L_rbB18
L_rsB19:
s_mov_b32 s100, 344064
s_call_b64 s[98:99], L_rareB
s_branch L_rbB19
L_rsB20:
s_mov_b32 s100, 360448
s_call_b64 s[98:99], L_rareB
s_branch L_rbB20
L_rsB21:
s_mov_b32 s100, 376832
s_call_b64 s[98:99], L_rareB
s_branch L_rbB21
L_rsB22:
s_mov_b32 s100, 393216
s_call_b64 s[98:99], L_rareB
s_branch L_rbB22
L_rsB23:
s_mov_b32 s100, 409600
s_call_b64 s[98:99], L_rareB
s_branch L_rbB23
L_rsB24:
s_mov_b32 s100, 425984
s_call_b64 s[98:99], L_rareB
s_branch L_rbB24
L_rsB25:
s_mov_b32 s100, 442368
s_call_b64 s[98:99], L_rareB
s_branch L_rbB25
.p2align 12
L_c2B:
M a,4,v,44,v,108
TW v,62,904
M a,8,v,32,v,112
DL 6,40,93,0
M a,8,v,36,v,116
v_permlane32_swap_b32 v28, v30
M a,8,v,40,v,120
v_permlane32_swap_b32 v29, v31
M a,8,v,44,v,124
s_waitcnt lgkmcnt(0)
TW v,32,64
M a,16,v,48,v,64
DL 6,44,93,1032
M a,16,v,52,v,68
TW v,34,192
M a,16,v,56,v,72
TW v,36,320
M a,16,v,60,v,76
TW v,38,448
M a,20,v,48,v,96
TW v,40,576
M a,20,v,52,v,100
TW v,42,704
M a,20,v,56,v,104
TW v,44,832
TW v,46,960
M a,20,v,60,v,108
DL 6,48,93,2112
M a,24,v,48,v,112
TW v,48,72
M a,24,v,52,v,116
TW v,50,200
M a,24,v,56,v,120
s_waitcnt vmcnt(12)
TW v,52,328
M a,24,v,60,v,124
s_waitcnt lgkmcnt(3)
TW v,54,456
M a,32,v,32,v,64
s_waitcnt vmcnt(11)
TW v,56,584
M a,32,v,36,v,68
TW v,58,712
v_cmp_ne_u32 vcc, 1, v8
M a,32,v,40,v,72
DL 6,52,93,3144
M a,32,v,44,v,76
TW v,60,840
M a,36,v,32,v,96
TW v,62,968
M a,36,v,36,v,100
s_cbranch_vccz L_sbB0
s_mov_b32 s97, 0x40000
L_sqB0:
v_mov_b32 v8, 0
global_load_dword v8, v8, s[0:1] sc1
s_waitcnt vmcnt(0)
v_cmp_ne_u32 vcc, 1, v8
s_sub_u32 s97, s97, 1
s_cbranch_scc1 L_sbB0
s_cbranch_vccnz L_sqB0
L_sbB0:
M a,36,v,40,v,104
RD v,224,3,16896
M a,36,v,44,v,108
RD v,240,3,16960
M a,40,v,32,v,112
RD v,228,3,17408
M a,40,v,36,v,116
RD v,244,3,17472
M a,40,v,40,v,120
RD v,232,3,33792
M a,40,v,44,v,124
s_waitcnt lgkmcnt(5)
s_waitcnt vmcnt(8)
M a,48,v,48,v,64
s_barrier
RD v,248,3,33856
M a,48,v,52,v,68
TW v,32,50688
s_add_u32 m0, s92, 0
M a,48,v,56,v,72
TW v,34,50816
s_mov_b32 s2, 262144
M a,48,v,60,v,76
TW v,36,50944
M a,52,v,48,v,96
TW v,38,51072
M a,52,v,52,v,100
TW v,40,50696
M a,52,v,56,v,104
TW v,42,50824
TW v,44,50952
M a,52,v,60,v,108
TW v,46,51080
M a,56,v,48,v,112
DN 4,8,2,0
M a,56,v,52,v,116
TW v,48,50752
M a,56,v,56,v,120
TW v,50,50880
M a,56,v,60,v,124
s_waitcnt lgkmcnt(2)
TW v,52,51008
M a,0,v,32,v,224
TW v,54,51136
s_add_u32 m0, s92, 16896
TW v,56,50760
M a,0,v,36,v,240
TW v,58,50888
s_mov_b32 s93, 2622208
TW v,60,51016
M a,4,v,32,v,228
TW v,62,51144
M a,4,v,36,v,244
DL 5,40,93,0
s_add_u32 m0, s92, 0
M a,8,v,32,v,232
TW v,32,51200
AR 20,0
AR 21,1
M a,8,v,36,v,248
TW v,34,51328
AR 24,4
AR 25,5
M a,16,v,40,v,224
DN 4,12,2,1056
TW v,36,51456
M a,16,v,44,v,240
TW v,38,51584
s_add_u32 m0, s92, 16896
AR 26,6
M a,20,v,40,v,228
AR 27,7
v_mul_f32 v24, 0x3db8aa3b, v24
v_mul_f32 v25, 0x3db8aa3b, v25
M a,20,v,44,v,244
v_mul_f32 v26, 0x3db8aa3b, v26
v_mul_f32 v27, 0x3db8aa3b, v27
CV 132,24
M a,24,v,40,v,232
TW v,40,51208
CV 133,26
AR 22,2
M a,24,v,44,v,248
s_waitcnt lgkmcnt(5)
TW v,42,51336
AR 23,3
M a,32,v,48,v,224
TW v,44,51464
AR 24,16
AR 25,17
M a,32,v,52,v,240
TW v,46,51592
AR 26,18
AR 27,19
M a,36,v,48,v,228
DL 5,44,93,1032
s_add_u32 m0, s92, 0
M a,36,v,52,v,244
v_mul_f32 v20, 0x3db8aa3b, v20
v_mul_f32 v21, 0x3db8aa3b, v21
v_mul_f32 v22, 0x3db8aa3b, v22
M a,40,v,48,v,232
TW v,48,51264
v_mul_f32 v23, 0x3db8aa3b, v23
v_mul_f32 v24, 0x3db8aa3b, v24
M a,40,v,52,v,248
TW v,50,51392
v_mul_f32 v25, 0x3db8aa3b, v25
v_mul_f32 v26, 0x3db8aa3b, v26
M a,48,v,56,v,224
TW v,52,51520
v_mul_f32 v27, 0x3db8aa3b, v27
CV 128,20
M a,48,v,60,v,240
TW v,54,51648
CV 129,22
CV 130,24
M a,52,v,56,v,228
CV 131,26
AR 20,8
AR 21,9
M a,52,v,60,v,244
DN 4,16,2,2112
s_add_u32 m0, s92, 16896
M a,56,v,56,v,232
TW v,56,51272
AR 22,10
AR 23,11
M a,56,v,60,v,248
s_waitcnt lgkmcnt(5)
TW v,58,51400
AR 24,24
M a,64,v,32,v,224
TW v,60,51528
AR 25,25
AR 26,26
M a,64,v,36,v,240
TW v,62,51656
v_xor_b32 v11, 81920, v11
AR 27,27
M a,68,v,32,v,228
DL 5,48,93,2112
s_add_u32 m0, s92, 0
M a,68,v,36,v,244
v_mul_f32 v20, 0x3db8aa3b, v20
v_mul_f32 v21, 0x3db8aa3b, v21
v_mul_f32 v22, 0x3db8aa3b, v22
M a,72,v,32,v,232
v_mul_f32 v23, 0x3db8aa3b, v23
v_mul_f32 v24, 0x3db8aa3b, v24
v_mul_f32 v25, 0x3db8aa3b, v25
M a,72,v,36,v,248
v_mul_f32 v26, 0x3db8aa3b, v26
v_mul_f32 v27, 0x3db8aa3b, v27
CV 136,20
M a,80,v,40,v,224
CV 137,22
CV 138,24
CV 139,26
M a,80,v,44,v,240
AR 20,20
AR 21,21
AR 22,22
M a,84,v,40,v,228
AR 23,23
AR 24,36
AR 25,37
M a,84,v,44,v,244
AR 26,38
AR 27,39
v_mul_f32 v20, 0x3db8aa3b, v20
M a,88,v,40,v,232
v_mul_f32 v21, 0x3db8aa3b, v21
v_mul_f32 v22, 0x3db8aa3b, v22
v_mul_f32 v23, 0x3db8aa3b, v23
M a,88,v,44,v,248
s_waitcnt lgkmcnt(0)
s_waitcnt vmcnt(10)
s_mov_b64 exec, 0
s_branch L_pad16
L_ret16:
s_mov_b64 exec, -1
s_barrier
M a,96,v,48,v,224
TW v,32,0
v_mul_f32 v24, 0x3db8aa3b, v24
v_mul_f32 v25, 0x3db8aa3b, v25
M a,96,v,52,v,240
TW v,34,128
v_mul_f32 v26, 0x3db8aa3b, v26
v_mul_f32 v27, 0x3db8aa3b, v27
M a,100,v,48,v,228
TW v,36,256
CV 134,20
CV 135,22
M a,100,v,52,v,244
TW v,38,384
CV 148,24
CV 149,26
M a,104,v,48,v,232
TW v,40,512
AR 20,32
AR 21,33
M a,104,v,52,v,248
TW v,42,640
AR 22,34
AR 23,35
M a,112,v,56,v,224
TW v,44,768
TW v,46,896
AR 24,48
M a,112,v,60,v,240
DN 4,20,2,3168
s_add_u32 m0, s92, 16896
M a,116,v,56,v,228
DL 5,52,93,3144
TW v,48,8
M a,116,v,60,v,244
TW v,50,136
s_add_u32 m0, s92, 33792
TW v,52,264
M a,120,v,56,v,232
TW v,54,392
s_mov_b32 s93, 2622336
TW v,56,520
M a,120,v,60,v,248
s_waitcnt lgkmcnt(5)
TW v,58,648
s_mov_b32 s2, 278528
M a,64,v,32,v,64
TW v,60,776
AR 25,49
AR 26,50
M a,64,v,36,v,68
TW v,62,904
AR 27,51
v_mul_f32 v20, 0x3db8aa3b, v20
M a,64,v,40,v,72
DL 5,40,93,0
s_add_u32 m0, s92, 50688
M a,64,v,44,v,76
v_mul_f32 v21, 0x3db8aa3b, v21
v_mul_f32 v22, 0x3db8aa3b, v22
v_mul_f32 v23, 0x3db8aa3b, v23
M a,68,v,32,v,96
v_mul_f32 v24, 0x3db8aa3b, v24
v_mul_f32 v25, 0x3db8aa3b, v25
v_mul_f32 v26, 0x3db8aa3b, v26
M a,68,v,36,v,100
v_mul_f32 v27, 0x3db8aa3b, v27
CV 144,20
CV 145,22
M a,68,v,40,v,104
DN 4,8,2,0
s_add_u32 m0, s92, 33792
M a,68,v,44,v,108
CV 146,24
CV 147,26
AR 20,40
M a,72,v,32,v,112
TW v,32,64
AR 21,41
AR 22,42
M a,72,v,36,v,116
TW v,34,192
AR 23,43
AR 24,56
M a,72,v,40,v,120
TW v,36,320
AR 25,57
AR 26,58
M a,72,v,44,v,124
s_waitcnt lgkmcnt(3)
TW v,38,448
AR 27,59
M a,80,v,48,v,64
TW v,40,576
v_mul_f32 v20, 0x3db8aa3b, v20
v_mul_f32 v21, 0x3db8aa3b, v21
M a,80,v,52,v,68
TW v,42,704
v_mul_f32 v22, 0x3db8aa3b, v22
v_mul_f32 v23, 0x3db8aa3b, v23
M a,80,v,56,v,72
TW v,44,832
v_mul_f32 v24, 0x3db8aa3b, v24
v_mul_f32 v25, 0x3db8aa3b, v25
M a,80,v,60,v,76
TW v,46,960
v_mul_f32 v26, 0x3db8aa3b, v26
v_mul_f32 v27, 0x3db8aa3b, v27
M a,84,v,48,v,96
DL 5,44,93,1032
s_add_u32 m0, s92, 50688
M a,84,v,52,v,100
CV 152,20
CV 153,22
CV 154,24
M a,84,v,56,v,104
CV 155,26
AR 20,52
AR 21,53
M a,84,v,60,v,108
DN 4,12,2,1056
s_add_u32 m0, s92, 33792
M a,88,v,48,v,112
TW v,48,72
AR 22,54
AR 23,55
M a,88,v,52,v,116
TW v,50,200
AR 24,68
AR 25,69
M a,88,v,56,v,120
TW v,52,328
AR 26,70
AR 27,71
M a,88,v,60,v,124
s_waitcnt lgkmcnt(3)
TW v,54,456
v_mul_f32 v20, 0x3db8aa3b, v20
M a,96,v,32,v,64
TW v,56,584
v_mul_f32 v21, 0x3db8aa3b, v21
v_mul_f32 v22, 0x3db8aa3b, v22
M a,96,v,36,v,68
TW v,58,712
v_mul_f32 v23, 0x3db8aa3b, v23
v_mul_f32 v24, 0x3db8aa3b, v24
M a,96,v,40,v,72
TW v,60,840
v_mul_f32 v25, 0x3db8aa3b, v25
v_mul_f32 v26, 0x3db8aa3b, v26
M a,96,v,44,v,76
TW v,62,968
v_mul_f32 v27, 0x3db8aa3b, v27
CV 150,20
M a,100,v,32,v,96
DL 5,48,93,2112
s_add_u32 m0, s92, 50688
M a,100,v,36,v,100
CV 151,22
CV 164,24
CV 165,26
M a,100,v,40,v,104
AR 20,64
AR 21,65
AR 22,66
M a,100,v,44,v,108
AR 23,67
AR 24,80
AR 25,81
M a,104,v,32,v,112
AR 26,82
AR 27,83
v_mul_f32 v20, 0x3db8aa3b, v20
M a,104,v,36,v,116
DN 4,16,2,2112
s_add_u32 m0, s92, 33792
M a,104,v,40,v,120
v_mul_f32 v21, 0x3db8aa3b, v21
v_mul_f32 v22, 0x3db8aa3b, v22
v_mul_f32 v23, 0x3db8aa3b, v23
M a,104,v,44,v,124
s_waitcnt lgkmcnt(0)
s_waitcnt vmcnt(14)
s_barrier
M a,112,v,48,v,64
TW v,32,50688
v_mul_f32 v24, 0x3db8aa3b, v24
v_mul_f32 v25, 0x3db8aa3b, v25
M a,112,v,52,v,68
TW v,34,50816
v_mul_f32 v26, 0x3db8aa3b, v26
v_mul_f32 v27, 0x3db8aa3b, v27
M a,112,v,56,v,72
TW v,36,50944
CV 160,20
CV 161,22
M a,112,v,60,v,76
TW v,38,51072
CV 162,24
CV 163,26
M a,116,v,48,v,96
TW v,40,50696
AR 20,72
AR 21,73
M a,116,v,52,v,100
TW v,42,50824
AR 22,74
AR 23,75
M a,116,v,56,v,104
TW v,44,50952
TW v,46,51080
AR 24,88
M a,116,v,60,v,108
DL 5,52,93,3144
s_add_u32 m0, s92, 50688
M a,120,v,48,v,112
TW v,48,50752
AR 25,89
AR 26,90
M a,120,v,52,v,116
TW v,50,50880
AR 27,91
v_mul_f32 v20, 0x3db8aa3b, v20
M a,120,v,56,v,120
TW v,52,51008
v_mul_f32 v21, 0x3db8aa3b, v21
v_mul_f32 v22, 0x3db8aa3b, v22
M a,120,v,60,v,124
s_waitcnt lgkmcnt(3)
TW v,54,51136
v_mul_f32 v23, 0x3db8aa3b, v23
M a,128,v,32,v,224
TW v,56,50760
v_mul_f32 v24, 0x3db8aa3b, v24
v_mul_f32 v25, 0x3db8aa3b, v25
M a,128,v,36,v,240
TW v,58,50888
v_mul_f32 v26, 0x3db8aa3b, v26
v_mul_f32 v27, 0x3db8aa3b, v27
M a,132,v,32,v,228
TW v,60,51016
CV 168,20
CV 169,22
M a,132,v,36,v,244
TW v,62,51144
CV 170,24
CV 171,26
M a,136,v,32,v,232
DN 4,20,2,3168
TW v,32,51200
M a,136,v,36,v,248
TW v,34,51328
s_add_u32 m0, s92, 81920
TW v,36,51456
M a,144,v,40,v,224
TW v,38,51584
s_mov_b32 s2, 262144
AR 20,84
M a,144,v,44,v,240
AR 21,85
AR 22,86
AR 23,87
M a,148,v,40,v,228
AR 24,100
AR 25,101
AR 26,102
M a,148,v,44,v,244
AR 27,103
v_mul_f32 v20, 0x3db8aa3b, v20
v_mul_f32 v21, 0x3db8aa3b, v21
M a,152,v,40,v,232
TW v,40,51208
v_mul_f32 v22, 0x3db8aa3b, v22
v_mul_f32 v23, 0x3db8aa3b, v23
M a,152,v,44,v,248
s_waitcnt lgkmcnt(5)
TW v,42,51336
v_mul_f32 v24, 0x3db8aa3b, v24
M a,160,v,48,v,224
TW v,44,51464
v_mul_f32 v25, 0x3db8aa3b, v25
v_mul_f32 v26, 0x3db8aa3b, v26
M a,160,v,52,v,240
TW v,46,51592
v_mul_f32 v27, 0x3db8aa3b, v27
CV 166,20
M a,164,v,48,v,228
CV 167,22
CV 180,24
CV 181,26
M a,164,v,52,v,244
DN 4,24,2,0
AR 20,96
M a,168,v,48,v,232
TW v,48,51264
AR 21,97
AR 22,98
M a,168,v,52,v,248
TW v,50,51392
AR 23,99
AR 24,112
M a,176,v,56,v,224
TW v,52,51520
AR 25,113
AR 26,114
M a,176,v,60,v,240
TW v,54,51648
AR 27,115
v_mul_f32 v20, 0x3db8aa3b, v20
M a,180,v,56,v,228
v_mul_f32 v21, 0x3db8aa3b, v21
v_mul_f32 v22, 0x3db8aa3b, v22
v_mul_f32 v23, 0x3db8aa3b, v23
M a,180,v,60,v,244
v_mul_f32 v24, 0x3db8aa3b, v24
v_mul_f32 v25, 0x3db8aa3b, v25
v_mul_f32 v26, 0x3db8aa3b, v26
M a,184,v,56,v,232
TW v,56,51272
v_mul_f32 v27, 0x3db8aa3b, v27
CV 176,20
M a,184,v,60,v,248
s_waitcnt lgkmcnt(5)
TW v,58,51400
CV 177,22
M a,192,v,32,v,224
TW v,60,51528
CV 178,24
CV 179,26
M a,192,v,36,v,240
TW v,62,51656
v_xor_b32 v11, 81920, v11
AR 20,104
M a,196,v,32,v,228
AR 21,105
AR 22,106
AR 23,107
M a,196,v,36,v,244
v_mul_f32 v20, 0x3db8aa3b, v20
v_mul_f32 v21, 0x3db8aa3b, v21
v_mul_f32 v22, 0x3db8aa3b, v22
M a,200,v,32,v,232
v_mul_f32 v23, 0x3db8aa3b, v23
CV 184,20
CV 185,22
M a,200,v,36,v,248
AR 20,116
AR 21,117
AR 22,118
M a,208,v,40,v,224
DN 4,28,2,1056
AR 23,119
M a,208,v,44,v,240
v_mul_f32 v20, 0x3db8aa3b, v20
v_mul_f32 v21, 0x3db8aa3b, v21
v_mul_f32 v22, 0x3db8aa3b, v22
M a,212,v,40,v,228
v_mul_f32 v23, 0x3db8aa3b, v23
CV 182,20
CV 183,22
M a,212,v,44,v,244
AR 24,120
AR 25,121
AR 26,122
M a,216,v,40,v,232
AR 27,123
v_mul_f32 v24, 0x3db8aa3b, v24
v_mul_f32 v25, 0x3db8aa3b, v25
M a,216,v,44,v,248
s_waitcnt lgkmcnt(0)
s_waitcnt vmcnt(10)
s_mov_b64 exec, 0
s_branch L_pad17
L_ret17:
s_mov_b64 exec, -1
s_barrier
M a,224,v,48,v,224
TW v,32,16896
v_mul_f32 v26, 0x3db8aa3b, v26
v_mul_f32 v27, 0x3db8aa3b, v27
M a,224,v,52,v,240
TW v,34,17024
CV 186,24
CV 187,26
M a,228,v,48,v,228
TW v,36,17152
M a,228,v,52,v,244
TW v,38,17280
M a,232,v,48,v,232
TW v,40,17408
M a,232,v,52,v,248
TW v,42,17536
M a,240,v,56,v,224
TW v,44,17664
TW v,46,17792
M a,240,v,60,v,240
TW v,48,16904
M a,244,v,56,v,228
TW v,50,17032
M a,244,v,60,v,244
DN 4,32,2,2112
TW v,52,17160
M a,248,v,56,v,232
TW v,54,17288
M a,248,v,60,v,248
s_waitcnt lgkmcnt(4)
TW v,56,17416
M a,128,v,32,v,64
TW v,58,17544
M a,128,v,36,v,68
TW v,60,17672
M a,128,v,40,v,72
TW v,62,17800
M a,128,v,44,v,76
M a,132,v,32,v,96
M a,132,v,36,v,100
M a,132,v,40,v,104
M a,132,v,44,v,108
M a,136,v,32,v,112
TW v,32,16960
M a,136,v,36,v,116
TW v,34,17088
AR 20,128
AR 21,129
M a,136,v,40,v,120
TW v,36,17216
AR 24,132
AR 25,133
M a,136,v,44,v,124
s_waitcnt lgkmcnt(3)
TW v,38,17344
AR 26,134
M a,144,v,48,v,64
TW v,40,17472
AR 27,135
v_mul_f32 v24, 0x3db8aa3b, v24
M a,144,v,52,v,68
TW v,42,17600
v_mul_f32 v25, 0x3db8aa3b, v25
v_mul_f32 v26, 0x3db8aa3b, v26
M a,144,v,56,v,72
TW v,44,17728
v_mul_f32 v27, 0x3db8aa3b, v27
CV 196,24
M a,144,v,60,v,76
TW v,46,17856
CV 197,26
AR 22,130
M a,148,v,48,v,96
DN 4,36,2,3168
s_add_u32 m0, s92, 132608
M a,148,v,52,v,100
s_mov_b32 s2, 294912
AR 23,131
AR 24,144
M a,148,v,56,v,104
AR 25,145
AR 26,146
AR 27,147
M a,148,v,60,v,108
v_mul_f32 v20, 0x3db8aa3b, v20
v_mul_f32 v21, 0x3db8aa3b, v21
v_mul_f32 v22, 0x3db8aa3b, v22
M a,152,v,48,v,112
TW v,48,16968
v_mul_f32 v23, 0x3db8aa3b, v23
v_mul_f32 v24, 0x3db8aa3b, v24
M a,152,v,52,v,116
TW v,50,17096
v_mul_f32 v25, 0x3db8aa3b, v25
v_mul_f32 v26, 0x3db8aa3b, v26
M a,152,v,56,v,120
TW v,52,17224
v_mul_f32 v27, 0x3db8aa3b, v27
CV 192,20
M a,152,v,60,v,124
s_waitcnt lgkmcnt(3)
TW v,54,17352
CV 193,22
M a,160,v,32,v,64
TW v,56,17480
CV 194,24
CV 195,26
M a,160,v,36,v,68
TW v,58,17608
AR 20,136
AR 21,137
M a,160,v,40,v,72
TW v,60,17736
AR 22,138
AR 23,139
M a,160,v,44,v,76
TW v,62,17864
AR 24,152
AR 25,153
M a,164,v,32,v,96
DN 4,8,2,0
AR 26,154
M a,164,v,36,v,100
AR 27,155
v_mul_f32 v20, 0x3db8aa3b, v20
v_mul_f32 v21, 0x3db8aa3b, v21
M a,164,v,40,v,104
v_mul_f32 v22, 0x3db8aa3b, v22
v_mul_f32 v23, 0x3db8aa3b, v23
v_mul_f32 v24, 0x3db8aa3b, v24
M a,164,v,44,v,108
v_mul_f32 v25, 0x3db8aa3b, v25
v_mul_f32 v26, 0x3db8aa3b, v26
v_mul_f32 v27, 0x3db8aa3b, v27
M a,168,v,32,v,112
CV 200,20
CV 201,22
CV 202,24
M a,168,v,36,v,116
CV 203,26
AR 20,148
AR 21,149
M a,168,v,40,v,120
AR 22,150
AR 23,151
AR 24,164
M a,168,v,44,v,124
s_waitcnt lgkmcnt(0)
s_waitcnt vmcnt(6)
s_barrier
M a,176,v,48,v,64
TW v,32,33792
AR 25,165
AR 26,166
M a,176,v,52,v,68
TW v,34,33920
AR 27,167
v_mul_f32 v20, 0x3db8aa3b, v20
M a,176,v,56,v,72
TW v,36,34048
v_mul_f32 v21, 0x3db8aa3b, v21
v_mul_f32 v22, 0x3db8aa3b, v22
M a,176,v,60,v,76
TW v,38,34176
v_mul_f32 v23, 0x3db8aa3b, v23
v_mul_f32 v24, 0x3db8aa3b, v24
M a,180,v,48,v,96
TW v,40,34304
v_mul_f32 v25, 0x3db8aa3b, v25
v_mul_f32 v26, 0x3db8aa3b, v26
M a,180,v,52,v,100
TW v,42,34432
v_mul_f32 v27, 0x3db8aa3b, v27
CV 198,20
M a,180,v,56,v,104
TW v,44,34560
TW v,46,34688
CV 199,22
M a,180,v,60,v,108
DN 4,12,2,1056
CV 212,24
M a,184,v,48,v,112
TW v,48,33800
CV 213,26
AR 20,160
M a,184,v,52,v,116
TW v,50,33928
AR 21,161
AR 22,162
M a,184,v,56,v,120
TW v,52,34056
AR 23,163
AR 24,176
M a,184,v,60,v,124
s_waitcnt lgkmcnt(3)
TW v,54,34184
AR 25,177
M a,192,v,32,v,64
TW v,56,34312
AR 26,178
AR 27,179
M a,192,v,36,v,68
TW v,58,34440
v_mul_f32 v20, 0x3db8aa3b, v20
v_mul_f32 v21, 0x3db8aa3b, v21
M a,192,v,40,v,72
TW v,60,34568
v_mul_f32 v22, 0x3db8aa3b, v22
v_mul_f32 v23, 0x3db8aa3b, v23
M a,192,v,44,v,76
TW v,62,34696
v_mul_f32 v24, 0x3db8aa3b, v24
v_mul_f32 v25, 0x3db8aa3b, v25
M a,196,v,32,v,96
v_mul_f32 v26, 0x3db8aa3b, v26
v_mul_f32 v27, 0x3db8aa3b, v27
CV 208,20
M a,196,v,36,v,100
CV 209,22
CV 210,24
CV 211,26
M a,196,v,40,v,104
AR 20,168
AR 21,169
AR 22,170
M a,196,v,44,v,108
DN 4,16,2,2112
AR 23,171
M a,200,v,32,v,112
TW v,32,33856
AR 24,184
AR 25,185
M a,200,v,36,v,116
TW v,34,33984
AR 26,186
AR 27,187
M a,200,v,40,v,120
TW v,36,34112
v_mul_f32 v20, 0x3db8aa3b, v20
v_mul_f32 v21, 0x3db8aa3b, v21
M a,200,v,44,v,124
s_waitcnt lgkmcnt(3)
TW v,38,34240
v_mul_f32 v22, 0x3db8aa3b, v22
M a,208,v,48,v,64
TW v,40,34368
v_mul_f32 v23, 0x3db8aa3b, v23
v_mul_f32 v24, 0x3db8aa3b, v24
M a,208,v,52,v,68
TW v,42,34496
v_mul_f32 v25, 0x3db8aa3b, v25
v_mul_f32 v26, 0x3db8aa3b, v26
M a,208,v,56,v,72
TW v,44,34624
v_mul_f32 v27, 0x3db8aa3b, v27
CV 216,20
M a,208,v,60,v,76
TW v,46,34752
CV 217,22
CV 218,24
M a,212,v,48,v,96
CV 219,26
AR 20,180
AR 21,181
M a,212,v,52,v,100
AR 22,182
AR 23,183
AR 24,196
M a,212,v,56,v,104
AR 25,197
AR 26,198
AR 27,199
M a,212,v,60,v,108
v_mul_f32 v20, 0x3db8aa3b, v20
v_mul_f32 v21, 0x3db8aa3b, v21
v_mul_f32 v22, 0x3db8aa3b, v22
M a,216,v,48,v,112
DN 4,20,2,3168
TW v,48,33864
M a,216,v,52,v,116
TW v,50,33992
s_add_u32 m0, s92, 16896
TW v,52,34120
M a,216,v,56,v,120
TW v,54,34248
s_mov_b32 s2, 278528
TW v,56,34376
M a,216,v,60,v,124
s_waitcnt lgkmcnt(5)
TW v,58,34504
v_mul_f32 v23, 0x3db8aa3b, v23
M a,224,v,32,v,64
TW v,60,34632
v_mul_f32 v24, 0x3db8aa3b, v24
v_mul_f32 v25, 0x3db8aa3b, v25
M a,224,v,36,v,68
TW v,62,34760
v_mul_f32 v26, 0x3db8aa3b, v26
v_mul_f32 v27, 0x3db8aa3b, v27
M a,224,v,40,v,72
CV 214,20
CV 215,22
CV 228,24
M a,224,v,44,v,76
CV 229,26
AR 20,192
AR 21,193
M a,228,v,32,v,96
AR 22,194
AR 23,195
AR 24,208
M a,228,v,36,v,100
AR 25,209
AR 26,210
AR 27,211
M a,228,v,40,v,104
v_mul_f32 v20, 0x3db8aa3b, v20
v_mul_f32 v21, 0x3db8aa3b, v21
v_mul_f32 v22, 0x3db8aa3b, v22
M a,228,v,44,v,108
v_mul_f32 v23, 0x3db8aa3b, v23
v_mul_f32 v24, 0x3db8aa3b, v24
v_mul_f32 v25, 0x3db8aa3b, v25
M a,232,v,32,v,112
v_mul_f32 v26, 0x3db8aa3b, v26
v_mul_f32 v27, 0x3db8aa3b, v27
CV 224,20
M a,232,v,36,v,116
CV 225,22
CV 226,24
CV 227,26
M a,232,v,40,v,120
DN 4,24,2,0
AR 20,200
M a,232,v,44,v,124
s_waitcnt lgkmcnt(0)
s_waitcnt vmcnt(10)
s_barrier
M a,240,v,48,v,64
RD v,32,1,0
AR 21,201
AR 22,202
M a,240,v,52,v,68
RD v,36,1,64
AR 23,203
AR 24,216
M a,240,v,56,v,72
RD v,40,1,128
AR 25,217
AR 26,218
M a,240,v,60,v,76
RD v,44,1,192
AR 27,219
v_mul_f32 v20, 0x3db8aa3b, v20
M a,244,v,48,v,96
v_mul_f32 v21, 0x3db8aa3b, v21
v_mul_f32 v22, 0x3db8aa3b, v22
v_mul_f32 v23, 0x3db8aa3b, v23
M a,244,v,52,v,100
v_mul_f32 v24, 0x3db8aa3b, v24
v_mul_f32 v25, 0x3db8aa3b, v25
v_mul_f32 v26, 0x3db8aa3b, v26
M a,244,v,56,v,104
v_mul_f32 v27, 0x3db8aa3b, v27
CV 232,20
CV 233,22
M a,244,v,60,v,108
CV 234,24
CV 235,26
AR 20,212
M a,248,v,48,v,112
RD v,48,1,512
AR 21,213
AR 22,214
M a,248,v,52,v,116
RD v,52,1,576
AR 23,215
AR 24,228
M a,248,v,56,v,120
RD v,56,1,640
AR 25,229
AR 26,230
M a,248,v,60,v,124
s_waitcnt lgkmcnt(3)
RD v,60,1,704
AR 27,231
Z v,64,v,32,v,128
DN 4,28,2,1056
v_mul_f32 v20, 0x3db8aa3b, v20
M v,64,v,36,v,144
v_mul_f32 v21, 0x3db8aa3b, v21
v_mul_f32 v22, 0x3db8aa3b, v22
v_mul_f32 v23, 0x3db8aa3b, v23
M v,64,v,40,v,160
v_mul_f32 v24, 0x3db8aa3b, v24
v_mul_f32 v25, 0x3db8aa3b, v25
v_mul_f32 v26, 0x3db8aa3b, v26
M v,64,v,44,v,176
v_mul_f32 v27, 0x3db8aa3b, v27
CV 230,20
CV 231,22
Z v,68,v,32,v,132
CV 244,24
CV 245,26
AR 20,224
M v,68,v,36,v,148
AR 21,225
AR 22,226
AR 23,227
M v,68,v,40,v,164
AR 24,240
AR 25,241
AR 26,242
M v,68,v,44,v,180
AR 27,243
v_mul_f32 v20, 0x3db8aa3b, v20
v_mul_f32 v21, 0x3db8aa3b, v21
Z v,72,v,32,v,136
RD v,32,1,256
v_mul_f32 v22, 0x3db8aa3b, v22
v_mul_f32 v23, 0x3db8aa3b, v23
M v,72,v,36,v,152
RD v,36,1,320
v_bfe_u32 v8, v4, 8, 2
v_lshrrev_b32 v9, 14, s95
M v,72,v,40,v,168
RD v,40,1,384
v_add_lshl_u32 v8, v8, v9, 7
v_add_u32 v8, 4096, v8
M v,72,v,44,v,184
s_waitcnt lgkmcnt(3)
RD v,44,1,448
v_mov_b32 v9, 0
Z v,80,v,48,v,128
s_getpc_b64 s[100:101]
s_and_b32 s100, s100, 0xfffff000
v_lshl_add_u64 v[8:9], v[8:9], 0, s[100:101]
M v,80,v,52,v,144
DN 4,32,2,2112
v_mul_f32 v24, 0x3db8aa3b, v24
M v,80,v,56,v,160
v_mul_f32 v25, 0x3db8aa3b, v25
v_mul_f32 v26, 0x3db8aa3b, v26
v_mul_f32 v27, 0x3db8aa3b, v27
M v,80,v,60,v,176
CV 240,20
CV 241,22
CV 242,24
Z v,84,v,48,v,132
CV 243,26
AR 20,232
AR 21,233
M v,84,v,52,v,148
AR 22,234
AR 23,235
v_mul_f32 v20, 0x3db8aa3b, v20
M v,84,v,56,v,164
global_load_dword v10, v[8:9], off
v_mul_f32 v21, 0x3db8aa3b, v21
M v,84,v,60,v,180
v_mul_f32 v22, 0x3db8aa3b, v22
v_mul_f32 v23, 0x3db8aa3b, v23
CV 248,20
Z v,88,v,48,v,136
RD v,48,1,768
CV 249,22
AR 20,244
M v,88,v,52,v,152
RD v,52,1,832
AR 21,245
AR 22,246
M v,88,v,56,v,168
RD v,56,1,896
AR 23,247
v_mul_f32 v20, 0x3db8aa3b, v20
M v,88,v,60,v,184
s_waitcnt lgkmcnt(3)
RD v,60,1,960
v_mul_f32 v21, 0x3db8aa3b, v21
M v,64,v,32,v,192
v_mul_f32 v22, 0x3db8aa3b, v22
v_mul_f32 v23, 0x3db8aa3b, v23
CV 246,20
M v,64,v,36,v,208
CV 247,22
AR 24,248
AR 25,249
M v,64,v,40,v,224
AR 26,250
AR 27,251
v_mul_f32 v24, 0x3db8aa3b, v24
M v,64,v,44,v,240
DN 4,36,2,3168
v_mul_f32 v25, 0x3db8aa3b, v25
M v,68,v,32,v,196
v_mul_f32 v26, 0x3db8aa3b, v26
v_mul_f32 v27, 0x3db8aa3b, v27
CV 250,24
M v,68,v,36,v,212
CV 251,26
s_add_u32 m0, s92, 33792
s_mov_b32 s2, 311296
M v,68,v,40,v,228
v_max3_f32 v24, v64, v65, v66
M v,68,v,44,v,244
M v,72,v,32,v,200
M v,72,v,36,v,216
M v,72,v,40,v,232
M v,72,v,44,v,248
s_waitcnt lgkmcnt(0)
s_waitcnt vmcnt(13)
s_mov_b64 exec, 0
s_branch L_pad18
L_ret18:
s_mov_b64 exec, -1
s_barrier
M v,80,v,48,v,192
RD v,32,1,50688
v_max3_f32 v25, v68, v69, v70
M v,80,v,52,v,208
RD v,36,1,50752
v_max3_f32 v26, v72, v73, v74
M v,80,v,56,v,224
RD v,40,1,50816
M v,80,v,60,v,240
RD v,44,1,50880
M v,84,v,48,v,196
DN 4,8,2,0
M v,84,v,52,v,212
M v,84,v,56,v,228
M v,84,v,60,v,244
M v,88,v,48,v,200
RD v,48,1,50944
v_max3_f32 v24, v24, v67, v80
v_max3_f32 v24, v24, v81, v82
M v,88,v,52,v,216
RD v,52,1,51008
v_max_f32 v24, v24, v83
M v,88,v,56,v,232
RD v,56,1,51072
v_max3_f32 v25, v25, v71, v84
v_max3_f32 v25, v25, v85, v86
M v,88,v,60,v,248
s_waitcnt lgkmcnt(3)
RD v,60,1,51136
v_max_f32 v25, v25, v87
Z v,96,v,32,v,128
v_mov_b32 v27, v25
M v,96,v,36,v,144
M v,96,v,40,v,160
v_permlane32_swap_b32 v25, v27
M v,96,v,44,v,176
v_max3_f32 v26, v26, v75, v88
v_max3_f32 v26, v26, v89, v90
Z v,100,v,32,v,132
v_max_f32 v26, v26, v91
v_max_f32 v25, v25, v27
M v,100,v,36,v,148
v_permlane32_swap_b32 v24, v26
M v,100,v,40,v,164
DN 4,12,2,1056
M v,100,v,44,v,180
v_max_f32 v24, v24, v26
Z v,104,v,32,v,136
RD v,32,1,51200
M v,104,v,36,v,152
v_permlane16_swap_b32 v24, v25
M v,104,v,40,v,168
RD v,36,1,51264
v_max_f32 v24, v24, v25
M v,104,v,44,v,184
s_waitcnt lgkmcnt(2)
RD v,40,1,51328
M v,96,v,48,v,192
RD v,44,1,51392
v_sub_f32 v24, 0, v24
M v,96,v,52,v,208
v_mov_b32 v25, v24
M v,96,v,56,v,224
M v,96,v,60,v,240
v_permlane16_swap_b32 v24, v25
M v,100,v,48,v,196
v_mov_b32 v26, v24
v_mov_b32 v27, v25
M v,100,v,52,v,212
v_permlane32_swap_b32 v24, v26
M v,100,v,56,v,228
v_xor_b32 v2, 81920, v2
AD 64,64,24
M v,100,v,60,v,244
AD 65,65,24
AD 66,66,24
M v,104,v,48,v,200
DN 4,16,2,2112
M v,104,v,52,v,216
RD v,48,1,51456
AD 67,67,24
M v,104,v,56,v,232
RD v,52,1,51520
AD 80,80,24
M v,104,v,60,v,248
s_waitcnt lgkmcnt(2)
RD v,56,1,51584
Z v,112,v,32,v,128
RD v,60,1,51648
AD 81,81,24
M v,112,v,36,v,144
v_permlane32_swap_b32 v25, v27
M v,112,v,40,v,160
EX 64
M v,112,v,44,v,176
EX 65
Z v,116,v,32,v,132
AD 68,68,25
AD 69,69,25
M v,116,v,36,v,148
EX 66
M v,116,v,40,v,164
AD 70,70,25
AD 12,64,65
M v,116,v,44,v,180
EX 67
Z v,120,v,32,v,136
AD 71,71,25
AD 72,72,26
M v,120,v,36,v,152
DN 4,20,2,3168
M v,120,v,40,v,168
EX 68
M v,120,v,44,v,184
s_waitcnt lgkmcnt(0)
s_waitcnt vmcnt(13)
M v,112,v,48,v,192
s_barrier
TR v,32,0
M v,112,v,52,v,208
TR v,34,512
AD 73,73,26
M v,112,v,56,v,224
TR v,36,32
AD 12,12,66
M v,112,v,60,v,240
TR v,38,544
AD 82,82,24
M v,116,v,48,v,196
TR v,40,64
AD 84,84,25
M v,116,v,52,v,212
TR v,42,576
AD 74,74,26
M v,116,v,56,v,228
TR v,44,96
TR v,46,608
M v,116,v,60,v,244
EX 69
M v,120,v,48,v,200
EX 80
M v,120,v,52,v,216
EX 70
M v,120,v,56,v,232
AD 12,12,67
AD 13,68,69
M v,120,v,60,v,248
AD 83,83,24
AD 85,85,25
EX 81
EX 71
AD 75,75,26
EX 72
EX 73
AD 12,12,80
AD 13,13,70
EX 82
v_pk_add_f32 v[86:87], v[86:87], v[24:25] op_sel:[0,1] op_sel_hi:[1,1]
EX 84
EX 74
v_pk_add_f32 v[88:89], v[88:89], v[26:27] op_sel:[0,0] op_sel_hi:[1,0]
AD 12,12,81
AD 13,13,71
AD 14,72,73
EX 83
EX 85
EX 75
AD 12,12,82
AD 13,13,84
AD 14,14,74
EX 86
v_pk_add_f32 v[90:91], v[90:91], v[26:27] op_sel:[0,0] op_sel_hi:[1,0]
EX 88
AD 12,12,83
AD 13,13,85
AD 14,14,75
EX 87
EX 89
AD 13,13,86
AD 14,14,88
CV 83,82
EX 90
AD 13,13,87
AD 14,14,89
CV 82,80
EX 91
AD 14,14,90
CV 81,66
CV 80,64
CV 87,86
AD 14,14,91
CV 86,84
s_waitcnt lgkmcnt(0)
Z a,0,v,32,v,80
CV 85,70
CV 84,68
CV 91,90
CV 90,88
Z a,4,v,32,v,84
CV 89,74
CV 88,72
s_add_u32 m0, s92, 0
s_mov_b32 s2, 294912
Z a,8,v,32,v,88
DN 4,24,2,0
Z a,16,v,36,v,80
TR v,48,128
AD 96,96,24
Z a,20,v,36,v,84
TR v,50,640
AD 97,97,24
Z a,24,v,36,v,88
TR v,52,160
AD 100,100,25
Z a,32,v,40,v,80
TR v,54,672
TR v,56,192
Z a,36,v,40,v,84
TR v,58,704
TR v,60,224
Z a,40,v,40,v,88
TR v,62,736
AD 101,101,25
Z a,48,v,44,v,80
TR v,32,256
AD 104,104,26
Z a,52,v,44,v,84
TR v,34,768
AD 105,105,26
Z a,56,v,44,v,88
s_waitcnt lgkmcnt(2)
TR v,36,288
Z a,64,v,48,v,80
TR v,38,800
AD 98,98,24
Z a,68,v,48,v,84
TR v,40,320
AD 102,102,25
Z a,72,v,48,v,88
TR v,42,832
AD 106,106,26
Z a,80,v,52,v,80
TR v,44,352
v_xor_b32 v1, 81920, v1
Z a,84,v,52,v,84
TR v,46,864
AD 99,99,24
Z a,88,v,52,v,88
DN 4,28,2,1056
Z a,96,v,56,v,80
TR v,48,384
AD 103,103,25
Z a,100,v,56,v,84
TR v,50,896
AD 107,107,26
Z a,104,v,56,v,88
TR v,52,416
AD 112,112,24
Z a,112,v,60,v,80
TR v,54,928
AD 116,116,25
Z a,116,v,60,v,84
TR v,56,448
AD 120,120,26
Z a,120,v,60,v,88
s_waitcnt lgkmcnt(5)
TR v,58,960
Z a,128,v,32,v,80
TR v,60,480
AD 113,113,24
Z a,132,v,32,v,84
TR v,62,992
AD 117,117,25
Z a,136,v,32,v,88
DN 4,32,2,2112
Z a,144,v,36,v,80
EX 96
Z a,148,v,36,v,84
EX 97
Z a,152,v,36,v,88
EX 100
Z a,160,v,40,v,80
EX 101
Z a,164,v,40,v,84
EX 104
Z a,168,v,40,v,88
EX 105
Z a,176,v,44,v,80
EX 98
Z a,180,v,44,v,84
EX 102
Z a,184,v,44,v,88
s_waitcnt lgkmcnt(0)
s_waitcnt vmcnt(12)
Z a,192,v,48,v,80
s_barrier
RD v,32,1,50688
Z a,196,v,48,v,84
RD v,36,1,50752
AD 16,96,97
Z a,200,v,48,v,88
RD v,40,1,50816
AD 17,100,101
Z a,208,v,52,v,80
RD v,44,1,50880
AD 18,104,105
Z a,212,v,52,v,84
EX 106
Z a,216,v,52,v,88
EX 99
Z a,224,v,56,v,80
EX 103
Z a,228,v,56,v,84
EX 107
Z a,232,v,56,v,88
AD 121,121,26
AD 16,16,98
Z a,240,v,60,v,80
AD 17,17,102
AD 18,18,106
Z a,244,v,60,v,84
AD 114,114,24
AD 118,118,25
Z a,248,v,60,v,88
EX 112
EX 116
AD 122,122,26
EX 120
AD 16,16,99
AD 17,17,103
AD 18,18,107
AD 115,115,24
EX 113
AD 119,119,25
EX 117
AD 123,123,26
EX 121
AD 16,16,112
AD 17,17,116
AD 18,18,120
EX 114
EX 118
EX 122
AD 16,16,113
AD 17,17,117
AD 18,18,121
EX 115
EX 119
EX 123
AD 16,16,114
AD 17,17,118
AD 18,18,122
AD 16,16,115
AD 17,17,119
AD 18,18,123
DN 4,36,2,3168
v_max3_f32 v20, v16, v17, v18
v_cmp_lt_f32 vcc, 0x4b800000, v20
v_mov_b32 v64, v24
v_mov_b32 v65, v24
v_mov_b32 v66, v24
v_mov_b32 v67, v24
v_mov_b32 v68, v25
v_mov_b32 v69, v25
v_mov_b32 v70, v25
v_mov_b32 v71, v25
v_mov_b32 v72, v26
v_mov_b32 v73, v26
v_mov_b32 v74, v26
v_mov_b32 v75, v26
s_waitcnt lgkmcnt(0)
CV 80,96
CV 81,98
s_cbranch_vccnz L_rsB15
L_rbB15:
MC 96,v,32,128,64
CV 84,100
CV 85,102
M v,96,v,36,v,144
RD v,48,1,50944
CV 88,104
M v,96,v,40,v,160
RD v,52,1,51008
CV 89,106
M v,96,v,44,v,176
RD v,56,1,51072
s_add_u32 m0, s92, 50688
MC 100,v,32,132,68
RD v,60,1,51136
s_mov_b32 s2, 327680
M v,100,v,36,v,148
CV 82,112
CV 83,114
M v,100,v,40,v,164
DN 4,8,2,0
M v,100,v,44,v,180
CV 86,116
CV 87,118
MC 104,v,32,136,72
RD v,32,1,51200
CV 90,120
M v,104,v,36,v,152
RD v,36,1,51264
CV 91,122
M v,104,v,40,v,168
RD v,40,1,51328
AD 12,12,16
M v,104,v,44,v,184
s_waitcnt lgkmcnt(3)
RD v,44,1,51392
M v,96,v,48,v,192
AD 13,13,17
AD 14,14,18
M v,96,v,52,v,208
M v,96,v,56,v,224
M v,96,v,60,v,240
v_xor_b32 v2, 81920, v2
M v,100,v,48,v,196
M v,100,v,52,v,212
M v,100,v,56,v,228
M v,100,v,60,v,244
DN 4,12,2,1056
M v,104,v,48,v,200
RD v,48,1,51456
M v,104,v,52,v,216
EX 96
M v,104,v,56,v,232
EX 97
M v,104,v,60,v,248
s_waitcnt lgkmcnt(1)
RD v,52,1,51520
MC 112,v,32,128,64
RD v,56,1,51584
AD 16,96,97
M v,112,v,36,v,144
EX 100
M v,112,v,40,v,160
EX 101
M v,112,v,44,v,176
RD v,60,1,51648
AD 17,100,101
MC 116,v,32,132,68
EX 104
M v,116,v,36,v,148
EX 105
M v,116,v,40,v,164
EX 98
M v,116,v,44,v,180
EX 102
MC 120,v,32,136,72
EX 106
M v,120,v,36,v,152
DN 4,16,2,2112
M v,120,v,40,v,168
AD 18,104,105
AD 16,16,98
M v,120,v,44,v,184
s_waitcnt lgkmcnt(0)
s_waitcnt vmcnt(11)
M v,112,v,48,v,192
s_barrier
TR v,32,16896
M v,112,v,52,v,208
TR v,34,17408
AD 17,17,102
M v,112,v,56,v,224
TR v,36,16928
AD 18,18,106
M v,112,v,60,v,240
TR v,38,17440
M v,116,v,48,v,196
TR v,40,16960
M v,116,v,52,v,212
TR v,42,17472
M v,116,v,56,v,228
TR v,44,16992
TR v,46,17504
M v,116,v,60,v,244
EX 99
M v,120,v,48,v,200
TR v,48,17024
AD 16,16,99
M v,120,v,52,v,216
EX 103
M v,120,v,56,v,232
TR v,50,17536
AD 17,17,103
M v,120,v,60,v,248
s_waitcnt lgkmcnt(2)
TR v,52,17056
M a,0,v,32,v,80
DN 4,20,2,3168
M a,4,v,32,v,84
TR v,54,17568
s_add_u32 m0, s92, 81920
M a,8,v,32,v,88
TR v,56,17088
s_mov_b32 s2, 311296
M a,16,v,36,v,80
TR v,58,17600
M a,20,v,36,v,84
TR v,60,17120
M a,24,v,36,v,88
TR v,62,17632
M a,32,v,40,v,80
EX 107
M a,36,v,40,v,84
TR v,32,17152
AD 18,18,107
M a,40,v,40,v,88
EX 112
M a,48,v,44,v,80
TR v,34,17664
AD 16,16,112
M a,52,v,44,v,84
EX 116
M a,56,v,44,v,88
s_waitcnt lgkmcnt(2)
TR v,36,17184
M a,64,v,48,v,80
TR v,38,17696
AD 17,17,116
M a,68,v,48,v,84
DN 4,24,2,0
M a,72,v,48,v,88
EX 120
M a,80,v,52,v,80
TR v,40,17216
v_xor_b32 v1, 81920, v1
M a,84,v,52,v,84
TR v,42,17728
AD 18,18,120
M a,88,v,52,v,88
TR v,44,17248
M a,96,v,56,v,80
TR v,46,17760
M a,100,v,56,v,84
EX 113
M a,104,v,56,v,88
TR v,48,17280
AD 16,16,113
M a,112,v,60,v,80
EX 117
M a,116,v,60,v,84
TR v,50,17792
AD 17,17,117
M a,120,v,60,v,88
s_waitcnt lgkmcnt(2)
TR v,52,17312
M a,128,v,32,v,80
EX 121
M a,132,v,32,v,84
TR v,54,17824
AD 18,18,121
M a,136,v,32,v,88
DN 4,28,2,1056
M a,144,v,36,v,80
TR v,56,17344
M a,148,v,36,v,84
TR v,58,17856
M a,152,v,36,v,88
TR v,60,17376
M a,160,v,40,v,80
TR v,62,17888
M a,164,v,40,v,84
EX 114
M a,168,v,40,v,88
EX 118
M a,176,v,44,v,80
EX 122
M a,180,v,44,v,84
EX 115
M a,184,v,44,v,88
s_waitcnt lgkmcnt(0)
s_waitcnt vmcnt(10)
M a,192,v,48,v,80
s_mov_b64 exec, 0
s_branch L_pad19
L_ret19:
s_mov_b64 exec, -1
s_barrier
RD v,32,1,33792
M a,196,v,48,v,84
RD v,36,1,33856
AD 16,16,114
M a,200,v,48,v,88
RD v,40,1,33920
AD 17,17,118
M a,208,v,52,v,80
RD v,44,1,33984
AD 18,18,122
M a,212,v,52,v,84
EX 119
M a,216,v,52,v,88
EX 123
M a,224,v,56,v,80
AD 16,16,115
AD 17,17,119
M a,228,v,56,v,84
RD v,48,1,34048
AD 18,18,123
M a,232,v,56,v,88
DN 4,32,2,2112
M a,240,v,60,v,80
v_max3_f32 v20, v16, v17, v18
v_cmp_lt_f32 vcc, 0x4b800000, v20
M a,244,v,60,v,84
s_waitcnt lgkmcnt(1)
CV 80,96
M a,248,v,60,v,88
CV 81,98
CV 84,100
s_cbranch_vccnz L_rsB16
L_rbB16:
MC 96,v,32,128,64
RD v,52,1,34112
CV 85,102
M v,96,v,36,v,144
RD v,56,1,34176
CV 88,104
M v,96,v,40,v,160
RD v,60,1,34240
CV 89,106
M v,96,v,44,v,176
CV 82,112
CV 83,114
MC 100,v,32,132,68
CV 86,116
CV 87,118
M v,100,v,36,v,148
DN 4,36,2,3168
M v,100,v,40,v,164
s_add_u32 m0, s92, 132608
s_mov_b32 s2, 344064
M v,100,v,44,v,180
CV 90,120
CV 91,122
MC 104,v,32,136,72
RD v,32,1,34304
AD 12,12,16
M v,104,v,36,v,152
RD v,36,1,34368
AD 13,13,17
M v,104,v,40,v,168
RD v,40,1,34432
AD 14,14,18
M v,104,v,44,v,184
s_waitcnt lgkmcnt(3)
RD v,44,1,34496
M v,96,v,48,v,192
M v,96,v,52,v,208
M v,96,v,56,v,224
M v,96,v,60,v,240
M v,100,v,48,v,196
M v,100,v,52,v,212
M v,100,v,56,v,228
M v,100,v,60,v,244
DN 4,8,2,0
M v,104,v,48,v,200
RD v,48,1,34560
M v,104,v,52,v,216
EX 96
M v,104,v,56,v,232
EX 97
M v,104,v,60,v,248
s_waitcnt lgkmcnt(1)
RD v,52,1,34624
MC 112,v,32,128,64
RD v,56,1,34688
AD 16,96,97
M v,112,v,36,v,144
EX 100
M v,112,v,40,v,160
EX 101
M v,112,v,44,v,176
RD v,60,1,34752
AD 17,100,101
MC 116,v,32,132,68
EX 104
M v,116,v,36,v,148
EX 105
M v,116,v,40,v,164
EX 98
M v,116,v,44,v,180
EX 102
MC 120,v,32,136,72
EX 106
M v,120,v,36,v,152
DN 4,12,2,1056
M v,120,v,40,v,168
AD 18,104,105
AD 16,16,98
M v,120,v,44,v,184
s_waitcnt lgkmcnt(0)
s_waitcnt vmcnt(10)
M v,112,v,48,v,192
s_barrier
TR v,32,0
M v,112,v,52,v,208
TR v,34,512
AD 17,17,102
M v,112,v,56,v,224
TR v,36,32
AD 18,18,106
M v,112,v,60,v,240
TR v,38,544
M v,116,v,48,v,196
TR v,40,64
M v,116,v,52,v,212
TR v,42,576
M v,116,v,56,v,228
TR v,44,96
TR v,46,608
M v,116,v,60,v,244
EX 99
M v,120,v,48,v,200
TR v,48,128
AD 16,16,99
M v,120,v,52,v,216
EX 103
M v,120,v,56,v,232
DN 4,16,2,2112
M v,120,v,60,v,248
s_waitcnt lgkmcnt(1)
TR v,50,640
M a,0,v,32,v,80
TR v,52,160
AD 17,17,103
M a,4,v,32,v,84
EX 107
M a,8,v,32,v,88
TR v,54,672
AD 18,18,107
M a,16,v,36,v,80
TR v,56,192
M a,20,v,36,v,84
TR v,58,704
M a,24,v,36,v,88
TR v,60,224
M a,32,v,40,v,80
TR v,62,736
M a,36,v,40,v,84
EX 112
M a,40,v,40,v,88
TR v,32,256
AD 16,16,112
M a,48,v,44,v,80
EX 116
M a,52,v,44,v,84
TR v,34,768
AD 17,17,116
M a,56,v,44,v,88
s_waitcnt lgkmcnt(2)
TR v,36,288
M a,64,v,48,v,80
DN 4,20,2,3168
M a,68,v,48,v,84
TR v,38,800
s_add_u32 m0, s92, 16896
M a,72,v,48,v,88
TR v,40,320
s_mov_b32 s2, 327680
M a,80,v,52,v,80
TR v,42,832
M a,84,v,52,v,84
TR v,44,352
M a,88,v,52,v,88
TR v,46,864
M a,96,v,56,v,80
EX 120
M a,100,v,56,v,84
TR v,48,384
AD 18,18,120
M a,104,v,56,v,88
EX 113
M a,112,v,60,v,80
TR v,50,896
AD 16,16,113
M a,116,v,60,v,84
EX 117
M a,120,v,60,v,88
s_waitcnt lgkmcnt(2)
TR v,52,416
M a,128,v,32,v,80
TR v,54,928
AD 17,17,117
M a,132,v,32,v,84
DN 4,24,2,0
M a,136,v,32,v,88
EX 121
M a,144,v,36,v,80
TR v,56,448
AD 18,18,121
M a,148,v,36,v,84
TR v,58,960
M a,152,v,36,v,88
TR v,60,480
M a,160,v,40,v,80
TR v,62,992
M a,164,v,40,v,84
EX 114
M a,168,v,40,v,88
EX 118
M a,176,v,44,v,80
EX 122
M a,180,v,44,v,84
EX 115
M a,184,v,44,v,88
s_waitcnt lgkmcnt(0)
s_waitcnt vmcnt(9)
M a,192,v,48,v,80
s_barrier
RD v,32,1,50688
M a,196,v,48,v,84
RD v,36,1,50752
AD 16,16,114
M a,200,v,48,v,88
RD v,40,1,50816
AD 17,17,118
M a,208,v,52,v,80
RD v,44,1,50880
AD 18,18,122
M a,212,v,52,v,84
EX 119
M a,216,v,52,v,88
EX 123
M a,224,v,56,v,80
DN 4,28,2,1056
M a,228,v,56,v,84
AD 16,16,115
AD 17,17,119
M a,232,v,56,v,88
RD v,48,1,50944
AD 18,18,123
M a,240,v,60,v,80
v_max3_f32 v20, v16, v17, v18
v_cmp_lt_f32 vcc, 0x4b800000, v20
M a,244,v,60,v,84
s_waitcnt lgkmcnt(1)
CV 80,96
M a,248,v,60,v,88
CV 81,98
CV 84,100
s_cbranch_vccnz L_rsB17
L_rbB17:
MC 96,v,32,128,64
RD v,52,1,51008
CV 85,102
M v,96,v,36,v,144
RD v,56,1,51072
CV 88,104
M v,96,v,40,v,160
RD v,60,1,51136
CV 89,106
M v,96,v,44,v,176
CV 82,112
CV 83,114
MC 100,v,32,132,68
CV 86,116
CV 87,118
M v,100,v,36,v,148
DN 4,32,2,2112
M v,100,v,40,v,164
CV 90,120
CV 91,122
M v,100,v,44,v,180
AD 12,12,16
AD 13,13,17
MC 104,v,32,136,72
RD v,32,1,51200
AD 14,14,18
M v,104,v,36,v,152
RD v,36,1,51264
M v,104,v,40,v,168
RD v,40,1,51328
M v,104,v,44,v,184
s_waitcnt lgkmcnt(3)
RD v,44,1,51392
M v,96,v,48,v,192
M v,96,v,52,v,208
M v,96,v,56,v,224
M v,96,v,60,v,240
v_xor_b32 v2, 81920, v2
M v,100,v,48,v,196
M v,100,v,52,v,212
M v,100,v,56,v,228
DN 4,36,2,3168
M v,100,v,60,v,244
s_add_u32 m0, s92, 33792
s_mov_b32 s2, 360448
M v,104,v,48,v,200
EX 96
M v,104,v,52,v,216
EX 97
M v,104,v,56,v,232
RD v,48,1,51456
AD 16,96,97
M v,104,v,60,v,248
s_waitcnt lgkmcnt(1)
RD v,52,1,51520
MC 112,v,32,128,64
EX 100
M v,112,v,36,v,144
EX 101
M v,112,v,40,v,160
RD v,56,1,51584
AD 17,100,101
M v,112,v,44,v,176
RD v,60,1,51648
MC 116,v,32,132,68
EX 104
M v,116,v,36,v,148
EX 105
M v,116,v,40,v,164
EX 98
M v,116,v,44,v,180
EX 102
MC 120,v,32,136,72
DN 4,8,2,0
M v,120,v,36,v,152
EX 106
M v,120,v,40,v,168
AD 18,104,105
AD 16,16,98
M v,120,v,44,v,184
s_waitcnt lgkmcnt(0)
s_waitcnt vmcnt(9)
M v,112,v,48,v,192
s_barrier
TR v,32,0
M v,112,v,52,v,208
TR v,34,512
AD 17,17,102
M v,112,v,56,v,224
TR v,36,32
AD 18,18,106
M v,112,v,60,v,240
TR v,38,544
M v,116,v,48,v,196
TR v,40,64
M v,116,v,52,v,212
TR v,42,576
M v,116,v,56,v,228
TR v,44,96
TR v,46,608
M v,116,v,60,v,244
EX 99
M v,120,v,48,v,200
TR v,48,128
AD 16,16,99
M v,120,v,52,v,216
EX 103
M v,120,v,56,v,232
DN 4,12,2,1056
M v,120,v,60,v,248
s_waitcnt lgkmcnt(1)
TR v,50,640
M a,0,v,32,v,80
TR v,52,160
AD 17,17,103
M a,4,v,32,v,84
EX 107
M a,8,v,32,v,88
TR v,54,672
AD 18,18,107
M a,16,v,36,v,80
TR v,56,192
M a,20,v,36,v,84
TR v,58,704
M a,24,v,36,v,88
TR v,60,224
M a,32,v,40,v,80
TR v,62,736
M a,36,v,40,v,84
EX 112
M a,40,v,40,v,88
TR v,32,256
AD 16,16,112
M a,48,v,44,v,80
EX 116
M a,52,v,44,v,84
TR v,34,768
AD 17,17,116
M a,56,v,44,v,88
s_waitcnt lgkmcnt(2)
TR v,36,288
M a,64,v,48,v,80
DN 4,16,2,2112
M a,68,v,48,v,84
EX 120
M a,72,v,48,v,88
TR v,38,800
AD 18,18,120
M a,80,v,52,v,80
TR v,40,320
v_xor_b32 v1, 81920, v1
M a,84,v,52,v,84
TR v,42,832
M a,88,v,52,v,88
TR v,44,352
M a,96,v,56,v,80
TR v,46,864
M a,100,v,56,v,84
EX 113
M a,104,v,56,v,88
TR v,48,384
AD 16,16,113
M a,112,v,60,v,80
EX 117
M a,116,v,60,v,84
TR v,50,896
AD 17,17,117
M a,120,v,60,v,88
s_waitcnt lgkmcnt(2)
TR v,52,416
M a,128,v,32,v,80
EX 121
M a,132,v,32,v,84
TR v,54,928
AD 18,18,121
M a,136,v,32,v,88
DN 4,20,2,3168
M a,144,v,36,v,80
TR v,56,448
s_add_u32 m0, s92, 0
M a,148,v,36,v,84
TR v,58,960
s_mov_b32 s2, 344064
M a,152,v,36,v,88
TR v,60,480
M a,160,v,40,v,80
TR v,62,992
M a,164,v,40,v,84
EX 114
M a,168,v,40,v,88
EX 118
M a,176,v,44,v,80
EX 122
M a,180,v,44,v,84
EX 115
M a,184,v,44,v,88
s_waitcnt lgkmcnt(0)
s_waitcnt vmcnt(8)
M a,192,v,48,v,80
s_mov_b64 exec, 0
s_branch L_pad20
L_ret20:
s_mov_b64 exec, -1
s_barrier
RD v,32,1,50688
M a,196,v,48,v,84
RD v,36,1,50752
AD 16,16,114
M a,200,v,48,v,88
RD v,40,1,50816
AD 17,17,118
M a,208,v,52,v,80
RD v,44,1,50880
AD 18,18,122
M a,212,v,52,v,84
EX 119
M a,216,v,52,v,88
EX 123
M a,224,v,56,v,80
DN 4,24,2,0
M a,228,v,56,v,84
AD 16,16,115
AD 17,17,119
M a,232,v,56,v,88
RD v,48,1,50944
AD 18,18,123
M a,240,v,60,v,80
v_max3_f32 v20, v16, v17, v18
v_cmp_lt_f32 vcc, 0x4b800000, v20
M a,244,v,60,v,84
s_waitcnt lgkmcnt(1)
CV 80,96
M a,248,v,60,v,88
CV 81,98
CV 84,100
s_cbranch_vccnz L_rsB18
L_rbB18:
MC 96,v,32,128,64
RD v,52,1,51008
CV 85,102
M v,96,v,36,v,144
RD v,56,1,51072
CV 88,104
M v,96,v,40,v,160
RD v,60,1,51136
CV 89,106
M v,96,v,44,v,176
CV 82,112
CV 83,114
MC 100,v,32,132,68
DN 4,28,2,1056
M v,100,v,36,v,148
CV 86,116
CV 87,118
M v,100,v,40,v,164
CV 90,120
CV 91,122
M v,100,v,44,v,180
AD 12,12,16
AD 13,13,17
MC 104,v,32,136,72
RD v,32,1,51200
AD 14,14,18
M v,104,v,36,v,152
RD v,36,1,51264
M v,104,v,40,v,168
RD v,40,1,51328
M v,104,v,44,v,184
s_waitcnt lgkmcnt(3)
RD v,44,1,51392
M v,96,v,48,v,192
M v,96,v,52,v,208
M v,96,v,56,v,224
M v,96,v,60,v,240
v_xor_b32 v2, 81920, v2
M v,100,v,48,v,196
M v,100,v,52,v,212
M v,100,v,56,v,228
DN 4,32,2,2112
M v,100,v,60,v,244
M v,104,v,48,v,200
RD v,48,1,51456
M v,104,v,52,v,216
EX 96
M v,104,v,56,v,232
EX 97
M v,104,v,60,v,248
s_waitcnt lgkmcnt(1)
RD v,52,1,51520
MC 112,v,32,128,64
RD v,56,1,51584
AD 16,96,97
M v,112,v,36,v,144
EX 100
M v,112,v,40,v,160
EX 101
M v,112,v,44,v,176
RD v,60,1,51648
AD 17,100,101
MC 116,v,32,132,68
EX 104
M v,116,v,36,v,148
EX 105
M v,116,v,40,v,164
EX 98
M v,116,v,44,v,180
EX 102
MC 120,v,32,136,72
DN 4,36,2,3168
M v,120,v,36,v,152
s_add_u32 m0, s92, 50688
s_mov_b32 s2, 376832
M v,120,v,40,v,168
EX 106
M v,120,v,44,v,184
s_waitcnt lgkmcnt(0)
s_waitcnt vmcnt(8)
M v,112,v,48,v,192
s_barrier
TR v,32,16896
M v,112,v,52,v,208
TR v,34,17408
AD 18,104,105
M v,112,v,56,v,224
TR v,36,16928
AD 16,16,98
M v,112,v,60,v,240
TR v,38,17440
AD 17,17,102
M v,116,v,48,v,196
TR v,40,16960
AD 18,18,106
M v,116,v,52,v,212
TR v,42,17472
M v,116,v,56,v,228
TR v,44,16992
TR v,46,17504
M v,116,v,60,v,244
EX 99
M v,120,v,48,v,200
TR v,48,17024
AD 16,16,99
M v,120,v,52,v,216
DN 4,8,2,0
M v,120,v,56,v,232
EX 103
M v,120,v,60,v,248
s_waitcnt lgkmcnt(1)
TR v,50,17536
M a,0,v,32,v,80
TR v,52,17056
AD 17,17,103
M a,4,v,32,v,84
EX 107
M a,8,v,32,v,88
TR v,54,17568
AD 18,18,107
M a,16,v,36,v,80
TR v,56,17088
M a,20,v,36,v,84
TR v,58,17600
M a,24,v,36,v,88
TR v,60,17120
M a,32,v,40,v,80
TR v,62,17632
M a,36,v,40,v,84
EX 112
M a,40,v,40,v,88
TR v,32,17152
AD 16,16,112
M a,48,v,44,v,80
DN 4,12,2,1056
M a,52,v,44,v,84
TR v,34,17664
v_bfe_u32 v8, v4, 8, 2
M a,56,v,44,v,88
s_waitcnt lgkmcnt(2)
TR v,36,17184
M a,64,v,48,v,80
TR v,38,17696
v_lshrrev_b32 v9, 14, s95
M a,68,v,48,v,84
TR v,40,17216
v_add_lshl_u32 v8, v8, v9, 7
M a,72,v,48,v,88
TR v,42,17728
v_add_u32 v8, 4096, v8
M a,80,v,52,v,80
TR v,44,17248
v_mov_b32 v9, 0
M a,84,v,52,v,84
TR v,46,17760
v_xor_b32 v1, 81920, v1
M a,88,v,52,v,88
s_getpc_b64 s[100:101]
s_and_b32 s100, s100, 0xfffff000
M a,96,v,56,v,80
TR v,48,17280
v_lshl_add_u64 v[8:9], v[8:9], 0, s[100:101]
M a,100,v,56,v,84
global_load_dword v10, v[8:9], off
M a,104,v,56,v,88
EX 116
M a,112,v,60,v,80
TR v,50,17792
AD 17,17,116
M a,116,v,60,v,84
DN 4,16,2,2112
M a,120,v,60,v,88
s_waitcnt lgkmcnt(2)
TR v,52,17312
M a,128,v,32,v,80
EX 120
M a,132,v,32,v,84
TR v,54,17824
AD 18,18,120
M a,136,v,32,v,88
EX 113
M a,144,v,36,v,80
TR v,56,17344
AD 16,16,113
M a,148,v,36,v,84
TR v,58,17856
M a,152,v,36,v,88
TR v,60,17376
M a,160,v,40,v,80
TR v,62,17888
M a,164,v,40,v,84
DN 4,20,2,3168
M a,168,v,40,v,88
EX 117
M a,176,v,44,v,80
EX 121
M a,180,v,44,v,84
EX 114
M a,184,v,44,v,88
s_waitcnt lgkmcnt(0)
s_waitcnt vmcnt(9)
M a,192,v,48,v,80
s_barrier
RD v,32,1,33792
M a,196,v,48,v,84
RD v,36,1,33856
AD 17,17,117
M a,200,v,48,v,88
RD v,40,1,33920
AD 18,18,121
M a,208,v,52,v,80
RD v,44,1,33984
AD 16,16,114
M a,212,v,52,v,84
EX 118
M a,216,v,52,v,88
EX 122
M a,224,v,56,v,80
EX 115
M a,228,v,56,v,84
EX 119
M a,232,v,56,v,88
EX 123
M a,240,v,60,v,80
AD 17,17,118
AD 18,18,122
M a,244,v,60,v,84
AD 16,16,115
AD 17,17,119
M a,248,v,60,v,88
AD 18,18,123
v_max3_f32 v20, v16, v17, v18
v_cmp_lt_f32 vcc, 0x4b800000, v20
s_waitcnt lgkmcnt(0)
s_add_u32 m0, s92, 81920
s_mov_b32 s2, 360448
CV 80,96
CV 81,98
s_cbranch_vccnz L_rsB19
L_rbB19:
MC 96,v,32,128,64
DN 4,24,2,0
M v,96,v,36,v,144
CV 84,100
CV 85,102
M v,96,v,40,v,160
RD v,48,1,34048
CV 88,104
M v,96,v,44,v,176
RD v,52,1,34112
CV 89,106
MC 100,v,32,132,68
RD v,56,1,34176
CV 82,112
M v,100,v,36,v,148
RD v,60,1,34240
CV 83,114
M v,100,v,40,v,164
DN 4,28,2,1056
M v,100,v,44,v,180
CV 86,116
CV 87,118
MC 104,v,32,136,72
RD v,32,1,34304
CV 90,120
M v,104,v,36,v,152
RD v,36,1,34368
CV 91,122
M v,104,v,40,v,168
RD v,40,1,34432
AD 12,12,16
M v,104,v,44,v,184
s_waitcnt lgkmcnt(3)
RD v,44,1,34496
M v,96,v,48,v,192
AD 13,13,17
AD 14,14,18
M v,96,v,52,v,208
M v,96,v,56,v,224
M v,96,v,60,v,240
M v,100,v,48,v,196
M v,100,v,52,v,212
M v,100,v,56,v,228
DN 4,32,2,2112
M v,100,v,60,v,244
M v,104,v,48,v,200
RD v,48,1,34560
M v,104,v,52,v,216
EX 96
M v,104,v,56,v,232
EX 97
M v,104,v,60,v,248
s_waitcnt lgkmcnt(1)
RD v,52,1,34624
MC 112,v,32,128,64
RD v,56,1,34688
AD 16,96,97
M v,112,v,36,v,144
EX 100
M v,112,v,40,v,160
EX 101
M v,112,v,44,v,176
RD v,60,1,34752
AD 17,100,101
MC 116,v,32,132,68
EX 104
M v,116,v,36,v,148
DN 4,36,2,3168
M v,116,v,40,v,164
s_add_u32 m0, s92, 132608
s_mov_b32 s2, 393216
M v,116,v,44,v,180
EX 105
MC 120,v,32,136,72
EX 98
M v,120,v,36,v,152
EX 102
M v,120,v,40,v,168
EX 106
M v,120,v,44,v,184
s_waitcnt lgkmcnt(0)
s_waitcnt vmcnt(9)
M v,112,v,48,v,192
s_barrier
TR v,32,0
M v,112,v,52,v,208
TR v,34,512
AD 18,104,105
M v,112,v,56,v,224
TR v,36,32
AD 16,16,98
M v,112,v,60,v,240
TR v,38,544
AD 17,17,102
M v,116,v,48,v,196
TR v,40,64
AD 18,18,106
M v,116,v,52,v,212
TR v,42,576
M v,116,v,56,v,228
TR v,44,96
TR v,46,608
M v,116,v,60,v,244
DN 4,8,2,0
M v,120,v,48,v,200
EX 99
M v,120,v,52,v,216
TR v,48,128
AD 16,16,99
M v,120,v,56,v,232
EX 103
M v,120,v,60,v,248
s_waitcnt lgkmcnt(1)
TR v,50,640
M a,0,v,32,v,80
TR v,52,160
AD 17,17,103
M a,4,v,32,v,84
EX 107
M a,8,v,32,v,88
TR v,54,672
AD 18,18,107
M a,16,v,36,v,80
TR v,56,192
M a,20,v,36,v,84
TR v,58,704
M a,24,v,36,v,88
TR v,60,224
M a,32,v,40,v,80
TR v,62,736
M a,36,v,40,v,84
DN 4,12,2,1056
M a,40,v,40,v,88
EX 112
M a,48,v,44,v,80
TR v,32,256
AD 16,16,112
M a,52,v,44,v,84
EX 116
M a,56,v,44,v,88
s_waitcnt lgkmcnt(1)
TR v,34,768
M a,64,v,48,v,80
TR v,36,288
AD 17,17,116
M a,68,v,48,v,84
EX 120
M a,72,v,48,v,88
TR v,38,800
AD 18,18,120
M a,80,v,52,v,80
TR v,40,320
M a,84,v,52,v,84
TR v,42,832
M a,88,v,52,v,88
TR v,44,352
M a,96,v,56,v,80
TR v,46,864
M a,100,v,56,v,84
DN 4,16,2,2112
M a,104,v,56,v,88
EX 113
M a,112,v,60,v,80
TR v,48,384
AD 16,16,113
M a,116,v,60,v,84
EX 117
M a,120,v,60,v,88
s_waitcnt lgkmcnt(1)
TR v,50,896
M a,128,v,32,v,80
TR v,52,416
AD 17,17,117
M a,132,v,32,v,84
EX 121
M a,136,v,32,v,88
TR v,54,928
AD 18,18,121
M a,144,v,36,v,80
TR v,56,448
M a,148,v,36,v,84
TR v,58,960
M a,152,v,36,v,88
TR v,60,480
M a,160,v,40,v,80
TR v,62,992
M a,164,v,40,v,84
DN 4,20,2,3168
M a,168,v,40,v,88
s_add_u32 m0, s92, 16896
s_mov_b32 s2, 376832
M a,176,v,44,v,80
EX 114
M a,180,v,44,v,84
EX 118
M a,184,v,44,v,88
s_waitcnt lgkmcnt(0)
s_waitcnt vmcnt(8)
M a,192,v,48,v,80
s_mov_b64 exec, 0
s_branch L_pad21
L_ret21:
s_mov_b64 exec, -1
s_barrier
RD v,32,1,50688
M a,196,v,48,v,84
RD v,36,1,50752
AD 16,16,114
M a,200,v,48,v,88
RD v,40,1,50816
AD 17,17,118
M a,208,v,52,v,80
RD v,44,1,50880
M a,212,v,52,v,84
DN 4,24,2,0
M a,216,v,52,v,88
EX 122
M a,224,v,56,v,80
EX 115
M a,228,v,56,v,84
EX 119
M a,232,v,56,v,88
EX 123
M a,240,v,60,v,80
AD 18,18,122
AD 16,16,115
M a,244,v,60,v,84
AD 17,17,119
AD 18,18,123
M a,248,v,60,v,88
v_max3_f32 v20, v16, v17, v18
v_cmp_lt_f32 vcc, 0x4b800000, v20
s_waitcnt lgkmcnt(0)
CV 80,96
CV 81,98
s_cbranch_vccnz L_rsB20
L_rbB20:
MC 96,v,32,128,64
CV 84,100
CV 85,102
M v,96,v,36,v,144
RD v,48,1,50944
CV 88,104
M v,96,v,40,v,160
RD v,52,1,51008
CV 89,106
M v,96,v,44,v,176
RD v,56,1,51072
CV 82,112
MC 100,v,32,132,68
RD v,60,1,51136
CV 83,114
M v,100,v,36,v,148
DN 4,28,2,1056
M v,100,v,40,v,164
CV 86,116
CV 87,118
M v,100,v,44,v,180
CV 90,120
CV 91,122
MC 104,v,32,136,72
RD v,32,1,51200
AD 12,12,16
M v,104,v,36,v,152
RD v,36,1,51264
AD 13,13,17
M v,104,v,40,v,168
RD v,40,1,51328
AD 14,14,18
M v,104,v,44,v,184
s_waitcnt lgkmcnt(3)
RD v,44,1,51392
M v,96,v,48,v,192
M v,96,v,52,v,208
DN 4,32,2,2112
M v,96,v,56,v,224
M v,96,v,60,v,240
v_xor_b32 v2, 81920, v2
M v,100,v,48,v,196
M v,100,v,52,v,212
M v,100,v,56,v,228
M v,100,v,60,v,244
M v,104,v,48,v,200
RD v,48,1,51456
M v,104,v,52,v,216
EX 96
M v,104,v,56,v,232
EX 97
M v,104,v,60,v,248
s_waitcnt lgkmcnt(1)
RD v,52,1,51520
MC 112,v,32,128,64
RD v,56,1,51584
AD 16,96,97
M v,112,v,36,v,144
DN 4,36,2,3168
M v,112,v,40,v,160
RD v,60,1,51648
s_add_u32 m0, s92, 33792
M v,112,v,44,v,176
EX 100
MC 116,v,32,132,68
EX 101
M v,116,v,36,v,148
s_mov_b32 s2, 409600
AD 17,100,101
M v,116,v,40,v,164
EX 104
M v,116,v,44,v,180
EX 105
MC 120,v,32,136,72
EX 98
M v,120,v,36,v,152
EX 102
M v,120,v,40,v,168
EX 106
M v,120,v,44,v,184
s_waitcnt lgkmcnt(0)
s_waitcnt vmcnt(8)
M v,112,v,48,v,192
s_barrier
TR v,32,0
M v,112,v,52,v,208
TR v,34,512
AD 18,104,105
M v,112,v,56,v,224
TR v,36,32
AD 16,16,98
M v,112,v,60,v,240
TR v,38,544
AD 17,17,102
M v,116,v,48,v,196
TR v,40,64
AD 18,18,106
M v,116,v,52,v,212
TR v,42,576
M v,116,v,56,v,228
TR v,44,96
TR v,46,608
M v,116,v,60,v,244
DN 4,8,2,0
M v,120,v,48,v,200
EX 99
M v,120,v,52,v,216
TR v,48,128
AD 16,16,99
M v,120,v,56,v,232
EX 103
M v,120,v,60,v,248
s_waitcnt lgkmcnt(1)
TR v,50,640
M a,0,v,32,v,80
DN 4,12,2,1056
M a,4,v,32,v,84
TR v,52,160
AD 17,17,103
M a,8,v,32,v,88
EX 107
M a,16,v,36,v,80
TR v,54,672
AD 18,18,107
M a,20,v,36,v,84
TR v,56,192
M a,24,v,36,v,88
TR v,58,704
M a,32,v,40,v,80
TR v,60,224
TR v,62,736
M a,36,v,40,v,84
EX 112
M a,40,v,40,v,88
TR v,32,256
AD 16,16,112
M a,48,v,44,v,80
EX 116
M a,52,v,44,v,84
DN 4,16,2,2112
M a,56,v,44,v,88
s_waitcnt lgkmcnt(1)
TR v,34,768
M a,64,v,48,v,80
TR v,36,288
AD 17,17,116
M a,68,v,48,v,84
EX 120
M a,72,v,48,v,88
TR v,38,800
AD 18,18,120
M a,80,v,52,v,80
TR v,40,320
v_xor_b32 v1, 81920, v1
M a,84,v,52,v,84
TR v,42,832
M a,88,v,52,v,88
TR v,44,352
M a,96,v,56,v,80
TR v,46,864
M a,100,v,56,v,84
EX 113
M a,104,v,56,v,88
TR v,48,384
AD 16,16,113
M a,112,v,60,v,80
EX 117
M a,116,v,60,v,84
DN 4,20,2,3168
M a,120,v,60,v,88
s_waitcnt lgkmcnt(1)
TR v,50,896
M a,128,v,32,v,80
TR v,52,416
s_add_u32 m0, s92, 0
M a,132,v,32,v,84
TR v,54,928
s_mov_b32 s2, 393216
M a,136,v,32,v,88
TR v,56,448
AD 17,17,117
M a,144,v,36,v,80
TR v,58,960
M a,148,v,36,v,84
TR v,60,480
M a,152,v,36,v,88
TR v,62,992
M a,160,v,40,v,80
EX 121
M a,164,v,40,v,84
EX 114
M a,168,v,40,v,88
EX 118
M a,176,v,44,v,80
DN 4,24,2,0
M a,180,v,44,v,84
EX 122
M a,184,v,44,v,88
s_waitcnt lgkmcnt(0)
s_waitcnt vmcnt(9)
M a,192,v,48,v,80
s_barrier
RD v,32,1,50688
M a,196,v,48,v,84
RD v,36,1,50752
AD 18,18,121
M a,200,v,48,v,88
RD v,40,1,50816
AD 16,16,114
M a,208,v,52,v,80
RD v,44,1,50880
AD 17,17,118
M a,212,v,52,v,84
EX 115
M a,216,v,52,v,88
EX 119
M a,224,v,56,v,80
EX 123
M a,228,v,56,v,84
AD 18,18,122
AD 16,16,115
M a,232,v,56,v,88
AD 17,17,119
AD 18,18,123
M a,240,v,60,v,80
v_max3_f32 v20, v16, v17, v18
v_cmp_lt_f32 vcc, 0x4b800000, v20
M a,244,v,60,v,84
s_waitcnt lgkmcnt(0)
CV 80,96
M a,248,v,60,v,88
CV 81,98
CV 84,100
s_cbranch_vccnz L_rsB21
L_rbB21:
MC 96,v,32,128,64
DN 4,28,2,1056
M v,96,v,36,v,144
RD v,48,1,50944
CV 85,102
M v,96,v,40,v,160
RD v,52,1,51008
CV 88,104
M v,96,v,44,v,176
RD v,56,1,51072
CV 89,106
MC 100,v,32,132,68
RD v,60,1,51136
CV 82,112
M v,100,v,36,v,148
CV 83,114
CV 86,116
M v,100,v,40,v,164
CV 87,118
CV 90,120
M v,100,v,44,v,180
CV 91,122
AD 12,12,16
MC 104,v,32,136,72
DN 4,32,2,2112
M v,104,v,36,v,152
RD v,32,1,51200
AD 13,13,17
M v,104,v,40,v,168
RD v,36,1,51264
AD 14,14,18
M v,104,v,44,v,184
s_waitcnt lgkmcnt(2)
RD v,40,1,51328
M v,96,v,48,v,192
RD v,44,1,51392
M v,96,v,52,v,208
M v,96,v,56,v,224
M v,96,v,60,v,240
v_xor_b32 v2, 81920, v2
M v,100,v,48,v,196
M v,100,v,52,v,212
M v,100,v,56,v,228
M v,100,v,60,v,244
DN 4,36,2,3168
M v,104,v,48,v,200
RD v,48,1,51456
s_add_u32 m0, s92, 50688
M v,104,v,52,v,216
RD v,52,1,51520
s_mov_b32 s2, 425984
M v,104,v,56,v,232
EX 96
M v,104,v,60,v,248
s_waitcnt lgkmcnt(2)
RD v,56,1,51584
MC 112,v,32,128,64
EX 97
M v,112,v,36,v,144
RD v,60,1,51648
AD 16,96,97
M v,112,v,40,v,160
EX 100
M v,112,v,44,v,176
EX 101
MC 116,v,32,132,68
EX 104
M v,116,v,36,v,148
EX 105
M v,116,v,40,v,164
EX 98
M v,116,v,44,v,180
DN 4,8,2,0
MC 120,v,32,136,72
EX 102
M v,120,v,36,v,152
EX 106
M v,120,v,40,v,168
AD 17,100,101
AD 18,104,105
M v,120,v,44,v,184
s_waitcnt lgkmcnt(0)
s_waitcnt vmcnt(9)
M v,112,v,48,v,192
s_barrier
TR v,32,16896
M v,112,v,52,v,208
TR v,34,17408
AD 16,16,98
M v,112,v,56,v,224
TR v,36,16928
AD 17,17,102
M v,112,v,60,v,240
TR v,38,17440
AD 18,18,106
M v,116,v,48,v,196
TR v,40,16960
M v,116,v,52,v,212
TR v,42,17472
M v,116,v,56,v,228
TR v,44,16992
TR v,46,17504
M v,116,v,60,v,244
DN 4,12,2,1056
M v,120,v,48,v,200
EX 99
M v,120,v,52,v,216
TR v,48,17024
AD 16,16,99
M v,120,v,56,v,232
EX 103
M v,120,v,60,v,248
s_waitcnt lgkmcnt(1)
TR v,50,17536
M a,0,v,32,v,80
TR v,52,17056
AD 17,17,103
M a,4,v,32,v,84
TR v,54,17568
v_bfe_u32 v6, v4, 7, 3
M a,8,v,32,v,88
TR v,56,17088
v_mul_u32_u24 v7, 14336, v6
M a,16,v,36,v,80
TR v,58,17600
v_lshlrev_b32 v6, 4, s95
M a,20,v,36,v,84
TR v,60,17120
v_and_b32 v6, 64, v6
M a,24,v,36,v,88
TR v,62,17632
v_xor_b32 v6, v6, v4
M a,32,v,40,v,80
DN 4,16,2,2112
M a,36,v,40,v,84
TR v,32,17152
v_xor_b32 v6, 64, v6
M a,40,v,40,v,88
TR v,34,17664
v_and_b32 v6, 0x70, v6
M a,48,v,44,v,80
TR v,36,17184
v_add_u32 v7, v6, v7
M a,52,v,44,v,84
TR v,38,17696
v_bfe_u32 v6, v4, 12, 1
M a,56,v,44,v,88
s_waitcnt lgkmcnt(4)
TR v,40,17216
M a,64,v,48,v,80
TR v,42,17728
v_mul_u32_u24 v6, 7168, v6
M a,68,v,48,v,84
TR v,44,17248
v_add_u32 v7, v6, v7
M a,72,v,48,v,88
TR v,46,17760
v_lshrrev_b32 v6, 13, v4
M a,80,v,52,v,80
TR v,48,17280
v_xor_b32 v1, 81920, v1
M a,84,v,52,v,84
TR v,50,17792
v_mul_u32_u24 v6, 3584, v6
M a,88,v,52,v,88
DN 4,20,2,3168
M a,96,v,56,v,80
TR v,52,17312
s_add_u32 m0, s92, 81920
M a,100,v,56,v,84
TR v,54,17824
s_mov_b32 s2, 409600
M a,104,v,56,v,88
TR v,56,17344
v_add_u32 v7, v6, v7
M a,112,v,60,v,80
EX 107
M a,116,v,60,v,84
TR v,58,17856
AD 18,18,107
M a,120,v,60,v,88
s_waitcnt lgkmcnt(6)
TR v,60,17376
M a,128,v,32,v,80
EX 112
M a,132,v,32,v,84
TR v,62,17888
AD 16,16,112
M a,136,v,32,v,88
EX 116
M a,144,v,36,v,80
EX 120
M a,148,v,36,v,84
DN 4,24,2,0
M a,152,v,36,v,88
EX 113
M a,160,v,40,v,80
EX 117
M a,164,v,40,v,84
EX 121
M a,168,v,40,v,88
AD 17,17,116
AD 18,18,120
M a,176,v,44,v,80
EX 114
M a,180,v,44,v,84
EX 118
M a,184,v,44,v,88
s_waitcnt lgkmcnt(0)
s_waitcnt vmcnt(9)
M a,192,v,48,v,80
s_mov_b64 exec, 0
s_branch L_pad22
L_ret22:
s_mov_b64 exec, -1
s_barrier
RD v,32,1,33792
M a,196,v,48,v,84
RD v,36,1,33856
AD 16,16,113
M a,200,v,48,v,88
RD v,40,1,33920
AD 17,17,117
M a,208,v,52,v,80
RD v,44,1,33984
AD 18,18,121
M a,212,v,52,v,84
EX 122
M a,216,v,52,v,88
EX 115
M a,224,v,56,v,80
EX 119
M a,228,v,56,v,84
EX 123
M a,232,v,56,v,88
AD 16,16,114
AD 17,17,118
M a,240,v,60,v,80
AD 18,18,122
AD 16,16,115
M a,244,v,60,v,84
AD 17,17,119
AD 18,18,123
M a,248,v,60,v,88
DN 4,28,2,1056
v_max3_f32 v20, v16, v17, v18
v_cmp_lt_f32 vcc, 0x4b800000, v20
s_waitcnt lgkmcnt(0)
CV 80,96
CV 81,98
s_cbranch_vccnz L_rsB22
L_rbB22:
MC 96,v,32,128,64
CV 84,100
CV 85,102
M v,96,v,36,v,144
RD v,48,1,34048
CV 88,104
M v,96,v,40,v,160
RD v,52,1,34112
CV 89,106
M v,96,v,44,v,176
RD v,56,1,34176
CV 82,112
MC 100,v,32,132,68
RD v,60,1,34240
CV 83,114
M v,100,v,36,v,148
DN 4,32,2,2112
M v,100,v,40,v,164
CV 86,116
CV 87,118
M v,100,v,44,v,180
CV 90,120
CV 91,122
MC 104,v,32,136,72
RD v,32,1,34304
AD 12,12,16
M v,104,v,36,v,152
RD v,36,1,34368
AD 13,13,17
M v,104,v,40,v,168
RD v,40,1,34432
AD 14,14,18
M v,104,v,44,v,184
s_waitcnt lgkmcnt(3)
RD v,44,1,34496
M v,96,v,48,v,192
M v,96,v,52,v,208
M v,96,v,56,v,224
M v,96,v,60,v,240
DN 4,36,2,3168
M v,100,v,48,v,196
s_add_u32 m0, s92, 132608
s_mov_b32 s2, 442368
M v,100,v,52,v,212
M v,100,v,56,v,228
M v,100,v,60,v,244
M v,104,v,48,v,200
EX 96
M v,104,v,52,v,216
EX 97
M v,104,v,56,v,232
RD v,48,1,34560
AD 16,96,97
M v,104,v,60,v,248
s_waitcnt lgkmcnt(1)
RD v,52,1,34624
MC 112,v,32,128,64
EX 100
M v,112,v,36,v,144
EX 101
M v,112,v,40,v,160
RD v,56,1,34688
AD 17,100,101
M v,112,v,44,v,176
RD v,60,1,34752
MC 116,v,32,132,68
DN 4,8,2,0
M v,116,v,36,v,148
EX 104
M v,116,v,40,v,164
EX 105
M v,116,v,44,v,180
EX 98
MC 120,v,32,136,72
EX 102
M v,120,v,36,v,152
EX 106
M v,120,v,40,v,168
AD 18,104,105
AD 16,16,98
M v,120,v,44,v,184
s_waitcnt lgkmcnt(0)
s_waitcnt vmcnt(9)
M v,112,v,48,v,192
s_barrier
TR v,32,0
M v,112,v,52,v,208
TR v,34,512
AD 17,17,102
M v,112,v,56,v,224
TR v,36,32
AD 18,18,106
M v,112,v,60,v,240
TR v,38,544
M v,116,v,48,v,196
TR v,40,64
M v,116,v,52,v,212
TR v,42,576
M v,116,v,56,v,228
TR v,44,96
TR v,46,608
M v,116,v,60,v,244
DN 4,12,2,1056
M v,120,v,48,v,200
EX 99
M v,120,v,52,v,216
TR v,48,128
AD 16,16,99
M v,120,v,56,v,232
EX 103
M v,120,v,60,v,248
s_waitcnt lgkmcnt(1)
TR v,50,640
M a,0,v,32,v,80
TR v,52,160
AD 17,17,103
M a,4,v,32,v,84
DN 4,16,2,2112
M a,8,v,32,v,88
EX 107
M a,16,v,36,v,80
TR v,54,672
AD 18,18,107
M a,20,v,36,v,84
TR v,56,192
M a,24,v,36,v,88
TR v,58,704
M a,32,v,40,v,80
TR v,60,224
TR v,62,736
M a,36,v,40,v,84
EX 112
M a,40,v,40,v,88
TR v,32,256
AD 16,16,112
M a,48,v,44,v,80
TR v,34,768
v_bfe_u32 v8, v4, 8, 2
M a,52,v,44,v,84
TR v,36,288
v_lshrrev_b32 v9, 14, s95
M a,56,v,44,v,88
s_waitcnt lgkmcnt(3)
TR v,38,800
M a,64,v,48,v,80
TR v,40,320
v_add_lshl_u32 v8, v8, v9, 7
M a,68,v,48,v,84
TR v,42,832
v_mov_b32 v9, 0
M a,72,v,48,v,88
DN 4,20,2,3168
M a,80,v,52,v,80
TR v,44,352
s_add_u32 m0, s92, 16896
M a,84,v,52,v,84
TR v,46,864
s_mov_b32 s2, 425984
M a,88,v,52,v,88
s_getpc_b64 s[100:101]
s_add_u32 s100, s100, L_c3B-.
s_addc_u32 s101, s101, 0
M a,96,v,56,v,80
TR v,48,384
v_lshl_add_u64 v[8:9], v[8:9], 0, s[100:101]
M a,100,v,56,v,84
global_load_dword v10, v[8:9], off
M a,104,v,56,v,88
EX 116
M a,112,v,60,v,80
TR v,50,896
AD 17,17,116
M a,116,v,60,v,84
EX 120
M a,120,v,60,v,88
s_waitcnt lgkmcnt(2)
TR v,52,416
M a,128,v,32,v,80
TR v,54,928
AD 18,18,120
M a,132,v,32,v,84
DN 4,24,2,0
M a,136,v,32,v,88
EX 113
M a,144,v,36,v,80
TR v,56,448
AD 16,16,113
M a,148,v,36,v,84
TR v,58,960
M a,152,v,36,v,88
TR v,60,480
M a,160,v,40,v,80
TR v,62,992
M a,164,v,40,v,84
EX 117
M a,168,v,40,v,88
EX 121
M a,176,v,44,v,80
EX 114
M a,180,v,44,v,84
EX 118
M a,184,v,44,v,88
s_waitcnt lgkmcnt(0)
s_waitcnt vmcnt(10)
M a,192,v,48,v,80
s_barrier
RD v,32,1,50688
M a,196,v,48,v,84
RD v,36,1,50752
AD 17,17,117
M a,200,v,48,v,88
RD v,40,1,50816
AD 18,18,121
M a,208,v,52,v,80
RD v,44,1,50880
AD 16,16,114
M a,212,v,52,v,84
DN 4,28,2,1056
M a,216,v,52,v,88
EX 122
M a,224,v,56,v,80
EX 115
M a,228,v,56,v,84
EX 119
M a,232,v,56,v,88
EX 123
M a,240,v,60,v,80
AD 17,17,118
AD 18,18,122
M a,244,v,60,v,84
AD 16,16,115
AD 17,17,119
M a,248,v,60,v,88
AD 18,18,123
v_max3_f32 v20, v16, v17, v18
v_cmp_lt_f32 vcc, 0x4b800000, v20
s_waitcnt lgkmcnt(0)
CV 80,96
CV 81,98
s_cbranch_vccnz L_rsB23
L_rbB23:
MC 96,v,32,128,64
DN 4,32,2,2112
M v,96,v,36,v,144
CV 84,100
CV 85,102
M v,96,v,40,v,160
RD v,48,1,50944
CV 88,104
M v,96,v,44,v,176
RD v,52,1,51008
CV 89,106
MC 100,v,32,132,68
RD v,56,1,51072
CV 82,112
M v,100,v,36,v,148
RD v,60,1,51136
CV 83,114
M v,100,v,40,v,164
CV 86,116
CV 87,118
M v,100,v,44,v,180
CV 90,120
CV 91,122
MC 104,v,32,136,72
RD v,32,1,51200
AD 12,12,16
M v,104,v,36,v,152
RD v,36,1,51264
AD 13,13,17
M v,104,v,40,v,168
DN 4,36,2,3168
M v,104,v,44,v,184
s_waitcnt lgkmcnt(2)
RD v,40,1,51328
M v,96,v,48,v,192
RD v,44,1,51392
s_add_u32 m0, s92, 33792
M v,96,v,52,v,208
s_mov_b32 s2, 458752
AD 14,14,18
M v,96,v,56,v,224
M v,96,v,60,v,240
v_xor_b32 v2, 81920, v2
M v,100,v,48,v,196
M v,100,v,52,v,212
M v,100,v,56,v,228
M v,100,v,60,v,244
M v,104,v,48,v,200
RD v,48,1,51456
M v,104,v,52,v,216
DN 4,8,2,0
M v,104,v,56,v,232
EX 96
M v,104,v,60,v,248
s_waitcnt lgkmcnt(1)
RD v,52,1,51520
MC 112,v,32,128,64
EX 97
M v,112,v,36,v,144
RD v,56,1,51584
AD 16,96,97
M v,112,v,40,v,160
EX 100
M v,112,v,44,v,176
RD v,60,1,51648
MC 116,v,32,132,68
EX 101
M v,116,v,36,v,148
EX 104
M v,116,v,40,v,164
EX 105
M v,116,v,44,v,180
EX 98
MC 120,v,32,136,72
EX 102
M v,120,v,36,v,152
DN 4,12,2,1056
M v,120,v,40,v,168
EX 106
M v,120,v,44,v,184
s_waitcnt lgkmcnt(0)
s_waitcnt vmcnt(11)
M v,112,v,48,v,192
s_barrier
TR v,32,0
M v,112,v,52,v,208
TR v,34,512
AD 17,100,101
M v,112,v,56,v,224
TR v,36,32
AD 18,104,105
M v,112,v,60,v,240
TR v,38,544
AD 16,16,98
M v,116,v,48,v,196
TR v,40,64
AD 17,17,102
M v,116,v,52,v,212
TR v,42,576
AD 18,18,106
M v,116,v,56,v,228
TR v,44,96
TR v,46,608
M v,116,v,60,v,244
EX 99
M v,120,v,48,v,200
DN 4,16,2,2112
M v,120,v,52,v,216
TR v,48,128
AD 16,16,99
M v,120,v,56,v,232
EX 103
M v,120,v,60,v,248
s_waitcnt lgkmcnt(1)
TR v,50,640
M a,0,v,32,v,80
TR v,52,160
AD 17,17,103
M a,4,v,32,v,84
EX 107
M a,8,v,32,v,88
TR v,54,672
AD 18,18,107
M a,16,v,36,v,80
TR v,56,192
M a,20,v,36,v,84
TR v,58,704
M a,24,v,36,v,88
TR v,60,224
M a,32,v,40,v,80
TR v,62,736
M a,36,v,40,v,84
DN 4,20,2,3168
M a,40,v,40,v,88
TR v,32,256
s_add_u32 m0, s92, 0
M a,48,v,44,v,80
TR v,34,768
s_mov_b32 s2, 442368
M a,52,v,44,v,84
EX 112
M a,56,v,44,v,88
s_waitcnt lgkmcnt(2)
TR v,36,288
M a,64,v,48,v,80
TR v,38,800
AD 16,16,112
M a,68,v,48,v,84
EX 116
M a,72,v,48,v,88
TR v,40,320
AD 17,17,116
M a,80,v,52,v,80
TR v,42,832
v_xor_b32 v1, 81920, v1
M a,84,v,52,v,84
TR v,44,352
M a,88,v,52,v,88
TR v,46,864
M a,96,v,56,v,80
EX 120
M a,100,v,56,v,84
DN 4,24,2,0
M a,104,v,56,v,88
TR v,48,384
AD 18,18,120
M a,112,v,60,v,80
EX 113
M a,116,v,60,v,84
TR v,50,896
AD 16,16,113
M a,120,v,60,v,88
s_waitcnt lgkmcnt(2)
TR v,52,416
M a,128,v,32,v,80
EX 117
M a,132,v,32,v,84
TR v,54,928
AD 17,17,117
M a,136,v,32,v,88
EX 121
M a,144,v,36,v,80
TR v,56,448
AD 18,18,121
M a,148,v,36,v,84
TR v,58,960
M a,152,v,36,v,88
TR v,60,480
M a,160,v,40,v,80
TR v,62,992
M a,164,v,40,v,84
DN 4,28,2,1056
M a,168,v,40,v,88
EX 114
M a,176,v,44,v,80
EX 118
M a,180,v,44,v,84
EX 122
M a,184,v,44,v,88
s_waitcnt lgkmcnt(0)
s_waitcnt vmcnt(11)
M a,192,v,48,v,80
s_barrier
RD v,32,1,50688
M a,196,v,48,v,84
RD v,36,1,50752
AD 16,16,114
M a,200,v,48,v,88
RD v,40,1,50816
AD 17,17,118
M a,208,v,52,v,80
RD v,44,1,50880
AD 18,18,122
M a,212,v,52,v,84
EX 115
M a,216,v,52,v,88
EX 119
M a,224,v,56,v,80
EX 123
M a,228,v,56,v,84
AD 16,16,115
AD 17,17,119
M a,232,v,56,v,88
RD v,48,1,50944
AD 18,18,123
M a,240,v,60,v,80
v_max3_f32 v20, v16, v17, v18
v_cmp_lt_f32 vcc, 0x4b800000, v20
M a,244,v,60,v,84
s_waitcnt lgkmcnt(1)
CV 80,96
M a,248,v,60,v,88
DN 4,32,2,2112
CV 81,98
s_cbranch_vccnz L_rsB24
L_rbB24:
MC 96,v,32,128,64
CV 84,100
CV 85,102
M v,96,v,36,v,144
RD v,52,1,51008
CV 88,104
M v,96,v,40,v,160
RD v,56,1,51072
CV 89,106
M v,96,v,44,v,176
RD v,60,1,51136
CV 82,112
MC 100,v,32,132,68
CV 83,114
CV 86,116
M v,100,v,36,v,148
DN 4,36,2,3168
M v,100,v,40,v,164
s_add_u32 m0, s92, 50688
s_mov_b32 s2, 475136
M v,100,v,44,v,180
CV 87,118
CV 90,120
MC 104,v,32,136,72
RD v,32,1,51200
CV 91,122
M v,104,v,36,v,152
RD v,36,1,51264
AD 12,12,16
M v,104,v,40,v,168
RD v,40,1,51328
AD 13,13,17
M v,104,v,44,v,184
s_waitcnt lgkmcnt(3)
RD v,44,1,51392
M v,96,v,48,v,192
AD 14,14,18
M v,96,v,52,v,208
M v,96,v,56,v,224
M v,96,v,60,v,240
v_xor_b32 v2, 81920, v2
M v,100,v,48,v,196
DN 4,8,2,0
M v,100,v,52,v,212
M v,100,v,56,v,228
M v,100,v,60,v,244
M v,104,v,48,v,200
RD v,48,1,51456
M v,104,v,52,v,216
EX 96
M v,104,v,56,v,232
EX 97
M v,104,v,60,v,248
s_waitcnt lgkmcnt(1)
RD v,52,1,51520
MC 112,v,32,128,64
RD v,56,1,51584
AD 16,96,97
M v,112,v,36,v,144
EX 100
M v,112,v,40,v,160
EX 101
M v,112,v,44,v,176
RD v,60,1,51648
AD 17,100,101
MC 116,v,32,132,68
DN 4,12,2,1056
M v,116,v,36,v,148
EX 104
M v,116,v,40,v,164
EX 105
M v,116,v,44,v,180
EX 98
MC 120,v,32,136,72
EX 102
M v,120,v,36,v,152
EX 106
M v,120,v,40,v,168
AD 18,104,105
AD 16,16,98
M v,120,v,44,v,184
s_waitcnt lgkmcnt(0)
s_waitcnt vmcnt(10)
M v,112,v,48,v,192
s_mov_b64 exec, 0
s_branch L_pad23
L_ret23:
s_branch L_pad24
L_ret24:
s_mov_b64 exec, -1
s_barrier
TR v,32,16896
M v,112,v,52,v,208
TR v,34,17408
AD 17,17,102
M v,112,v,56,v,224
TR v,36,16928
AD 18,18,106
M v,112,v,60,v,240
TR v,38,17440
M v,116,v,48,v,196
TR v,40,16960
M v,116,v,52,v,212
TR v,42,17472
M v,116,v,56,v,228
TR v,44,16992
TR v,46,17504
M v,116,v,60,v,244
DN 4,16,2,2112
M v,120,v,48,v,200
EX 99
M v,120,v,52,v,216
TR v,48,17024
AD 16,16,99
M v,120,v,56,v,232
EX 103
M v,120,v,60,v,248
s_waitcnt lgkmcnt(1)
TR v,50,17536
M a,0,v,32,v,80
TR v,52,17056
AD 17,17,103
M a,4,v,32,v,84
EX 107
M a,8,v,32,v,88
TR v,54,17568
AD 18,18,107
M a,16,v,36,v,80
TR v,56,17088
M a,20,v,36,v,84
TR v,58,17600
M a,24,v,36,v,88
TR v,60,17120
M a,32,v,40,v,80
TR v,62,17632
M a,36,v,40,v,84
DN 4,20,2,3168
M a,40,v,40,v,88
TR v,32,17152
s_add_u32 m0, s92, 81920
M a,48,v,44,v,80
TR v,34,17664
s_mov_b32 s2, 458752
M a,52,v,44,v,84
EX 112
M a,56,v,44,v,88
s_waitcnt lgkmcnt(2)
TR v,36,17184
M a,64,v,48,v,80
TR v,38,17696
AD 16,16,112
M a,68,v,48,v,84
EX 116
M a,72,v,48,v,88
TR v,40,17216
AD 17,17,116
M a,80,v,52,v,80
TR v,42,17728
v_xor_b32 v1, 81920, v1
M a,84,v,52,v,84
TR v,44,17248
M a,88,v,52,v,88
TR v,46,17760
M a,96,v,56,v,80
DN 4,24,2,0
M a,100,v,56,v,84
EX 120
M a,104,v,56,v,88
TR v,48,17280
AD 18,18,120
M a,112,v,60,v,80
EX 113
M a,116,v,60,v,84
TR v,50,17792
AD 16,16,113
M a,120,v,60,v,88
s_waitcnt lgkmcnt(2)
TR v,52,17312
M a,128,v,32,v,80
EX 117
M a,132,v,32,v,84
TR v,54,17824
AD 17,17,117
M a,136,v,32,v,88
DN 4,28,2,1056
M a,144,v,36,v,80
TR v,56,17344
M a,148,v,36,v,84
TR v,58,17856
M a,152,v,36,v,88
TR v,60,17376
M a,160,v,40,v,80
TR v,62,17888
M a,164,v,40,v,84
EX 121
M a,168,v,40,v,88
EX 114
M a,176,v,44,v,80
EX 118
M a,180,v,44,v,84
EX 122
M a,184,v,44,v,88
s_waitcnt lgkmcnt(0)
s_waitcnt vmcnt(10)
M a,192,v,48,v,80
s_barrier
RD v,32,1,33792
M a,196,v,48,v,84
RD v,36,1,33856
AD 18,18,121
M a,200,v,48,v,88
RD v,40,1,33920
AD 16,16,114
M a,208,v,52,v,80
RD v,44,1,33984
AD 17,17,118
M a,212,v,52,v,84
DN 4,32,2,2112
M a,216,v,52,v,88
EX 115
M a,224,v,56,v,80
EX 119
M a,228,v,56,v,84
EX 123
M a,232,v,56,v,88
AD 18,18,122
AD 16,16,115
M a,240,v,60,v,80
AD 17,17,119
AD 18,18,123
M a,244,v,60,v,84
v_max3_f32 v20, v16, v17, v18
v_cmp_lt_f32 vcc, 0x4b800000, v20
M a,248,v,60,v,88
s_waitcnt lgkmcnt(0)
CV 80,96
CV 81,98
s_cbranch_vccnz L_rsB25
L_rbB25:
MC 96,v,32,128,64
CV 84,100
CV 85,102
M v,96,v,36,v,144
RD v,48,1,34048
CV 88,104
M v,96,v,40,v,160
RD v,52,1,34112
CV 89,106
M v,96,v,44,v,176
RD v,56,1,34176
CV 82,112
MC 100,v,32,132,68
RD v,60,1,34240
CV 83,114
M v,100,v,36,v,148
DN 4,36,2,3168
M v,100,v,40,v,164
s_branch L_c3B
L_rsA26:
s_mov_b32 s100, 458752
s_call_b64 s[98:99], L_rareA
s_branch L_rbA26
L_rsA27:
s_mov_b32 s100, 475136
s_call_b64 s[98:99], L_rareA
s_branch L_rbA27
L_rsA28:
s_mov_b32 s100, 491520
s_call_b64 s[98:99], L_rareA
s_branch L_rbA28
L_rsA29:
s_mov_b32 s100, 507904
s_call_b64 s[98:99], L_rareA
s_branch L_rbA29
.p2align 12
L_c3A:
L_pad24:
s_cbranch_execz L_ret24
M v,104,a,232,v,168
AD 14,14,18
AD 15,15,19
M v,104,a,236,v,184
MC 108,a,224,140,76
RD a,224,1,34304
M v,108,a,228,v,156
RD a,228,1,34368
M v,108,a,232,v,172
RD a,232,1,34432
M v,108,a,236,v,188
s_waitcnt lgkmcnt(3)
RD a,236,1,34496
M v,96,a,240,v,192
DN 4,8,2,0
M v,96,a,244,v,208
M v,96,a,248,v,224
M v,96,a,252,v,240
M v,100,a,240,v,196
M v,100,a,244,v,212
M v,100,a,248,v,228
M v,100,a,252,v,244
M v,104,a,240,v,200
M v,104,a,244,v,216
M v,104,a,248,v,232
M v,104,a,252,v,248
EX 96
M v,108,a,240,v,204
EX 97
M v,108,a,244,v,220
RD a,240,1,34560
AD 16,96,97
M v,108,a,248,v,236
EX 100
M v,108,a,252,v,252
s_waitcnt lgkmcnt(1)
RD a,244,1,34624
MC 112,a,224,128,64
DN 4,12,2,1056
M v,112,a,228,v,144
EX 101
M v,112,a,232,v,160
RD a,248,1,34688
AD 17,100,101
M v,112,a,236,v,176
EX 104
MC 116,a,224,132,68
EX 105
M v,116,a,228,v,148
RD a,252,1,34752
AD 18,104,105
M v,116,a,232,v,164
EX 98
M v,116,a,236,v,180
EX 102
MC 120,a,224,136,72
EX 106
M v,120,a,228,v,152
EX 108
M v,120,a,232,v,168
EX 109
M v,120,a,236,v,184
EX 99
MC 124,a,224,140,76
EX 103
M v,124,a,228,v,156
EX 107
M v,124,a,232,v,172
DN 4,16,2,2112
M v,124,a,236,v,188
s_waitcnt lgkmcnt(0)
s_waitcnt vmcnt(11)
M v,112,a,240,v,192
s_barrier
TR a,224,0
M v,112,a,244,v,208
TR a,226,512
AD 16,16,98
M v,112,a,248,v,224
TR a,228,32
AD 17,17,102
M v,112,a,252,v,240
TR a,230,544
AD 18,18,106
M v,116,a,240,v,196
TR a,232,64
AD 19,108,109
M v,116,a,244,v,212
TR a,234,576
AD 16,16,99
M v,116,a,248,v,228
TR a,236,96
AD 17,17,103
M v,116,a,252,v,244
TR a,238,608
AD 18,18,107
M v,120,a,240,v,200
EX 110
M v,120,a,244,v,216
EX 111
M v,120,a,248,v,232
EX 112
M v,120,a,252,v,248
EX 116
M v,124,a,240,v,204
TR a,240,128
AD 19,19,110
M v,124,a,244,v,220
DN 4,20,2,3168
M v,124,a,248,v,236
TR a,242,640
s_add_u32 m0, s92, 16896
M v,124,a,252,v,252
s_waitcnt lgkmcnt(2)
TR a,244,160
M a,0,a,224,v,80
TR a,246,672
s_mov_b32 s2, 475136
M a,4,a,224,v,84
TR a,248,192
AD 19,19,111
M a,8,a,224,v,88
TR a,250,704
AD 16,16,112
M a,12,a,224,v,92
TR a,252,224
AD 17,17,116
M a,16,a,228,v,80
EX 120
M a,20,a,228,v,84
TR a,254,736
AD 18,18,120
M a,24,a,228,v,88
EX 113
M a,28,a,228,v,92
TR a,224,256
AD 16,16,113
M a,32,a,232,v,80
EX 117
M a,36,a,232,v,84
TR a,226,768
AD 17,17,117
M a,40,a,232,v,88
EX 121
M a,44,a,232,v,92
TR a,228,288
AD 18,18,121
M a,48,a,236,v,80
EX 124
M a,52,a,236,v,84
DN 4,24,2,0
M a,56,a,236,v,88
TR a,230,800
AD 19,19,124
M a,60,a,236,v,92
s_waitcnt lgkmcnt(4)
TR a,232,320
M a,64,a,240,v,80
EX 114
M a,68,a,240,v,84
TR a,234,832
AD 16,16,114
M a,72,a,240,v,88
EX 118
M a,76,a,240,v,92
TR a,236,352
AD 17,17,118
M a,80,a,244,v,80
EX 122
M a,84,a,244,v,84
TR a,238,864
AD 18,18,122
M a,88,a,244,v,88
EX 125
M a,92,a,244,v,92
TR a,240,384
AD 19,19,125
M a,96,a,248,v,80
EX 115
M a,100,a,248,v,84
TR a,242,896
AD 16,16,115
M a,104,a,248,v,88
EX 119
M a,108,a,248,v,92
TR a,244,416
AD 17,17,119
M a,112,a,252,v,80
DN 4,28,2,1056
M a,116,a,252,v,84
EX 123
M a,120,a,252,v,88
TR a,246,928
AD 18,18,123
M a,124,a,252,v,92
s_waitcnt lgkmcnt(4)
TR a,248,448
M a,128,a,224,v,80
TR a,250,960
v_max3_f32 v20, v16, v17, v18
M a,132,a,224,v,84
EX 126
M a,136,a,224,v,88
TR a,252,480
AD 19,19,126
M a,140,a,224,v,92
EX 127
M a,144,a,228,v,80
TR a,254,992
AD 19,19,127
M a,148,a,228,v,84
v_max_f32 v20, v20, v19
v_cmp_lt_f32 vcc, 0x4b800000, v20
M a,152,a,228,v,88
M a,156,a,228,v,92
M a,160,a,232,v,80
M a,164,a,232,v,84
M a,168,a,232,v,88
M a,172,a,232,v,92
DN 4,32,2,2112
M a,176,a,236,v,80
M a,180,a,236,v,84
M a,184,a,236,v,88
M a,188,a,236,v,92
s_waitcnt lgkmcnt(0)
s_waitcnt vmcnt(11)
M a,192,a,240,v,80
s_barrier
RD a,224,1,50688
M a,196,a,240,v,84
RD a,228,1,50752
M a,200,a,240,v,88
RD a,232,1,50816
M a,204,a,240,v,92
RD a,236,1,50880
M a,208,a,244,v,80
RD a,240,1,50944
M a,212,a,244,v,84
M a,216,a,244,v,88
M a,220,a,244,v,92
RD a,244,1,51008
M v,32,a,248,v,80
M v,36,a,248,v,84
M v,40,a,248,v,88
DN 4,36,2,3168
M v,44,a,248,v,92
RD a,248,1,51072
s_add_u32 m0, s92, 33792
M v,48,a,252,v,80
CV 80,96
CV 81,98
M v,52,a,252,v,84
CV 84,100
CV 85,102
M v,56,a,252,v,88
s_waitcnt lgkmcnt(3)
CV 88,104
M v,60,a,252,v,92
s_cbranch_vccnz L_rsA26
L_rbA26:
MC 96,a,224,128,64
RD a,252,1,51136
CV 89,106
M v,96,a,228,v,144
CV 92,108
CV 93,110
M v,96,a,232,v,160
s_mov_b32 s2, 507904
CV 82,112
M v,96,a,236,v,176
CV 83,114
CV 86,116
MC 100,a,224,132,68
CV 87,118
CV 90,120
M v,100,a,228,v,148
CV 91,122
CV 94,124
M v,100,a,232,v,164
CV 95,126
AD 12,12,16
M v,100,a,236,v,180
AD 13,13,17
AD 14,14,18
MC 104,a,224,136,72
AD 15,15,19
M v,104,a,228,v,152
DN 4,8,2,0
M v,104,a,232,v,168
M v,104,a,236,v,184
MC 108,a,224,140,76
RD a,224,1,51200
M v,108,a,228,v,156
RD a,228,1,51264
M v,108,a,232,v,172
RD a,232,1,51328
M v,108,a,236,v,188
s_waitcnt lgkmcnt(3)
RD a,236,1,51392
M v,96,a,240,v,192
M v,96,a,244,v,208
M v,96,a,248,v,224
M v,96,a,252,v,240
M v,100,a,240,v,196
v_xor_b32 v2, 81920, v2
M v,100,a,244,v,212
M v,100,a,248,v,228
M v,100,a,252,v,244
M v,104,a,240,v,200
M v,104,a,244,v,216
DN 4,12,2,1056
M v,104,a,248,v,232
EX 96
M v,104,a,252,v,248
EX 97
M v,108,a,240,v,204
RD a,240,1,51456
AD 16,96,97
M v,108,a,244,v,220
EX 100
M v,108,a,248,v,236
EX 101
M v,108,a,252,v,252
s_waitcnt lgkmcnt(1)
RD a,244,1,51520
MC 112,a,224,128,64
RD a,248,1,51584
AD 17,100,101
M v,112,a,228,v,144
EX 104
M v,112,a,232,v,160
EX 105
M v,112,a,236,v,176
RD a,252,1,51648
AD 18,104,105
MC 116,a,224,132,68
EX 98
M v,116,a,228,v,148
EX 102
M v,116,a,232,v,164
EX 106
M v,116,a,236,v,180
EX 108
MC 120,a,224,136,72
DN 4,16,2,2112
M v,120,a,228,v,152
EX 109
M v,120,a,232,v,168
EX 99
M v,120,a,236,v,184
EX 103
MC 124,a,224,140,76
EX 107
M v,124,a,228,v,156
EX 110
M v,124,a,232,v,172
AD 16,16,98
AD 17,17,102
M v,124,a,236,v,188
s_waitcnt lgkmcnt(0)
s_waitcnt vmcnt(11)
M v,112,a,240,v,192
s_barrier
TR a,224,0
M v,112,a,244,v,208
TR a,226,512
AD 18,18,106
M v,112,a,248,v,224
TR a,228,32
AD 19,108,109
M v,112,a,252,v,240
TR a,230,544
AD 16,16,99
M v,116,a,240,v,196
TR a,232,64
AD 17,17,103
M v,116,a,244,v,212
TR a,234,576
AD 18,18,107
M v,116,a,248,v,228
TR a,236,96
AD 19,19,110
M v,116,a,252,v,244
TR a,238,608
M v,120,a,240,v,200
DN 4,20,2,3168
M v,120,a,244,v,216
s_add_u32 m0, s92, 0
s_mov_b32 s2, 491520
M v,120,a,248,v,232
EX 111
M v,120,a,252,v,248
EX 112
M v,124,a,240,v,204
TR a,240,128
AD 19,19,111
M v,124,a,244,v,220
TR a,242,640
AD 16,16,112
M v,124,a,248,v,236
EX 116
M v,124,a,252,v,252
s_waitcnt lgkmcnt(2)
TR a,244,160
M a,0,a,224,v,80
TR a,246,672
AD 17,17,116
M a,4,a,224,v,84
EX 120
M a,8,a,224,v,88
TR a,248,192
AD 18,18,120
M a,12,a,224,v,92
EX 113
M a,16,a,228,v,80
TR a,250,704
AD 16,16,113
M a,20,a,228,v,84
EX 117
M a,24,a,228,v,88
TR a,252,224
AD 17,17,117
M a,28,a,228,v,92
TR a,254,736
M a,32,a,232,v,80
DN 4,24,2,0
M a,36,a,232,v,84
EX 121
M a,40,a,232,v,88
TR a,224,256
AD 18,18,121
M a,44,a,232,v,92
EX 124
M a,48,a,236,v,80
TR a,226,768
AD 19,19,124
M a,52,a,236,v,84
EX 114
M a,56,a,236,v,88
TR a,228,288
AD 16,16,114
M a,60,a,236,v,92
s_waitcnt lgkmcnt(3)
TR a,230,800
M a,64,a,240,v,80
EX 118
M a,68,a,240,v,84
TR a,232,320
AD 17,17,118
M a,72,a,240,v,88
EX 122
M a,76,a,240,v,92
TR a,234,832
AD 18,18,122
M a,80,a,244,v,80
TR a,236,352
v_xor_b32 v1, 81920, v1
M a,84,a,244,v,84
DN 4,28,2,1056
M a,88,a,244,v,88
EX 125
M a,92,a,244,v,92
TR a,238,864
AD 19,19,125
M a,96,a,248,v,80
EX 115
M a,100,a,248,v,84
TR a,240,384
AD 16,16,115
M a,104,a,248,v,88
EX 119
M a,108,a,248,v,92
TR a,242,896
AD 17,17,119
M a,112,a,252,v,80
EX 123
M a,116,a,252,v,84
TR a,244,416
AD 18,18,123
M a,120,a,252,v,88
TR a,246,928
v_max3_f32 v20, v16, v17, v18
M a,124,a,252,v,92
s_waitcnt lgkmcnt(4)
TR a,248,448
M a,128,a,224,v,80
EX 126
M a,132,a,224,v,84
TR a,250,960
AD 19,19,126
M a,136,a,224,v,88
EX 127
M a,140,a,224,v,92
TR a,252,480
AD 19,19,127
M a,144,a,228,v,80
TR a,254,992
v_max_f32 v20, v20, v19
M a,148,a,228,v,84
DN 4,32,2,2112
M a,152,a,228,v,88
v_cmp_lt_f32 vcc, 0x4b800000, v20
M a,156,a,228,v,92
M a,160,a,232,v,80
M a,164,a,232,v,84
M a,168,a,232,v,88
M a,172,a,232,v,92
M a,176,a,236,v,80
M a,180,a,236,v,84
M a,184,a,236,v,88
M a,188,a,236,v,92
s_waitcnt lgkmcnt(0)
s_waitcnt vmcnt(11)
M a,192,a,240,v,80
s_barrier
RD a,224,1,50688
M a,196,a,240,v,84
RD a,228,1,50752
s_mov_b32 s93, 229376
M a,200,a,240,v,88
RD a,232,1,50816
M a,204,a,240,v,92
RD a,236,1,50880
M a,208,a,244,v,80
DN 4,36,2,3168
M a,212,a,244,v,84
s_add_u32 m0, s92, 81920
s_mov_b32 s2, 507904
M a,216,a,244,v,88
RD a,240,1,50944
M a,220,a,244,v,92
RD a,244,1,51008
M v,32,a,248,v,80
M v,36,a,248,v,84
M v,40,a,248,v,88
M v,44,a,248,v,92
DL 7,72,93,0
M v,48,a,252,v,80
CV 80,96
CV 81,98
M v,52,a,252,v,84
CV 84,100
CV 85,102
M v,56,a,252,v,88
s_waitcnt lgkmcnt(2)
s_add_u32 m0, s92, 50688
M v,60,a,252,v,92
s_cbranch_vccnz L_rsA27
L_rbA27:
MC 96,a,224,128,64
CV 88,104
CV 89,106
M v,96,a,228,v,144
RD a,248,1,51072
CV 92,108
M v,96,a,232,v,160
RD a,252,1,51136
CV 93,110
M v,96,a,236,v,176
DN 4,24,2,0
MC 100,a,224,132,68
s_add_u32 m0, s92, 81920
CV 82,112
M v,100,a,228,v,148
CV 83,114
CV 86,116
M v,100,a,232,v,164
CV 87,118
CV 90,120
M v,100,a,236,v,180
CV 91,122
CV 94,124
MC 104,a,224,136,72
CV 95,126
AD 12,12,16
M v,104,a,228,v,152
AD 13,13,17
AD 14,14,18
M v,104,a,232,v,168
AD 15,15,19
M v,104,a,236,v,184
DL 7,76,93,1056
MC 108,a,224,140,76
s_add_u32 m0, s92, 50688
RD a,224,1,51200
M v,108,a,228,v,156
RD a,228,1,51264
M v,108,a,232,v,172
RD a,232,1,51328
M v,108,a,236,v,188
s_waitcnt lgkmcnt(3)
RD a,236,1,51392
M v,96,a,240,v,192
M v,96,a,244,v,208
L_pad25:
s_cbranch_execz L_ret25
M v,96,a,248,v,224
DN 4,28,2,1056
M v,96,a,252,v,240
s_add_u32 m0, s92, 81920
M v,100,a,240,v,196
v_xor_b32 v2, 81920, v2
M v,100,a,244,v,212
M v,100,a,248,v,228
M v,100,a,252,v,244
M v,104,a,240,v,200
M v,104,a,244,v,216
EX 96
M v,104,a,248,v,232
EX 97
M v,104,a,252,v,248
DL 7,80,93,2112
M v,108,a,240,v,204
s_add_u32 m0, s92, 50688
RD a,240,1,51456
M v,108,a,244,v,220
RD a,244,1,51520
AD 16,96,97
M v,108,a,248,v,236
EX 100
M v,108,a,252,v,252
s_waitcnt lgkmcnt(2)
RD a,248,1,51584
MC 112,a,224,128,64
EX 101
M v,112,a,228,v,144
DN 4,32,2,2112
M v,112,a,232,v,160
RD a,252,1,51648
s_add_u32 m0, s92, 81920
M v,112,a,236,v,176
EX 104
MC 116,a,224,132,68
EX 105
M v,116,a,228,v,148
EX 98
M v,116,a,232,v,164
EX 102
M v,116,a,236,v,180
EX 106
MC 120,a,224,136,72
EX 108
M v,120,a,228,v,152
EX 109
M v,120,a,232,v,168
AD 17,100,101
AD 18,104,105
M v,120,a,236,v,184
DL 7,84,93,3168
MC 124,a,224,140,76
s_add_u32 m0, s92, 50688
AD 16,16,98
M v,124,a,228,v,156
EX 99
M v,124,a,232,v,172
EX 103
M v,124,a,236,v,188
s_waitcnt lgkmcnt(0)
s_waitcnt vmcnt(15)
M v,112,a,240,v,192
s_barrier
TR a,224,16896
M v,112,a,244,v,208
DN 4,36,2,3168
M v,112,a,248,v,224
TR a,226,17408
s_add_u32 m0, s92, 132608
M v,112,a,252,v,240
TR a,228,16928
s_mov_b32 s93, 4194304
M v,116,a,240,v,196
TR a,230,17440
AD 17,17,102
M v,116,a,244,v,212
TR a,232,16960
AD 18,18,106
M v,116,a,248,v,228
TR a,234,17472
AD 19,108,109
M v,116,a,252,v,244
TR a,236,16992
AD 16,16,99
M v,120,a,240,v,200
TR a,238,17504
AD 17,17,103
M v,120,a,244,v,216
EX 107
M v,120,a,248,v,232
EX 110
M v,120,a,252,v,248
DL 4,88,93,0
M v,124,a,240,v,204
TR a,240,17024
s_mov_b32 s93, 5241824
M v,124,a,244,v,220
TR a,242,17536
AD 18,18,107
M v,124,a,248,v,236
TR a,244,17056
AD 19,19,110
M v,124,a,252,v,252
s_waitcnt lgkmcnt(3)
TR a,246,17568
M a,0,a,224,v,80
EX 111
M a,4,a,224,v,84
TR a,248,17088
AD 19,19,111
M a,8,a,224,v,88
EX 112
M a,12,a,224,v,92
TR a,250,17600
AD 16,16,112
M a,16,a,228,v,80
EX 116
M a,20,a,228,v,84
TR a,252,17120
AD 17,17,116
M a,24,a,228,v,88
TR a,254,17632
s_bfe_u32 s94, s95, 0x40008
M a,28,a,228,v,92
TR a,224,17152
s_lshl_b32 s94, s94, 15
M a,32,a,232,v,80
DL 4,88,93,1056
M a,36,a,232,v,84
TR a,226,17664
s_mov_b32 s93, 6289344
M a,40,a,232,v,88
EX 120
M a,44,a,232,v,92
TR a,228,17184
AD 18,18,120
M a,48,a,236,v,80
EX 113
M a,52,a,236,v,84
TR a,230,17696
AD 16,16,113
M a,56,a,236,v,88
buffer_load_dword v10, v4, s[72:75], s94 offen offset:0
M a,60,a,236,v,92
s_waitcnt lgkmcnt(4)
TR a,232,17216
M a,64,a,240,v,80
EX 117
M a,68,a,240,v,84
TR a,234,17728
AD 17,17,117
M a,72,a,240,v,88
EX 121
M a,76,a,240,v,92
TR a,236,17248
AD 18,18,121
M a,80,a,244,v,80
TR a,238,17760
v_xor_b32 v1, 81920, v1
M a,84,a,244,v,84
DL 4,88,93,2112
M a,88,a,244,v,88
s_mov_b32 s93, 7336864
TR a,240,17280
M a,92,a,244,v,92
EX 124
M a,96,a,248,v,80
TR a,242,17792
AD 19,19,124
M a,100,a,248,v,84
EX 114
M a,104,a,248,v,88
TR a,244,17312
AD 16,16,114
M a,108,a,248,v,92
EX 118
M a,112,a,252,v,80
TR a,246,17824
AD 17,17,118
M a,116,a,252,v,84
EX 122
M a,120,a,252,v,88
TR a,248,17344
AD 18,18,122
M a,124,a,252,v,92
s_waitcnt lgkmcnt(5)
TR a,250,17856
M a,128,a,224,v,80
EX 125
M a,132,a,224,v,84
TR a,252,17376
AD 19,19,125
M a,136,a,224,v,88
DL 4,88,93,3168
M a,140,a,224,v,92
EX 115
M a,144,a,228,v,80
TR a,254,17888
AD 16,16,115
M a,148,a,228,v,84
EX 119
M a,152,a,228,v,88
EX 123
M a,156,a,228,v,92
EX 126
M a,160,a,232,v,80
EX 127
M a,164,a,232,v,84
buffer_load_dword v10, v4, s[72:75], s94 offen offset:1024
M a,168,a,232,v,88
AD 17,17,119
AD 18,18,123
M a,172,a,232,v,92
AD 19,19,126
AD 19,19,127
M a,176,a,236,v,80
v_max3_f32 v20, v16, v17, v18
v_max_f32 v20, v20, v19
M a,180,a,236,v,84
v_cmp_lt_f32 vcc, 0x4b800000, v20
M a,184,a,236,v,88
M a,188,a,236,v,92
s_waitcnt lgkmcnt(0)
s_waitcnt vmcnt(18)
M a,192,a,240,v,80
s_barrier
RD a,224,1,33792
M a,196,a,240,v,84
RD a,228,1,33856
s_add_u32 m0, s92, 16896
M a,200,a,240,v,88
RD a,232,1,33920
s_mov_b32 s93, 229504
M a,204,a,240,v,92
RD a,236,1,33984
M a,208,a,244,v,80
RD a,240,1,34048
M a,212,a,244,v,84
M a,216,a,244,v,88
M a,220,a,244,v,92
RD a,244,1,34112
M v,32,a,248,v,80
M v,36,a,248,v,84
M v,40,a,248,v,88
M v,44,a,248,v,92
DL 7,72,93,0
M v,48,a,252,v,80
CV 80,96
CV 81,98
M v,52,a,252,v,84
CV 84,100
CV 85,102
M v,56,a,252,v,88
s_waitcnt lgkmcnt(2)
CV 88,104
M v,60,a,252,v,92
s_cbranch_vccnz L_rsA28
L_rbA28:
MC 96,a,224,128,64
RD a,248,1,34176
CV 89,106
M v,96,a,228,v,144
RD a,252,1,34240
CV 92,108
M v,96,a,232,v,160
CV 93,110
CV 82,112
M v,96,a,236,v,176
CV 83,114
CV 86,116
MC 100,a,224,132,68
CV 87,118
CV 90,120
M v,100,a,228,v,148
CV 91,122
CV 94,124
M v,100,a,232,v,164
CV 95,126
AD 12,12,16
M v,100,a,236,v,180
AD 13,13,17
AD 14,14,18
MC 104,a,224,136,72
DL 7,76,93,1056
M v,104,a,228,v,152
AD 15,15,19
M v,104,a,232,v,168
M v,104,a,236,v,184
MC 108,a,224,140,76
RD a,224,1,34304
v_bfe_u32 v8, v4, 8, 2
M v,108,a,228,v,156
RD a,228,1,34368
v_lshrrev_b32 v9, 14, s95
M v,108,a,232,v,172
RD a,232,1,34432
v_add_lshl_u32 v8, v8, v9, 7
M v,108,a,236,v,188
s_waitcnt lgkmcnt(3)
RD a,236,1,34496
M v,96,a,240,v,192
s_getpc_b64 s[100:101]
s_and_b32 s100, s100, 0xfffff000
M v,96,a,244,v,208
v_add_u32 v8, 4096, v8
v_mov_b32 v9, 0
M v,96,a,248,v,224
buffer_load_dword v10, v4, s[72:75], s94 offen offset:2048
M v,96,a,252,v,240
v_lshl_add_u64 v[8:9], v[8:9], 0, s[100:101]
M v,100,a,240,v,196
M v,100,a,244,v,212
DL 7,80,93,2112
M v,100,a,248,v,228
M v,100,a,252,v,244
M v,104,a,240,v,200
M v,104,a,244,v,216
global_load_dword v10, v[8:9], off
M v,104,a,248,v,232
EX 96
M v,104,a,252,v,248
EX 97
M v,108,a,240,v,204
RD a,240,1,34560
AD 16,96,97
M v,108,a,244,v,220
EX 100
M v,108,a,248,v,236
EX 101
M v,108,a,252,v,252
s_waitcnt lgkmcnt(1)
RD a,244,1,34624
MC 112,a,224,128,64
RD a,248,1,34688
AD 17,100,101
M v,112,a,228,v,144
EX 104
M v,112,a,232,v,160
DL 7,84,93,3168
M v,112,a,236,v,176
EX 105
MC 116,a,224,132,68
RD a,252,1,34752
AD 18,104,105
M v,116,a,228,v,148
EX 98
M v,116,a,232,v,164
EX 102
M v,116,a,236,v,180
EX 106
MC 120,a,224,136,72
buffer_load_dword v10, v4, s[72:75], s94 offen offset:3072
M v,120,a,228,v,152
s_add_u32 s94, s94, 16384
AD 16,16,98
M v,120,a,232,v,168
EX 108
M v,120,a,236,v,184
EX 109
MC 124,a,224,140,76
EX 99
M v,124,a,228,v,156
EX 103
M v,124,a,232,v,172
EX 107
M v,124,a,236,v,188
s_waitcnt lgkmcnt(0)
s_waitcnt vmcnt(21)
M v,112,a,240,v,192
s_barrier
TR a,224,0
M v,112,a,244,v,208
TR a,226,512
s_add_u32 m0, s92, 33792
M v,112,a,248,v,224
TR a,228,32
s_mov_b32 s93, 8388608
M v,112,a,252,v,240
TR a,230,544
AD 17,17,102
M v,116,a,240,v,196
TR a,232,64
AD 18,18,106
M v,116,a,244,v,212
TR a,234,576
AD 19,108,109
M v,116,a,248,v,228
TR a,236,96
AD 16,16,99
M v,116,a,252,v,244
TR a,238,608
AD 17,17,103
M v,120,a,240,v,200
EX 110
M v,120,a,244,v,216
EX 111
M v,120,a,248,v,232
EX 112
M v,120,a,252,v,248
DL 4,88,93,0
M v,124,a,240,v,204
TR a,240,128
s_mov_b32 s93, 9436128
M v,124,a,244,v,220
TR a,242,640
AD 18,18,107
M v,124,a,248,v,236
TR a,244,160
AD 19,19,110
M v,124,a,252,v,252
s_waitcnt lgkmcnt(3)
TR a,246,672
M a,0,a,224,v,80
TR a,248,192
AD 19,19,111
M a,4,a,224,v,84
TR a,250,704
AD 16,16,112
M a,8,a,224,v,88
TR a,252,224
v_add_u32 v9, 149504, v4
M a,12,a,224,v,92
TR a,254,736
v_add_u32 v8, 67584, v4
M a,16,a,228,v,80
EX 116
M a,20,a,228,v,84
TR a,224,256
AD 17,17,116
M a,24,a,228,v,88
EX 120
M a,28,a,228,v,92
TR a,226,768
AD 18,18,120
M a,32,a,232,v,80
DL 4,88,93,1056
M a,36,a,232,v,84
TR a,228,288
s_mov_b32 s93, 10483648
M a,40,a,232,v,88
EX 113
M a,44,a,232,v,92
TR a,230,800
AD 16,16,113
M a,48,a,236,v,80
EX 117
M a,52,a,236,v,84
TR a,232,320
AD 17,17,117
M a,56,a,236,v,88
buffer_load_dword v10, v4, s[72:75], s94 offen offset:0
M a,60,a,236,v,92
s_waitcnt lgkmcnt(5)
TR a,234,832
M a,64,a,240,v,80
EX 121
M a,68,a,240,v,84
TR a,236,352
AD 18,18,121
M a,72,a,240,v,88
EX 124
M a,76,a,240,v,92
TR a,238,864
AD 19,19,124
M a,80,a,244,v,80
EX 114
M a,84,a,244,v,84
DL 4,88,93,2112
M a,88,a,244,v,88
s_mov_b32 s93, 11531168
TR a,240,384
M a,92,a,244,v,92
TR a,242,896
AD 16,16,114
M a,96,a,248,v,80
EX 118
M a,100,a,248,v,84
TR a,244,416
AD 17,17,118
M a,104,a,248,v,88
EX 122
M a,108,a,248,v,92
TR a,246,928
AD 18,18,122
M a,112,a,252,v,80
EX 125
M a,116,a,252,v,84
TR a,248,448
AD 19,19,125
M a,120,a,252,v,88
EX 115
M a,124,a,252,v,92
s_waitcnt lgkmcnt(5)
TR a,250,960
M a,128,a,224,v,80
TR a,252,480
AD 16,16,115
M a,132,a,224,v,84
EX 119
M a,136,a,224,v,88
DL 4,88,93,3168
M a,140,a,224,v,92
TR a,254,992
AD 17,17,119
M a,144,a,228,v,80
EX 123
M a,148,a,228,v,84
EX 126
M a,152,a,228,v,88
EX 127
M a,156,a,228,v,92
AD 18,18,123
AD 19,19,126
M a,160,a,232,v,80
buffer_load_dword v10, v4, s[72:75], s94 offen offset:1024
M a,164,a,232,v,84
AD 19,19,127
v_max3_f32 v20, v16, v17, v18
M a,168,a,232,v,88
v_max_f32 v20, v20, v19
v_cmp_lt_f32 vcc, 0x4b800000, v20
M a,172,a,232,v,92
M a,176,a,236,v,80
M a,180,a,236,v,84
M a,184,a,236,v,88
M a,188,a,236,v,92
s_waitcnt lgkmcnt(0)
s_waitcnt vmcnt(19)
M a,192,a,240,v,80
s_barrier
TR a,224,50688
M a,196,a,240,v,84
TR a,226,51200
s_add_u32 m0, s92, 0
M a,200,a,240,v,88
TR a,228,50720
s_mov_b32 s93, 12582912
M a,204,a,240,v,92
TR a,230,51232
M a,208,a,244,v,80
TR a,232,50752
M a,212,a,244,v,84
TR a,234,51264
M a,216,a,244,v,88
TR a,236,50784
M a,220,a,244,v,92
TR a,238,51296
M v,32,a,248,v,80
TR a,240,50816
M v,36,a,248,v,84
DL 4,88,93,0
M v,40,a,248,v,88
TR a,242,51328
s_mov_b32 s93, 13630432
M v,44,a,248,v,92
TR a,244,50848
M v,48,a,252,v,80
CV 80,96
CV 81,98
M v,52,a,252,v,84
CV 82,112
CV 83,114
M v,56,a,252,v,88
s_waitcnt lgkmcnt(3)
CV 84,100
M v,60,a,252,v,92
s_cbranch_vccnz L_rsA29
L_rbA29:
M a,0,a,224,v,80
CV 85,102
CV 86,116
CV 87,118
CV 88,104
CV 89,106
M a,4,a,224,v,84
CV 90,120
CV 91,122
CV 92,108
CV 93,110
M a,8,a,224,v,88
CV 94,124
CV 95,126
TR a,246,51360
TR a,248,50880
M a,12,a,224,v,92
TR a,250,51392
AD 12,12,16
M a,16,a,228,v,80
TR a,252,50912
AD 13,13,17
L_pad26:
s_cbranch_execz L_ret26
M a,20,a,228,v,84
TR a,254,51424
AD 14,14,18
M a,24,a,228,v,88
DL 4,88,93,1056
M a,28,a,228,v,92
s_mov_b32 s93, 14677952
TR a,224,50944
M a,32,a,232,v,80
TR a,226,51456
AD 15,15,19
M a,36,a,232,v,84
TR a,228,50976
AR 20,0
M a,40,a,232,v,88
TR a,230,51488
AR 21,1
M a,44,a,232,v,92
TR a,232,51008
AR 22,2
M a,48,a,236,v,80
TR a,234,51520
AR 23,3
M a,52,a,236,v,84
buffer_load_dword v10, v4, s[72:75], s94 offen offset:2048
M a,56,a,236,v,88
v_permlane32_swap_b32 v12, v14
M a,60,a,236,v,92
s_waitcnt lgkmcnt(6)
TR a,236,51040
M a,64,a,240,v,80
TR a,238,51552
v_add_f32 v12, v12, v14
M a,68,a,240,v,84
v_permlane32_swap_b32 v13, v15
M a,72,a,240,v,88
v_add_f32 v13, v13, v15
AR 24,16
M a,76,a,240,v,92
DL 4,88,93,2112
M a,80,a,244,v,80
s_mov_b32 s93, 15725472
TR a,240,51072
M a,84,a,244,v,84
v_permlane16_swap_b32 v12, v13
M a,88,a,244,v,88
TR a,242,51584
v_add_f32 v12, v12, v13
M a,92,a,244,v,92
TR a,244,51104
AR 25,17
M a,96,a,248,v,80
TR a,246,51616
AR 26,18
M a,100,a,248,v,84
v_rcp_f32 v16, v12
M a,104,a,248,v,88
v_mov_b32 v17, v16
AR 27,19
M a,108,a,248,v,92
TR a,248,51136
v_xor_b32 v3, 81920, v3
M a,112,a,252,v,80
v_permlane16_swap_b32 v16, v17
M a,116,a,252,v,84
TR a,250,51648
v_mov_b32 v18, v16
M a,120,a,252,v,88
v_mov_b32 v19, v17
M a,124,a,252,v,92
s_waitcnt lgkmcnt(6)
TR a,252,51168
M a,128,a,224,v,80
DL 4,88,93,3168
M a,132,a,224,v,84
TR a,254,51680
v_xor_b32 v2, 81920, v2
M a,136,a,224,v,88
v_permlane32_swap_b32 v16, v18
M a,140,a,224,v,92
MU 16,28
v_mul_f32 v20, v16, v20
M a,144,a,228,v,80
v_mul_f32 v21, v16, v21
v_mul_f32 v22, v16, v22
M a,148,a,228,v,84
v_mul_f32 v23, v16, v23
v_mul_f32 v24, v16, v24
M a,152,a,228,v,88
v_mul_f32 v25, v16, v25
v_mul_f32 v26, v16, v26
M a,156,a,228,v,92
v_mul_f32 v27, v16, v27
CV 128,20
M a,160,a,232,v,80
v_permlane32_swap_b32 v17, v19
M a,164,a,232,v,84
CV 129,22
CV 130,24
M a,168,a,232,v,88
CV 131,26
MU 17,29
M a,172,a,232,v,92
AR 20,4
AR 21,5
M a,176,a,236,v,80
AR 22,6
AR 23,7
M a,180,a,236,v,84
AR 24,20
AR 25,21
M a,184,a,236,v,88
AR 26,22
AR 27,23
M a,188,a,236,v,92
s_waitcnt lgkmcnt(0)
s_waitcnt vmcnt(19)
M a,192,a,240,v,80
v_mul_f32 v20, v17, v20
v_mul_f32 v21, v17, v21
M a,196,a,240,v,84
v_mul_f32 v22, v17, v22
v_mul_f32 v23, v17, v23
M a,200,a,240,v,88
v_mul_f32 v24, v17, v24
v_mul_f32 v25, v17, v25
M a,204,a,240,v,92
v_mul_f32 v26, v17, v26
v_mul_f32 v27, v17, v27
M a,208,a,244,v,80
s_barrier
CV 132,20
M a,212,a,244,v,84
CV 133,22
CV 134,24
M a,216,a,244,v,88
CV 135,26
MU 18,30
M a,220,a,244,v,92
AR 20,8
AR 21,9
M v,32,a,248,v,80
AR 22,10
AR 23,11
M v,36,a,248,v,84
AR 24,24
AR 25,25
M v,40,a,248,v,88
AR 26,26
AR 27,27
M v,44,a,248,v,92
v_mul_f32 v20, v18, v20
v_mul_f32 v21, v18, v21
M v,48,a,252,v,80
v_mul_f32 v22, v18, v22
v_mul_f32 v23, v18, v23
M v,52,a,252,v,84
v_mul_f32 v24, v18, v24
v_mul_f32 v25, v18, v25
M v,56,a,252,v,88
v_mul_f32 v26, v18, v26
v_mul_f32 v27, v18, v27
M v,60,a,252,v,92
CV 136,20
CV 137,22
CV 138,24
CV 139,26
MU 19,31
AR 20,12
AR 21,13
AR 22,14
AR 23,15
AR 24,28
AR 25,29
AR 26,30
AR 27,31
v_pk_mul_f32 v[20:21], v[20:21], v[18:19] op_sel:[0,1] op_sel_hi:[1,1]
v_pk_mul_f32 v[22:23], v[22:23], v[18:19] op_sel:[0,1] op_sel_hi:[1,1]
v_pk_mul_f32 v[24:25], v[24:25], v[18:19] op_sel:[0,1] op_sel_hi:[1,1]
v_pk_mul_f32 v[26:27], v[26:27], v[18:19] op_sel:[0,1] op_sel_hi:[1,1]
CV 140,20
CV 141,22
CV 142,24
CV 143,26
AR 20,32
AR 21,33
AR 22,34
AR 23,35
AR 24,48
AR 25,49
AR 26,50
AR 27,51
v_pk_mul_f32 v[20:21], v[20:21], v[16:17] op_sel:[0,0] op_sel_hi:[1,0]
v_pk_mul_f32 v[22:23], v[22:23], v[16:17] op_sel:[0,0] op_sel_hi:[1,0]
v_pk_mul_f32 v[24:25], v[24:25], v[16:17] op_sel:[0,0] op_sel_hi:[1,0]
v_pk_mul_f32 v[26:27], v[26:27], v[16:17] op_sel:[0,0] op_sel_hi:[1,0]
CV 144,20
CV 145,22
CV 146,24
CV 147,26
AR 20,36
AR 21,37
AR 22,38
AR 23,39
AR 24,52
AR 25,53
AR 26,54
AR 27,55
v_pk_mul_f32 v[20:21], v[20:21], v[16:17] op_sel:[0,1] op_sel_hi:[1,1]
v_pk_mul_f32 v[22:23], v[22:23], v[16:17] op_sel:[0,1] op_sel_hi:[1,1]
v_pk_mul_f32 v[24:25], v[24:25], v[16:17] op_sel:[0,1] op_sel_hi:[1,1]
v_pk_mul_f32 v[26:27], v[26:27], v[16:17] op_sel:[0,1] op_sel_hi:[1,1]
CV 148,20
CV 149,22
CV 150,24
CV 151,26
AR 20,40
AR 21,41
AR 22,42
AR 23,43
AR 24,56
AR 25,57
AR 26,58
AR 27,59
v_pk_mul_f32 v[20:21], v[20:21], v[18:19] op_sel:[0,0] op_sel_hi:[1,0]
v_pk_mul_f32 v[22:23], v[22:23], v[18:19] op_sel:[0,0] op_sel_hi:[1,0]
v_pk_mul_f32 v[24:25], v[24:25], v[18:19] op_sel:[0,0] op_sel_hi:[1,0]
v_pk_mul_f32 v[26:27], v[26:27], v[18:19] op_sel:[0,0] op_sel_hi:[1,0]
TR a,224,0
TR a,226,128
TR a,228,256
TR a,230,384
TR a,232,512
TR a,234,640
TR a,236,768
TR a,238,896
CV 152,20
CV 153,22
CV 154,24
CV 155,26
AR 20,44
AR 21,45
AR 22,46
AR 23,47
AR 24,60
AR 25,61
AR 26,62
AR 27,63
v_pk_mul_f32 v[20:21], v[20:21], v[18:19] op_sel:[0,1] op_sel_hi:[1,1]
v_pk_mul_f32 v[22:23], v[22:23], v[18:19] op_sel:[0,1] op_sel_hi:[1,1]
v_pk_mul_f32 v[24:25], v[24:25], v[18:19] op_sel:[0,1] op_sel_hi:[1,1]
v_pk_mul_f32 v[26:27], v[26:27], v[18:19] op_sel:[0,1] op_sel_hi:[1,1]
CV 156,20
CV 157,22
CV 158,24
CV 159,26
AR 20,64
AR 21,65
AR 22,66
AR 23,67
AR 24,80
AR 25,81
AR 26,82
AR 27,83
v_pk_mul_f32 v[20:21], v[20:21], v[16:17] op_sel:[0,0] op_sel_hi:[1,0]
v_pk_mul_f32 v[22:23], v[22:23], v[16:17] op_sel:[0,0] op_sel_hi:[1,0]
v_pk_mul_f32 v[24:25], v[24:25], v[16:17] op_sel:[0,0] op_sel_hi:[1,0]
v_pk_mul_f32 v[26:27], v[26:27], v[16:17] op_sel:[0,0] op_sel_hi:[1,0]
CV 160,20
CV 161,22
CV 162,24
CV 163,26
AR 20,68
AR 21,69
AR 22,70
AR 23,71
AR 24,84
AR 25,85
AR 26,86
AR 27,87
buffer_load_dword v10, v4, s[72:75], s94 offen offset:3072
v_pk_mul_f32 v[20:21], v[20:21], v[16:17] op_sel:[0,1] op_sel_hi:[1,1]
v_pk_mul_f32 v[22:23], v[22:23], v[16:17] op_sel:[0,1] op_sel_hi:[1,1]
v_pk_mul_f32 v[24:25], v[24:25], v[16:17] op_sel:[0,1] op_sel_hi:[1,1]
v_pk_mul_f32 v[26:27], v[26:27], v[16:17] op_sel:[0,1] op_sel_hi:[1,1]
CV 164,20
CV 165,22
CV 166,24
CV 167,26
AR 20,72
AR 21,73
AR 22,74
AR 23,75
AR 24,88
AR 25,89
AR 26,90
AR 27,91
v_pk_mul_f32 v[20:21], v[20:21], v[18:19] op_sel:[0,0] op_sel_hi:[1,0]
v_pk_mul_f32 v[22:23], v[22:23], v[18:19] op_sel:[0,0] op_sel_hi:[1,0]
v_pk_mul_f32 v[24:25], v[24:25], v[18:19] op_sel:[0,0] op_sel_hi:[1,0]
v_pk_mul_f32 v[26:27], v[26:27], v[18:19] op_sel:[0,0] op_sel_hi:[1,0]
CV 168,20
CV 169,22
CV 170,24
CV 171,26
s_add_u32 m0, s92, 50688
AR 20,76
AR 21,77
AR 22,78
AR 23,79
AR 24,92
AR 25,93
AR 26,94
AR 27,95
s_mov_b32 s93, 0
s_waitcnt lgkmcnt(0)
Z v,64,a,224,v,128
v_mul_f32 v20, v19, v20
v_mul_f32 v21, v19, v21
M v,64,a,228,v,144
v_mul_f32 v22, v19, v22
v_mul_f32 v23, v19, v23
M v,64,a,232,v,160
v_mul_f32 v24, v19, v24
v_mul_f32 v25, v19, v25
v_mul_f32 v26, v19, v26
v_mul_f32 v27, v19, v27
CV 172,20
CV 173,22
CV 174,24
CV 175,26
DL 7,72,93,0
AR 20,96
AR 21,97
AR 22,98
AR 23,99
AR 24,112
AR 25,113
AR 26,114
AR 27,115
v_pk_mul_f32 v[20:21], v[20:21], v[16:17] op_sel:[0,0] op_sel_hi:[1,0]
v_pk_mul_f32 v[22:23], v[22:23], v[16:17] op_sel:[0,0] op_sel_hi:[1,0]
v_pk_mul_f32 v[24:25], v[24:25], v[16:17] op_sel:[0,0] op_sel_hi:[1,0]
v_pk_mul_f32 v[26:27], v[26:27], v[16:17] op_sel:[0,0] op_sel_hi:[1,0]
CV 176,20
CV 177,22
CV 178,24
CV 179,26
AR 20,100
AR 21,101
M v,64,a,236,v,176
AR 22,102
AR 23,103
Z v,68,a,224,v,132
AR 24,116
AR 25,117
M v,68,a,228,v,148
AR 26,118
AR 27,119
M v,68,a,232,v,164
v_mul_f32 v20, v17, v20
v_mul_f32 v21, v17, v21
v_mul_f32 v22, v17, v22
v_mul_f32 v23, v17, v23
v_mul_f32 v24, v17, v24
v_mul_f32 v25, v17, v25
v_pk_mul_f32 v[26:27], v[26:27], v[16:17] op_sel:[0,1] op_sel_hi:[1,1]
CV 180,20
CV 181,22
CV 182,24
CV 183,26
TR a,240,32
TR a,242,160
M v,68,a,236,v,180
TR a,244,288
AR 20,104
Z v,72,a,224,v,136
TR a,246,416
AR 21,105
M v,72,a,228,v,152
TR a,248,544
AR 22,106
M v,72,a,232,v,168
TR a,250,672
TR a,252,800
TR a,254,928
AR 23,107
AR 24,120
AR 25,121
AR 26,122
AR 27,123
v_pk_mul_f32 v[20:21], v[20:21], v[18:19] op_sel:[0,0] op_sel_hi:[1,0]
v_pk_mul_f32 v[22:23], v[22:23], v[18:19] op_sel:[0,0] op_sel_hi:[1,0]
v_pk_mul_f32 v[24:25], v[24:25], v[18:19] op_sel:[0,0] op_sel_hi:[1,0]
v_pk_mul_f32 v[26:27], v[26:27], v[18:19] op_sel:[0,0] op_sel_hi:[1,0]
CV 184,20
CV 185,22
CV 186,24
CV 187,26
AR 20,108
AR 21,109
M v,72,a,236,v,184
AR 22,110
AR 23,111
Z v,76,a,224,v,140
AR 24,124
AR 25,125
M v,76,a,228,v,156
AR 26,126
AR 27,127
M v,76,a,232,v,172
v_mul_f32 v20, v19, v20
v_mul_f32 v21, v19, v21
v_mul_f32 v22, v19, v22
v_mul_f32 v23, v19, v23
v_mul_f32 v24, v19, v24
v_mul_f32 v25, v19, v25
v_pk_mul_f32 v[26:27], v[26:27], v[18:19] op_sel:[0,1] op_sel_hi:[1,1]
DL 7,76,93,1056
CV 188,20
CV 189,22
CV 190,24
CV 191,26
RD a,80,3,50688
RD a,84,3,51744
M v,76,a,236,v,188
s_waitcnt lgkmcnt(2)
RD a,88,3,52800
Z v,80,a,240,v,128
RD a,92,3,53856
AR 20,128
M v,80,a,244,v,144
TR a,224,64
AR 21,129
M v,80,a,248,v,160
TR a,226,192
AR 22,130
M v,80,a,252,v,176
TR a,228,320
AR 23,131
Z v,84,a,240,v,132
TR a,230,448
v_xor_b32 v3, 81920, v3
M v,84,a,244,v,148
TR a,232,576
v_mul_f32 v20, v16, v20
M v,84,a,248,v,164
TR a,234,704
v_mul_f32 v21, v16, v21
M v,84,a,252,v,180
TR a,236,832
v_mul_f32 v22, v16, v22
Z v,88,a,240,v,136
TR a,238,960
v_mul_f32 v23, v16, v23
M v,88,a,244,v,152
DL 7,80,93,2112
M v,88,a,248,v,168
RD a,64,9,0
CV 192,20
M v,88,a,252,v,184
RD a,68,9,1024
CV 193,22
Z v,92,a,240,v,140
TR a,240,96
AR 20,132
M v,92,a,244,v,156
TR a,242,224
AR 21,133
M v,92,a,248,v,172
TR a,244,352
AR 22,134
M v,92,a,252,v,188
s_waitcnt lgkmcnt(5)
TR a,246,480
Z v,96,a,224,v,128
DL 7,84,93,3168
M v,96,a,228,v,144
TR a,248,608
AR 23,135
M v,96,a,232,v,160
TR a,250,736
v_mul_f32 v20, v17, v20
M v,96,a,236,v,176
TR a,252,864
v_mul_f32 v21, v17, v21
Z v,100,a,224,v,132
TR a,254,992
v_xor_b32 v2, 81920, v2
M v,100,a,228,v,148
RD a,72,9,2048
v_mul_f32 v22, v17, v22
M v,100,a,232,v,164
RD a,76,9,3072
v_mul_f32 v23, v17, v23
M v,100,a,236,v,180
CV 196,20
CV 197,22
Z v,104,a,224,v,136
AR 20,136
AR 21,137
M v,104,a,228,v,152
AR 22,138
AR 23,139
M v,104,a,232,v,168
v_mul_f32 v20, v18, v20
v_mul_f32 v21, v18, v21
M v,104,a,236,v,184
v_mul_f32 v22, v18, v22
v_mul_f32 v23, v18, v23
Z v,108,a,224,v,140
CV 200,20
CV 201,22
M v,108,a,228,v,156
AR 20,140
AR 21,141
M v,108,a,232,v,172
AR 22,142
AR 23,143
M v,108,a,236,v,188
s_waitcnt lgkmcnt(2)
s_waitcnt vmcnt(5)
Z v,112,a,240,v,128
s_barrier
s_add_u32 m0, s92, 81920
M v,112,a,244,v,144
s_mov_b32 s93, 128
TR a,224,16896
M v,112,a,248,v,160
DL 7,72,93,0
M v,112,a,252,v,176
TR a,226,17024
v_mul_f32 v20, v19, v20
Z v,116,a,240,v,132
TR a,228,17152
v_mul_f32 v21, v19, v21
M v,116,a,244,v,148
TR a,230,17280
v_mul_f32 v22, v19, v22
M v,116,a,248,v,164
TR a,232,17408
v_mul_f32 v23, v19, v23
M v,116,a,252,v,180
TR a,234,17536
CV 204,20
Z v,120,a,240,v,136
TR a,236,17664
CV 205,22
M v,120,a,244,v,152
TR a,238,17792
AR 24,144
M v,120,a,248,v,168
DL 7,76,93,1056
M v,120,a,252,v,184
RD a,96,3,33792
AR 25,145
Z v,124,a,240,v,140
TR a,240,16928
AR 26,146
L_pad27:
s_cbranch_execz L_ret27
M v,124,a,244,v,156
DL 7,80,93,2112
M v,124,a,248,v,172
TR a,242,17056
AR 27,147
M v,124,a,252,v,188
s_waitcnt lgkmcnt(3)
TR a,244,17184
Z a,0,a,224,v,128
DL 7,84,93,3168
M a,0,a,228,v,144
s_add_u32 m0, s92, 132608
s_mov_b32 s93, 16777216
M a,0,a,232,v,160
TR a,246,17312
AR 20,160
M a,0,a,236,v,176
DL 4,88,93,0
Z a,4,a,224,v,132
TR a,248,17440
s_mov_b32 s93, 17824736
M a,4,a,228,v,148
TR a,250,17568
AR 21,161
M a,4,a,232,v,164
TR a,252,17696
AR 22,162
M a,4,a,236,v,180
TR a,254,17824
AR 23,163
Z a,8,a,224,v,136
DL 4,88,93,1056
M a,8,a,228,v,152
s_mov_b32 s93, 18872256
RD a,100,3,34848
M a,8,a,232,v,168
RD a,104,3,35904
v_mul_f32 v24, v16, v24
M a,8,a,236,v,184
RD a,108,3,36960
v_mul_f32 v25, v16, v25
Z a,12,a,224,v,140
TR a,224,16960
v_mul_f32 v26, v16, v26
M a,12,a,228,v,156
TR a,226,17088
v_mul_f32 v27, v16, v27
M a,12,a,232,v,172
TR a,228,17216
v_mul_f32 v20, v16, v20
M a,12,a,236,v,188
s_waitcnt lgkmcnt(6)
TR a,230,17344
Z a,16,a,240,v,128
TR a,232,17472
v_mul_f32 v21, v16, v21
M a,16,a,244,v,144
TR a,234,17600
v_mul_f32 v22, v16, v22
M a,16,a,248,v,160
TR a,236,17728
v_mul_f32 v23, v16, v23
M a,16,a,252,v,176
DL 4,88,93,2112
Z a,20,a,240,v,132
TR a,238,17856
s_mov_b32 s93, 19919776
M a,20,a,244,v,148
RD a,112,3,0
CV 194,24
M a,20,a,248,v,164
RD a,116,3,1056
CV 195,26
M a,20,a,252,v,180
RD a,120,3,2112
CV 208,20
Z a,24,a,240,v,136
RD a,124,3,3168
CV 209,22
M a,24,a,244,v,152
AR 24,148
AR 25,149
M a,24,a,248,v,168
AR 26,150
AR 27,151
M a,24,a,252,v,184
AR 20,164
AR 21,165
Z a,28,a,240,v,140
TR a,240,16992
AR 22,166
M a,28,a,244,v,156
TR a,242,17120
AR 23,167
M a,28,a,248,v,172
TR a,244,17248
v_mul_f32 v24, v17, v24
M a,28,a,252,v,188
s_waitcnt lgkmcnt(7)
TR a,246,17376
Z a,32,a,224,v,128
DL 4,88,93,3168
M a,32,a,228,v,144
TR a,248,17504
v_mul_f32 v25, v17, v25
M a,32,a,232,v,160
TR a,250,17632
v_mul_f32 v26, v17, v26
M a,32,a,236,v,176
TR a,252,17760
v_mul_f32 v27, v17, v27
Z a,36,a,224,v,132
TR a,254,17888
v_mul_f32 v20, v17, v20
M a,36,a,228,v,148
v_mul_f32 v21, v17, v21
v_mul_f32 v22, v17, v22
M a,36,a,232,v,164
v_mul_f32 v23, v17, v23
CV 198,24
M a,36,a,236,v,180
CV 199,26
CV 212,20
Z a,40,a,224,v,136
CV 213,22
AR 24,152
M a,40,a,228,v,152
AR 25,153
AR 26,154
M a,40,a,232,v,168
AR 27,155
AR 20,168
M a,40,a,236,v,184
AR 21,169
AR 22,170
Z a,44,a,224,v,140
AR 23,171
v_mul_f32 v24, v18, v24
M a,44,a,228,v,156
v_mul_f32 v25, v18, v25
v_mul_f32 v26, v18, v26
M a,44,a,232,v,172
v_mul_f32 v27, v18, v27
v_mul_f32 v20, v18, v20
M a,44,a,236,v,188
s_waitcnt lgkmcnt(0)
s_waitcnt vmcnt(8)
Z a,48,a,240,v,128
s_barrier
TR a,224,50688
M a,48,a,244,v,144
TR a,226,50816
s_add_u32 m0, s92, 16896
M a,48,a,248,v,160
TR a,228,50944
s_mov_b32 s93, 114688
M a,48,a,252,v,176
TR a,230,51072
v_mul_f32 v21, v18, v21
Z a,52,a,240,v,132
TR a,232,51200
v_mul_f32 v22, v18, v22
M a,52,a,244,v,148
TR a,234,51328
v_mul_f32 v23, v18, v23
M a,52,a,248,v,164
TR a,236,51456
CV 202,24
M a,52,a,252,v,180
TR a,238,51584
CV 203,26
Z a,56,a,240,v,136
CV 216,20
CV 217,22
M a,56,a,244,v,152
AR 24,156
AR 25,157
M a,56,a,248,v,168
AR 26,158
AR 27,159
M a,56,a,252,v,184
DL 7,72,93,0
Z a,60,a,240,v,140
TR a,240,50720
AR 20,172
M a,60,a,244,v,156
TR a,242,50848
AR 21,173
M a,60,a,248,v,172
TR a,244,50976
AR 22,174
M a,60,a,252,v,188
s_waitcnt lgkmcnt(3)
TR a,246,51104
M v,64,a,224,a,64
TR a,248,51232
AR 23,175
M v,64,a,228,a,80
TR a,250,51360
v_mul_f32 v24, v19, v24
M v,64,a,232,a,96
TR a,252,51488
v_mul_f32 v25, v19, v25
M v,64,a,236,a,112
TR a,254,51616
v_mul_f32 v26, v19, v26
M v,68,a,224,a,68
v_mul_f32 v27, v19, v27
CV 206,24
M v,68,a,228,a,84
CV 207,26
AR 24,176
M v,68,a,232,a,100
AR 25,177
AR 26,178
M v,68,a,236,a,116
AR 27,179
v_mul_f32 v24, v16, v24
M v,72,a,224,a,72
v_mul_f32 v25, v16, v25
v_mul_f32 v26, v16, v26
M v,72,a,228,a,88
v_mul_f32 v27, v16, v27
CV 210,24
M v,72,a,232,a,104
DL 7,76,93,1056
M v,72,a,236,a,120
CV 211,26
AR 24,180
M v,76,a,224,a,76
TR a,224,50752
AR 25,181
M v,76,a,228,a,92
TR a,226,50880
AR 26,182
M v,76,a,232,a,108
TR a,228,51008
AR 27,183
M v,76,a,236,a,124
s_waitcnt lgkmcnt(3)
TR a,230,51136
M v,80,a,240,a,64
TR a,232,51264
v_mul_f32 v24, v17, v24
M v,80,a,244,a,80
TR a,234,51392
v_mul_f32 v25, v17, v25
M v,80,a,248,a,96
TR a,236,51520
v_mul_f32 v26, v17, v26
M v,80,a,252,a,112
TR a,238,51648
v_mul_f32 v27, v17, v27
M v,84,a,240,a,68
v_xor_b32 v3, 81920, v3
CV 214,24
M v,84,a,244,a,84
CV 215,26
AR 24,184
M v,84,a,248,a,100
AR 25,185
AR 26,186
M v,84,a,252,a,116
AR 27,187
v_mul_f32 v24, v18, v24
M v,88,a,240,a,72
v_mul_f32 v25, v18, v25
v_mul_f32 v26, v18, v26
M v,88,a,244,a,88
DL 7,80,93,2112
M v,88,a,248,a,104
v_mul_f32 v27, v18, v27
CV 218,24
M v,88,a,252,a,120
CV 219,26
AR 24,188
M v,92,a,240,a,76
TR a,240,50784
AR 25,189
M v,92,a,244,a,92
TR a,242,50912
AR 26,190
M v,92,a,248,a,108
TR a,244,51040
AR 27,191
M v,92,a,252,a,124
s_waitcnt lgkmcnt(3)
TR a,246,51168
M v,96,a,224,a,64
DL 7,84,93,3168
M v,96,a,228,a,80
TR a,248,51296
s_add_u32 m0, s92, 33792
M v,96,a,232,a,96
TR a,250,51424
s_mov_b32 s93, 344064
M v,96,a,236,a,112
TR a,252,51552
v_mul_f32 v20, v19, v20
M v,100,a,224,a,68
TR a,254,51680
v_xor_b32 v2, 81920, v2
M v,100,a,228,a,84
RD a,176,8,0
v_mul_f32 v21, v19, v21
M v,100,a,232,a,100
RD a,180,8,1024
v_mul_f32 v22, v19, v22
M v,100,a,236,a,116
RD a,184,8,2048
v_mul_f32 v23, v19, v23
M v,104,a,224,a,72
RD a,188,8,3072
v_mul_f32 v24, v19, v24
M v,104,a,228,a,88
v_mul_f32 v25, v19, v25
v_mul_f32 v26, v19, v26
M v,104,a,232,a,104
v_mul_f32 v27, v19, v27
CV 220,20
M v,104,a,236,a,120
CV 221,22
CV 222,24
M v,108,a,224,a,76
CV 223,26
AR 20,192
M v,108,a,228,a,92
AR 21,193
AR 22,194
M v,108,a,232,a,108
AR 23,195
AR 24,208
M v,108,a,236,a,124
s_waitcnt lgkmcnt(4)
s_waitcnt vmcnt(4)
M v,112,a,240,a,64
s_barrier
TR a,224,0
M v,112,a,244,a,80
DL 7,72,93,0
M v,112,a,248,a,96
TR a,226,128
AR 25,209
M v,112,a,252,a,112
TR a,228,256
AR 26,210
M v,116,a,240,a,68
TR a,230,384
AR 27,211
M v,116,a,244,a,84
TR a,232,512
v_mul_f32 v20, v16, v20
M v,116,a,248,a,100
TR a,234,640
v_mul_f32 v21, v16, v21
M v,116,a,252,a,116
TR a,236,768
v_mul_f32 v22, v16, v22
M v,120,a,240,a,72
TR a,238,896
v_mul_f32 v23, v16, v23
M v,120,a,244,a,88
RD a,128,3,50688
v_mul_f32 v24, v16, v24
M v,120,a,248,a,104
RD a,132,3,51744
v_mul_f32 v25, v16, v25
M v,120,a,252,a,120
RD a,136,3,52800
v_mul_f32 v26, v16, v26
M v,124,a,240,a,76
TR a,240,32
v_mul_f32 v27, v16, v27
M v,124,a,244,a,92
TR a,242,160
CV 224,20
M v,124,a,248,a,108
DL 7,76,93,1056
M v,124,a,252,a,124
s_waitcnt lgkmcnt(5)
TR a,244,288
M a,0,a,224,a,64
TR a,246,416
CV 225,22
M a,0,a,228,a,80
TR a,248,544
CV 226,24
M a,0,a,232,a,96
TR a,250,672
CV 227,26
M a,0,a,236,a,112
TR a,252,800
v_mul_f32 v32, v16, v32
M a,4,a,224,a,68
TR a,254,928
v_mul_f32 v33, v16, v33
M a,4,a,228,a,84
RD a,140,3,53856
v_mul_f32 v34, v16, v34
M a,4,a,232,a,100
RD a,144,3,16896
v_mul_f32 v35, v16, v35
M a,4,a,236,a,116
RD a,148,3,17952
v_mul_f32 v48, v16, v48
M a,8,a,224,a,72
RD a,152,3,19008
v_mul_f32 v49, v16, v49
M a,8,a,228,a,88
RD a,156,3,20064
v_mul_f32 v50, v16, v50
M a,8,a,232,a,104
RD a,160,3,33792
v_mul_f32 v51, v16, v51
M a,8,a,236,a,120
RD a,164,3,34848
CV 240,32
M a,12,a,224,a,76
TR a,224,64
CV 241,34
M a,12,a,228,a,92
DL 7,80,93,2112
M a,12,a,232,a,108
TR a,226,192
CV 242,48
M a,12,a,236,a,124
s_waitcnt lgkmcnt(9)
TR a,228,320
M a,16,a,240,a,64
TR a,230,448
CV 243,50
M a,16,a,244,a,80
TR a,232,576
AR 20,196
M a,16,a,248,a,96
TR a,234,704
AR 21,197
M a,16,a,252,a,112
TR a,236,832
AR 22,198
M a,20,a,240,a,68
TR a,238,960
AR 23,199
M a,20,a,244,a,84
RD a,168,3,35904
AR 24,212
M a,20,a,248,a,100
RD a,172,3,36960
AR 25,213
M a,20,a,252,a,116
AR 26,214
AR 27,215
M a,24,a,240,a,72
v_mul_f32 v20, v17, v20
v_mul_f32 v21, v17, v21
M a,24,a,244,a,88
v_mul_f32 v22, v17, v22
v_mul_f32 v23, v17, v23
M a,24,a,248,a,104
v_mul_f32 v24, v17, v24
v_mul_f32 v25, v17, v25
M a,24,a,252,a,120
v_mul_f32 v26, v17, v26
v_mul_f32 v27, v17, v27
M a,28,a,240,a,76
DL 7,84,93,3168
M a,28,a,244,a,92
TR a,240,96
s_add_u32 m0, s92, 0
M a,28,a,248,a,108
TR a,242,224
s_mov_b32 s93, 114816
M a,28,a,252,a,124
s_waitcnt lgkmcnt(4)
TR a,244,352
M a,32,a,224,a,64
TR a,246,480
CV 228,20
M a,32,a,228,a,80
TR a,248,608
CV 229,22
M a,32,a,232,a,96
TR a,250,736
CV 230,24
M a,32,a,236,a,112
TR a,252,864
CV 231,26
M a,36,a,224,a,68
TR a,254,992
v_xor_b32 v2, 81920, v2
M a,36,a,228,a,84
v_mul_f32 v36, v17, v36
v_mul_f32 v37, v17, v37
M a,36,a,232,a,100
v_mul_f32 v38, v17, v38
v_mul_f32 v39, v17, v39
M a,36,a,236,a,116
v_mul_f32 v52, v17, v52
v_mul_f32 v53, v17, v53
M a,40,a,224,a,72
v_mul_f32 v54, v17, v54
v_mul_f32 v55, v17, v55
M a,40,a,228,a,88
CV 244,36
CV 245,38
M a,40,a,232,a,104
CV 246,52
CV 247,54
M a,40,a,236,a,120
DL 7,72,93,0
M a,44,a,224,a,76
AR 20,200
AR 21,201
M a,44,a,228,a,92
AR 22,202
AR 23,203
M a,44,a,232,a,108
AR 24,216
AR 25,217
M a,44,a,236,a,124
s_waitcnt lgkmcnt(0)
s_waitcnt vmcnt(5)
M a,48,a,240,a,64
s_barrier
TR a,224,16896
M a,48,a,244,a,80
TR a,226,17024
AR 26,218
M a,48,a,248,a,96
TR a,228,17152
AR 27,219
M a,48,a,252,a,112
TR a,230,17280
v_mul_f32 v20, v18, v20
M a,52,a,240,a,68
TR a,232,17408
v_mul_f32 v21, v18, v21
M a,52,a,244,a,84
TR a,234,17536
v_mul_f32 v22, v18, v22
M a,52,a,248,a,100
TR a,236,17664
v_mul_f32 v23, v18, v23
M a,52,a,252,a,116
TR a,238,17792
v_mul_f32 v24, v18, v24
M a,56,a,240,a,72
v_mul_f32 v25, v18, v25
v_mul_f32 v26, v18, v26
M a,56,a,244,a,88
v_mul_f32 v27, v18, v27
CV 232,20
M a,56,a,248,a,104
DL 7,76,93,1056
M a,56,a,252,a,120
CV 233,22
CV 234,24
M a,60,a,240,a,76
TR a,240,16928
CV 235,26
M a,60,a,244,a,92
TR a,242,17056
v_mul_f32 v40, v18, v40
L_pad28:
s_cbranch_execz L_ret28
M a,60,a,248,a,108
TR a,244,17184
v_mul_f32 v41, v18, v41
M a,60,a,252,a,124
s_waitcnt lgkmcnt(3)
TR a,246,17312
M v,64,a,224,a,128
TR a,248,17440
v_mul_f32 v42, v18, v42
M v,64,a,228,a,144
TR a,250,17568
v_mul_f32 v43, v18, v43
M v,64,a,232,a,160
TR a,252,17696
v_mul_f32 v56, v18, v56
M v,64,a,236,a,176
TR a,254,17824
v_mul_f32 v57, v18, v57
M v,68,a,224,a,132
v_mul_f32 v58, v18, v58
v_mul_f32 v59, v18, v59
M v,68,a,228,a,148
CV 248,40
CV 249,42
M v,68,a,232,a,164
CV 250,56
CV 251,58
M v,68,a,236,a,180
AR 20,204
AR 21,205
M v,72,a,224,a,136
AR 22,206
AR 23,207
M v,72,a,228,a,152
DL 7,80,93,2112
M v,72,a,232,a,168
AR 24,220
AR 25,221
M v,72,a,236,a,184
AR 26,222
AR 27,223
M v,76,a,224,a,140
TR a,224,16960
v_bfe_u32 v8, v4, 8, 2
M v,76,a,228,a,156
TR a,226,17088
v_lshrrev_b32 v9, 14, s95
M v,76,a,232,a,172
TR a,228,17216
v_add_lshl_u32 v8, v8, v9, 7
M v,76,a,236,a,188
s_waitcnt lgkmcnt(3)
TR a,230,17344
M v,80,a,240,a,128
TR a,232,17472
v_add_u32 v8, 4096, v8
M v,80,a,244,a,144
TR a,234,17600
v_mov_b32 v9, 0
M v,80,a,248,a,160
TR a,236,17728
v_mul_f32 v20, v19, v20
M v,80,a,252,a,176
TR a,238,17856
v_mul_f32 v21, v19, v21
M v,84,a,240,a,132
s_getpc_b64 s[100:101]
s_and_b32 s100, s100, 0xfffff000
M v,84,a,244,a,148
v_lshl_add_u64 v[8:9], v[8:9], 0, s[100:101]
v_mul_f32 v22, v19, v22
M v,84,a,248,a,164
global_load_dword v10, v[8:9], off
M v,84,a,252,a,180
v_mul_f32 v23, v19, v23
v_mul_f32 v24, v19, v24
M v,88,a,240,a,136
v_mul_f32 v25, v19, v25
v_mul_f32 v26, v19, v26
M v,88,a,244,a,152
DL 7,84,93,3168
M v,88,a,248,a,168
s_add_u32 m0, s92, 50688
s_mov_b32 s93, 344192
M v,88,a,252,a,184
v_mul_f32 v27, v19, v27
CV 236,20
M v,92,a,240,a,140
TR a,240,16992
CV 237,22
M v,92,a,244,a,156
TR a,242,17120
CV 238,24
M v,92,a,248,a,172
TR a,244,17248
CV 239,26
M v,92,a,252,a,188
s_waitcnt lgkmcnt(3)
TR a,246,17376
M v,96,a,224,a,128
TR a,248,17504
v_mul_f32 v44, v19, v44
M v,96,a,228,a,144
TR a,250,17632
v_mul_f32 v45, v19, v45
M v,96,a,232,a,160
TR a,252,17760
v_mul_f32 v46, v19, v46
M v,96,a,236,a,176
TR a,254,17888
v_mul_f32 v47, v19, v47
M v,100,a,224,a,132
v_mul_f32 v60, v19, v60
v_mul_f32 v61, v19, v61
M v,100,a,228,a,148
v_mul_f32 v62, v19, v62
v_mul_f32 v63, v19, v63
M v,100,a,232,a,164
CV 252,44
CV 253,46
M v,100,a,236,a,180
DL 7,72,93,0
M v,104,a,224,a,136
CV 254,60
CV 255,62
M v,104,a,228,a,152
v_rcp_f32 v28, v28
M v,104,a,232,a,168
s_mov_b32 s94, 33554432
s_and_b32 s16, s95, 3
M v,104,a,236,a,184
v_rcp_f32 v29, v29
M v,108,a,224,a,140
v_rcp_f32 v30, v30
M v,108,a,228,a,156
v_rcp_f32 v31, v31
M v,108,a,232,a,172
v_bfe_u32 v11, v4, 4, 6
s_lshl_b32 s16, s16, 12
M v,108,a,236,a,188
s_waitcnt lgkmcnt(0)
s_waitcnt vmcnt(6)
M v,112,a,240,a,128
s_barrier
TR a,224,33792
M v,112,a,244,a,144
TR a,226,33920
v_lshrrev_b32 v1, 3, v11
M v,112,a,248,a,160
TR a,228,34048
s_add_u32 s12, s16, 94371840
M v,112,a,252,a,176
TR a,230,34176
v_mul_u32_u24 v1, 992, v1
M v,116,a,240,a,132
TR a,232,34304
v_lshl_add_u32 v1, v11, 2, v1
M v,116,a,244,a,148
TR a,234,34432
s_mov_b32 s43, 0x20000
M v,116,a,248,a,164
TR a,236,34560
v_lshlrev_b32 v11, 2, v11
M v,116,a,252,a,180
TR a,238,34688
v_and_b32 v5, 60, v11
M v,120,a,240,a,136
DL 7,76,93,1056
M v,120,a,244,a,152
s_add_u32 s40, s88, s12
s_addc_u32 s41, s89, 0
M v,120,a,248,a,168
s_bfe_u32 s19, s95, 0x30002
v_mul_u32_u24 v3, 448, v5
M v,120,a,252,a,184
s_lshl_b32 s17, s19, 10
v_lshrrev_b32 v5, 6, v11
M v,124,a,240,a,140
TR a,240,33824
s_sub_u32 s13, s12, s17
M v,124,a,244,a,156
TR a,242,33952
v_lshl_add_u32 v3, v5, 4, v3
M v,124,a,248,a,172
TR a,244,34080
s_sub_u32 s16, 33554432, s17
M v,124,a,252,a,188
s_waitcnt lgkmcnt(3)
TR a,246,34208
M v,64,a,224,v,192
TR a,248,34336
s_xor_b32 s31, s17, 7168
M v,64,a,228,v,208
TR a,250,34464
s_add_u32 s31, s31, s16
M v,64,a,232,v,224
TR a,252,34592
s_xor_b32 s29, s17, 5120
M v,64,a,236,v,240
TR a,254,34720
s_add_u32 s29, s29, s16
M v,68,a,224,v,196
s_xor_b32 s27, s17, 3072
s_add_u32 s27, s27, s16
M v,68,a,228,v,212
DL 7,80,93,2112
M v,68,a,232,v,228
MU 64,28
MU 65,28
M v,68,a,236,v,244
MU 66,28
MU 67,28
M v,72,a,224,v,200
CV 32,64
CV 33,66
M v,72,a,228,v,216
s_xor_b32 s25, s17, 1024
s_add_u32 s25, s25, s16
M v,72,a,232,v,232
MU 68,29
MU 69,29
M v,72,a,236,v,248
MU 70,29
MU 71,29
M v,76,a,224,v,204
TR a,224,33856
CV 36,68
M v,76,a,228,v,220
TR a,226,33984
CV 37,70
M v,76,a,232,v,236
TR a,228,34112
MU 72,30
M v,76,a,236,v,252
s_waitcnt lgkmcnt(3)
TR a,230,34240
M v,80,a,240,v,192
TR a,232,34368
MU 73,30
M v,80,a,244,v,208
TR a,234,34496
MU 74,30
M v,80,a,248,v,224
TR a,236,34624
MU 75,30
M v,80,a,252,v,240
TR a,238,34752
CV 40,72
M v,84,a,240,v,196
DL 7,84,93,3168
M v,84,a,244,v,212
s_add_u32 m0, s92, 98816
s_mov_b32 s93, 229632
M v,84,a,248,v,228
MU 80,28
MU 81,28
M v,84,a,252,v,244
MU 82,28
MU 83,28
M v,88,a,240,v,200
CV 34,80
CV 35,82
M v,88,a,244,v,216
ST 32
M v,88,a,248,v,232
MU 84,29
MU 85,29
M v,88,a,252,v,248
MU 86,29
MU 87,29
M v,92,a,240,v,204
TR a,240,33888
CV 38,84
M v,92,a,244,v,220
TR a,242,34016
CV 39,86
M v,92,a,248,v,236
TR a,244,34144
s_mov_b32 s94, 34603008
M v,92,a,252,v,252
s_waitcnt lgkmcnt(3)
TR a,246,34272
M v,96,a,224,v,192
TR a,248,34400
MU 88,30
M v,96,a,228,v,208
TR a,250,34528
MU 89,30
M v,96,a,232,v,224
TR a,252,34656
MU 90,30
M v,96,a,236,v,240
DL 7,72,93,0
M v,100,a,224,v,196
TR a,254,34784
MU 91,30
M v,100,a,228,v,212
CV 41,74
CV 42,88
M v,100,a,232,v,228
CV 43,90
MU 76,31
M v,100,a,236,v,244
MU 77,31
MU 78,31
M v,104,a,224,v,200
MU 79,31
MU 92,31
M v,104,a,228,v,216
MU 93,31
MU 94,31
M v,104,a,232,v,232
MU 95,31
CV 44,76
M v,104,a,236,v,248
CV 45,78
CV 46,92
M v,108,a,224,v,204
CV 47,94
MU 96,28
M v,108,a,228,v,220
MU 97,28
MU 98,28
M v,108,a,232,v,236
MU 99,28
CV 48,96
M v,108,a,236,v,252
s_waitcnt lgkmcnt(0)
s_waitcnt vmcnt(6)
M v,112,a,240,v,192
s_barrier
TR a,224,0
M v,112,a,244,v,208
TR a,226,128
CV 49,98
M v,112,a,248,v,224
DL 7,76,93,1056
M v,112,a,252,v,240
TR a,228,256
MU 100,29
M v,116,a,240,v,196
TR a,230,384
MU 101,29
M v,116,a,244,v,212
TR a,232,512
MU 102,29
M v,116,a,248,v,228
TR a,234,640
MU 112,28
M v,116,a,252,v,244
TR a,236,768
MU 113,28
M v,120,a,240,v,200
TR a,238,896
MU 114,28
M v,120,a,244,v,216
ST 36
M v,120,a,248,v,232
s_mov_b32 s94, 35651584
MU 115,28
M v,120,a,252,v,248
CV 50,112
CV 51,114
M v,124,a,240,v,204
TR a,240,32
MU 103,29
M v,124,a,244,v,220
TR a,242,160
MU 116,29
M v,124,a,248,v,236
TR a,244,288
MU 117,29
M v,124,a,252,v,252
s_waitcnt lgkmcnt(3)
TR a,246,416
M a,0,a,224,a,128
TR a,248,544
MU 118,29
M a,0,a,228,a,144
DL 7,80,93,2112
M a,0,a,232,a,160
TR a,250,672
MU 119,29
M a,0,a,236,a,176
TR a,252,800
CV 52,100
M a,4,a,224,a,132
TR a,254,928
CV 53,102
M a,4,a,228,a,148
CV 54,116
CV 55,118
M a,4,a,232,a,164
MU 104,30
MU 105,30
M a,4,a,236,a,180
MU 106,30
MU 107,30
M a,8,a,224,a,136
DL 7,84,93,3168
M a,8,a,228,a,152
s_add_u32 m0, s92, 115712
s_mov_b32 s93, 344320
M a,8,a,232,a,168
MU 120,30
MU 121,30
M a,8,a,236,a,184
MU 122,30
MU 123,30
M a,12,a,224,a,140
TR a,224,64
CV 56,104
M a,12,a,228,a,156
TR a,226,192
CV 57,106
M a,12,a,232,a,172
DL 7,72,93,0
M a,12,a,236,a,188
s_waitcnt lgkmcnt(2)
TR a,228,320
M a,16,a,240,a,128
TR a,230,448
CV 58,120
M a,16,a,244,a,144
ST 40
M a,16,a,248,a,160
TR a,232,576
s_mov_b32 s94, 36700160
M a,16,a,252,a,176
TR a,234,704
CV 59,122
M a,20,a,240,a,132
TR a,236,832
MU 108,31
M a,20,a,244,a,148
TR a,238,960
MU 109,31
M a,20,a,248,a,164
DL 7,76,93,1056
M a,20,a,252,a,180
MU 110,31
MU 111,31
M a,24,a,240,a,136
CV 60,108
CV 61,110
M a,24,a,244,a,152
AW 220,60
AW 221,61
M a,24,a,248,a,168
DL 7,80,93,2112
M a,24,a,252,a,184
MU 124,31
MU 125,31
M a,28,a,240,a,140
TR a,240,96
MU 126,31
M a,28,a,244,a,156
TR a,242,224
MU 127,31
M a,28,a,248,a,172
TR a,244,352
CV 62,124
M a,28,a,252,a,188
s_waitcnt lgkmcnt(3)
TR a,246,480
M a,32,a,224,a,128
DL 7,84,93,3168
M a,32,a,228,a,144
TR a,248,608
s_add_u32 m0, s92, 81920
M a,32,a,232,a,160
TR a,250,736
s_mov_b32 s93, 256
M a,32,a,236,a,176
TR a,252,864
CV 63,126
M a,36,a,224,a,132
TR a,254,992
s_xor_b32 s30, s17, 6144
M a,36,a,228,a,148
s_add_u32 s30, s30, s16
s_xor_b32 s28, s17, 4096
M a,36,a,232,a,164
s_add_u32 s28, s28, s16
s_xor_b32 s26, s17, 2048
M a,36,a,236,a,180
s_add_u32 s26, s26, s16
AW 222,62
M a,40,a,224,a,136
AW 223,63
s_mov_b64 s[8:9], s[6:7]
M a,40,a,228,a,152
ST 44
M a,40,a,232,a,168
s_mov_b32 s94, 37748736
s_mov_b32 s10, 27712
M a,40,a,236,a,184
s_mov_b32 s11, 0x20000
M a,44,a,224,a,140
M a,44,a,228,a,156
M a,44,a,232,a,172
M a,44,a,236,a,188
s_waitcnt lgkmcnt(0)
s_waitcnt vmcnt(12)
M a,48,a,240,a,128
s_barrier
TR a,224,50688
M a,48,a,244,a,144
DL 7,72,93,0
M a,48,a,248,a,160
TR a,226,50816
M a,48,a,252,a,176
TR a,228,50944
M a,52,a,240,a,132
TR a,230,51072
M a,52,a,244,a,148
TR a,232,51200
M a,52,a,248,a,164
TR a,234,51328
M a,52,a,252,a,180
TR a,236,51456
M a,56,a,240,a,136
TR a,238,51584
M a,56,a,244,a,152
M a,56,a,248,a,168
M a,56,a,252,a,184
M a,60,a,240,a,140
DL 7,76,93,1056
M a,60,a,244,a,156
TR a,240,50720
M a,60,a,248,a,172
TR a,242,50848
M a,60,a,252,a,188
s_waitcnt lgkmcnt(2)
TR a,244,50976
M a,0,a,224,v,192
TR a,246,51104
M a,0,a,228,v,208
ST 48
M a,0,a,232,v,224
TR a,248,51232
s_mov_b32 s94, 38797312
M a,0,a,236,v,240
TR a,250,51360
M a,4,a,224,v,196
DL 7,80,93,2112
M a,4,a,228,v,212
TR a,252,51488
M a,4,a,232,v,228
TR a,254,51616
M a,4,a,236,v,244
AR 20,0
AR 21,1
M a,8,a,224,v,200
DL 7,84,93,3168
M a,8,a,228,v,216
s_add_u32 m0, s92, 132608
s_mov_b32 s93, 114944
M a,8,a,232,v,232
AR 22,2
AR 23,3
M a,8,a,236,v,248
v_mul_f32 v20, v28, v20
v_mul_f32 v21, v28, v21
M a,12,a,224,v,204
TR a,224,50752
v_mul_f32 v22, v28, v22
M a,12,a,228,v,220
TR a,226,50880
v_mul_f32 v23, v28, v23
M a,12,a,232,v,236
DL 7,72,93,0
M a,12,a,236,v,252
s_waitcnt lgkmcnt(2)
TR a,228,51008
M a,16,a,240,v,192
TR a,230,51136
CV 32,20
M a,16,a,244,v,208
TR a,232,51264
CV 33,22
L_pad29:
s_cbranch_execz L_ret29
M a,16,a,248,v,224
TR a,234,51392
AR 20,8
M a,16,a,252,v,240
TR a,236,51520
AR 21,9
M a,20,a,240,v,196
TR a,238,51648
AR 22,10
M a,20,a,244,v,212
DL 7,76,93,1056
M a,20,a,248,v,228
AR 23,11
v_mul_f32 v20, v30, v20
M a,20,a,252,v,244
v_mul_f32 v21, v30, v21
v_mul_f32 v22, v30, v22
M a,24,a,240,v,200
v_mul_f32 v23, v30, v23
CV 40,20
M a,24,a,244,v,216
ST 52
M a,24,a,248,v,232
s_mov_b32 s94, 39845888
CV 41,22
M a,24,a,252,v,248
AR 20,16
AR 21,17
M a,28,a,240,v,204
DL 7,80,93,2112
M a,28,a,244,v,220
TR a,240,50784
AR 22,18
M a,28,a,248,v,236
TR a,242,50912
AR 23,19
M a,28,a,252,v,252
s_waitcnt lgkmcnt(2)
TR a,244,51040
M a,32,a,224,v,192
DL 7,84,93,3168
M a,32,a,228,v,208
TR a,246,51168
s_add_u32 m0, s92, 16896
M a,32,a,232,v,224
TR a,248,51296
s_mov_b32 s93, 229760
M a,32,a,236,v,240
TR a,250,51424
v_mul_f32 v20, v28, v20
M a,36,a,224,v,196
TR a,252,51552
v_mul_f32 v21, v28, v21
M a,36,a,228,v,212
TR a,254,51680
v_xor_b32 v2, 81920, v2
M a,36,a,232,v,228
v_mul_f32 v22, v28, v22
v_mul_f32 v23, v28, v23
M a,36,a,236,v,244
CV 34,20
CV 35,22
M a,40,a,224,v,200
AR 24,4
AR 25,5
M a,40,a,228,v,216
AR 26,6
AR 27,7
M a,40,a,232,v,232
v_mul_f32 v24, v29, v24
v_mul_f32 v25, v29, v25
M a,40,a,236,v,248
v_mul_f32 v26, v29, v26
v_mul_f32 v27, v29, v27
M a,44,a,224,v,204
CV 36,24
CV 37,26
M a,44,a,228,v,220
AR 24,12
AR 25,13
M a,44,a,232,v,236
AR 26,14
AR 27,15
M a,44,a,236,v,252
s_waitcnt lgkmcnt(0)
s_waitcnt vmcnt(11)
M a,48,a,240,v,192
s_barrier
TR a,224,16896
M a,48,a,244,v,208
DL 7,72,93,0
M a,48,a,248,v,224
TR a,226,17024
v_mul_f32 v24, v31, v24
M a,48,a,252,v,240
TR a,228,17152
v_mul_f32 v25, v31, v25
M a,52,a,240,v,196
ST 56
M a,52,a,244,v,212
TR a,230,17280
s_mov_b32 s94, 41943040
M a,52,a,248,v,228
TR a,232,17408
v_mul_f32 v26, v31, v26
M a,52,a,252,v,244
TR a,234,17536
v_mul_f32 v27, v31, v27
M a,56,a,240,v,200
TR a,236,17664
CV 44,24
M a,56,a,244,v,216
TR a,238,17792
CV 45,26
M a,56,a,248,v,232
AR 24,20
AR 25,21
M a,56,a,252,v,248
AR 26,22
AR 27,23
M a,60,a,240,v,204
TR a,240,33792
v_mul_f32 v24, v29, v24
M a,60,a,244,v,220
TR a,242,33920
v_mul_f32 v25, v29, v25
M a,60,a,248,v,236
DL 7,76,93,1056
M a,60,a,252,v,252
s_waitcnt lgkmcnt(2)
TR a,244,34048
Z v,64,a,224,v,128
TR a,246,34176
v_mul_f32 v26, v29, v26
M v,64,a,228,v,144
TR a,248,34304
v_mul_f32 v27, v29, v27
M v,64,a,232,v,160
TR a,250,34432
CV 38,24
M v,64,a,236,v,176
TR a,252,34560
CV 39,26
Z v,68,a,224,v,132
TR a,254,34688
AR 20,24
M v,68,a,228,v,148
AR 21,25
AR 22,26
M v,68,a,232,v,164
AR 23,27
v_mul_f32 v20, v30, v20
M v,68,a,236,v,180
v_mul_f32 v21, v30, v21
v_mul_f32 v22, v30, v22
Z v,72,a,224,v,136
v_mul_f32 v23, v30, v23
CV 42,20
M v,72,a,228,v,152
CV 43,22
AR 24,28
M v,72,a,232,v,168
AR 25,29
AR 26,30
M v,72,a,236,v,184
AR 27,31
v_mul_f32 v24, v31, v24
Z v,76,a,224,v,140
ST 32
M v,76,a,228,v,156
TR a,224,16928
s_mov_b32 s94, 42991616
M v,76,a,232,v,172
TR a,226,17056
v_mul_f32 v25, v31, v25
M v,76,a,236,v,188
s_waitcnt lgkmcnt(2)
TR a,228,17184
M v,64,a,240,v,192
DL 7,80,93,2112
M v,64,a,244,v,208
TR a,230,17312
v_mul_f32 v26, v31, v26
M v,64,a,248,v,224
TR a,232,17440
v_mul_f32 v27, v31, v27
M v,64,a,252,v,240
TR a,234,17568
CV 46,24
M v,68,a,240,v,196
TR a,236,17696
CV 47,26
M v,68,a,244,v,212
TR a,238,17824
AR 20,32
M v,68,a,248,v,228
AR 21,33
AR 22,34
M v,68,a,252,v,244
AR 23,35
v_mul_f32 v20, v28, v20
M v,72,a,240,v,200
v_mul_f32 v21, v28, v21
v_mul_f32 v22, v28, v22
M v,72,a,244,v,216
v_mul_f32 v23, v28, v23
CV 48,20
M v,72,a,248,v,232
CV 49,22
AR 20,40
M v,72,a,252,v,248
AR 21,41
AR 22,42
M v,76,a,240,v,204
DL 7,84,93,3168
M v,76,a,244,v,220
TR a,240,33824
s_add_u32 m0, s92, 33792
M v,76,a,248,v,236
TR a,242,33952
s_mov_b32 s93, 344448
M v,76,a,252,v,252
s_waitcnt lgkmcnt(2)
TR a,244,34080
Z v,80,a,224,v,128
TR a,246,34208
AR 23,43
M v,80,a,228,v,144
TR a,248,34336
v_mul_f32 v20, v30, v20
M v,80,a,232,v,160
TR a,250,34464
v_mul_f32 v21, v30, v21
M v,80,a,236,v,176
TR a,252,34592
v_mul_f32 v22, v30, v22
Z v,84,a,224,v,132
ST 36
M v,84,a,228,v,148
TR a,254,34720
s_mov_b32 s94, 44040192
M v,84,a,232,v,164
v_mul_f32 v23, v30, v23
CV 56,20
M v,84,a,236,v,180
CV 57,22
AR 20,48
Z v,88,a,224,v,136
AR 21,49
AR 22,50
M v,88,a,228,v,152
AR 23,51
v_mul_f32 v20, v28, v20
M v,88,a,232,v,168
v_mov_b32 v6, 2
s_mov_b32 s42, 128
M v,88,a,236,v,184
DL 7,72,93,0
Z v,92,a,224,v,140
v_mul_f32 v21, v28, v21
v_mul_f32 v22, v28, v22
M v,92,a,228,v,156
v_mul_f32 v23, v28, v23
CV 50,20
M v,92,a,232,v,172
CV 51,22
AR 24,36
M v,92,a,236,v,188
s_waitcnt lgkmcnt(0)
s_waitcnt vmcnt(8)
M v,80,a,240,v,192
s_barrier
TR a,224,0
M v,80,a,244,v,208
TR a,226,128
AR 25,37
M v,80,a,248,v,224
s_waitcnt vmcnt(6)
TR a,228,256
M v,80,a,252,v,240
buffer_store_dword v6, v11, s[40:43], 0 offen offset:0 sc1
M v,84,a,240,v,196
TR a,230,384
AR 26,38
M v,84,a,244,v,212
TR a,232,512
AR 27,39
M v,84,a,248,v,228
TR a,234,640
v_mul_f32 v24, v29, v24
M v,84,a,252,v,244
TR a,236,768
v_mul_f32 v25, v29, v25
M v,88,a,240,v,200
TR a,238,896
v_mul_f32 v26, v29, v26
M v,88,a,244,v,216
v_mul_f32 v27, v29, v27
CV 52,24
M v,88,a,248,v,232
DL 7,76,93,1056
M v,88,a,252,v,248
CV 53,26
AR 24,44
M v,92,a,240,v,204
TR a,240,50688
AR 25,45
M v,92,a,244,v,220
ST 40
M v,92,a,248,v,236
TR a,242,50816
s_mov_b32 s94, 45088768
M v,92,a,252,v,252
s_waitcnt lgkmcnt(2)
TR a,244,50944
M v,64,a,224,a,64
TR a,246,51072
AR 26,46
M v,64,a,228,a,80
TR a,248,51200
AR 27,47
M v,64,a,232,a,96
TR a,250,51328
v_mul_f32 v24, v31, v24
M v,64,a,236,a,112
TR a,252,51456
v_mul_f32 v25, v31, v25
M v,68,a,224,a,68
TR a,254,51584
v_mul_f32 v26, v31, v26
M v,68,a,228,a,84
v_mul_f32 v27, v31, v27
CV 60,24
M v,68,a,232,a,100
CV 61,26
AR 24,52
M v,68,a,236,a,116
AR 25,53
AR 26,54
M v,72,a,224,a,72
AR 27,55
v_mul_f32 v24, v29, v24
M v,72,a,228,a,88
DL 7,80,93,2112
M v,72,a,232,a,104
v_mul_f32 v25, v29, v25
v_mul_f32 v26, v29, v26
M v,72,a,236,a,120
v_mul_f32 v27, v29, v27
CV 54,24
M v,76,a,224,a,76
TR a,224,32
CV 55,26
M v,76,a,228,a,92
TR a,226,160
AR 20,56
M v,76,a,232,a,108
TR a,228,288
AR 21,57
M v,76,a,236,a,124
s_waitcnt lgkmcnt(3)
TR a,230,416
M v,64,a,240,a,128
TR a,232,544
AR 22,58
M v,64,a,244,a,144
TR a,234,672
AR 23,59
M v,64,a,248,a,160
TR a,236,800
v_mul_f32 v20, v30, v20
M v,64,a,252,a,176
TR a,238,928
v_mul_f32 v21, v30, v21
M v,68,a,240,a,132
v_mul_f32 v22, v30, v22
v_mul_f32 v23, v30, v23
M v,68,a,244,a,148
ST 44
M v,68,a,248,a,164
s_mov_b32 s94, 46137344
CV 58,20
M v,68,a,252,a,180
CV 59,22
MU 64,28
M v,72,a,240,a,136
DL 7,84,93,3168
M v,72,a,244,a,152
s_add_u32 m0, s92, 0
s_mov_b32 s93, 384
M v,72,a,248,a,168
MU 65,28
MU 66,28
M v,72,a,252,a,184
MU 67,28
CV 32,64
M v,76,a,240,a,140
TR a,240,50720
CV 33,66
M v,76,a,244,a,156
TR a,242,50848
MU 68,29
M v,76,a,248,a,172
TR a,244,50976
MU 69,29
M v,76,a,252,a,188
s_waitcnt lgkmcnt(3)
TR a,246,51104
M v,80,a,224,a,64
TR a,248,51232
MU 70,29
M v,80,a,228,a,80
TR a,250,51360
MU 71,29
M v,80,a,232,a,96
TR a,252,51488
CV 36,68
M v,80,a,236,a,112
TR a,254,51616
CV 37,70
M v,84,a,224,a,68
MU 72,30
MU 73,30
M v,84,a,228,a,84
MU 74,30
MU 75,30
M v,84,a,232,a,100
CV 40,72
CV 41,74
M v,84,a,236,a,116
DL 7,72,93,0
M v,88,a,224,a,72
MU 76,31
MU 77,31
M v,88,a,228,a,88
MU 78,31
MU 79,31
M v,88,a,232,a,104
CV 44,76
CV 45,78
M v,88,a,236,a,120
AW 48,60
AW 49,61
M v,92,a,224,a,76
TR a,224,16960
AR 24,60
M v,92,a,228,a,92
ST 48
M v,92,a,232,a,108
TR a,226,17088
s_mov_b32 s94, 47185920
M v,92,a,236,a,124
s_waitcnt lgkmcnt(2)
TR a,228,17216
M v,80,a,240,a,128
TR a,230,17344
AR 25,61
M v,80,a,244,a,144
TR a,232,17472
AR 26,62
M v,80,a,248,a,160
TR a,234,17600
AR 27,63
M v,80,a,252,a,176
TR a,236,17728
v_mul_f32 v24, v31, v24
M v,84,a,240,a,132
TR a,238,17856
v_mul_f32 v25, v31, v25
M v,84,a,244,a,148
v_mul_f32 v26, v31, v26
v_mul_f32 v27, v31, v27
M v,84,a,248,a,164
DL 7,76,93,1056
M v,84,a,252,a,180
MU 80,28
MU 81,28
M v,88,a,240,a,136
MU 82,28
MU 83,28
M v,88,a,244,a,152
CV 34,80
CV 35,82
M v,88,a,248,a,168
MU 84,29
MU 85,29
M v,88,a,252,a,184
MU 86,29
MU 87,29
M v,92,a,240,a,140
TR a,240,33856
CV 38,84
M v,92,a,244,a,156
TR a,242,33984
CV 39,86
M v,92,a,248,a,172
TR a,244,34112
MU 88,30
M v,92,a,252,a,188
s_waitcnt lgkmcnt(3)
TR a,246,34240
Z v,96,a,224,v,128
TR a,248,34368
MU 89,30
M v,96,a,228,v,144
TR a,250,34496
MU 90,30
M v,96,a,232,v,160
TR a,252,34624
MU 91,30
M v,96,a,236,v,176
TR a,254,34752
CV 42,88
Z v,100,a,224,v,132
CV 43,90
MU 92,31
M v,100,a,228,v,148
DL 7,80,93,2112
M v,100,a,232,v,164
MU 93,31
MU 94,31
M v,100,a,236,v,180
MU 95,31
CV 46,92
Z v,104,a,224,v,136
ST 52
M v,104,a,228,v,152
s_mov_b32 s94, 48234496
CV 47,94
M v,104,a,232,v,168
CV 62,24
CV 63,26
M v,104,a,236,v,184
AW 50,62
AW 51,63
Z v,108,a,224,v,140
TR a,224,16992
v_lshrrev_b32 v20, 6, v11
M v,108,a,228,v,156
TR a,226,17120
v_bfe_u32 v21, v11, 4, 1
M v,108,a,232,v,172
TR a,228,17248
v_xor_b32 v20, v20, v21
M v,108,a,236,v,188
s_waitcnt lgkmcnt(3)
TR a,230,17376
M v,96,a,240,v,192
TR a,232,17504
v_and_b32 v21, 1, v20
M v,96,a,244,v,208
TR a,234,17632
v_lshlrev_b32 v20, 1, v20
M v,96,a,248,v,224
TR a,236,17760
v_lshl_add_u32 v20, v21, 4, v20
M v,96,a,252,v,240
TR a,238,17888
v_bfe_u32 v21, v11, 5, 1
M v,100,a,240,v,196
DL 7,84,93,3168
M v,100,a,244,v,212
s_add_u32 m0, s92, 50688
s_mov_b32 s93, 115072
M v,100,a,248,v,228
v_lshl_add_u32 v20, v21, 1, v20
v_bfe_u32 v21, v11, 3, 1
L_pad30:
s_cbranch_execz L_ret30
M v,100,a,252,v,244
v_add_u32 v20, v20, v21
v_and_b32 v21, 4, v11
M v,104,a,240,v,200
v_lshlrev_b32 v21, 2, v21
v_mov_b32 v22, 0x3f80
M v,104,a,244,v,216
v_lshlrev_b32 v20, v20, 1
v_lshlrev_b32 v21, v21, v22
M v,104,a,248,v,232
v_bfe_i32 v22, v20, 0, 1
v_and_b32 v22, v22, v21
M v,104,a,252,v,248
AW 0,22
v_bfe_i32 v22, v20, 1, 1
M v,108,a,240,v,204
TR a,240,33888
v_and_b32 v22, v22, v21
M v,108,a,244,v,220
TR a,242,34016
AW 1,22
M v,108,a,248,v,236
TR a,244,34144
v_bfe_i32 v22, v20, 2, 1
M v,108,a,252,v,252
s_waitcnt lgkmcnt(3)
TR a,246,34272
Z v,112,a,224,v,128
buffer_load_dword v5, v1, s[88:91], s13 offen offset:0 sc1
M v,112,a,228,v,144
TR a,248,34400
v_and_b32 v22, v22, v21
M v,112,a,232,v,160
TR a,250,34528
AW 2,22
M v,112,a,236,v,176
ST 56
Z v,116,a,224,v,132
TR a,252,34656
s_mov_b32 s94, 50331648
M v,116,a,228,v,148
TR a,254,34784
v_bfe_i32 v22, v20, 3, 1
M v,116,a,232,v,164
DL 7,72,93,0
M v,116,a,236,v,180
v_and_b32 v22, v22, v21
AW 3,22
Z v,120,a,224,v,136
v_bfe_i32 v22, v20, 4, 1
v_and_b32 v22, v22, v21
M v,120,a,228,v,152
AW 4,22
v_bfe_i32 v22, v20, 5, 1
M v,120,a,232,v,168
v_and_b32 v22, v22, v21
AW 5,22
M v,120,a,236,v,184
v_bfe_i32 v22, v20, 6, 1
v_and_b32 v22, v22, v21
Z v,124,a,224,v,140
TR a,224,64
AW 6,22
M v,124,a,228,v,156
TR a,226,192
v_bfe_i32 v22, v20, 7, 1
M v,124,a,232,v,172
TR a,228,320
v_and_b32 v22, v22, v21
M v,124,a,236,v,188
s_waitcnt lgkmcnt(3)
s_barrier
M v,112,a,240,v,192
TR a,230,448
AW 7,22
M v,112,a,244,v,208
TR a,232,576
M v,112,a,248,v,224
DL 7,76,93,1056
M v,112,a,252,v,240
TR a,234,704
M v,116,a,240,v,196
TR a,236,832
M v,116,a,244,v,212
TR a,238,960
M v,116,a,248,v,228
M v,116,a,252,v,244
M v,120,a,240,v,200
M v,120,a,244,v,216
M v,120,a,248,v,232
M v,120,a,252,v,248
ST 32
M v,124,a,240,v,204
TR a,240,50752
s_mov_b32 s94, 51380224
M v,124,a,244,v,220
TR a,242,50880
M v,124,a,248,v,236
TR a,244,51008
M v,124,a,252,v,252
s_waitcnt lgkmcnt(3)
TR a,246,51136
M v,96,a,224,a,64
TR a,248,51264
M v,96,a,228,a,80
DL 7,80,93,2112
M v,96,a,232,a,96
TR a,250,51392
M v,96,a,236,a,112
TR a,252,51520
M v,100,a,224,a,68
TR a,254,51648
M v,100,a,228,a,84
M v,100,a,232,a,100
M v,100,a,236,a,116
M v,104,a,224,a,72
M v,104,a,228,a,88
M v,104,a,232,a,104
M v,104,a,236,a,120
M v,108,a,224,a,76
TR a,224,96
M v,108,a,228,a,92
TR a,226,224
M v,108,a,232,a,108
TR a,228,352
M v,108,a,236,a,124
s_waitcnt lgkmcnt(3)
TR a,230,480
M v,96,a,240,a,128
DL 7,84,93,3168
M v,96,a,244,a,144
TR a,232,608
s_add_u32 m0, s92, 98816
M v,96,a,248,a,160
TR a,234,736
s_mov_b32 s93, 229888
M v,96,a,252,a,176
ST 36
M v,100,a,240,a,132
TR a,236,864
s_mov_b32 s94, 52428800
M v,100,a,244,a,148
TR a,238,992
M v,100,a,248,a,164
M v,100,a,252,a,180
MU 96,28
MU 97,28
M v,104,a,240,a,136
MU 98,28
MU 99,28
M v,104,a,244,a,152
v_mov_b32 v6, 4
s_mov_b32 s42, 256
M v,104,a,248,a,168
CV 48,96
CV 49,98
M v,104,a,252,a,184
MU 100,29
MU 101,29
M v,108,a,240,a,140
TR a,240,50784
MU 102,29
M v,108,a,244,a,156
TR a,242,50912
MU 103,29
M v,108,a,248,a,172
TR a,244,51040
CV 52,100
M v,108,a,252,a,188
s_waitcnt lgkmcnt(3)
TR a,246,51168
M v,112,a,224,a,64
DL 7,72,93,0
M v,112,a,228,a,80
s_waitcnt vmcnt(7)
TR a,248,51296
M v,112,a,232,a,96
buffer_store_dword v6, v11, s[40:43], 0 offen offset:128 sc1
M v,112,a,236,a,112
TR a,250,51424
s_add_u32 s14, s31, 0
M v,116,a,224,a,68
TR a,252,51552
CV 53,102
M v,116,a,228,a,84
TR a,254,51680
v_xor_b32 v2, 81920, v2
M v,116,a,232,a,100
s_waitcnt vmcnt(8)
v_cmp_gt_u32 vcc, 2, v5
M v,116,a,236,a,116
s_cbranch_vccz L_sbA0
s_mov_b32 s18, 0x40000
L_sqA0:
buffer_load_dword v5, v1, s[88:91], s13 offen offset:0 sc1
s_waitcnt vmcnt(0)
v_cmp_gt_u32 vcc, 2, v5
s_sub_u32 s18, s18, 1
s_cbranch_scc1 L_sbA0
s_cbranch_vccnz L_sqA0
L_sbA0:
M v,120,a,224,a,72
buffer_load_dwordx4 a[192:195], v4, s[88:91], s14 offen sc1
M v,120,a,228,a,88
MU 104,30
MU 105,30
M v,120,a,232,a,104
MU 106,30
MU 107,30
M v,120,a,236,a,120
ST 40
M v,124,a,224,a,76
s_mov_b32 s94, 53477376
CV 56,104
M v,124,a,228,a,92
CV 57,106
MU 108,31
M v,124,a,232,a,108
DL 7,76,93,1056
M v,124,a,236,a,124
s_waitcnt lgkmcnt(0)
s_waitcnt vmcnt(11)
M v,112,a,240,a,128
s_barrier
TR a,224,16896
M v,112,a,244,a,144
TR a,226,17024
MU 109,31
M v,112,a,248,a,160
TR a,228,17152
MU 110,31
M v,112,a,252,a,176
TR a,230,17280
MU 111,31
M v,116,a,240,a,132
TR a,232,17408
CV 60,108
M v,116,a,244,a,148
TR a,234,17536
CV 61,110
M v,116,a,248,a,164
TR a,236,17664
MU 112,28
M v,116,a,252,a,180
TR a,238,17792
MU 113,28
M v,120,a,240,a,136
MU 114,28
MU 115,28
M v,120,a,244,a,152
CV 50,112
CV 51,114
M v,120,a,248,a,168
s_add_u32 s15, s29, 1048576
MU 116,29
M v,120,a,252,a,184
MU 117,29
MU 118,29
M v,124,a,240,a,140
TR a,240,33792
MU 119,29
M v,124,a,244,a,156
DL 7,80,93,2112
M v,124,a,248,a,172
TR a,242,33920
CV 54,116
M v,124,a,252,a,188
s_waitcnt lgkmcnt(2)
TR a,244,34048
Z v,64,a,224,v,128
buffer_load_dwordx4 a[196:199], v4, s[88:91], s15 offen sc1
M v,64,a,228,v,144
TR a,246,34176
CV 55,118
M v,64,a,232,v,160
TR a,248,34304
MU 120,30
M v,64,a,236,v,176
TR a,250,34432
MU 121,30
Z v,68,a,224,v,132
TR a,252,34560
MU 122,30
M v,68,a,228,v,148
TR a,254,34688
MU 123,30
M v,68,a,232,v,164
ST 44
M v,68,a,236,v,180
s_mov_b32 s94, 54525952
CV 58,120
Z v,72,a,224,v,136
CV 59,122
MU 124,31
M v,72,a,228,v,152
MU 125,31
MU 126,31
M v,72,a,232,v,168
MU 127,31
CV 62,124
M v,72,a,236,v,184
CV 63,126
AW 52,60
Z v,76,a,224,v,140
DL 7,84,93,3168
M v,76,a,228,v,156
TR a,224,16928
v_bfe_u32 v8, v4, 8, 2
M v,76,a,232,v,172
TR a,226,17056
v_lshrrev_b32 v9, 14, s95
M v,76,a,236,v,188
s_waitcnt lgkmcnt(2)
TR a,228,17184
M v,64,a,240,v,192
TR a,230,17312
s_add_u32 m0, s92, 115712
M v,64,a,244,v,208
TR a,232,17440
s_mov_b32 s93, 344576
M v,64,a,248,v,224
TR a,234,17568
s_add_u32 s14, s27, 2097152
M v,64,a,252,v,240
TR a,236,17696
v_add_lshl_u32 v8, v8, v9, 7
M v,68,a,240,v,196
TR a,238,17824
v_add_u32 v8, 4096, v8
M v,68,a,244,v,212
s_getpc_b64 s[100:101]
s_and_b32 s100, s100, 0xfffff000
M v,68,a,248,v,228
v_mov_b32 v9, 0
v_lshl_add_u64 v[8:9], v[8:9], 0, s[100:101]
M v,68,a,252,v,244
global_load_dword v10, v[8:9], off
M v,72,a,240,v,200
AW 53,61
AW 54,62
M v,72,a,244,v,216
AW 55,63
M v,72,a,248,v,232
buffer_load_dwordx4 a[200:203], v4, s[88:91], s14 offen sc1
M v,72,a,252,v,248
M v,76,a,240,v,204
TR a,240,33824
M v,76,a,244,v,220
DL 7,72,93,0
M v,76,a,248,v,236
TR a,242,33952
M v,76,a,252,v,252
s_waitcnt lgkmcnt(2)
TR a,244,34080
Z v,80,a,224,v,128
ST 48
M v,80,a,228,v,144
TR a,246,34208
s_mov_b32 s94, 55574528
M v,80,a,232,v,160
TR a,248,34336
M v,80,a,236,v,176
TR a,250,34464
Z v,84,a,224,v,132
TR a,252,34592
M v,84,a,228,v,148
TR a,254,34720
M v,84,a,232,v,164
M v,84,a,236,v,180
Z v,88,a,224,v,136
M v,88,a,228,v,152
M v,88,a,232,v,168
DL 7,76,93,1056
M v,88,a,236,v,184
s_add_u32 s15, s25, 3145728
Z v,92,a,224,v,140
M v,92,a,228,v,156
M v,92,a,232,v,172
M v,92,a,236,v,188
s_waitcnt lgkmcnt(0)
s_waitcnt vmcnt(15)
M v,80,a,240,v,192
s_barrier
TR a,224,0
M v,80,a,244,v,208
buffer_load_dwordx4 a[204:207], v4, s[88:91], s15 offen sc1
M v,80,a,248,v,224
TR a,226,128
M v,80,a,252,v,240
TR a,228,256
M v,84,a,240,v,196
TR a,230,384
M v,84,a,244,v,212
TR a,232,512
M v,84,a,248,v,228
TR a,234,640
M v,84,a,252,v,244
TR a,236,768
M v,88,a,240,v,200
TR a,238,896
M v,88,a,244,v,216
ST 52
M v,88,a,248,v,232
s_mov_b32 s94, 56623104
M v,88,a,252,v,248
M v,92,a,240,v,204
DL 7,80,93,2112
M v,92,a,244,v,220
TR a,240,50688
M v,92,a,248,v,236
TR a,242,50816
M v,92,a,252,v,252
s_waitcnt lgkmcnt(2)
TR a,244,50944
M v,64,a,224,a,64
TR a,246,51072
M v,64,a,228,a,80
TR a,248,51200
M v,64,a,232,a,96
TR a,250,51328
s_add_u32 s14, s30, 4194304
M v,64,a,236,a,112
TR a,252,51456
M v,68,a,224,a,68
TR a,254,51584
M v,68,a,228,a,84
M v,68,a,232,a,100
M v,68,a,236,a,116
M v,72,a,224,a,72
DL 7,84,93,3168
M v,72,a,228,a,88
s_add_u32 m0, s92, 81920
s_mov_b32 s93, 512
M v,72,a,232,a,104
M v,72,a,236,a,120
buffer_load_dwordx4 a[208:211], v4, s[88:91], s14 offen sc1
M v,76,a,224,a,76
TR a,224,32
M v,76,a,228,a,92
TR a,226,160
M v,76,a,232,a,108
TR a,228,288
M v,76,a,236,a,124
s_waitcnt lgkmcnt(3)
TR a,230,416
M v,64,a,240,a,128
buffer_load_dword v5, v1, s[88:91], s13 offen offset:128 sc1
M v,64,a,244,a,144
TR a,232,544
M v,64,a,248,a,160
TR a,234,672
M v,64,a,252,a,176
ST 56
M v,68,a,240,a,132
TR a,236,800
s_mov_b32 s94, 58720256
M v,68,a,244,a,148
TR a,238,928
M v,68,a,248,a,164
M v,68,a,252,a,180
DL 7,72,93,0
M v,72,a,240,a,136
MU 64,28
MU 65,28
M v,72,a,244,a,152
MU 66,28
MU 67,28
M v,72,a,248,a,168
s_add_u32 s15, s28, 5242880
CV 32,64
M v,72,a,252,a,184
CV 33,66
MU 68,29
M v,76,a,240,a,140
TR a,240,50720
MU 69,29
M v,76,a,244,a,156
TR a,242,50848
MU 70,29
M v,76,a,248,a,172
TR a,244,50976
MU 71,29
M v,76,a,252,a,188
s_waitcnt lgkmcnt(3)
TR a,246,51104
M v,80,a,224,a,64
buffer_load_dwordx4 a[212:215], v4, s[88:91], s15 offen sc1
M v,80,a,228,a,80
TR a,248,51232
CV 36,68
M v,80,a,232,a,96
TR a,250,51360
CV 37,70
M v,80,a,236,a,112
TR a,252,51488
MU 72,30
M v,84,a,224,a,68
TR a,254,51616
MU 73,30
M v,84,a,228,a,84
MU 74,30
MU 75,30
M v,84,a,232,a,100
DL 7,76,93,1056
M v,84,a,236,a,116
CV 40,72
CV 41,74
M v,88,a,224,a,72
MU 76,31
MU 77,31
M v,88,a,228,a,88
MU 78,31
MU 79,31
M v,88,a,232,a,104
CV 44,76
CV 45,78
M v,88,a,236,a,120
M v,92,a,224,a,76
TR a,224,16960
M v,92,a,228,a,92
TR a,226,17088
M v,92,a,232,a,108
TR a,228,17216
M v,92,a,236,a,124
s_waitcnt lgkmcnt(3)
TR a,230,17344
M v,80,a,240,a,128
TR a,232,17472
M v,80,a,244,a,144
TR a,234,17600
s_add_u32 s14, s26, 6291456
M v,80,a,248,a,160
TR a,236,17728
M v,80,a,252,a,176
TR a,238,17856
M v,84,a,240,a,132
M v,84,a,244,a,148
DL 7,80,93,2112
M v,84,a,248,a,164
M v,84,a,252,a,180
M v,88,a,240,a,136
buffer_load_dwordx4 a[216:219], v4, s[88:91], s14 offen sc1
M v,88,a,244,a,152
MU 80,28
MU 81,28
M v,88,a,248,a,168
MU 82,28
MU 83,28
M v,88,a,252,a,184
CV 34,80
CV 35,82
M v,92,a,240,a,140
ST 32
M v,92,a,244,a,156
TR a,240,33856
MU 84,29
M v,92,a,248,a,172
TR a,242,33984
MU 85,29
M v,92,a,252,a,188
s_waitcnt lgkmcnt(2)
TR a,244,34112
Z v,96,a,224,v,128
TR a,246,34240
MU 86,29
L_pad31:
s_cbranch_execz L_ret31
M v,96,a,228,v,144
TR a,248,34368
MU 87,29
M v,96,a,232,v,160
TR a,250,34496
CV 38,84
M v,96,a,236,v,176
TR a,252,34624
CV 39,86
Z v,100,a,224,v,132
TR a,254,34752
s_mov_b32 s94, 59768832
M v,100,a,228,v,148
DL 7,84,93,3168
M v,100,a,232,v,164
s_add_u32 m0, s92, 132608
s_mov_b32 s93, 115200
M v,100,a,236,v,180
MU 88,30
MU 89,30
Z v,104,a,224,v,136
v_mov_b32 v6, 6
s_mov_b32 s42, 384
M v,104,a,228,v,152
MU 90,30
MU 91,30
M v,104,a,232,v,168
CV 42,88
CV 43,90
M v,104,a,236,v,184
MU 92,31
MU 93,31
Z v,108,a,224,v,140
TR a,224,16992
MU 94,31
M v,108,a,228,v,156
TR a,226,17120
MU 95,31
M v,108,a,232,v,172
TR a,228,17248
CV 46,92
M v,108,a,236,v,188
s_waitcnt lgkmcnt(3)
TR a,230,17376
M v,96,a,240,v,192
s_waitcnt vmcnt(7)
TR a,232,17504
M v,96,a,244,v,208
buffer_store_dword v6, v11, s[40:43], 0 offen offset:256 sc1
M v,96,a,248,v,224
TR a,234,17632
s_add_u32 s14, s31, 8388608
M v,96,a,252,v,240
TR a,236,17760
CV 47,94
M v,100,a,240,v,196
DL 7,72,93,0
M v,100,a,244,v,212
s_waitcnt vmcnt(9)
v_cmp_gt_u32 vcc, 4, v5
M v,100,a,248,v,228
s_cbranch_vccz L_sbA1
s_mov_b32 s18, 0x40000
L_sqA1:
buffer_load_dword v5, v1, s[88:91], s13 offen offset:128 sc1
s_waitcnt vmcnt(0)
v_cmp_gt_u32 vcc, 4, v5
s_sub_u32 s18, s18, 1
s_cbranch_scc1 L_sbA1
s_cbranch_vccnz L_sqA1
L_sbA1:
M v,100,a,252,v,244
TR a,238,17888
M v,104,a,240,v,200
ST 36
M v,104,a,244,v,216
s_mov_b32 s94, 60817408
M v,104,a,248,v,232
M v,104,a,252,v,248
buffer_load_dwordx4 a[16:19], v4, s[88:91], s14 offen sc1
M v,108,a,240,v,204
TR a,240,33888
M v,108,a,244,v,220
TR a,242,34016
M v,108,a,248,v,236
TR a,244,34144
M v,108,a,252,v,252
s_waitcnt lgkmcnt(3)
TR a,246,34272
Z v,112,a,224,v,128
TR a,248,34400
M v,112,a,228,v,144
TR a,250,34528
M v,112,a,232,v,160
DL 7,76,93,1056
M v,112,a,236,v,176
TR a,252,34656
Z v,116,a,224,v,132
TR a,254,34784
M v,116,a,228,v,148
M v,116,a,232,v,164
M v,116,a,236,v,180
Z v,120,a,224,v,136
M v,120,a,228,v,152
M v,120,a,232,v,168
M v,120,a,236,v,184
Z v,124,a,224,v,140
TR a,224,64
M v,124,a,228,v,156
s_add_u32 s15, s29, 9437184
TR a,226,192
M v,124,a,232,v,172
TR a,228,320
M v,124,a,236,v,188
s_waitcnt lgkmcnt(3)
s_barrier
M v,112,a,240,v,192
ST 40
M v,112,a,244,v,208
TR a,230,448
s_mov_b32 s94, 61865984
M v,112,a,248,v,224
TR a,232,576
M v,112,a,252,v,240
DL 7,80,93,2112
M v,116,a,240,v,196
TR a,234,704
M v,116,a,244,v,212
TR a,236,832
M v,116,a,248,v,228
buffer_load_dwordx4 a[20:23], v4, s[88:91], s15 offen sc1
M v,116,a,252,v,244
TR a,238,960
M v,120,a,240,v,200
M v,120,a,244,v,216
M v,120,a,248,v,232
M v,120,a,252,v,248
M v,124,a,240,v,204
TR a,240,50752
M v,124,a,244,v,220
TR a,242,50880
M v,124,a,248,v,236
TR a,244,51008
M v,124,a,252,v,252
s_waitcnt vmcnt(10)
TR a,246,51136
Z v,12,a,0,a,192
DL 7,84,93,3168
M v,12,a,0,a,196
s_add_u32 m0, s92, 16896
s_mov_b32 s93, 230016
M v,12,a,0,a,200
TR a,248,51264
M v,12,a,0,a,204
TR a,250,51392
M v,12,a,0,a,208
TR a,252,51520
M v,12,a,0,a,212
TR a,254,51648
M v,12,a,0,a,216
M v,12,a,0,a,220
Z v,24,a,4,a,192
ST 44
M v,24,a,4,a,196
s_add_u32 s14, s27, 10485760
s_mov_b32 s94, 62914560
M v,24,a,4,a,200
M v,24,a,4,a,204
M v,24,a,4,a,208
CV 20,12
CV 21,14
M v,24,a,4,a,212
M v,24,a,4,a,216
M v,24,a,4,a,220
s_waitcnt lgkmcnt(8)
M v,96,a,224,a,64
DL 7,72,93,0
M v,96,a,228,a,80
M v,96,a,232,a,96
M v,96,a,236,a,112
buffer_load_dwordx4 a[24:27], v4, s[88:91], s14 offen sc1
M v,100,a,224,a,68
CV 22,24
CV 23,26
M v,100,a,228,a,84
M v,100,a,232,a,100
buffer_store_dwordx4 v[20:23], v3, s[8:11], 0 offen offset:0 sc1
M v,100,a,236,a,116
M v,104,a,224,a,72
M v,104,a,228,a,88
M v,104,a,232,a,104
M v,104,a,236,a,120
M v,108,a,224,a,76
TR a,224,96
M v,108,a,228,a,92
TR a,226,224
M v,108,a,232,a,108
DL 7,76,93,1056
M v,108,a,236,a,124
s_waitcnt lgkmcnt(2)
TR a,228,352
M v,96,a,240,a,128
TR a,230,480
M v,96,a,244,a,144
TR a,232,608
M v,96,a,248,a,160
TR a,234,736
M v,96,a,252,a,176
TR a,236,864
M v,100,a,240,a,132
TR a,238,992
M v,100,a,244,a,148
s_add_u32 s15, s25, 11534336
M v,100,a,248,a,164
M v,100,a,252,a,180
M v,104,a,240,a,136
MU 96,28
MU 97,28
M v,104,a,244,a,152
MU 98,28
MU 99,28
M v,104,a,248,a,168
CV 48,96
CV 49,98
M v,104,a,252,a,184
buffer_load_dwordx4 a[28:31], v4, s[88:91], s15 offen sc1
M v,108,a,240,a,140
TR a,240,50784
MU 100,29
M v,108,a,244,a,156
TR a,242,50912
MU 101,29
M v,108,a,248,a,172
DL 7,80,93,2112
M v,108,a,252,a,188
s_waitcnt lgkmcnt(2)
TR a,244,51040
M v,112,a,224,a,64
TR a,246,51168
MU 102,29
M v,112,a,228,a,80
TR a,248,51296
MU 103,29
M v,112,a,232,a,96
TR a,250,51424
CV 52,100
M v,112,a,236,a,112
TR a,252,51552
CV 53,102
M v,116,a,224,a,68
TR a,254,51680
v_xor_b32 v2, 81920, v2
M v,116,a,228,a,84
MU 104,30
MU 105,30
M v,116,a,232,a,100
MU 106,30
MU 107,30
M v,116,a,236,a,116
CV 56,104
CV 57,106
M v,120,a,224,a,72
MU 108,31
MU 109,31
M v,120,a,228,a,88
MU 110,31
MU 111,31
M v,120,a,232,a,104
CV 60,108
CV 61,110
M v,120,a,236,a,120
AW 56,60
AW 57,61
M v,124,a,224,a,76
DL 7,84,93,3168
M v,124,a,228,a,92
s_add_u32 m0, s92, 33792
s_mov_b32 s93, 344704
M v,124,a,232,a,108
M v,124,a,236,a,124
s_waitcnt lgkmcnt(0)
s_waitcnt vmcnt(19)
M v,112,a,240,a,128
s_barrier
TR a,224,16896
M v,112,a,244,a,144
TR a,226,17024
s_add_u32 s14, s30, 12582912
M v,112,a,248,a,160
TR a,228,17152
M v,112,a,252,a,176
TR a,230,17280
M v,116,a,240,a,132
TR a,232,17408
M v,116,a,244,a,148
TR a,234,17536
M v,116,a,248,a,164
TR a,236,17664
M v,116,a,252,a,180
TR a,238,17792
MU 112,28
M v,120,a,240,a,136
buffer_load_dwordx4 a[32:35], v4, s[88:91], s14 offen sc1
M v,120,a,244,a,152
MU 113,28
MU 114,28
M v,120,a,248,a,168
MU 115,28
CV 50,112
M v,120,a,252,a,184
CV 51,114
MU 116,29
M v,124,a,240,a,140
DL 7,72,93,0
M v,124,a,244,a,156
TR a,240,33792
MU 117,29
M v,124,a,248,a,172
TR a,242,33920
MU 118,29
M v,124,a,252,a,188
s_waitcnt lgkmcnt(2)
TR a,244,34048
Z v,64,a,224,v,128
ST 48
M v,64,a,228,v,144
TR a,246,34176
MU 119,29
M v,64,a,232,v,160
TR a,248,34304
CV 54,116
M v,64,a,236,v,176
buffer_load_dword v5, v1, s[88:91], s13 offen offset:256 sc1
Z v,68,a,224,v,132
TR a,250,34432
CV 55,118
M v,68,a,228,v,148
TR a,252,34560
s_mov_b32 s94, 63963136
M v,68,a,232,v,164
TR a,254,34688
MU 120,30
M v,68,a,236,v,180
MU 121,30
MU 122,30
Z v,72,a,224,v,136
MU 123,30
CV 58,120
M v,72,a,228,v,152
CV 59,122
MU 124,31
M v,72,a,232,v,168
DL 7,76,93,1056
M v,72,a,236,v,184
MU 125,31
MU 126,31
Z v,76,a,224,v,140
TR a,224,16928
MU 127,31
M v,76,a,228,v,156
TR a,226,17056
s_add_u32 s15, s28, 13631488
M v,76,a,232,v,172
TR a,228,17184
CV 62,124
M v,76,a,236,v,188
s_waitcnt lgkmcnt(3)
TR a,230,17312
M v,64,a,240,v,192
TR a,232,17440
CV 63,126
M v,64,a,244,v,208
TR a,234,17568
AW 58,62
M v,64,a,248,v,224
TR a,236,17696
AW 59,63
M v,64,a,252,v,240
buffer_load_dwordx4 a[36:39], v4, s[88:91], s15 offen sc1
M v,68,a,240,v,196
TR a,238,17824
M v,68,a,244,v,212
M v,68,a,248,v,228
M v,68,a,252,v,244
M v,72,a,240,v,200
ST 52
M v,72,a,244,v,216
s_mov_b32 s94, 65011712
M v,72,a,248,v,232
M v,72,a,252,v,248
DL 7,80,93,2112
M v,76,a,240,v,204
TR a,240,33824
M v,76,a,244,v,220
TR a,242,33952
M v,76,a,248,v,236
TR a,244,34080
M v,76,a,252,v,252
s_waitcnt lgkmcnt(3)
TR a,246,34208
Z v,80,a,224,v,128
TR a,248,34336
M v,80,a,228,v,144
TR a,250,34464
M v,80,a,232,v,160
TR a,252,34592
M v,80,a,236,v,176
TR a,254,34720
Z v,84,a,224,v,132
M v,84,a,228,v,148
M v,84,a,232,v,164
M v,84,a,236,v,180
Z v,88,a,224,v,136
DL 7,84,93,3168
M v,88,a,228,v,152
s_add_u32 s14, s26, 14680064
s_add_u32 m0, s92, 0
M v,88,a,232,v,168
s_mov_b32 s93, 640
M v,88,a,236,v,184
Z v,92,a,224,v,140
M v,92,a,228,v,156
M v,92,a,232,v,172
M v,92,a,236,v,188
s_waitcnt lgkmcnt(0)
s_waitcnt vmcnt(17)
M v,80,a,240,v,192
s_barrier
TR a,224,0
M v,80,a,244,v,208
ST 56
M v,80,a,248,v,224
TR a,226,128
s_mov_b32 s94, 67108864
M v,80,a,252,v,240
TR a,228,256
M v,84,a,240,v,196
buffer_load_dwordx4 a[40:43], v4, s[88:91], s14 offen sc1
M v,84,a,244,v,212
TR a,230,384
M v,84,a,248,v,228
TR a,232,512
M v,84,a,252,v,244
TR a,234,640
M v,88,a,240,v,200
TR a,236,768
M v,88,a,244,v,216
TR a,238,896
M v,88,a,248,v,232
DL 7,72,93,0
M v,88,a,252,v,248
M v,92,a,240,v,204
TR a,240,50688
M v,92,a,244,v,220
TR a,242,50816
M v,92,a,248,v,236
TR a,244,50944
M v,92,a,252,v,252
s_waitcnt lgkmcnt(3)
TR a,246,51072
M v,64,a,224,a,64
TR a,248,51200
M v,64,a,228,a,80
TR a,250,51328
M v,64,a,232,a,96
TR a,252,51456
M v,64,a,236,a,112
TR a,254,51584
M v,68,a,224,a,68
M v,68,a,228,a,84
s_add_u32 s14, s31, 16777216
M v,68,a,232,a,100
DL 7,76,93,1056
M v,68,a,236,a,116
M v,72,a,224,a,72
M v,72,a,228,a,88
s_waitcnt vmcnt(9)
v_cmp_gt_u32 vcc, 6, v5
M v,72,a,232,a,104
s_cbranch_vccz L_sbA2
s_mov_b32 s18, 0x40000
L_sqA2:
buffer_load_dword v5, v1, s[88:91], s13 offen offset:256 sc1
s_waitcnt vmcnt(0)
v_cmp_gt_u32 vcc, 6, v5
s_sub_u32 s18, s18, 1
s_cbranch_scc1 L_sbA2
s_cbranch_vccnz L_sqA2
L_sbA2:
M v,72,a,236,a,120
buffer_load_dwordx4 a[192:195], v4, s[88:91], s14 offen sc1
M v,76,a,224,a,76
TR a,224,32
M v,76,a,228,a,92
TR a,226,160
M v,76,a,232,a,108
TR a,228,288
M v,76,a,236,a,124
s_waitcnt lgkmcnt(3)
TR a,230,416
M v,64,a,240,a,128
TR a,232,544
M v,64,a,244,a,144
TR a,234,672
M v,64,a,248,a,160
TR a,236,800
M v,64,a,252,a,176
TR a,238,928
M v,68,a,240,a,132
M v,68,a,244,a,148
DL 7,80,93,2112
M v,68,a,248,a,164
M v,68,a,252,a,180
M v,72,a,240,a,136
M v,72,a,244,a,152
MU 64,28
MU 65,28
M v,72,a,248,a,168
MU 66,28
MU 67,28
M v,72,a,252,a,184
CV 32,64
CV 33,66
M v,76,a,240,a,140
TR a,240,50720
MU 68,29
M v,76,a,244,a,156
TR a,242,50848
MU 69,29
M v,76,a,248,a,172
TR a,244,50976
MU 70,29
M v,76,a,252,a,188
s_waitcnt lgkmcnt(3)
TR a,246,51104
M v,80,a,224,a,64
TR a,248,51232
MU 71,29
M v,80,a,228,a,80
TR a,250,51360
s_add_u32 s15, s29, 17825792
M v,80,a,232,a,96
TR a,252,51488
CV 36,68
M v,80,a,236,a,112
TR a,254,51616
CV 37,70
M v,84,a,224,a,68
DL 7,84,93,3168
M v,84,a,228,a,84
s_add_u32 m0, s92, 50688
s_mov_b32 s93, 115328
M v,84,a,232,a,100
v_mov_b32 v6, 8
s_mov_b32 s42, 512
M v,84,a,236,a,116
buffer_load_dwordx4 a[196:199], v4, s[88:91], s15 offen sc1
M v,88,a,224,a,72
MU 72,30
MU 73,30
L_pad32:
s_cbranch_execz L_ret32
M v,88,a,228,a,88
MU 74,30
MU 75,30
M v,88,a,232,a,104
CV 40,72
CV 41,74
M v,88,a,236,a,120
MU 76,31
MU 77,31
M v,92,a,224,a,76
TR a,224,16960
MU 78,31
M v,92,a,228,a,92
TR a,226,17088
MU 79,31
M v,92,a,232,a,108
s_waitcnt vmcnt(7)
TR a,228,17216
M v,92,a,236,a,124
s_waitcnt lgkmcnt(3)
TR a,230,17344
M v,80,a,240,a,128
buffer_store_dword v6, v11, s[40:43], 0 offen offset:384 sc1
M v,80,a,244,a,144
TR a,232,17472
CV 44,76
M v,80,a,248,a,160
TR a,234,17600
CV 45,78
M v,80,a,252,a,176
DL 7,72,93,0
M v,84,a,240,a,132
TR a,236,17728
M v,84,a,244,a,148
TR a,238,17856
M v,84,a,248,a,164
M v,84,a,252,a,180
M v,88,a,240,a,136
MU 80,28
MU 81,28
M v,88,a,244,a,152
MU 82,28
MU 83,28
M v,88,a,248,a,168
CV 34,80
CV 35,82
M v,88,a,252,a,184
ST 32
M v,92,a,240,a,140
MU 84,29
MU 85,29
M v,92,a,244,a,156
s_add_u32 s14, s27, 18874368
MU 86,29
M v,92,a,248,a,172
MU 87,29
CV 38,84
M v,92,a,252,a,188
s_waitcnt vmcnt(9)
CV 39,86
Z v,12,a,0,a,16
s_mov_b32 s94, 68157440
TR a,240,33856
M v,12,a,0,a,20
TR a,242,33984
MU 88,30
M v,12,a,0,a,24
DL 7,76,93,1056
M v,12,a,0,a,28
TR a,244,34112
MU 89,30
M v,12,a,0,a,32
TR a,246,34240
MU 90,30
M v,12,a,0,a,36
buffer_load_dwordx4 a[200:203], v4, s[88:91], s14 offen sc1
M v,12,a,0,a,40
TR a,248,34368
MU 91,30
M v,12,a,0,a,48
TR a,250,34496
CV 42,88
Z v,24,a,4,a,16
TR a,252,34624
CV 43,90
M v,24,a,4,a,20
TR a,254,34752
MU 92,31
M v,24,a,4,a,24
CV 20,12
CV 21,14
M v,24,a,4,a,28
MU 93,31
MU 94,31
M v,24,a,4,a,32
MU 95,31
CV 46,92
M v,24,a,4,a,36
CV 47,94
M v,24,a,4,a,40
M v,24,a,4,a,48
s_waitcnt lgkmcnt(8)
Z v,96,a,224,v,128
M v,96,a,228,v,144
DL 7,80,93,2112
M v,96,a,232,v,160
M v,96,a,236,v,176
Z v,100,a,224,v,132
ST 36
M v,100,a,228,v,148
CV 22,24
CV 23,26
M v,100,a,232,v,164
s_mov_b32 s94, 69206016
M v,100,a,236,v,180
Z v,104,a,224,v,136
M v,104,a,228,v,152
s_add_u32 s15, s25, 19922944
M v,104,a,232,v,168
M v,104,a,236,v,184
Z v,108,a,224,v,140
buffer_store_dwordx4 v[20:23], v3, s[8:11], 0 offen offset:128 sc1
M v,108,a,228,v,156
TR a,224,16992
M v,108,a,232,v,172
TR a,226,17120
M v,108,a,236,v,188
s_waitcnt lgkmcnt(2)
TR a,228,17248
M v,96,a,240,v,192
DL 7,84,93,3168
M v,96,a,244,v,208
TR a,230,17376
M v,96,a,248,v,224
TR a,232,17504
M v,96,a,252,v,240
buffer_load_dwordx4 a[204:207], v4, s[88:91], s15 offen sc1
M v,100,a,240,v,196
TR a,234,17632
M v,100,a,244,v,212
TR a,236,17760
M v,100,a,248,v,228
TR a,238,17888
M v,100,a,252,v,244
M v,104,a,240,v,200
M v,104,a,244,v,216
M v,104,a,248,v,232
M v,104,a,252,v,248
M v,108,a,240,v,204
TR a,240,33888
M v,108,a,244,v,220
TR a,242,34016
M v,108,a,248,v,236
TR a,244,34144
M v,108,a,252,v,252
s_waitcnt lgkmcnt(3)
TR a,246,34272
Z v,112,a,224,v,128
TR a,248,34400
M v,112,a,228,v,144
ST 40
M v,112,a,232,v,160
TR a,250,34528
s_mov_b32 s94, 70254592
M v,112,a,236,v,176
TR a,252,34656
Z v,116,a,224,v,132
TR a,254,34784
M v,116,a,228,v,148
s_add_u32 s14, s30, 20971520
M v,116,a,232,v,164
M v,116,a,236,v,180
Z v,120,a,224,v,136
M v,120,a,228,v,152
M v,120,a,232,v,168
M v,120,a,236,v,184
buffer_load_dwordx4 a[208:211], v4, s[88:91], s14 offen sc1
Z v,124,a,224,v,140
TR a,224,64
M v,124,a,228,v,156
TR a,226,192
M v,124,a,232,v,172
TR a,228,320
M v,124,a,236,v,188
s_waitcnt lgkmcnt(3)
s_barrier
M v,112,a,240,v,192
TR a,230,448
s_add_u32 m0, s92, 98816
M v,112,a,244,v,208
TR a,232,576
s_mov_b32 s93, 230144
M v,112,a,248,v,224
TR a,234,704
M v,112,a,252,v,240
TR a,236,832
M v,116,a,240,v,196
TR a,238,960
M v,116,a,244,v,212
M v,116,a,248,v,228
M v,116,a,252,v,244
M v,120,a,240,v,200
M v,120,a,244,v,216
ST 44
M v,120,a,248,v,232
s_mov_b32 s94, 71303168
M v,120,a,252,v,248
M v,124,a,240,v,204
DL 7,72,93,0
M v,124,a,244,v,220
TR a,240,50752
M v,124,a,248,v,236
TR a,242,50880
M v,124,a,252,v,252
s_waitcnt lgkmcnt(2)
TR a,244,51008
M v,96,a,224,a,64
TR a,246,51136
M v,96,a,228,a,80
TR a,248,51264
s_add_u32 s15, s28, 22020096
M v,96,a,232,a,96
TR a,250,51392
M v,96,a,236,a,112
TR a,252,51520
M v,100,a,224,a,68
TR a,254,51648
M v,100,a,228,a,84
M v,100,a,232,a,100
M v,100,a,236,a,116
buffer_load_dwordx4 a[212:215], v4, s[88:91], s15 offen sc1
M v,104,a,224,a,72
M v,104,a,228,a,88
M v,104,a,232,a,104
DL 7,76,93,1056
M v,104,a,236,a,120
M v,108,a,224,a,76
TR a,224,96
v_bfe_u32 v8, v4, 8, 2
M v,108,a,228,a,92
buffer_load_dword v5, v1, s[88:91], s13 offen offset:384 sc1
M v,108,a,232,a,108
TR a,226,224
v_lshrrev_b32 v9, 14, s95
M v,108,a,236,a,124
s_waitcnt lgkmcnt(2)
TR a,228,352
M v,96,a,240,a,128
TR a,230,480
v_add_lshl_u32 v8, v8, v9, 7
M v,96,a,244,a,144
TR a,232,608
v_add_u32 v8, 4096, v8
M v,96,a,248,a,160
TR a,234,736
v_mov_b32 v9, 0
M v,96,a,252,a,176
s_getpc_b64 s[100:101]
s_and_b32 s100, s100, 0xfffff000
M v,100,a,240,a,132
TR a,236,864
v_lshl_add_u64 v[8:9], v[8:9], 0, s[100:101]
M v,100,a,244,a,148
global_load_dword v10, v[8:9], off
M v,100,a,248,a,164
TR a,238,992
MU 96,28
M v,100,a,252,a,180
MU 97,28
MU 98,28
M v,104,a,240,a,136
MU 99,28
CV 48,96
M v,104,a,244,a,152
DL 7,80,93,2112
M v,104,a,248,a,168
CV 49,98
MU 100,29
M v,104,a,252,a,184
MU 101,29
MU 102,29
M v,108,a,240,a,140
TR a,240,50784
MU 103,29
M v,108,a,244,a,156
TR a,242,50912
s_add_u32 s14, s26, 23068672
M v,108,a,248,a,172
TR a,244,51040
CV 52,100
M v,108,a,252,a,188
s_waitcnt lgkmcnt(3)
TR a,246,51168
M v,112,a,224,a,64
TR a,248,51296
CV 53,102
M v,112,a,228,a,80
TR a,250,51424
MU 104,30
M v,112,a,232,a,96
TR a,252,51552
MU 105,30
M v,112,a,236,a,112
TR a,254,51680
v_xor_b32 v2, 81920, v2
M v,116,a,224,a,68
buffer_load_dwordx4 a[216:219], v4, s[88:91], s14 offen sc1
M v,116,a,228,a,84
MU 106,30
MU 107,30
M v,116,a,232,a,100
CV 56,104
CV 57,106
M v,116,a,236,a,116
MU 108,31
MU 109,31
M v,120,a,224,a,72
DL 7,84,93,3168
M v,120,a,228,a,88
s_add_u32 m0, s92, 115712
s_mov_b32 s93, 344832
M v,120,a,232,a,104
MU 110,31
MU 111,31
M v,120,a,236,a,120
CV 60,108
CV 61,110
M v,124,a,224,a,76
AW 220,60
AW 221,61
M v,124,a,228,a,92
M v,124,a,232,a,108
M v,124,a,236,a,124
s_waitcnt lgkmcnt(0)
s_waitcnt vmcnt(27)
M v,112,a,240,a,128
s_barrier
TR a,224,16896
M v,112,a,244,a,144
TR a,226,17024
M v,112,a,248,a,160
TR a,228,17152
M v,112,a,252,a,176
TR a,230,17280
M v,116,a,240,a,132
TR a,232,17408
M v,116,a,244,a,148
TR a,234,17536
M v,116,a,248,a,164
TR a,236,17664
M v,116,a,252,a,180
TR a,238,17792
MU 112,28
M v,120,a,240,a,136
DL 7,72,93,0
M v,120,a,244,a,152
MU 113,28
MU 114,28
M v,120,a,248,a,168
MU 115,28
CV 50,112
M v,120,a,252,a,184
CV 51,114
MU 116,29
M v,124,a,240,a,140
ST 48
M v,124,a,244,a,156
TR a,240,33792
MU 117,29
M v,124,a,248,a,172
TR a,242,33920
MU 118,29
M v,124,a,252,a,188
s_waitcnt lgkmcnt(2)
TR a,244,34048
Z v,64,a,224,v,128
TR a,246,34176
MU 119,29
M v,64,a,228,v,144
TR a,248,34304
CV 54,116
M v,64,a,232,v,160
TR a,250,34432
CV 55,118
M v,64,a,236,v,176
TR a,252,34560
s_mov_b32 s94, 72351744
Z v,68,a,224,v,132
TR a,254,34688
MU 120,30
M v,68,a,228,v,148
MU 121,30
MU 122,30
M v,68,a,232,v,164
DL 7,76,93,1056
M v,68,a,236,v,180
MU 123,30
CV 58,120
Z v,72,a,224,v,136
CV 59,122
MU 124,31
M v,72,a,228,v,152
MU 125,31
MU 126,31
M v,72,a,232,v,168
MU 127,31
CV 62,124
M v,72,a,236,v,184
CV 63,126
AW 222,62
Z v,76,a,224,v,140
TR a,224,16928
AW 223,63
M v,76,a,228,v,156
TR a,226,17056
M v,76,a,232,v,172
TR a,228,17184
s_add_u32 s14, s31, 25165824
M v,76,a,236,v,188
s_waitcnt lgkmcnt(3)
TR a,230,17312
M v,64,a,240,v,192
TR a,232,17440
M v,64,a,244,v,208
TR a,234,17568
M v,64,a,248,v,224
s_waitcnt vmcnt(7)
v_cmp_gt_u32 vcc, 8, v5
M v,64,a,252,v,240
s_cbranch_vccz L_sbA3
s_mov_b32 s18, 0x40000
L_sqA3:
buffer_load_dword v5, v1, s[88:91], s13 offen offset:384 sc1
s_waitcnt vmcnt(0)
v_cmp_gt_u32 vcc, 8, v5
s_sub_u32 s18, s18, 1
s_cbranch_scc1 L_sbA3
s_cbranch_vccnz L_sqA3
L_sbA3:
M v,68,a,240,v,196
ST 52
M v,68,a,244,v,212
TR a,236,17696
s_mov_b32 s94, 73400320
M v,68,a,248,v,228
TR a,238,17824
M v,68,a,252,v,244
DL 7,80,93,2112
M v,72,a,240,v,200
M v,72,a,244,v,216
buffer_load_dwordx4 a[16:19], v4, s[88:91], s14 offen sc1
M v,72,a,248,v,232
M v,72,a,252,v,248
M v,76,a,240,v,204
TR a,240,33824
M v,76,a,244,v,220
TR a,242,33952
M v,76,a,248,v,236
TR a,244,34080
M v,76,a,252,v,252
s_waitcnt lgkmcnt(3)
TR a,246,34208
Z v,80,a,224,v,128
TR a,248,34336
M v,80,a,228,v,144
TR a,250,34464
M v,80,a,232,v,160
TR a,252,34592
M v,80,a,236,v,176
TR a,254,34720
Z v,84,a,224,v,132
DL 7,84,93,3168
M v,84,a,228,v,148
s_add_u32 m0, s92, 81920
s_mov_b32 s93, 768
M v,84,a,232,v,164
M v,84,a,236,v,180
Z v,88,a,224,v,136
M v,88,a,228,v,152
M v,88,a,232,v,168
s_add_u32 s15, s29, 26214400
M v,88,a,236,v,184
Z v,92,a,224,v,140
ST 56
M v,92,a,228,v,156
s_mov_b32 s94, 75497472
M v,92,a,232,v,172
M v,92,a,236,v,188
s_waitcnt lgkmcnt(0)
s_waitcnt vmcnt(12)
M v,80,a,240,v,192
s_barrier
TR a,224,0
M v,80,a,244,v,208
buffer_load_dwordx4 a[20:23], v4, s[88:91], s15 offen sc1
M v,80,a,248,v,224
TR a,226,128
M v,80,a,252,v,240
TR a,228,256
M v,84,a,240,v,196
DL 7,72,93,0
M v,84,a,244,v,212
TR a,230,384
M v,84,a,248,v,228
TR a,232,512
M v,84,a,252,v,244
TR a,234,640
M v,88,a,240,v,200
TR a,236,768
M v,88,a,244,v,216
TR a,238,896
M v,88,a,248,v,232
M v,88,a,252,v,248
M v,92,a,240,v,204
TR a,240,50688
M v,92,a,244,v,220
TR a,242,50816
M v,92,a,248,v,236
TR a,244,50944
M v,92,a,252,v,252
s_waitcnt vmcnt(11)
TR a,246,51072
Z v,12,a,0,a,192
TR a,248,51200
M v,12,a,0,a,196
TR a,250,51328
M v,12,a,0,a,200
DL 7,76,93,1056
M v,12,a,0,a,204
TR a,252,51456
M v,12,a,0,a,208
TR a,254,51584
M v,12,a,0,a,212
M v,12,a,0,a,216
s_add_u32 s14, s27, 27262976
M v,12,a,0,a,52
Z v,24,a,4,a,192
M v,24,a,4,a,196
M v,24,a,4,a,200
M v,24,a,4,a,204
M v,24,a,4,a,208
buffer_load_dwordx4 a[24:27], v4, s[88:91], s14 offen sc1
M v,24,a,4,a,212
M v,24,a,4,a,216
CV 20,12
CV 21,14
M v,24,a,4,a,52
s_waitcnt lgkmcnt(8)
M v,64,a,224,a,64
M v,64,a,228,a,80
DL 7,80,93,2112
M v,64,a,232,a,96
M v,64,a,236,a,112
M v,68,a,224,a,68
M v,68,a,228,a,84
CV 22,24
CV 23,26
M v,68,a,232,a,100
buffer_store_dwordx4 v[20:23], v3, s[8:11], 0 offen offset:256 sc1
M v,68,a,236,a,116
L_pad33:
s_cbranch_execz L_ret33
M v,72,a,224,a,72
M v,72,a,228,a,88
M v,72,a,232,a,104
M v,72,a,236,a,120
M v,76,a,224,a,76
TR a,224,32
M v,76,a,228,a,92
TR a,226,160
M v,76,a,232,a,108
TR a,228,288
M v,76,a,236,a,124
s_waitcnt lgkmcnt(3)
TR a,230,416
M v,64,a,240,a,128
DL 7,84,93,3168
M v,64,a,244,a,144
TR a,232,544
s_add_u32 m0, s92, 132608
M v,64,a,248,a,160
TR a,234,672
s_add_u32 s15, s25, 28311552
M v,64,a,252,a,176
TR a,236,800
s_mov_b32 s93, 115456
M v,68,a,240,a,132
TR a,238,928
M v,68,a,244,a,148
M v,68,a,248,a,164
v_mov_b32 v6, 10
s_mov_b32 s42, 640
M v,68,a,252,a,180
MU 64,28
MU 65,28
M v,72,a,240,a,136
buffer_load_dwordx4 a[28:31], v4, s[88:91], s15 offen sc1
M v,72,a,244,a,152
MU 66,28
MU 67,28
M v,72,a,248,a,168
CV 32,64
CV 33,66
M v,72,a,252,a,184
MU 68,29
MU 69,29
M v,76,a,240,a,140
TR a,240,50720
MU 70,29
M v,76,a,244,a,156
TR a,242,50848
MU 71,29
M v,76,a,248,a,172
s_waitcnt vmcnt(8)
TR a,244,50976
M v,76,a,252,a,188
s_waitcnt lgkmcnt(3)
TR a,246,51104
M v,80,a,224,a,64
buffer_store_dword v6, v11, s[40:43], 0 offen offset:512 sc1
M v,80,a,228,a,80
TR a,248,51232
CV 36,68
M v,80,a,232,a,96
TR a,250,51360
CV 37,70
M v,80,a,236,a,112
DL 7,72,93,0
M v,84,a,224,a,68
TR a,252,51488
MU 72,30
M v,84,a,228,a,84
TR a,254,51616
MU 73,30
M v,84,a,232,a,100
MU 74,30
MU 75,30
M v,84,a,236,a,116
CV 40,72
CV 41,74
M v,88,a,224,a,72
MU 76,31
MU 77,31
M v,88,a,228,a,88
MU 78,31
MU 79,31
M v,88,a,232,a,104
CV 44,76
CV 45,78
M v,88,a,236,a,120
M v,92,a,224,a,76
TR a,224,16960
M v,92,a,228,a,92
TR a,226,17088
M v,92,a,232,a,108
DL 7,76,93,1056
M v,92,a,236,a,124
s_waitcnt lgkmcnt(2)
TR a,228,17216
M v,80,a,240,a,128
TR a,230,17344
s_add_u32 s14, s30, 29360128
M v,80,a,244,a,144
TR a,232,17472
M v,80,a,248,a,160
TR a,234,17600
M v,80,a,252,a,176
TR a,236,17728
M v,84,a,240,a,132
buffer_load_dwordx4 a[32:35], v4, s[88:91], s14 offen sc1
M v,84,a,244,a,148
TR a,238,17856
M v,84,a,248,a,164
M v,84,a,252,a,180
M v,88,a,240,a,136
MU 80,28
MU 81,28
M v,88,a,244,a,152
MU 82,28
MU 83,28
M v,88,a,248,a,168
CV 34,80
CV 35,82
M v,88,a,252,a,184
ST 32
M v,92,a,240,a,140
TR a,240,33856
MU 84,29
M v,92,a,244,a,156
TR a,242,33984
MU 85,29
M v,92,a,248,a,172
DL 7,80,93,2112
M v,92,a,252,a,188
s_waitcnt lgkmcnt(2)
TR a,244,34112
Z v,96,a,224,v,128
TR a,246,34240
MU 86,29
M v,96,a,228,v,144
TR a,248,34368
MU 87,29
M v,96,a,232,v,160
TR a,250,34496
CV 38,84
M v,96,a,236,v,176
TR a,252,34624
CV 39,86
Z v,100,a,224,v,132
TR a,254,34752
s_mov_b32 s94, 76546048
M v,100,a,228,v,148
MU 88,30
MU 89,30
M v,100,a,232,v,164
MU 90,30
MU 91,30
M v,100,a,236,v,180
CV 42,88
CV 43,90
Z v,104,a,224,v,136
MU 92,31
MU 93,31
M v,104,a,228,v,152
MU 94,31
MU 95,31
M v,104,a,232,v,168
s_add_u32 s15, s28, 30408704
CV 46,92
M v,104,a,236,v,184
CV 47,94
Z v,108,a,224,v,140
DL 7,84,93,3168
M v,108,a,228,v,156
TR a,224,16992
M v,108,a,232,v,172
TR a,226,17120
M v,108,a,236,v,188
s_waitcnt lgkmcnt(2)
TR a,228,17248
M v,96,a,240,v,192
buffer_load_dwordx4 a[36:39], v4, s[88:91], s15 offen sc1
M v,96,a,244,v,208
TR a,230,17376
M v,96,a,248,v,224
TR a,232,17504
M v,96,a,252,v,240
ST 36
M v,100,a,240,v,196
TR a,234,17632
s_mov_b32 s94, 77594624
M v,100,a,244,v,212
TR a,236,17760
M v,100,a,248,v,228
TR a,238,17888
M v,100,a,252,v,244
M v,104,a,240,v,200
M v,104,a,244,v,216
M v,104,a,248,v,232
M v,104,a,252,v,248
M v,108,a,240,v,204
TR a,240,33888
M v,108,a,244,v,220
TR a,242,34016
M v,108,a,248,v,236
TR a,244,34144
M v,108,a,252,v,252
s_waitcnt lgkmcnt(3)
TR a,246,34272
Z v,112,a,224,v,128
TR a,248,34400
M v,112,a,228,v,144
TR a,250,34528
M v,112,a,232,v,160
TR a,252,34656
M v,112,a,236,v,176
TR a,254,34784
Z v,116,a,224,v,132
M v,116,a,228,v,148
M v,116,a,232,v,164
s_add_u32 s14, s26, 31457280
M v,116,a,236,v,180
Z v,120,a,224,v,136
M v,120,a,228,v,152
M v,120,a,232,v,168
M v,120,a,236,v,184
ST 40
Z v,124,a,224,v,140
TR a,224,64
s_mov_b32 s94, 78643200
M v,124,a,228,v,156
TR a,226,192
M v,124,a,232,v,172
buffer_load_dwordx4 a[40:43], v4, s[88:91], s14 offen sc1
M v,124,a,236,v,188
s_waitcnt lgkmcnt(2)
TR a,228,320
M v,112,a,240,v,192
TR a,230,448
M v,112,a,244,v,208
TR a,232,576
M v,112,a,248,v,224
TR a,234,704
M v,112,a,252,v,240
TR a,236,832
M v,116,a,240,v,196
TR a,238,960
M v,116,a,244,v,212
M v,116,a,248,v,228
M v,116,a,252,v,244
M v,120,a,240,v,200
M v,120,a,244,v,216
M v,120,a,248,v,232
M v,120,a,252,v,248
M v,124,a,240,v,204
TR a,240,50752
M v,124,a,244,v,220
TR a,242,50880
M v,124,a,248,v,236
TR a,244,51008
M v,124,a,252,v,252
s_waitcnt lgkmcnt(3)
TR a,246,51136
M v,96,a,224,a,64
TR a,248,51264
M v,96,a,228,a,80
TR a,250,51392
M v,96,a,232,a,96
TR a,252,51520
M v,96,a,236,a,112
ST 44
M v,100,a,224,a,68
TR a,254,51648
s_mov_b32 s94, 79691776
M v,100,a,228,a,84
M v,100,a,232,a,100
M v,100,a,236,a,116
M v,104,a,224,a,72
M v,104,a,228,a,88
M v,104,a,232,a,104
M v,104,a,236,a,120
M v,108,a,224,a,76
buffer_load_dword v5, v1, s[88:91], s13 offen offset:512 sc1
M v,108,a,228,a,92
TR a,224,96
M v,108,a,232,a,108
TR a,226,224
M v,108,a,236,a,124
s_waitcnt lgkmcnt(2)
TR a,228,352
M v,96,a,240,a,128
TR a,230,480
M v,96,a,244,a,144
TR a,232,608
M v,96,a,248,a,160
TR a,234,736
M v,96,a,252,a,176
TR a,236,864
M v,100,a,240,a,132
TR a,238,992
M v,100,a,244,a,148
M v,100,a,248,a,164
M v,100,a,252,a,180
M v,104,a,240,a,136
M v,104,a,244,a,152
MU 96,28
MU 97,28
M v,104,a,248,a,168
MU 98,28
MU 99,28
M v,104,a,252,a,184
CV 48,96
CV 49,98
M v,108,a,240,a,140
TR a,240,50784
MU 100,29
M v,108,a,244,a,156
TR a,242,50912
MU 101,29
M v,108,a,248,a,172
TR a,244,51040
MU 102,29
M v,108,a,252,a,188
s_waitcnt lgkmcnt(3)
TR a,246,51168
M v,112,a,224,a,64
TR a,248,51296
MU 103,29
M v,112,a,228,a,80
TR a,250,51424
CV 52,100
M v,112,a,232,a,96
TR a,252,51552
CV 53,102
M v,112,a,236,a,112
TR a,254,51680
v_xor_b32 v2, 81920, v2
M v,116,a,224,a,68
MU 104,30
MU 105,30
M v,116,a,228,a,84
MU 106,30
MU 107,30
M v,116,a,232,a,100
CV 56,104
CV 57,106
M v,116,a,236,a,116
MU 108,31
MU 109,31
M v,120,a,224,a,72
MU 110,31
MU 111,31
M v,120,a,228,a,88
CV 60,108
CV 61,110
M v,120,a,232,a,104
AW 48,60
AW 49,61
M v,120,a,236,a,120
M v,124,a,224,a,76
M v,124,a,228,a,92
M v,124,a,232,a,108
M v,124,a,236,a,124
s_waitcnt lgkmcnt(0)
s_waitcnt vmcnt(21)
M v,112,a,240,a,128
s_barrier
TR a,224,16896
M v,112,a,244,a,144
TR a,226,17024
M v,112,a,248,a,160
TR a,228,17152
M v,112,a,252,a,176
TR a,230,17280
M v,116,a,240,a,132
TR a,232,17408
M v,116,a,244,a,148
TR a,234,17536
M v,116,a,248,a,164
TR a,236,17664
M v,116,a,252,a,180
MU 112,28
MU 113,28
M v,120,a,240,a,136
MU 114,28
MU 115,28
M v,120,a,244,a,152
CV 50,112
CV 51,114
M v,120,a,248,a,168
ST 48
M v,120,a,252,a,184
TR a,238,17792
MU 116,29
M v,124,a,240,a,140
MU 117,29
MU 118,29
M v,124,a,244,a,156
MU 119,29
CV 54,116
M v,124,a,248,a,172
CV 55,118
s_mov_b32 s94, 80740352
M v,124,a,252,a,188
s_waitcnt vmcnt(3)
TR a,240,33792
Z v,12,a,0,a,16
TR a,242,33920
MU 120,30
M v,12,a,0,a,20
TR a,244,34048
MU 121,30
M v,12,a,0,a,24
TR a,246,34176
MU 122,30
M v,12,a,0,a,28
TR a,248,34304
MU 123,30
M v,12,a,0,a,32
TR a,250,34432
CV 58,120
M v,12,a,0,a,36
TR a,252,34560
CV 59,122
M v,12,a,0,a,40
TR a,254,34688
MU 124,31
M v,12,a,0,a,56
MU 125,31
MU 126,31
Z v,24,a,4,a,16
MU 127,31
CV 62,124
M v,24,a,4,a,20
ST 52
M v,24,a,4,a,24
s_mov_b32 s94, 81788928
CV 20,12
M v,24,a,4,a,28
CV 21,14
CV 63,126
M v,24,a,4,a,32
AW 50,62
AW 51,63
M v,24,a,4,a,36
M v,24,a,4,a,40
s_add_u32 s14, s31, 33554432
M v,24,a,4,a,56
s_waitcnt lgkmcnt(8)
Z v,64,a,224,v,128
M v,64,a,228,v,144
M v,64,a,232,v,160
s_waitcnt vmcnt(2)
v_cmp_gt_u32 vcc, 10, v5
M v,64,a,236,v,176
s_cbranch_vccz L_sbA4
s_mov_b32 s18, 0x40000
L_sqA4:
buffer_load_dword v5, v1, s[88:91], s13 offen offset:512 sc1
s_waitcnt vmcnt(0)
v_cmp_gt_u32 vcc, 10, v5
s_sub_u32 s18, s18, 1
s_cbranch_scc1 L_sbA4
s_cbranch_vccnz L_sqA4
L_sbA4:
Z v,68,a,224,v,132
buffer_load_dwordx4 a[192:195], v4, s[88:91], s14 offen sc1
M v,68,a,228,v,148
CV 22,24
CV 23,26
M v,68,a,232,v,164
M v,68,a,236,v,180
buffer_store_dwordx4 v[20:23], v3, s[8:11], 0 offen offset:384 sc1
Z v,72,a,224,v,136
M v,72,a,228,v,152
M v,72,a,232,v,168
M v,72,a,236,v,184
Z v,76,a,224,v,140
TR a,224,16928
M v,76,a,228,v,156
TR a,226,17056
M v,76,a,232,v,172
TR a,228,17184
M v,76,a,236,v,188
s_waitcnt lgkmcnt(3)
TR a,230,17312
M v,64,a,240,v,192
ST 56
M v,64,a,244,v,208
TR a,232,17440
s_mov_b32 s94, 83886080
M v,64,a,248,v,224
TR a,234,17568
s_add_u32 s15, s29, 34603008
M v,64,a,252,v,240
TR a,236,17696
M v,68,a,240,v,196
TR a,238,17824
M v,68,a,244,v,212
M v,68,a,248,v,228
M v,68,a,252,v,244
M v,72,a,240,v,200
buffer_load_dwordx4 a[196:199], v4, s[88:91], s15 offen sc1
M v,72,a,244,v,216
M v,72,a,248,v,232
M v,72,a,252,v,248
M v,76,a,240,v,204
TR a,240,33824
M v,76,a,244,v,220
TR a,242,33952
M v,76,a,248,v,236
TR a,244,34080
M v,76,a,252,v,252
s_waitcnt lgkmcnt(3)
TR a,246,34208
Z v,80,a,224,v,128
TR a,248,34336
M v,80,a,228,v,144
TR a,250,34464
M v,80,a,232,v,160
TR a,252,34592
M v,80,a,236,v,176
TR a,254,34720
Z v,84,a,224,v,132
M v,84,a,228,v,148
s_add_u32 s14, s27, 35651584
M v,84,a,232,v,164
M v,84,a,236,v,180
Z v,88,a,224,v,136
M v,88,a,228,v,152
M v,88,a,232,v,168
M v,88,a,236,v,184
buffer_load_dwordx4 a[200:203], v4, s[88:91], s14 offen sc1
Z v,92,a,224,v,140
M v,92,a,228,v,156
M v,92,a,232,v,172
M v,92,a,236,v,188
s_waitcnt lgkmcnt(0)
s_waitcnt vmcnt(7)
M v,80,a,240,v,192
s_barrier
TR a,224,0
M v,80,a,244,v,208
TR a,226,128
M v,80,a,248,v,224
TR a,228,256
M v,80,a,252,v,240
TR a,230,384
M v,84,a,240,v,196
TR a,232,512
M v,84,a,244,v,212
TR a,234,640
v_mov_b32 v6, 12
M v,84,a,248,v,228
TR a,236,768
s_mov_b32 s42, 768
M v,84,a,252,v,244
TR a,238,896
M v,88,a,240,v,200
s_add_u32 s15, s25, 36700160
M v,88,a,244,v,216
L_pad34:
s_cbranch_execz L_ret34
M v,88,a,248,v,232
M v,88,a,252,v,248
M v,92,a,240,v,204
TR a,240,50688
M v,92,a,244,v,220
s_waitcnt vmcnt(2)
TR a,242,50816
M v,92,a,248,v,236
buffer_store_dword v6, v11, s[40:43], 0 offen offset:640 sc1
M v,92,a,252,v,252
s_waitcnt lgkmcnt(2)
TR a,244,50944
M v,64,a,224,a,64
TR a,246,51072
M v,64,a,228,a,80
buffer_load_dwordx4 a[204:207], v4, s[88:91], s15 offen sc1
M v,64,a,232,a,96
TR a,248,51200
M v,64,a,236,a,112
TR a,250,51328
M v,68,a,224,a,68
TR a,252,51456
M v,68,a,228,a,84
TR a,254,51584
M v,68,a,232,a,100
M v,68,a,236,a,116
M v,72,a,224,a,72
M v,72,a,228,a,88
M v,72,a,232,a,104
M v,72,a,236,a,120
s_add_u32 s14, s30, 37748736
M v,76,a,224,a,76
TR a,224,32
M v,76,a,228,a,92
TR a,226,160
M v,76,a,232,a,108
TR a,228,288
M v,76,a,236,a,124
s_waitcnt lgkmcnt(3)
TR a,230,416
M v,64,a,240,a,128
TR a,232,544
M v,64,a,244,a,144
buffer_load_dwordx4 a[208:211], v4, s[88:91], s14 offen sc1
M v,64,a,248,a,160
TR a,234,672
M v,64,a,252,a,176
TR a,236,800
M v,68,a,240,a,132
TR a,238,928
M v,68,a,244,a,148
M v,68,a,248,a,164
M v,68,a,252,a,180
M v,72,a,240,a,136
M v,72,a,244,a,152
MU 64,28
MU 65,28
M v,72,a,248,a,168
MU 66,28
MU 67,28
M v,72,a,252,a,184
CV 32,64
CV 33,66
M v,76,a,240,a,140
TR a,240,50720
MU 68,29
M v,76,a,244,a,156
TR a,242,50848
MU 69,29
M v,76,a,248,a,172
TR a,244,50976
s_add_u32 s15, s28, 38797312
M v,76,a,252,a,188
s_waitcnt lgkmcnt(3)
TR a,246,51104
M v,80,a,224,a,64
TR a,248,51232
MU 70,29
M v,80,a,228,a,80
TR a,250,51360
MU 71,29
M v,80,a,232,a,96
TR a,252,51488
CV 36,68
M v,80,a,236,a,112
TR a,254,51616
CV 37,70
M v,84,a,224,a,68
buffer_load_dwordx4 a[212:215], v4, s[88:91], s15 offen sc1
M v,84,a,228,a,84
MU 72,30
MU 73,30
M v,84,a,232,a,100
MU 74,30
MU 75,30
M v,84,a,236,a,116
CV 40,72
CV 41,74
M v,88,a,224,a,72
MU 76,31
MU 77,31
M v,88,a,228,a,88
MU 78,31
MU 79,31
M v,88,a,232,a,104
CV 44,76
CV 45,78
M v,88,a,236,a,120
TR v,64,64
M v,92,a,224,a,76
TR a,224,16960
M v,92,a,228,a,92
TR a,226,17088
M v,92,a,232,a,108
TR a,228,17216
M v,92,a,236,a,124
s_waitcnt lgkmcnt(4)
TR a,230,17344
M v,80,a,240,a,128
TR a,232,17472
M v,80,a,244,a,144
TR a,234,17600
s_add_u32 s14, s26, 39845888
M v,80,a,248,a,160
TR a,236,17728
M v,80,a,252,a,176
TR a,238,17856
M v,84,a,240,a,132
TR v,66,192
M v,84,a,244,a,148
TR v,68,320
M v,84,a,248,a,164
TR v,70,448
M v,84,a,252,a,180
buffer_load_dwordx4 a[216:219], v4, s[88:91], s14 offen sc1
M v,88,a,240,a,136
MU 80,28
MU 81,28
M v,88,a,244,a,152
MU 82,28
MU 83,28
M v,88,a,248,a,168
CV 34,80
CV 35,82
M v,88,a,252,a,184
ST 32
M v,92,a,240,a,140
TR a,240,16992
MU 84,29
M v,92,a,244,a,156
TR a,242,17120
MU 85,29
M v,92,a,248,a,172
TR a,244,17248
MU 86,29
M v,92,a,252,a,188
s_waitcnt lgkmcnt(6)
TR a,246,17376
Z v,96,a,224,v,128
TR a,248,17504
MU 87,29
M v,96,a,228,v,144
TR a,250,17632
CV 38,84
M v,96,a,232,v,160
TR a,252,17760
CV 39,86
M v,96,a,236,v,176
TR a,254,17888
s_mov_b32 s94, 84934656
Z v,100,a,224,v,132
MU 88,30
MU 89,30
M v,100,a,228,v,148
MU 90,30
MU 91,30
M v,100,a,232,v,164
CV 42,88
CV 43,90
M v,100,a,236,v,180
MU 92,31
MU 93,31
Z v,104,a,224,v,136
buffer_load_dword v5, v1, s[88:91], s13 offen offset:640 sc1
M v,104,a,228,v,152
MU 94,31
MU 95,31
M v,104,a,232,v,168
CV 46,92
CV 47,94
M v,104,a,236,v,184
ST 36
Z v,108,a,224,v,140
TR a,224,33856
s_mov_b32 s94, 85983232
M v,108,a,228,v,156
TR a,226,33984
M v,108,a,232,v,172
TR a,228,34112
M v,108,a,236,v,188
s_waitcnt lgkmcnt(3)
TR a,230,34240
Z v,112,a,240,v,128
TR a,232,34368
M v,112,a,244,v,144
TR a,234,34496
M v,112,a,248,v,160
TR a,236,34624
M v,112,a,252,v,176
TR a,238,34752
Z v,116,a,240,v,132
TR v,72,576
M v,116,a,244,v,148
TR v,74,704
M v,116,a,248,v,164
TR v,76,832
M v,116,a,252,v,180
TR v,78,960
Z v,120,a,240,v,136
TR v,80,50752
M v,120,a,244,v,152
TR v,82,50880
M v,120,a,248,v,168
ST 40
M v,120,a,252,v,184
s_mov_b32 s94, 87031808
TR v,84,51008
Z v,124,a,240,v,140
TR a,240,33888
M v,124,a,244,v,156
TR a,242,34016
M v,124,a,248,v,172
TR a,244,34144
M v,124,a,252,v,188
s_waitcnt lgkmcnt(10)
TR a,246,34272
M v,96,a,224,v,192
TR a,248,34400
M v,96,a,228,v,208
TR a,250,34528
M v,96,a,232,v,224
TR a,252,34656
M v,96,a,236,v,240
TR a,254,34784
M v,100,a,224,v,196
TR v,86,51136
M v,100,a,228,v,212
TR v,88,51264
M v,100,a,232,v,228
TR v,90,51392
M v,100,a,236,v,244
TR v,92,51520
M v,104,a,224,v,200
TR v,94,51648
M v,104,a,228,v,216
ST 44
M v,104,a,232,v,232
TR v,128,96
s_mov_b32 s94, 88080384
M v,104,a,236,v,248
TR v,130,224
M v,108,a,224,v,204
TR v,132,352
M v,108,a,228,v,220
TR v,134,480
M v,108,a,232,v,236
TR v,136,608
M v,108,a,236,v,252
s_waitcnt lgkmcnt(10)
TR v,138,736
M v,112,a,240,v,192
TR v,140,864
M v,112,a,244,v,208
s_add_u32 s14, s31, 41943040
TR v,142,992
M v,112,a,248,v,224
TR v,144,50784
M v,112,a,252,v,240
TR v,146,50912
M v,116,a,240,v,196
TR v,148,51040
M v,116,a,244,v,212
s_waitcnt vmcnt(3)
v_cmp_gt_u32 vcc, 12, v5
M v,116,a,248,v,228
s_cbranch_vccz L_sbA5
s_mov_b32 s18, 0x40000
L_sqA5:
buffer_load_dword v5, v1, s[88:91], s13 offen offset:640 sc1
s_waitcnt vmcnt(0)
v_cmp_gt_u32 vcc, 12, v5
s_sub_u32 s18, s18, 1
s_cbranch_scc1 L_sbA5
s_cbranch_vccnz L_sqA5
L_sbA5:
M v,116,a,252,v,244
buffer_load_dwordx4 a[16:19], v4, s[88:91], s14 offen sc1
M v,120,a,240,v,200
TR v,150,51168
M v,120,a,244,v,216
TR v,152,51296
M v,120,a,248,v,232
TR v,154,51424
M v,120,a,252,v,248
TR v,156,51552
M v,124,a,240,v,204
TR v,158,51680
M v,124,a,244,v,220
M v,124,a,248,v,236
s_add_u32 s15, s29, 42991616
M v,124,a,252,v,252
s_waitcnt lgkmcnt(14)
M v,96,v,64,a,64
M v,96,v,68,a,80
M v,96,v,72,a,96
M v,96,v,76,a,112
M v,96,v,80,a,128
buffer_load_dwordx4 a[20:23], v4, s[88:91], s15 offen sc1
M v,96,v,84,a,144
M v,96,v,88,a,160
M v,96,v,92,a,176
s_waitcnt lgkmcnt(0)
M v,112,v,128,a,64
M v,112,v,132,a,80
M v,112,v,136,a,96
M v,112,v,140,a,112
s_add_u32 s14, s27, 44040192
M v,112,v,144,a,128
M v,112,v,148,a,144
MU 96,28
MU 97,28
M v,112,v,152,a,160
MU 98,28
MU 99,28
M v,112,v,156,a,176
CV 48,96
CV 49,98
M v,100,v,64,a,68
M v,100,v,68,a,84
buffer_load_dwordx4 a[24:27], v4, s[88:91], s14 offen sc1
M v,100,v,72,a,100
s_nop 1
M v,100,v,76,a,116
MU 112,28
MU 113,28
M v,100,v,80,a,132
MU 114,28
MU 115,28
M v,100,v,84,a,148
CV 50,112
CV 51,114
M v,100,v,88,a,164
ST 48
M v,100,v,92,a,180
s_add_u32 s15, s25, 45088768
s_mov_b32 s94, 89128960
M v,116,v,128,a,68
M v,116,v,132,a,84
M v,116,v,136,a,100
M v,116,v,140,a,116
M v,116,v,144,a,132
M v,116,v,148,a,148
buffer_load_dwordx4 a[28:31], v4, s[88:91], s15 offen sc1
M v,116,v,152,a,164
MU 100,29
MU 101,29
M v,116,v,156,a,180
MU 102,29
MU 103,29
M v,104,v,64,a,72
CV 52,100
CV 53,102
M v,104,v,68,a,88
s_nop 1
M v,104,v,72,a,104
MU 116,29
MU 117,29
M v,104,v,76,a,120
MU 118,29
MU 119,29
M v,104,v,80,a,136
CV 54,116
CV 55,118
M v,104,v,84,a,152
ST 52
M v,104,v,88,a,168
s_add_u32 s14, s30, 46137344
s_mov_b32 s94, 90177536
M v,104,v,92,a,184
M v,120,v,128,a,72
M v,120,v,132,a,88
M v,120,v,136,a,104
buffer_load_dwordx4 a[32:35], v4, s[88:91], s14 offen sc1
M v,120,v,140,a,120
M v,120,v,144,a,136
M v,120,v,148,a,152
M v,120,v,152,a,168
MU 104,30
MU 105,30
M v,120,v,156,a,184
MU 106,30
MU 107,30
M v,108,v,64,a,76
CV 56,104
CV 57,106
M v,108,v,68,a,92
s_add_u32 s15, s28, 47185920
s_nop 0
M v,108,v,72,a,108
MU 120,30
MU 121,30
M v,108,v,76,a,124
MU 122,30
MU 123,30
M v,108,v,80,a,140
CV 58,120
CV 59,122
M v,108,v,84,a,156
ST 56
M v,108,v,88,a,172
M v,108,v,92,a,188
v_mov_b32 v6, 14
s_mov_b32 s42, 896
M v,124,v,128,a,76
buffer_load_dwordx4 a[36:39], v4, s[88:91], s15 offen sc1
M v,124,v,132,a,92
M v,124,v,136,a,108
M v,124,v,140,a,124
M v,124,v,144,a,140
MU 108,31
MU 109,31
M v,124,v,148,a,156
s_add_u32 s14, s26, 48234496
MU 110,31
M v,124,v,152,a,172
MU 111,31
CV 60,108
M v,124,v,156,a,188
s_waitcnt vmcnt(1)
CV 61,110
buffer_store_dword v6, v11, s[40:43], 0 offen offset:768 sc1
s_waitcnt vmcnt(2)
Z v,12,a,0,a,192
M v,12,a,0,a,196
M v,12,a,0,a,200
M v,12,a,0,a,204
buffer_load_dwordx4 a[40:43], v4, s[88:91], s14 offen sc1
M v,12,a,0,a,208
MU 124,31
MU 125,31
M v,12,a,0,a,212
MU 126,31
MU 127,31
M v,12,a,0,a,216
CV 62,124
CV 63,126
M v,12,a,0,a,220
Z v,24,a,4,a,192
M v,24,a,4,a,196
s_nop 1
M v,24,a,4,a,200
s_nop 1
M v,24,a,4,a,204
CV 20,12
CV 21,14
M v,24,a,4,a,208
M v,24,a,4,a,212
M v,24,a,4,a,216
M v,24,a,4,a,220
s_waitcnt vmcnt(0)
Z v,12,a,0,a,16
M v,12,a,0,a,20
s_nop 1
M v,12,a,0,a,24
s_nop 1
M v,12,a,0,a,28
CV 22,24
CV 23,26
M v,12,a,0,a,32
buffer_store_dwordx4 v[20:23], v3, s[8:11], 0 offen offset:512 sc1
M v,12,a,0,a,36
M v,12,a,0,a,40
M v,12,a,0,a,48
Z v,24,a,4,a,16
M v,24,a,4,a,20
s_add_u32 s14, s31, 50331648
s_add_u32 s15, s29, 51380224
M v,24,a,4,a,24
s_nop 1
M v,24,a,4,a,28
CV 20,12
CV 21,14
M v,24,a,4,a,32
M v,24,a,4,a,36
M v,24,a,4,a,40
M v,24,a,4,a,48
s_nop 1
Z v,12,a,0,v,60
s_nop 4
CV 22,24
CV 23,26
buffer_store_dwordx4 v[20:23], v3, s[8:11], 0 offen offset:640 sc1
s_waitcnt vmcnt(2)
buffer_load_dword v5, v1, s[88:91], s13 offen offset:768 sc1
s_waitcnt vmcnt(0)
v_cmp_gt_u32 vcc, 14, v5
s_nop 0
s_cbranch_vccz L_sbA6
s_mov_b32 s18, 0x40000
L_sqA6:
buffer_load_dword v5, v1, s[88:91], s13 offen offset:768 sc1
s_waitcnt vmcnt(0)
v_cmp_gt_u32 vcc, 14, v5
s_sub_u32 s18, s18, 1
s_cbranch_scc1 L_sbA6
s_cbranch_vccnz L_sqA6
L_sbA6:
buffer_load_dwordx4 a[192:195], v4, s[88:91], s14 offen sc1
buffer_load_dwordx4 a[196:199], v4, s[88:91], s15 offen sc1
s_add_u32 s14, s27, 52428800
buffer_load_dwordx4 a[200:203], v4, s[88:91], s14 offen sc1
s_add_u32 s15, s25, 53477376
buffer_load_dwordx4 a[204:207], v4, s[88:91], s15 offen sc1
s_add_u32 s14, s30, 54525952
buffer_load_dwordx4 a[208:211], v4, s[88:91], s14 offen sc1
s_add_u32 s15, s28, 55574528
buffer_load_dwordx4 a[212:215], v4, s[88:91], s15 offen sc1
s_add_u32 s14, s26, 56623104
buffer_load_dwordx4 a[216:219], v4, s[88:91], s14 offen sc1
s_waitcnt vmcnt(4)
M v,12,a,0,a,192
M v,12,a,0,a,196
M v,12,a,0,a,200
Z v,24,a,4,v,60
M v,24,a,4,a,192
M v,24,a,4,a,196
M v,24,a,4,a,200
s_waitcnt vmcnt(0)
M v,12,a,0,a,204
M v,12,a,0,a,208
M v,12,a,0,a,212
M v,12,a,0,a,216
s_nop 1
M v,24,a,4,a,204
s_nop 1
M v,24,a,4,a,208
s_nop 1
M v,24,a,4,a,212
CV 20,12
CV 21,14
M v,24,a,4,a,216
s_nop 7
CV 22,24
CV 23,26
buffer_store_dwordx4 v[20:23], v3, s[8:11], 0 offen offset:768 sc1
s_endpgm
L_endA:
L_rsB26:
s_mov_b32 s100, 458752
s_call_b64 s[98:99], L_rareB
s_branch L_rbB26
L_rsB27:
s_mov_b32 s100, 475136
s_call_b64 s[98:99], L_rareB
s_branch L_rbB27
L_rsB28:
s_mov_b32 s100, 491520
s_call_b64 s[98:99], L_rareB
s_branch L_rbB28
L_rsB29:
s_mov_b32 s100, 507904
s_call_b64 s[98:99], L_rareB
s_branch L_rbB29
.p2align 12
L_c3B:
M v,100,v,44,v,180
s_add_u32 m0, s92, 132608
s_mov_b32 s2, 491520
MC 104,v,32,136,72
RD v,32,1,34304
CV 86,116
M v,104,v,36,v,152
RD v,36,1,34368
CV 87,118
M v,104,v,40,v,168
RD v,40,1,34432
CV 90,120
M v,104,v,44,v,184
s_waitcnt lgkmcnt(3)
RD v,44,1,34496
M v,96,v,48,v,192
DN 4,8,2,0
M v,96,v,52,v,208
CV 91,122
AD 12,12,16
M v,96,v,56,v,224
AD 13,13,17
AD 14,14,18
M v,96,v,60,v,240
M v,100,v,48,v,196
M v,100,v,52,v,212
M v,100,v,56,v,228
M v,100,v,60,v,244
M v,104,v,48,v,200
RD v,48,1,34560
M v,104,v,52,v,216
RD v,52,1,34624
M v,104,v,56,v,232
EX 96
M v,104,v,60,v,248
s_waitcnt lgkmcnt(2)
RD v,56,1,34688
MC 112,v,32,128,64
DN 4,12,2,1056
M v,112,v,36,v,144
EX 97
M v,112,v,40,v,160
RD v,60,1,34752
AD 16,96,97
M v,112,v,44,v,176
EX 100
MC 116,v,32,132,68
EX 101
M v,116,v,36,v,148
EX 104
M v,116,v,40,v,164
EX 105
M v,116,v,44,v,180
EX 98
MC 120,v,32,136,72
EX 102
M v,120,v,36,v,152
EX 106
M v,120,v,40,v,168
DN 4,16,2,2112
M v,120,v,44,v,184
s_waitcnt lgkmcnt(0)
s_waitcnt vmcnt(11)
M v,112,v,48,v,192
s_barrier
TR v,32,0
M v,112,v,52,v,208
TR v,34,512
AD 17,100,101
M v,112,v,56,v,224
TR v,36,32
AD 18,104,105
M v,112,v,60,v,240
TR v,38,544
AD 16,16,98
M v,116,v,48,v,196
TR v,40,64
AD 17,17,102
M v,116,v,52,v,212
TR v,42,576
AD 18,18,106
M v,116,v,56,v,228
TR v,44,96
TR v,46,608
M v,116,v,60,v,244
EX 99
M v,120,v,48,v,200
TR v,48,128
AD 16,16,99
M v,120,v,52,v,216
EX 103
M v,120,v,56,v,232
DN 4,20,2,3168
M v,120,v,60,v,248
s_waitcnt lgkmcnt(1)
TR v,50,640
M a,0,v,32,v,80
TR v,52,160
s_add_u32 m0, s92, 16896
M a,4,v,32,v,84
TR v,54,672
s_mov_b32 s2, 475136
M a,8,v,32,v,88
TR v,56,192
AD 17,17,103
M a,16,v,36,v,80
TR v,58,704
M a,20,v,36,v,84
TR v,60,224
M a,24,v,36,v,88
TR v,62,736
M a,32,v,40,v,80
EX 107
M a,36,v,40,v,84
TR v,32,256
AD 18,18,107
M a,40,v,40,v,88
EX 112
M a,48,v,44,v,80
DN 4,24,2,0
M a,52,v,44,v,84
TR v,34,768
AD 16,16,112
M a,56,v,44,v,88
s_waitcnt lgkmcnt(2)
TR v,36,288
M a,64,v,48,v,80
EX 116
M a,68,v,48,v,84
TR v,38,800
AD 17,17,116
M a,72,v,48,v,88
EX 120
M a,80,v,52,v,80
TR v,40,320
AD 18,18,120
M a,84,v,52,v,84
TR v,42,832
M a,88,v,52,v,88
TR v,44,352
M a,96,v,56,v,80
TR v,46,864
M a,100,v,56,v,84
EX 113
M a,104,v,56,v,88
TR v,48,384
AD 16,16,113
M a,112,v,60,v,80
DN 4,28,2,1056
M a,116,v,60,v,84
EX 117
M a,120,v,60,v,88
s_waitcnt lgkmcnt(1)
TR v,50,896
M a,128,v,32,v,80
TR v,52,416
AD 17,17,117
M a,132,v,32,v,84
EX 121
M a,136,v,32,v,88
TR v,54,928
AD 18,18,121
M a,144,v,36,v,80
TR v,56,448
M a,148,v,36,v,84
TR v,58,960
M a,152,v,36,v,88
TR v,60,480
M a,160,v,40,v,80
TR v,62,992
M a,164,v,40,v,84
EX 114
M a,168,v,40,v,88
DN 4,32,2,2112
M a,176,v,44,v,80
EX 118
M a,180,v,44,v,84
EX 122
M a,184,v,44,v,88
s_waitcnt lgkmcnt(0)
s_waitcnt vmcnt(11)
M a,192,v,48,v,80
s_barrier
RD v,32,1,50688
M a,196,v,48,v,84
RD v,36,1,50752
AD 16,16,114
M a,200,v,48,v,88
RD v,40,1,50816
AD 17,17,118
M a,208,v,52,v,80
RD v,44,1,50880
AD 18,18,122
M a,212,v,52,v,84
EX 115
M a,216,v,52,v,88
EX 119
M a,224,v,56,v,80
EX 123
M a,228,v,56,v,84
AD 16,16,115
AD 17,17,119
M a,232,v,56,v,88
RD v,48,1,50944
AD 18,18,123
M a,240,v,60,v,80
v_max3_f32 v20, v16, v17, v18
v_cmp_lt_f32 vcc, 0x4b800000, v20
M a,244,v,60,v,84
s_waitcnt lgkmcnt(1)
CV 80,96
M a,248,v,60,v,88
CV 81,98
CV 84,100
s_cbranch_vccnz L_rsB26
L_rbB26:
MC 96,v,32,128,64
DN 4,36,2,3168
M v,96,v,36,v,144
RD v,52,1,51008
CV 85,102
M v,96,v,40,v,160
RD v,56,1,51072
CV 88,104
M v,96,v,44,v,176
RD v,60,1,51136
CV 89,106
MC 100,v,32,132,68
s_add_u32 m0, s92, 33792
s_mov_b32 s2, 507904
M v,100,v,36,v,148
CV 82,112
CV 83,114
M v,100,v,40,v,164
CV 86,116
CV 87,118
M v,100,v,44,v,180
DN 4,8,2,0
MC 104,v,32,136,72
RD v,32,1,51200
CV 90,120
M v,104,v,36,v,152
RD v,36,1,51264
CV 91,122
M v,104,v,40,v,168
RD v,40,1,51328
AD 12,12,16
M v,104,v,44,v,184
s_waitcnt lgkmcnt(3)
RD v,44,1,51392
M v,96,v,48,v,192
AD 13,13,17
AD 14,14,18
M v,96,v,52,v,208
M v,96,v,56,v,224
M v,96,v,60,v,240
v_xor_b32 v2, 81920, v2
M v,100,v,48,v,196
M v,100,v,52,v,212
M v,100,v,56,v,228
DN 4,12,2,1056
M v,100,v,60,v,244
M v,104,v,48,v,200
RD v,48,1,51456
M v,104,v,52,v,216
EX 96
M v,104,v,56,v,232
EX 97
M v,104,v,60,v,248
s_waitcnt lgkmcnt(1)
RD v,52,1,51520
MC 112,v,32,128,64
RD v,56,1,51584
AD 16,96,97
M v,112,v,36,v,144
EX 100
M v,112,v,40,v,160
EX 101
M v,112,v,44,v,176
RD v,60,1,51648
AD 17,100,101
MC 116,v,32,132,68
EX 104
M v,116,v,36,v,148
EX 105
M v,116,v,40,v,164
DN 4,16,2,2112
M v,116,v,44,v,180
EX 98
MC 120,v,32,136,72
EX 102
M v,120,v,36,v,152
EX 106
M v,120,v,40,v,168
AD 18,104,105
AD 16,16,98
M v,120,v,44,v,184
s_waitcnt lgkmcnt(0)
s_waitcnt vmcnt(11)
M v,112,v,48,v,192
s_mov_b64 exec, 0
s_branch L_pad25
L_ret25:
s_mov_b64 exec, -1
s_barrier
TR v,32,0
M v,112,v,52,v,208
TR v,34,512
AD 17,17,102
M v,112,v,56,v,224
TR v,36,32
AD 18,18,106
M v,112,v,60,v,240
TR v,38,544
M v,116,v,48,v,196
TR v,40,64
M v,116,v,52,v,212
TR v,42,576
M v,116,v,56,v,228
TR v,44,96
TR v,46,608
M v,116,v,60,v,244
DN 4,20,2,3168
M v,120,v,48,v,200
TR v,48,128
s_add_u32 m0, s92, 0
M v,120,v,52,v,216
TR v,50,640
s_mov_b32 s2, 491520
M v,120,v,56,v,232
EX 99
M v,120,v,60,v,248
s_waitcnt lgkmcnt(2)
TR v,52,160
M a,0,v,32,v,80
TR v,54,672
AD 16,16,99
M a,4,v,32,v,84
EX 103
M a,8,v,32,v,88
TR v,56,192
AD 17,17,103
M a,16,v,36,v,80
TR v,58,704
M a,20,v,36,v,84
TR v,60,224
M a,24,v,36,v,88
TR v,62,736
M a,32,v,40,v,80
DN 4,24,2,0
M a,36,v,40,v,84
EX 107
M a,40,v,40,v,88
TR v,32,256
AD 18,18,107
M a,48,v,44,v,80
EX 112
M a,52,v,44,v,84
TR v,34,768
AD 16,16,112
M a,56,v,44,v,88
s_waitcnt lgkmcnt(2)
TR v,36,288
M a,64,v,48,v,80
EX 116
M a,68,v,48,v,84
TR v,38,800
AD 17,17,116
M a,72,v,48,v,88
EX 120
M a,80,v,52,v,80
TR v,40,320
v_xor_b32 v1, 81920, v1
M a,84,v,52,v,84
TR v,42,832
AD 18,18,120
M a,88,v,52,v,88
TR v,44,352
M a,96,v,56,v,80
TR v,46,864
M a,100,v,56,v,84
DN 4,28,2,1056
M a,104,v,56,v,88
EX 113
M a,112,v,60,v,80
TR v,48,384
AD 16,16,113
M a,116,v,60,v,84
EX 117
M a,120,v,60,v,88
s_waitcnt lgkmcnt(1)
TR v,50,896
M a,128,v,32,v,80
TR v,52,416
AD 17,17,117
M a,132,v,32,v,84
EX 121
M a,136,v,32,v,88
TR v,54,928
AD 18,18,121
M a,144,v,36,v,80
TR v,56,448
M a,148,v,36,v,84
TR v,58,960
M a,152,v,36,v,88
TR v,60,480
M a,160,v,40,v,80
TR v,62,992
M a,164,v,40,v,84
DN 4,32,2,2112
M a,168,v,40,v,88
EX 114
M a,176,v,44,v,80
EX 118
M a,180,v,44,v,84
EX 122
M a,184,v,44,v,88
s_waitcnt lgkmcnt(0)
s_waitcnt vmcnt(11)
M a,192,v,48,v,80
s_barrier
RD v,32,1,50688
M a,196,v,48,v,84
RD v,36,1,50752
AD 16,16,114
M a,200,v,48,v,88
RD v,40,1,50816
AD 17,17,118
M a,208,v,52,v,80
RD v,44,1,50880
AD 18,18,122
M a,212,v,52,v,84
EX 115
M a,216,v,52,v,88
EX 119
M a,224,v,56,v,80
EX 123
M a,228,v,56,v,84
DN 4,36,2,3168
M a,232,v,56,v,88
AD 16,16,115
AD 17,17,119
M a,240,v,60,v,80
AD 18,18,123
v_max3_f32 v20, v16, v17, v18
M a,244,v,60,v,84
v_cmp_lt_f32 vcc, 0x4b800000, v20
s_waitcnt lgkmcnt(0)
M a,248,v,60,v,88
CV 80,96
CV 81,98
s_cbranch_vccnz L_rsB27
L_rbB27:
MC 96,v,32,128,64
s_add_u32 m0, s92, 81920
s_mov_b32 s93, 229376
M v,96,v,36,v,144
CV 84,100
CV 85,102
M v,96,v,40,v,160
DL 7,72,93,0
M v,96,v,44,v,176
RD v,48,1,50944
s_add_u32 m0, s92, 50688
MC 100,v,32,132,68
RD v,52,1,51008
s_mov_b32 s2, 507904
M v,100,v,36,v,148
RD v,56,1,51072
CV 88,104
M v,100,v,40,v,164
RD v,60,1,51136
CV 89,106
M v,100,v,44,v,180
DN 4,24,2,0
MC 104,v,32,136,72
s_add_u32 m0, s92, 81920
RD v,32,1,51200
M v,104,v,36,v,152
RD v,36,1,51264
CV 82,112
M v,104,v,40,v,168
RD v,40,1,51328
CV 83,114
M v,104,v,44,v,184
s_waitcnt lgkmcnt(3)
RD v,44,1,51392
M v,96,v,48,v,192
DL 7,76,93,1056
M v,96,v,52,v,208
s_add_u32 m0, s92, 50688
CV 86,116
M v,96,v,56,v,224
CV 87,118
CV 90,120
M v,96,v,60,v,240
DN 4,28,2,1056
M v,100,v,48,v,196
s_add_u32 m0, s92, 81920
CV 91,122
M v,100,v,52,v,212
v_xor_b32 v2, 81920, v2
AD 12,12,16
M v,100,v,56,v,228
EX 96
M v,100,v,60,v,244
EX 97
M v,104,v,48,v,200
RD v,48,1,51456
AD 13,13,17
M v,104,v,52,v,216
RD v,52,1,51520
AD 14,14,18
M v,104,v,56,v,232
RD v,56,1,51584
AD 16,96,97
M v,104,v,60,v,248
s_waitcnt lgkmcnt(3)
RD v,60,1,51648
MC 112,v,32,128,64
DL 7,80,93,2112
M v,112,v,36,v,144
EX 100
M v,112,v,40,v,160
EX 101
M v,112,v,44,v,176
s_add_u32 m0, s92, 50688
AD 17,100,101
MC 116,v,32,132,68
DN 4,32,2,2112
M v,116,v,36,v,148
EX 104
M v,116,v,40,v,164
EX 105
M v,116,v,44,v,180
s_add_u32 m0, s92, 81920
AD 18,104,105
MC 120,v,32,136,72
EX 98
M v,120,v,36,v,152
EX 102
M v,120,v,40,v,168
EX 106
M v,120,v,44,v,184
s_waitcnt lgkmcnt(0)
s_waitcnt vmcnt(14)
M v,112,v,48,v,192
s_barrier
TR v,32,16896
M v,112,v,52,v,208
DL 7,84,93,3168
M v,112,v,56,v,224
TR v,34,17408
s_add_u32 m0, s92, 50688
M v,112,v,60,v,240
TR v,36,16928
AD 16,16,98
M v,116,v,48,v,196
TR v,38,17440
AD 17,17,102
M v,116,v,52,v,212
TR v,40,16960
AD 18,18,106
M v,116,v,56,v,228
TR v,42,17472
TR v,44,16992
M v,116,v,60,v,244
TR v,46,17504
M v,120,v,48,v,200
DN 4,36,2,3168
M v,120,v,52,v,216
EX 99
M v,120,v,56,v,232
TR v,48,17024
AD 16,16,99
M v,120,v,60,v,248
s_waitcnt lgkmcnt(1)
TR v,50,17536
M a,0,v,32,v,80
EX 103
M a,4,v,32,v,84
TR v,52,17056
AD 17,17,103
M a,8,v,32,v,88
EX 107
M a,16,v,36,v,80
TR v,54,17568
s_bfe_u32 s94, s95, 0x40008
M a,20,v,36,v,84
TR v,56,17088
s_lshl_b32 s94, s94, 15
M a,24,v,36,v,88
TR v,58,17600
AD 18,18,107
M a,32,v,40,v,80
TR v,60,17120
TR v,62,17632
M a,36,v,40,v,84
EX 112
M a,40,v,40,v,88
TR v,32,17152
AD 16,16,112
M a,48,v,44,v,80
buffer_load_dword v10, v4, s[72:75], s94 offen offset:0
M a,52,v,44,v,84
EX 116
M a,56,v,44,v,88
s_waitcnt lgkmcnt(1)
TR v,34,17664
M a,64,v,48,v,80
TR v,36,17184
AD 17,17,116
M a,68,v,48,v,84
EX 120
M a,72,v,48,v,88
TR v,38,17696
AD 18,18,120
M a,80,v,52,v,80
TR v,40,17216
v_xor_b32 v1, 81920, v1
M a,84,v,52,v,84
TR v,42,17728
M a,88,v,52,v,88
TR v,44,17248
M a,96,v,56,v,80
TR v,46,17760
M a,100,v,56,v,84
EX 113
M a,104,v,56,v,88
TR v,48,17280
AD 16,16,113
M a,112,v,60,v,80
EX 117
M a,116,v,60,v,84
TR v,50,17792
AD 17,17,117
M a,120,v,60,v,88
s_waitcnt lgkmcnt(2)
TR v,52,17312
M a,128,v,32,v,80
EX 121
M a,132,v,32,v,84
TR v,54,17824
AD 18,18,121
M a,136,v,32,v,88
EX 114
M a,144,v,36,v,80
TR v,56,17344
AD 16,16,114
M a,148,v,36,v,84
TR v,58,17856
M a,152,v,36,v,88
TR v,60,17376
M a,160,v,40,v,80
TR v,62,17888
M a,164,v,40,v,84
EX 118
M a,168,v,40,v,88
EX 122
M a,176,v,44,v,80
EX 115
M a,180,v,44,v,84
EX 119
M a,184,v,44,v,88
s_waitcnt lgkmcnt(0)
s_waitcnt vmcnt(13)
M a,192,v,48,v,80
s_barrier
RD v,32,1,33792
M a,196,v,48,v,84
RD v,36,1,33856
AD 17,17,118
M a,200,v,48,v,88
RD v,40,1,33920
AD 18,18,122
M a,208,v,52,v,80
RD v,44,1,33984
AD 16,16,115
M a,212,v,52,v,84
EX 123
M a,216,v,52,v,88
AD 17,17,119
AD 18,18,123
M a,224,v,56,v,80
buffer_load_dword v10, v4, s[72:75], s94 offen offset:1024
M a,228,v,56,v,84
v_max3_f32 v20, v16, v17, v18
v_cmp_lt_f32 vcc, 0x4b800000, v20
M a,232,v,56,v,88
s_add_u32 m0, s92, 16896
s_mov_b32 s93, 229504
M a,240,v,60,v,80
CV 80,96
CV 81,98
M a,244,v,60,v,84
s_waitcnt lgkmcnt(0)
CV 84,100
M a,248,v,60,v,88
s_cbranch_vccnz L_rsB28
L_rbB28:
MC 96,v,32,128,64
RD v,48,1,34048
CV 85,102
M v,96,v,36,v,144
DL 7,72,93,0
M v,96,v,40,v,160
RD v,52,1,34112
CV 88,104
M v,96,v,44,v,176
RD v,56,1,34176
CV 89,106
MC 100,v,32,132,68
RD v,60,1,34240
CV 82,112
M v,100,v,36,v,148
CV 83,114
CV 86,116
M v,100,v,40,v,164
CV 87,118
CV 90,120
M v,100,v,44,v,180
CV 91,122
AD 12,12,16
MC 104,v,32,136,72
DL 7,76,93,1056
M v,104,v,36,v,152
RD v,32,1,34304
v_bfe_u32 v8, v4, 8, 2
M v,104,v,40,v,168
RD v,36,1,34368
v_lshrrev_b32 v9, 14, s95
M v,104,v,44,v,184
s_waitcnt lgkmcnt(2)
RD v,40,1,34432
M v,96,v,48,v,192
RD v,44,1,34496
v_add_lshl_u32 v8, v8, v9, 7
M v,96,v,52,v,208
s_getpc_b64 s[100:101]
s_and_b32 s100, s100, 0xfffff000
M v,96,v,56,v,224
v_add_u32 v8, 4096, v8
v_mov_b32 v9, 0
M v,96,v,60,v,240
v_lshl_add_u64 v[8:9], v[8:9], 0, s[100:101]
AD 13,13,17
M v,100,v,48,v,196
buffer_load_dword v10, v4, s[72:75], s94 offen offset:2048
M v,100,v,52,v,212
AD 14,14,18
M v,100,v,56,v,228
M v,100,v,60,v,244
DL 7,80,93,2112
M v,104,v,48,v,200
EX 96
M v,104,v,52,v,216
EX 97
M v,104,v,56,v,232
RD v,48,1,34560
AD 16,96,97
M v,104,v,60,v,248
s_waitcnt lgkmcnt(1)
RD v,52,1,34624
MC 112,v,32,128,64
global_load_dword v10, v[8:9], off
M v,112,v,36,v,144
EX 100
M v,112,v,40,v,160
EX 101
M v,112,v,44,v,176
RD v,56,1,34688
AD 17,100,101
MC 116,v,32,132,68
RD v,60,1,34752
M v,116,v,36,v,148
DL 7,84,93,3168
M v,116,v,40,v,164
EX 104
M v,116,v,44,v,180
EX 105
MC 120,v,32,136,72
EX 98
M v,120,v,36,v,152
EX 102
M v,120,v,40,v,168
buffer_load_dword v10, v4, s[72:75], s94 offen offset:3072
M v,120,v,44,v,184
s_waitcnt lgkmcnt(0)
s_waitcnt vmcnt(17)
M v,112,v,48,v,192
s_mov_b64 exec, 0
s_branch L_pad26
L_ret26:
s_mov_b64 exec, -1
s_barrier
TR v,32,0
M v,112,v,52,v,208
TR v,34,512
s_add_u32 s94, s94, 16384
M v,112,v,56,v,224
TR v,36,32
AD 18,104,105
M v,112,v,60,v,240
TR v,38,544
AD 16,16,98
M v,116,v,48,v,196
TR v,40,64
AD 17,17,102
M v,116,v,52,v,212
TR v,42,576
M v,116,v,56,v,228
TR v,44,96
TR v,46,608
M v,116,v,60,v,244
EX 106
M v,120,v,48,v,200
TR v,48,128
AD 18,18,106
M v,120,v,52,v,216
EX 99
M v,120,v,56,v,232
TR v,50,640
AD 16,16,99
M v,120,v,60,v,248
s_waitcnt lgkmcnt(2)
TR v,52,160
M a,0,v,32,v,80
EX 103
M a,4,v,32,v,84
TR v,54,672
AD 17,17,103
M a,8,v,32,v,88
EX 107
M a,16,v,36,v,80
TR v,56,192
AD 18,18,107
M a,20,v,36,v,84
TR v,58,704
M a,24,v,36,v,88
TR v,60,224
M a,32,v,40,v,80
TR v,62,736
M a,36,v,40,v,84
EX 112
M a,40,v,40,v,88
TR v,32,256
AD 16,16,112
M a,48,v,44,v,80
buffer_load_dword v10, v4, s[72:75], s94 offen offset:0
M a,52,v,44,v,84
EX 116
M a,56,v,44,v,88
s_waitcnt lgkmcnt(1)
TR v,34,768
M a,64,v,48,v,80
TR v,36,288
AD 17,17,116
M a,68,v,48,v,84
EX 120
M a,72,v,48,v,88
TR v,38,800
AD 18,18,120
M a,80,v,52,v,80
TR v,40,320
M a,84,v,52,v,84
TR v,42,832
M a,88,v,52,v,88
TR v,44,352
M a,96,v,56,v,80
TR v,46,864
M a,100,v,56,v,84
EX 113
M a,104,v,56,v,88
TR v,48,384
AD 16,16,113
M a,112,v,60,v,80
EX 117
M a,116,v,60,v,84
TR v,50,896
AD 17,17,117
M a,120,v,60,v,88
s_waitcnt lgkmcnt(2)
TR v,52,416
M a,128,v,32,v,80
EX 121
M a,132,v,32,v,84
TR v,54,928
AD 18,18,121
M a,136,v,32,v,88
EX 114
M a,144,v,36,v,80
TR v,56,448
AD 16,16,114
M a,148,v,36,v,84
TR v,58,960
M a,152,v,36,v,88
TR v,60,480
M a,160,v,40,v,80
TR v,62,992
M a,164,v,40,v,84
EX 118
M a,168,v,40,v,88
EX 122
M a,176,v,44,v,80
EX 115
M a,180,v,44,v,84
EX 119
M a,184,v,44,v,88
s_waitcnt lgkmcnt(0)
s_waitcnt vmcnt(10)
M a,192,v,48,v,80
s_barrier
TR v,32,50688
M a,196,v,48,v,84
TR v,34,51200
AD 17,17,118
M a,200,v,48,v,88
TR v,36,50720
AD 18,18,122
M a,208,v,52,v,80
TR v,38,51232
AD 16,16,115
M a,212,v,52,v,84
TR v,40,50752
AD 17,17,119
M a,216,v,52,v,88
TR v,42,51264
TR v,44,50784
M a,224,v,56,v,80
TR v,46,51296
M a,228,v,56,v,84
EX 123
M a,232,v,56,v,88
TR v,48,50816
AD 18,18,123
M a,240,v,60,v,80
buffer_load_dword v10, v4, s[72:75], s94 offen offset:1024
M a,244,v,60,v,84
v_max3_f32 v20, v16, v17, v18
v_cmp_lt_f32 vcc, 0x4b800000, v20
M a,248,v,60,v,88
s_waitcnt lgkmcnt(1)
CV 80,96
CV 81,98
CV 82,112
CV 83,114
s_cbranch_vccnz L_rsB29
L_rbB29:
CV 84,100
M a,0,v,32,v,80
CV 85,102
CV 86,116
CV 87,118
CV 88,104
CV 89,106
M a,4,v,32,v,84
CV 90,120
CV 91,122
TR v,50,51328
TR v,52,50848
M a,8,v,32,v,88
TR v,54,51360
AD 13,13,17
M a,16,v,36,v,80
TR v,56,50880
AD 12,12,16
M a,20,v,36,v,84
TR v,58,51392
AD 14,14,18
M a,24,v,36,v,88
TR v,60,50912
v_mov_b32 v15, v13
M a,32,v,40,v,80
TR v,62,51424
AR 20,0
M a,36,v,40,v,84
TR v,32,50944
AR 21,1
M a,40,v,40,v,88
TR v,34,51456
AR 22,2
M a,48,v,44,v,80
TR v,36,50976
AR 23,3
M a,52,v,44,v,84
TR v,38,51488
AR 24,16
M a,56,v,44,v,88
s_waitcnt lgkmcnt(4)
TR v,40,51008
M a,64,v,48,v,80
TR v,42,51520
AR 25,17
M a,68,v,48,v,84
TR v,44,51040
AR 26,18
M a,72,v,48,v,88
TR v,46,51552
AR 27,19
M a,80,v,52,v,80
buffer_load_dword v10, v4, s[72:75], s94 offen offset:2048
M a,84,v,52,v,84
v_permlane32_swap_b32 v12, v14
M a,88,v,52,v,88
v_permlane32_swap_b32 v13, v15
M a,96,v,56,v,80
v_add_f32 v12, v12, v14
v_add_f32 v13, v13, v15
M a,100,v,56,v,84
TR v,48,51072
M a,104,v,56,v,88
v_permlane16_swap_b32 v12, v13
M a,112,v,60,v,80
TR v,50,51584
v_add_f32 v12, v12, v13
M a,116,v,60,v,84
v_rcp_f32 v16, v12
M a,120,v,60,v,88
s_waitcnt lgkmcnt(2)
TR v,52,51104
M a,128,v,32,v,80
TR v,54,51616
v_mov_b32 v17, v16
M a,132,v,32,v,84
TR v,56,51136
M a,136,v,32,v,88
v_permlane16_swap_b32 v16, v17
M a,144,v,36,v,80
TR v,58,51648
v_mov_b32 v18, v16
M a,148,v,36,v,84
TR v,60,51168
v_mov_b32 v19, v17
M a,152,v,36,v,88
TR v,62,51680
v_xor_b32 v2, 81920, v2
M a,160,v,40,v,80
v_permlane32_swap_b32 v16, v18
M a,164,v,40,v,84
MU 16,28
v_mul_f32 v20, v16, v20
M a,168,v,40,v,88
v_mul_f32 v21, v16, v21
v_mul_f32 v22, v16, v22
M a,176,v,44,v,80
v_mul_f32 v23, v16, v23
v_mul_f32 v24, v16, v24
M a,180,v,44,v,84
v_mul_f32 v25, v16, v25
v_mul_f32 v26, v16, v26
M a,184,v,44,v,88
s_waitcnt lgkmcnt(0)
v_mul_f32 v27, v16, v27
M a,192,v,48,v,80
v_permlane32_swap_b32 v17, v19
M a,196,v,48,v,84
CV 128,20
CV 129,22
M a,200,v,48,v,88
CV 130,24
CV 131,26
M a,208,v,52,v,80
s_waitcnt vmcnt(12)
MU 17,29
M a,212,v,52,v,84
AR 20,4
AR 21,5
M a,216,v,52,v,88
AR 22,6
AR 23,7
M a,224,v,56,v,80
AR 24,20
AR 25,21
M a,228,v,56,v,84
AR 26,22
AR 27,23
M a,232,v,56,v,88
s_mov_b64 exec, 0
s_branch L_pad27
L_ret27:
s_mov_b64 exec, -1
s_barrier
v_mul_f32 v20, v17, v20
M a,240,v,60,v,80
v_mul_f32 v21, v17, v21
v_mul_f32 v22, v17, v22
M a,244,v,60,v,84
v_mul_f32 v23, v17, v23
v_mul_f32 v24, v17, v24
M a,248,v,60,v,88
v_mul_f32 v25, v17, v25
v_mul_f32 v26, v17, v26
v_mul_f32 v27, v17, v27
CV 132,20
CV 133,22
CV 134,24
CV 135,26
MU 18,30
AR 20,8
AR 21,9
AR 22,10
AR 23,11
AR 24,24
AR 25,25
AR 26,26
AR 27,27
v_pk_mul_f32 v[20:21], v[20:21], v[18:19] op_sel:[0,0] op_sel_hi:[1,0]
v_pk_mul_f32 v[22:23], v[22:23], v[18:19] op_sel:[0,0] op_sel_hi:[1,0]
v_pk_mul_f32 v[24:25], v[24:25], v[18:19] op_sel:[0,0] op_sel_hi:[1,0]
v_pk_mul_f32 v[26:27], v[26:27], v[18:19] op_sel:[0,0] op_sel_hi:[1,0]
CV 136,20
CV 137,22
CV 138,24
CV 139,26
AR 20,32
AR 21,33
AR 22,34
AR 23,35
AR 24,48
AR 25,49
AR 26,50
AR 27,51
v_pk_mul_f32 v[20:21], v[20:21], v[16:17] op_sel:[0,0] op_sel_hi:[1,0]
v_pk_mul_f32 v[22:23], v[22:23], v[16:17] op_sel:[0,0] op_sel_hi:[1,0]
v_pk_mul_f32 v[24:25], v[24:25], v[16:17] op_sel:[0,0] op_sel_hi:[1,0]
v_pk_mul_f32 v[26:27], v[26:27], v[16:17] op_sel:[0,0] op_sel_hi:[1,0]
TR v,32,0
TR v,34,128
TR v,36,256
TR v,38,384
TR v,40,512
TR v,42,640
TR v,44,768
TR v,46,896
CV 144,20
CV 145,22
CV 146,24
CV 147,26
AR 20,36
AR 21,37
AR 22,38
AR 23,39
AR 24,52
AR 25,53
AR 26,54
AR 27,55
v_pk_mul_f32 v[20:21], v[20:21], v[16:17] op_sel:[0,1] op_sel_hi:[1,1]
v_pk_mul_f32 v[22:23], v[22:23], v[16:17] op_sel:[0,1] op_sel_hi:[1,1]
v_pk_mul_f32 v[24:25], v[24:25], v[16:17] op_sel:[0,1] op_sel_hi:[1,1]
v_pk_mul_f32 v[26:27], v[26:27], v[16:17] op_sel:[0,1] op_sel_hi:[1,1]
CV 148,20
CV 149,22
CV 150,24
CV 151,26
AR 20,40
AR 21,41
AR 22,42
AR 23,43
AR 24,56
AR 25,57
AR 26,58
AR 27,59
v_pk_mul_f32 v[20:21], v[20:21], v[18:19] op_sel:[0,0] op_sel_hi:[1,0]
v_pk_mul_f32 v[22:23], v[22:23], v[18:19] op_sel:[0,0] op_sel_hi:[1,0]
v_pk_mul_f32 v[24:25], v[24:25], v[18:19] op_sel:[0,0] op_sel_hi:[1,0]
v_pk_mul_f32 v[26:27], v[26:27], v[18:19] op_sel:[0,0] op_sel_hi:[1,0]
CV 152,20
CV 153,22
CV 154,24
CV 155,26
AR 20,64
AR 21,65
AR 22,66
AR 23,67
AR 24,80
AR 25,81
AR 26,82
AR 27,83
v_pk_mul_f32 v[20:21], v[20:21], v[16:17] op_sel:[0,0] op_sel_hi:[1,0]
v_pk_mul_f32 v[22:23], v[22:23], v[16:17] op_sel:[0,0] op_sel_hi:[1,0]
v_pk_mul_f32 v[24:25], v[24:25], v[16:17] op_sel:[0,0] op_sel_hi:[1,0]
v_pk_mul_f32 v[26:27], v[26:27], v[16:17] op_sel:[0,0] op_sel_hi:[1,0]
CV 160,20
CV 161,22
CV 162,24
CV 163,26
buffer_load_dword v10, v4, s[72:75], s94 offen offset:3072
AR 20,68
AR 21,69
AR 22,70
AR 23,71
AR 24,84
AR 25,85
AR 26,86
AR 27,87
v_pk_mul_f32 v[20:21], v[20:21], v[16:17] op_sel:[0,1] op_sel_hi:[1,1]
v_pk_mul_f32 v[22:23], v[22:23], v[16:17] op_sel:[0,1] op_sel_hi:[1,1]
v_pk_mul_f32 v[24:25], v[24:25], v[16:17] op_sel:[0,1] op_sel_hi:[1,1]
v_pk_mul_f32 v[26:27], v[26:27], v[16:17] op_sel:[0,1] op_sel_hi:[1,1]
CV 164,20
CV 165,22
CV 166,24
CV 167,26
AR 20,72
AR 21,73
AR 22,74
AR 23,75
AR 24,88
AR 25,89
AR 26,90
AR 27,91
s_waitcnt lgkmcnt(0)
Z v,64,v,32,v,128
v_mul_f32 v20, v18, v20
v_mul_f32 v21, v18, v21
M v,64,v,36,v,144
v_mul_f32 v22, v18, v22
v_mul_f32 v23, v18, v23
M v,64,v,40,v,160
v_mul_f32 v24, v18, v24
v_mul_f32 v25, v18, v25
v_mul_f32 v26, v18, v26
v_mul_f32 v27, v18, v27
CV 168,20
CV 169,22
CV 170,24
CV 171,26
AR 20,96
AR 21,97
AR 22,98
AR 23,99
AR 24,112
AR 25,113
AR 26,114
AR 27,115
v_pk_mul_f32 v[20:21], v[20:21], v[16:17] op_sel:[0,0] op_sel_hi:[1,0]
v_pk_mul_f32 v[22:23], v[22:23], v[16:17] op_sel:[0,0] op_sel_hi:[1,0]
v_pk_mul_f32 v[24:25], v[24:25], v[16:17] op_sel:[0,0] op_sel_hi:[1,0]
v_pk_mul_f32 v[26:27], v[26:27], v[16:17] op_sel:[0,0] op_sel_hi:[1,0]
CV 176,20
CV 177,22
CV 178,24
CV 179,26
s_add_u32 m0, s92, 50688
s_mov_b32 s93, 0
M v,64,v,44,v,176
DL 7,72,93,0
Z v,68,v,32,v,132
TR v,48,32
AR 20,100
M v,68,v,36,v,148
TR v,50,160
AR 21,101
M v,68,v,40,v,164
TR v,52,288
TR v,54,416
TR v,56,544
TR v,58,672
TR v,60,800
TR v,62,928
AR 22,102
AR 23,103
AR 24,116
AR 25,117
AR 26,118
AR 27,119
v_pk_mul_f32 v[20:21], v[20:21], v[16:17] op_sel:[0,1] op_sel_hi:[1,1]
v_pk_mul_f32 v[22:23], v[22:23], v[16:17] op_sel:[0,1] op_sel_hi:[1,1]
v_pk_mul_f32 v[24:25], v[24:25], v[16:17] op_sel:[0,1] op_sel_hi:[1,1]
v_pk_mul_f32 v[26:27], v[26:27], v[16:17] op_sel:[0,1] op_sel_hi:[1,1]
CV 180,20
CV 181,22
CV 182,24
CV 183,26
AR 20,104
AR 21,105
M v,68,v,44,v,180
AR 22,106
AR 23,107
Z v,72,v,32,v,136
AR 24,120
AR 25,121
M v,72,v,36,v,152
AR 26,122
AR 27,123
M v,72,v,40,v,168
v_mul_f32 v20, v18, v20
v_mul_f32 v21, v18, v21
v_mul_f32 v22, v18, v22
v_mul_f32 v23, v18, v23
v_mul_f32 v24, v18, v24
v_mul_f32 v25, v18, v25
v_pk_mul_f32 v[26:27], v[26:27], v[18:19] op_sel:[0,0] op_sel_hi:[1,0]
CV 184,20
CV 185,22
CV 186,24
CV 187,26
DL 7,76,93,1056
TR v,32,64
M v,72,v,44,v,184
s_waitcnt lgkmcnt(1)
TR v,34,192
Z v,80,v,48,v,128
TR v,36,320
AR 20,128
M v,80,v,52,v,144
TR v,38,448
AR 21,129
M v,80,v,56,v,160
TR v,40,576
AR 22,130
M v,80,v,60,v,176
TR v,42,704
AR 23,131
Z v,84,v,48,v,132
TR v,44,832
v_mul_f32 v20, v16, v20
M v,84,v,52,v,148
TR v,46,960
v_mul_f32 v21, v16, v21
M v,84,v,56,v,164
v_mul_f32 v22, v16, v22
v_mul_f32 v23, v16, v23
M v,84,v,60,v,180
DL 7,80,93,2112
Z v,88,v,48,v,136
TR v,48,96
CV 192,20
M v,88,v,52,v,152
TR v,50,224
CV 193,22
M v,88,v,56,v,168
TR v,52,352
AR 20,132
M v,88,v,60,v,184
s_waitcnt lgkmcnt(3)
TR v,54,480
Z v,96,v,32,v,128
TR v,56,608
AR 21,133
M v,96,v,36,v,144
TR v,58,736
AR 22,134
M v,96,v,40,v,160
TR v,60,864
AR 23,135
M v,96,v,44,v,176
TR v,62,992
v_xor_b32 v2, 81920, v2
Z v,100,v,32,v,132
DL 7,84,93,3168
M v,100,v,36,v,148
v_mul_f32 v20, v17, v20
v_mul_f32 v21, v17, v21
M v,100,v,40,v,164
v_mul_f32 v22, v17, v22
v_mul_f32 v23, v17, v23
M v,100,v,44,v,180
CV 196,20
CV 197,22
Z v,104,v,32,v,136
AR 24,144
AR 25,145
M v,104,v,36,v,152
AR 26,146
AR 27,147
M v,104,v,40,v,168
AR 20,136
AR 21,137
M v,104,v,44,v,184
s_waitcnt lgkmcnt(0)
s_waitcnt vmcnt(9)
Z v,112,v,48,v,128
s_barrier
TR v,32,16896
M v,112,v,52,v,144
TR v,34,17024
s_add_u32 m0, s92, 81920
M v,112,v,56,v,160
TR v,36,17152
s_mov_b32 s93, 128
M v,112,v,60,v,176
TR v,38,17280
AR 22,138
Z v,116,v,48,v,132
TR v,40,17408
AR 23,139
M v,116,v,52,v,148
TR v,42,17536
v_mul_f32 v24, v16, v24
M v,116,v,56,v,164
TR v,44,17664
TR v,46,17792
M v,116,v,60,v,180
DL 7,72,93,0
Z v,120,v,48,v,136
TR v,48,16928
v_mul_f32 v25, v16, v25
M v,120,v,52,v,152
TR v,50,17056
v_mul_f32 v26, v16, v26
M v,120,v,56,v,168
DL 7,76,93,1056
M v,120,v,60,v,184
s_waitcnt lgkmcnt(2)
TR v,52,17184
Z a,0,v,32,v,128
TR v,54,17312
v_mul_f32 v27, v16, v27
M a,0,v,36,v,144
DL 7,80,93,2112
M a,0,v,40,v,160
TR v,56,17440
v_mul_f32 v20, v18, v20
M a,0,v,44,v,176
TR v,58,17568
v_mul_f32 v21, v18, v21
Z a,4,v,32,v,132
TR v,60,17696
v_mul_f32 v22, v18, v22
M a,4,v,36,v,148
TR v,62,17824
v_mul_f32 v23, v18, v23
M a,4,v,40,v,164
DL 7,84,93,3168
M a,4,v,44,v,180
CV 194,24
CV 195,26
Z a,8,v,32,v,136
TR v,32,16960
CV 200,20
M a,8,v,36,v,152
TR v,34,17088
CV 201,22
M a,8,v,40,v,168
TR v,36,17216
AR 24,148
M a,8,v,44,v,184
s_waitcnt lgkmcnt(3)
TR v,38,17344
Z a,16,v,48,v,128
TR v,40,17472
AR 25,149
M a,16,v,52,v,144
TR v,42,17600
AR 26,150
M a,16,v,56,v,160
TR v,44,17728
AR 27,151
M a,16,v,60,v,176
TR v,46,17856
AR 20,160
Z a,20,v,48,v,132
AR 21,161
AR 22,162
M a,20,v,52,v,148
AR 23,163
v_mul_f32 v24, v17, v24
M a,20,v,56,v,164
v_mul_f32 v25, v17, v25
v_mul_f32 v26, v17, v26
M a,20,v,60,v,180
v_mul_f32 v27, v17, v27
v_mul_f32 v20, v16, v20
Z a,24,v,48,v,136
TR v,48,16992
v_mul_f32 v21, v16, v21
M a,24,v,52,v,152
TR v,50,17120
v_mul_f32 v22, v16, v22
M a,24,v,56,v,168
TR v,52,17248
v_mul_f32 v23, v16, v23
M a,24,v,60,v,184
s_waitcnt lgkmcnt(3)
TR v,54,17376
Z a,32,v,32,v,128
TR v,56,17504
CV 198,24
M a,32,v,36,v,144
TR v,58,17632
CV 199,26
M a,32,v,40,v,160
TR v,60,17760
CV 208,20
M a,32,v,44,v,176
TR v,62,17888
CV 209,22
Z a,36,v,32,v,132
AR 24,152
AR 25,153
M a,36,v,36,v,148
AR 26,154
AR 27,155
M a,36,v,40,v,164
AR 20,164
AR 21,165
M a,36,v,44,v,180
AR 22,166
AR 23,167
Z a,40,v,32,v,136
v_mul_f32 v24, v18, v24
v_mul_f32 v25, v18, v25
M a,40,v,36,v,152
v_mul_f32 v26, v18, v26
v_mul_f32 v27, v18, v27
M a,40,v,40,v,168
v_mul_f32 v20, v17, v20
v_mul_f32 v21, v17, v21
M a,40,v,44,v,184
s_waitcnt lgkmcnt(0)
s_waitcnt vmcnt(4)
Z a,48,v,48,v,128
s_barrier
TR v,32,50688
M a,48,v,52,v,144
TR v,34,50816
s_add_u32 m0, s92, 16896
M a,48,v,56,v,160
TR v,36,50944
s_mov_b32 s93, 114688
M a,48,v,60,v,176
TR v,38,51072
v_mul_f32 v22, v17, v22
Z a,52,v,48,v,132
TR v,40,51200
v_mul_f32 v23, v17, v23
M a,52,v,52,v,148
TR v,42,51328
CV 202,24
M a,52,v,56,v,164
TR v,44,51456
TR v,46,51584
M a,52,v,60,v,180
CV 203,26
CV 212,20
Z a,56,v,48,v,136
TR v,48,50720
CV 213,22
M a,56,v,52,v,152
TR v,50,50848
AR 24,176
M a,56,v,56,v,168
TR v,52,50976
AR 25,177
M a,56,v,60,v,184
s_waitcnt lgkmcnt(3)
TR v,54,51104
M v,64,v,32,v,140
DL 7,72,93,0
M v,64,v,36,v,156
TR v,56,51232
AR 26,178
M v,64,v,40,v,172
TR v,58,51360
AR 27,179
M v,64,v,44,v,188
TR v,60,51488
AR 20,168
M v,68,v,32,a,12
TR v,62,51616
AR 21,169
M v,68,v,36,a,44
AR 22,170
AR 23,171
M v,68,v,40,a,76
v_mul_f32 v24, v16, v24
v_mul_f32 v25, v16, v25
M v,68,v,44,a,108
v_mul_f32 v26, v16, v26
v_mul_f32 v27, v16, v27
M v,72,v,32,a,28
TR v,32,50752
v_mul_f32 v20, v18, v20
M v,72,v,36,a,60
TR v,34,50880
v_mul_f32 v21, v18, v21
M v,72,v,40,a,92
DL 7,76,93,1056
M v,72,v,44,a,124
s_waitcnt lgkmcnt(2)
TR v,36,51008
M v,80,v,48,v,140
TR v,38,51136
v_mul_f32 v22, v18, v22
M v,80,v,52,v,156
TR v,40,51264
v_mul_f32 v23, v18, v23
M v,80,v,56,v,172
TR v,42,51392
CV 210,24
M v,80,v,60,v,188
TR v,44,51520
CV 211,26
M v,84,v,48,a,12
TR v,46,51648
CV 216,20
M v,84,v,52,a,44
CV 217,22
AR 24,180
M v,84,v,56,a,76
AR 25,181
AR 26,182
M v,84,v,60,a,108
DL 7,80,93,2112
M v,88,v,48,a,28
TR v,48,50784
AR 27,183
M v,88,v,52,a,60
TR v,50,50912
AR 20,192
M v,88,v,56,a,92
TR v,52,51040
AR 21,193
M v,88,v,60,a,124
s_waitcnt lgkmcnt(3)
TR v,54,51168
M v,96,v,32,v,140
TR v,56,51296
AR 22,194
M v,96,v,36,v,156
TR v,58,51424
AR 23,195
M v,96,v,40,v,172
TR v,60,51552
v_mul_f32 v24, v17, v24
M v,96,v,44,v,188
TR v,62,51680
v_xor_b32 v2, 81920, v2
M v,100,v,32,a,12
DL 7,84,93,3168
M v,100,v,36,a,44
s_add_u32 m0, s92, 33792
s_mov_b32 s93, 344064
M v,100,v,40,a,76
v_mul_f32 v25, v17, v25
v_mul_f32 v26, v17, v26
M v,100,v,44,a,108
v_mul_f32 v27, v17, v27
v_mul_f32 v20, v16, v20
M v,104,v,32,a,28
v_mul_f32 v21, v16, v21
v_mul_f32 v22, v16, v22
M v,104,v,36,a,60
v_mul_f32 v23, v16, v23
CV 214,24
M v,104,v,40,a,92
CV 215,26
CV 224,20
M v,104,v,44,a,124
s_waitcnt lgkmcnt(0)
s_waitcnt vmcnt(4)
M v,112,v,48,v,140
s_mov_b64 exec, 0
s_branch L_pad28
L_ret28:
s_mov_b64 exec, -1
s_barrier
TR v,32,0
M v,112,v,52,v,156
DL 7,72,93,0
M v,112,v,56,v,172
TR v,34,128
CV 225,22
M v,112,v,60,v,188
TR v,36,256
AR 24,184
M v,116,v,48,a,12
TR v,38,384
AR 25,185
M v,116,v,52,a,44
TR v,40,512
AR 26,186
M v,116,v,56,a,76
TR v,42,640
TR v,44,768
M v,116,v,60,a,108
TR v,46,896
AR 27,187
M v,120,v,48,a,28
TR v,48,32
AR 20,196
M v,120,v,52,a,60
TR v,50,160
AR 21,197
M v,120,v,56,a,92
DL 7,76,93,1056
M v,120,v,60,a,124
s_waitcnt lgkmcnt(2)
TR v,52,288
M a,0,v,32,v,140
TR v,54,416
AR 22,198
M a,0,v,36,v,156
TR v,56,544
AR 23,199
M a,0,v,40,v,172
TR v,58,672
v_mul_f32 v24, v18, v24
M a,0,v,44,v,188
TR v,60,800
v_mul_f32 v25, v18, v25
M a,4,v,32,a,12
TR v,62,928
v_mul_f32 v26, v18, v26
M a,4,v,36,a,44
v_mul_f32 v27, v18, v27
v_mul_f32 v20, v17, v20
M a,4,v,40,a,76
v_mul_f32 v21, v17, v21
v_mul_f32 v22, v17, v22
M a,4,v,44,a,108
v_mul_f32 v23, v17, v23
CV 218,24
M a,8,v,32,a,28
TR v,32,64
CV 219,26
M a,8,v,36,a,60
DL 7,80,93,2112
M a,8,v,40,a,92
TR v,34,192
CV 228,20
M a,8,v,44,a,124
s_waitcnt lgkmcnt(2)
TR v,36,320
M a,16,v,48,v,140
TR v,38,448
CV 229,22
M a,16,v,52,v,156
TR v,40,576
AR 24,208
M a,16,v,56,v,172
TR v,42,704
AR 25,209
M a,16,v,60,v,188
TR v,44,832
AR 26,210
M a,20,v,48,a,12
TR v,46,960
AR 27,211
M a,20,v,52,a,44
AR 20,200
AR 21,201
M a,20,v,56,a,76
AR 22,202
AR 23,203
M a,20,v,60,a,108
v_mul_f32 v24, v16, v24
v_mul_f32 v25, v16, v25
M a,24,v,48,a,28
TR v,48,96
v_mul_f32 v26, v16, v26
M a,24,v,52,a,60
DL 7,84,93,3168
M a,24,v,56,a,92
TR v,50,224
s_add_u32 m0, s92, 0
M a,24,v,60,a,124
s_waitcnt lgkmcnt(2)
TR v,52,352
M a,32,v,32,v,140
TR v,54,480
s_mov_b32 s93, 114816
M a,32,v,36,v,156
TR v,56,608
v_mul_f32 v27, v16, v27
M a,32,v,40,v,172
TR v,58,736
v_mul_f32 v20, v18, v20
M a,32,v,44,v,188
TR v,60,864
v_mul_f32 v21, v18, v21
M a,36,v,32,a,12
TR v,62,992
v_xor_b32 v2, 81920, v2
M a,36,v,36,a,44
v_mul_f32 v22, v18, v22
v_mul_f32 v23, v18, v23
M a,36,v,40,a,76
CV 226,24
CV 227,26
M a,36,v,44,a,108
CV 232,20
CV 233,22
M a,40,v,32,a,28
DL 7,72,93,0
M a,40,v,36,a,60
AR 24,212
AR 25,213
M a,40,v,40,a,92
AR 26,214
AR 27,215
M a,40,v,44,a,124
s_waitcnt lgkmcnt(0)
s_waitcnt vmcnt(5)
M a,48,v,48,v,140
s_barrier
TR v,32,16896
M a,48,v,52,v,156
TR v,34,17024
AR 20,224
M a,48,v,56,v,172
TR v,36,17152
AR 21,225
M a,48,v,60,v,188
TR v,38,17280
AR 22,226
M a,52,v,48,a,12
TR v,40,17408
AR 23,227
M a,52,v,52,a,44
TR v,42,17536
v_mul_f32 v24, v17, v24
M a,52,v,56,a,76
TR v,44,17664
TR v,46,17792
M a,52,v,60,a,108
DL 7,76,93,1056
M a,56,v,48,a,28
TR v,48,16928
v_mul_f32 v25, v17, v25
M a,56,v,52,a,60
TR v,50,17056
v_mul_f32 v26, v17, v26
M a,56,v,56,a,92
TR v,52,17184
v_mul_f32 v27, v17, v27
M a,56,v,60,a,124
s_waitcnt lgkmcnt(3)
TR v,54,17312
M v,64,v,32,v,204
TR v,56,17440
v_mul_f32 v20, v16, v20
M v,64,v,36,v,220
TR v,58,17568
v_mul_f32 v21, v16, v21
M v,64,v,40,v,236
TR v,60,17696
v_mul_f32 v22, v16, v22
M v,64,v,44,v,252
TR v,62,17824
v_mul_f32 v23, v16, v23
M v,68,v,32,a,140
CV 230,24
CV 231,26
M v,68,v,36,a,172
CV 240,20
CV 241,22
M v,68,v,40,a,204
DL 7,80,93,2112
M v,68,v,44,a,236
AR 24,216
AR 25,217
M v,72,v,32,a,156
TR v,32,16960
AR 26,218
M v,72,v,36,a,188
TR v,34,17088
v_bfe_u32 v8, v4, 8, 2
M v,72,v,40,a,220
TR v,36,17216
v_lshrrev_b32 v9, 14, s95
M v,72,v,44,a,252
s_waitcnt lgkmcnt(3)
TR v,38,17344
M v,80,v,48,v,204
TR v,40,17472
v_add_lshl_u32 v8, v8, v9, 7
M v,80,v,52,v,220
TR v,42,17600
v_add_u32 v8, 4096, v8
M v,80,v,56,v,236
TR v,44,17728
v_mov_b32 v9, 0
M v,80,v,60,v,252
TR v,46,17856
AR 27,219
M v,84,v,48,a,140
s_getpc_b64 s[100:101]
s_and_b32 s100, s100, 0xfffff000
M v,84,v,52,a,172
v_lshl_add_u64 v[8:9], v[8:9], 0, s[100:101]
AR 20,228
M v,84,v,56,a,204
DL 7,84,93,3168
M v,84,v,60,a,236
s_add_u32 m0, s92, 50688
s_mov_b32 s93, 344192
M v,88,v,48,a,156
TR v,48,16992
AR 21,229
M v,88,v,52,a,188
TR v,50,17120
AR 22,230
M v,88,v,56,a,220
TR v,52,17248
AR 23,231
M v,88,v,60,a,252
s_waitcnt lgkmcnt(3)
TR v,54,17376
M v,96,v,32,v,204
TR v,56,17504
v_mul_f32 v24, v18, v24
M v,96,v,36,v,220
TR v,58,17632
v_mul_f32 v25, v18, v25
M v,96,v,40,v,236
TR v,60,17760
v_mul_f32 v26, v18, v26
M v,96,v,44,v,252
TR v,62,17888
v_mul_f32 v27, v18, v27
M v,100,v,32,a,140
global_load_dword v10, v[8:9], off
M v,100,v,36,a,172
CV 234,24
CV 235,26
M v,100,v,40,a,204
AR 24,240
AR 25,241
M v,100,v,44,a,236
DL 7,72,93,0
M v,104,v,32,a,156
AR 26,242
AR 27,243
M v,104,v,36,a,188
v_mul_f32 v24, v16, v24
v_mul_f32 v25, v16, v25
M v,104,v,40,a,220
v_mul_f32 v26, v16, v26
v_mul_f32 v27, v16, v27
M v,104,v,44,a,252
s_waitcnt lgkmcnt(0)
s_waitcnt vmcnt(6)
M v,112,v,48,v,204
s_barrier
TR a,212,33792
M v,112,v,52,v,220
TR a,214,33920
CV 242,24
M v,112,v,56,v,236
TR a,216,34048
CV 243,26
M v,112,v,60,v,252
TR a,218,34176
AR 24,244
M v,116,v,48,a,140
TR a,224,34304
AR 25,245
M v,116,v,52,a,172
TR a,226,34432
AR 26,246
M v,116,v,56,a,204
TR a,228,34560
TR a,230,34688
M v,116,v,60,a,236
DL 7,76,93,1056
M v,120,v,48,a,156
AR 27,247
v_mul_f32 v20, v17, v20
M v,120,v,52,a,188
v_mul_f32 v21, v17, v21
v_mul_f32 v22, v17, v22
M v,120,v,56,a,220
v_mul_f32 v23, v17, v23
v_mul_f32 v24, v17, v24
M v,120,v,60,a,252
s_waitcnt lgkmcnt(0)
v_mul_f32 v25, v17, v25
M v,64,a,212,v,192
v_mul_f32 v26, v17, v26
v_mul_f32 v27, v17, v27
M v,64,a,216,v,208
CV 244,20
CV 245,22
M v,64,a,224,v,224
CV 246,24
CV 247,26
M v,64,a,228,v,240
AR 20,232
AR 21,233
M v,68,a,212,v,196
AR 22,234
AR 23,235
M v,68,a,216,v,212
AR 24,248
AR 25,249
M v,68,a,224,v,228
AR 26,250
AR 27,251
M v,68,a,228,v,244
TR a,232,33824
TR a,234,33952
M v,72,a,212,v,200
TR a,240,34080
TR a,242,34208
M v,72,a,216,v,216
TR a,244,34336
TR a,246,34464
M v,72,a,224,v,232
TR a,248,34592
TR a,250,34720
DL 7,80,93,2112
v_mul_f32 v20, v18, v20
v_mul_f32 v21, v18, v21
v_pk_mul_f32 v[22:23], v[22:23], v[18:19] op_sel:[0,0] op_sel_hi:[1,0]
v_pk_mul_f32 v[24:25], v[24:25], v[18:19] op_sel:[0,0] op_sel_hi:[1,0]
v_pk_mul_f32 v[26:27], v[26:27], v[18:19] op_sel:[0,0] op_sel_hi:[1,0]
CV 248,20
CV 249,22
CV 250,24
CV 251,26
TR a,212,33856
TR a,214,33984
M v,72,a,228,v,248
s_waitcnt lgkmcnt(2)
TR a,216,34112
M v,80,a,232,v,192
TR a,218,34240
s_mov_b32 s94, 33554432
M v,80,a,240,v,208
TR a,224,34368
s_and_b32 s16, s95, 3
M v,80,a,244,v,224
TR a,226,34496
v_bfe_u32 v11, v4, 4, 6
M v,80,a,248,v,240
TR a,228,34624
s_lshl_b32 s16, s16, 12
M v,84,a,232,v,196
TR a,230,34752
v_lshrrev_b32 v1, 3, v11
M v,84,a,240,v,212
DL 7,84,93,3168
M v,84,a,244,v,228
v_rcp_f32 v28, v28
M v,84,a,248,v,244
MU 64,28
MU 65,28
M v,88,a,232,v,200
MU 66,28
MU 67,28
M v,88,a,240,v,216
MU 80,28
MU 81,28
M v,88,a,244,v,232
MU 82,28
MU 83,28
M v,88,a,248,v,248
CV 32,64
CV 33,66
s_waitcnt lgkmcnt(0)
M v,96,a,212,v,192
CV 34,80
CV 35,82
M v,96,a,216,v,208
ST 32
M v,96,a,224,v,224
TR a,232,33888
s_add_u32 m0, s92, 98816
M v,96,a,228,v,240
TR a,234,34016
s_mov_b32 s93, 229632
M v,100,a,212,v,196
TR a,240,34144
s_mov_b32 s94, 34603008
M v,100,a,216,v,212
TR a,242,34272
s_add_u32 s12, s16, 94371840
M v,100,a,224,v,228
TR a,244,34400
TR a,246,34528
M v,100,a,228,v,244
TR a,248,34656
TR a,250,34784
M v,104,a,212,v,200
DL 7,72,93,0
M v,104,a,216,v,216
v_rcp_f32 v29, v29
M v,104,a,224,v,232
MU 68,29
MU 69,29
M v,104,a,228,v,248
s_waitcnt lgkmcnt(0)
s_waitcnt vmcnt(7)
M v,112,a,232,v,192
s_mov_b64 exec, 0
s_branch L_pad29
L_ret29:
s_mov_b64 exec, -1
s_barrier
TR a,212,0
M v,112,a,240,v,208
TR a,214,128
MU 70,29
M v,112,a,244,v,224
TR a,216,256
MU 71,29
M v,112,a,248,v,240
TR a,218,384
MU 84,29
M v,116,a,232,v,196
TR a,224,512
MU 85,29
M v,116,a,240,v,212
TR a,226,640
MU 86,29
M v,116,a,244,v,228
TR a,228,768
TR a,230,896
M v,116,a,248,v,244
DL 7,76,93,1056
M v,120,a,232,v,200
MU 87,29
CV 36,68
M v,120,a,240,v,216
CV 37,70
CV 38,84
M v,120,a,244,v,232
TR a,232,32
CV 39,86
M v,120,a,248,v,248
s_waitcnt lgkmcnt(1)
TR a,234,160
M a,0,a,212,v,204
ST 36
M a,0,a,216,v,220
TR a,240,288
s_mov_b32 s94, 35651584
M a,0,a,224,v,236
TR a,242,416
MU 96,28
M a,0,a,228,v,252
TR a,244,544
MU 97,28
M a,4,a,212,a,140
TR a,246,672
MU 98,28
M a,4,a,216,a,172
TR a,248,800
MU 99,28
M a,4,a,224,a,204
TR a,250,928
MU 112,28
M a,4,a,228,a,236
DL 7,80,93,2112
M a,8,a,212,a,156
TR a,212,64
MU 113,28
M a,8,a,216,a,188
TR a,214,192
MU 114,28
M a,8,a,224,a,220
DL 7,84,93,3168
M a,8,a,228,a,252
s_waitcnt lgkmcnt(2)
s_add_u32 m0, s92, 115712
M a,16,a,232,v,204
s_mov_b32 s93, 344320
TR a,216,320
M a,16,a,240,v,220
DL 7,72,93,0
M a,16,a,244,v,236
TR a,218,448
MU 115,28
M a,16,a,248,v,252
TR a,224,576
CV 48,96
M a,20,a,232,a,140
TR a,226,704
CV 49,98
M a,20,a,240,a,172
TR a,228,832
CV 50,112
M a,20,a,244,a,204
TR a,230,960
CV 51,114
M a,20,a,248,a,236
DL 7,76,93,1056
M a,24,a,232,a,156
v_rcp_f32 v30, v30
M a,24,a,240,a,188
MU 72,30
MU 73,30
M a,24,a,244,a,220
DL 7,80,93,2112
M a,24,a,248,a,252
s_waitcnt lgkmcnt(0)
MU 74,30
M a,32,a,212,v,204
MU 75,30
MU 88,30
M a,32,a,216,v,220
MU 89,30
MU 90,30
M a,32,a,224,v,236
MU 91,30
CV 40,72
M a,32,a,228,v,252
CV 41,74
CV 42,88
M a,36,a,212,a,140
TR a,232,96
CV 43,90
M a,36,a,216,a,172
ST 40
M a,36,a,224,a,204
TR a,234,224
TR a,240,352
M a,36,a,228,a,236
TR a,242,480
TR a,244,608
M a,40,a,212,a,156
TR a,246,736
TR a,248,864
M a,40,a,216,a,188
TR a,250,992
s_mov_b32 s94, 37748736
M a,40,a,224,a,220
DL 7,84,93,3168
M a,40,a,228,a,252
s_waitcnt lgkmcnt(0)
s_waitcnt vmcnt(11)
M a,48,a,232,v,204
s_barrier
s_add_u32 m0, s92, 81920
M a,48,a,240,v,220
s_mov_b32 s93, 256
TR a,212,50688
M a,48,a,244,v,236
DL 7,72,93,0
M a,48,a,248,v,252
TR a,214,50816
MU 100,29
M a,52,a,232,a,140
TR a,216,50944
MU 101,29
M a,52,a,240,a,172
TR a,218,51072
MU 102,29
M a,52,a,244,a,204
TR a,224,51200
TR a,226,51328
M a,52,a,248,a,236
TR a,228,51456
TR a,230,51584
M a,56,a,232,a,156
TR a,232,50720
MU 103,29
M a,56,a,240,a,188
DL 7,76,93,1056
M a,56,a,244,a,220
TR a,234,50848
MU 116,29
M a,56,a,248,a,252
s_waitcnt lgkmcnt(2)
TR a,240,50976
M a,0,a,212,v,192
TR a,242,51104
MU 117,29
M a,0,a,216,v,208
TR a,244,51232
MU 118,29
M a,0,a,224,v,224
ST 48
M a,0,a,228,v,240
TR a,246,51360
MU 119,29
M a,4,a,212,v,196
TR a,248,51488
CV 52,100
M a,4,a,216,v,212
TR a,250,51616
CV 53,102
M a,4,a,224,v,228
DL 7,80,93,2112
M a,4,a,228,v,244
CV 54,116
CV 55,118
M a,8,a,212,v,200
TR a,212,50752
s_mov_b32 s94, 38797312
M a,8,a,216,v,216
DL 7,84,93,3168
M a,8,a,224,v,232
s_add_u32 m0, s92, 132608
s_mov_b32 s93, 114944
M a,8,a,228,v,248
s_waitcnt lgkmcnt(1)
TR a,214,50880
M a,16,a,232,v,192
DL 7,72,93,0
M a,16,a,240,v,208
TR a,216,51008
MU 104,30
M a,16,a,244,v,224
TR a,218,51136
MU 105,30
M a,16,a,248,v,240
TR a,224,51264
MU 106,30
M a,20,a,232,v,196
TR a,226,51392
MU 107,30
M a,20,a,240,v,212
TR a,228,51520
MU 120,30
M a,20,a,244,v,228
TR a,230,51648
MU 121,30
M a,20,a,248,v,244
DL 7,76,93,1056
M a,24,a,232,v,200
TR a,232,50784
MU 122,30
M a,24,a,240,v,216
TR a,234,50912
MU 123,30
M a,24,a,244,v,232
DL 7,80,93,2112
M a,24,a,248,v,248
s_waitcnt lgkmcnt(2)
TR a,240,51040
M a,32,a,212,v,192
TR a,242,51168
CV 56,104
M a,32,a,216,v,208
TR a,244,51296
CV 57,106
M a,32,a,224,v,224
ST 52
M a,32,a,228,v,240
TR a,246,51424
CV 58,120
M a,36,a,212,v,196
TR a,248,51552
CV 59,122
M a,36,a,216,v,212
TR a,250,51680
v_xor_b32 v2, 81920, v2
M a,36,a,224,v,228
DL 7,84,93,3168
M a,36,a,228,v,244
s_add_u32 m0, s92, 16896
s_mov_b32 s93, 229760
M a,40,a,212,v,200
s_mov_b32 s94, 39845888
AR 24,4
M a,40,a,216,v,216
AR 25,5
AR 26,6
M a,40,a,224,v,232
AR 27,7
v_mul_f32 v24, v29, v24
M a,40,a,228,v,248
s_waitcnt lgkmcnt(0)
s_waitcnt vmcnt(10)
M a,48,a,232,v,192
s_barrier
TR a,212,16896
M a,48,a,240,v,208
DL 7,72,93,0
M a,48,a,244,v,224
TR a,214,17024
v_mul_f32 v25, v29, v25
M a,48,a,248,v,240
TR a,216,17152
v_mul_f32 v26, v29, v26
M a,52,a,232,v,196
TR a,218,17280
v_mul_f32 v27, v29, v27
M a,52,a,240,v,212
TR a,224,17408
CV 36,24
M a,52,a,244,v,228
TR a,226,17536
TR a,228,17664
M a,52,a,248,v,244
TR a,230,17792
CV 37,26
M a,56,a,232,v,200
TR a,232,33792
AR 20,0
M a,56,a,240,v,216
TR a,234,33920
AR 21,1
M a,56,a,244,v,232
DL 7,76,93,1056
M a,56,a,248,v,248
s_waitcnt lgkmcnt(2)
TR a,240,34048
Z v,64,a,212,v,128
TR a,242,34176
AR 22,2
M v,64,a,216,v,144
TR a,244,34304
AR 23,3
M v,64,a,224,v,160
TR a,246,34432
AR 24,16
M v,64,a,228,v,176
TR a,248,34560
AR 25,17
Z v,68,a,212,v,132
TR a,250,34688
AR 26,18
M v,68,a,216,v,148
ST 56
M v,68,a,224,v,164
AR 27,19
v_mul_f32 v20, v28, v20
M v,68,a,228,v,180
v_mul_f32 v21, v28, v21
v_mul_f32 v22, v28, v22
Z v,72,a,212,v,136
TR a,212,16928
v_mul_f32 v23, v28, v23
M v,72,a,216,v,152
DL 7,80,93,2112
M v,72,a,224,v,168
TR a,214,17056
v_mul_f32 v24, v28, v24
M v,72,a,228,v,184
s_waitcnt lgkmcnt(2)
TR a,216,17184
M v,64,a,232,v,192
TR a,218,17312
v_mul_f32 v25, v28, v25
M v,64,a,240,v,208
TR a,224,17440
v_mul_f32 v26, v28, v26
M v,64,a,244,v,224
TR a,226,17568
v_mul_f32 v27, v28, v27
M v,64,a,248,v,240
TR a,228,17696
CV 32,20
M v,68,a,232,v,196
TR a,230,17824
CV 33,22
M v,68,a,240,v,212
CV 34,24
CV 35,26
M v,68,a,244,v,228
s_mov_b32 s94, 41943040
v_mul_u32_u24 v1, 992, v1
M v,68,a,248,v,244
v_lshl_add_u32 v1, v11, 2, v1
s_mov_b32 s43, 0x20000
M v,72,a,232,v,200
TR a,232,33824
v_lshlrev_b32 v11, 2, v11
M v,72,a,240,v,216
DL 7,84,93,3168
M v,72,a,244,v,232
TR a,234,33952
s_add_u32 m0, s92, 33792
M v,72,a,248,v,248
s_waitcnt lgkmcnt(2)
TR a,240,34080
Z v,80,a,212,v,128
TR a,242,34208
s_mov_b32 s93, 344448
M v,80,a,216,v,144
TR a,244,34336
AR 20,8
M v,80,a,224,v,160
TR a,246,34464
AR 21,9
M v,80,a,228,v,176
TR a,248,34592
AR 22,10
Z v,84,a,212,v,132
TR a,250,34720
AR 23,11
M v,84,a,216,v,148
ST 32
M v,84,a,224,v,164
s_add_u32 s40, s88, s12
s_addc_u32 s41, s89, 0
M v,84,a,228,v,180
v_mul_f32 v20, v30, v20
v_mul_f32 v21, v30, v21
Z v,88,a,212,v,136
DL 7,72,93,0
M v,88,a,216,v,152
v_mul_f32 v22, v30, v22
v_mul_f32 v23, v30, v23
M v,88,a,224,v,168
CV 40,20
CV 41,22
M v,88,a,228,v,184
s_waitcnt lgkmcnt(0)
s_waitcnt vmcnt(7)
M v,80,a,232,v,192
s_mov_b64 exec, 0
s_branch L_pad30
L_ret30:
s_mov_b64 exec, -1
s_barrier
TR a,212,0
M v,80,a,240,v,208
TR a,214,128
AR 20,20
M v,80,a,244,v,224
TR a,216,256
AR 21,21
M v,80,a,248,v,240
TR a,218,384
AR 22,22
M v,84,a,232,v,196
TR a,224,512
AR 23,23
M v,84,a,240,v,212
TR a,226,640
v_mul_f32 v20, v29, v20
M v,84,a,244,v,228
TR a,228,768
TR a,230,896
M v,84,a,248,v,244
DL 7,76,93,1056
M v,88,a,232,v,200
v_mov_b32 v6, 2
s_mov_b32 s42, 128
M v,88,a,240,v,216
TR a,232,50688
v_mul_f32 v21, v29, v21
M v,88,a,244,v,232
TR a,234,50816
v_mul_f32 v22, v29, v22
M v,88,a,248,v,248
s_waitcnt lgkmcnt(2)
TR a,240,50944
M v,64,a,212,v,140
TR a,242,51072
v_mul_f32 v23, v29, v23
M v,64,a,216,v,156
TR a,244,51200
CV 38,20
M v,64,a,224,v,172
s_waitcnt vmcnt(5)
TR a,246,51328
M v,64,a,228,v,188
buffer_store_dword v6, v11, s[40:43], 0 offen offset:0 sc1
M v,68,a,212,a,12
TR a,248,51456
CV 39,22
M v,68,a,216,a,44
TR a,250,51584
s_mov_b32 s94, 42991616
M v,68,a,224,a,76
ST 36
M v,68,a,228,a,108
AR 24,24
AR 25,25
M v,72,a,212,a,28
TR a,212,32
AR 26,26
M v,72,a,216,a,60
DL 7,80,93,2112
M v,72,a,224,a,92
TR a,214,160
AR 27,27
M v,72,a,228,a,124
s_waitcnt lgkmcnt(2)
TR a,216,288
M v,64,a,232,v,204
TR a,218,416
v_mul_f32 v24, v30, v24
M v,64,a,240,v,220
TR a,224,544
v_mul_f32 v25, v30, v25
M v,64,a,244,v,236
TR a,226,672
v_mul_f32 v26, v30, v26
M v,64,a,248,v,252
TR a,228,800
v_mul_f32 v27, v30, v27
M v,68,a,232,a,140
TR a,230,928
CV 42,24
M v,68,a,240,a,172
CV 43,26
s_mov_b32 s94, 44040192
M v,68,a,244,a,204
DL 7,84,93,3168
M v,68,a,248,a,236
s_add_u32 m0, s92, 0
s_mov_b32 s93, 384
M v,72,a,232,a,156
TR a,232,50720
AR 24,36
M v,72,a,240,a,188
TR a,234,50848
AR 25,37
M v,72,a,244,a,220
TR a,240,50976
AR 26,38
M v,72,a,248,a,252
s_waitcnt lgkmcnt(3)
TR a,242,51104
M v,80,a,212,v,140
TR a,244,51232
AR 27,39
M v,80,a,216,v,156
TR a,246,51360
v_mul_f32 v24, v29, v24
M v,80,a,224,v,172
TR a,248,51488
v_mul_f32 v25, v29, v25
M v,80,a,228,v,188
TR a,250,51616
v_mul_f32 v26, v29, v26
M v,84,a,212,a,12
v_mul_f32 v27, v29, v27
CV 52,24
M v,84,a,216,a,44
DL 7,72,93,0
M v,84,a,224,a,76
CV 53,26
AR 20,32
M v,84,a,228,a,108
ST 40
M v,88,a,212,a,28
TR a,212,16960
AR 21,33
M v,88,a,216,a,60
TR a,214,17088
AR 22,34
M v,88,a,224,a,92
TR a,216,17216
AR 23,35
M v,88,a,228,a,124
s_waitcnt lgkmcnt(3)
TR a,218,17344
M v,80,a,232,v,204
TR a,224,17472
AR 24,48
M v,80,a,240,v,220
TR a,226,17600
AR 25,49
M v,80,a,244,v,236
TR a,228,17728
AR 26,50
M v,80,a,248,v,252
TR a,230,17856
AR 27,51
M v,84,a,232,a,140
DL 7,76,93,1056
M v,84,a,240,a,172
v_mul_f32 v20, v28, v20
v_mul_f32 v21, v28, v21
M v,84,a,244,a,204
v_mul_f32 v22, v28, v22
v_mul_f32 v23, v28, v23
M v,84,a,248,a,236
v_mul_f32 v24, v28, v24
v_mul_f32 v25, v28, v25
M v,88,a,232,a,156
TR a,232,33856
v_mul_f32 v26, v28, v26
M v,88,a,240,a,188
TR a,234,33984
v_mul_f32 v27, v28, v27
M v,88,a,244,a,220
TR a,240,34112
CV 48,20
M v,88,a,248,a,252
s_waitcnt lgkmcnt(3)
TR a,242,34240
Z v,96,a,212,v,128
TR a,244,34368
CV 49,22
M v,96,a,216,v,144
TR a,246,34496
CV 50,24
M v,96,a,224,v,160
TR a,248,34624
CV 51,26
M v,96,a,228,v,176
TR a,250,34752
s_mov_b32 s94, 46137344
Z v,100,a,212,v,132
DL 7,80,93,2112
M v,100,a,216,v,148
AR 20,40
AR 21,41
M v,100,a,224,v,164
AR 22,42
AR 23,43
M v,100,a,228,v,180
ST 48
Z v,104,a,212,v,136
TR a,212,16992
v_mul_f32 v20, v30, v20
M v,104,a,216,v,152
TR a,214,17120
v_mul_f32 v21, v30, v21
M v,104,a,224,v,168
TR a,216,17248
v_mul_f32 v22, v30, v22
M v,104,a,228,v,184
s_waitcnt lgkmcnt(3)
TR a,218,17376
M v,96,a,232,v,192
TR a,224,17504
v_mul_f32 v23, v30, v23
M v,96,a,240,v,208
TR a,226,17632
CV 56,20
M v,96,a,244,v,224
TR a,228,17760
CV 57,22
M v,96,a,248,v,240
TR a,230,17888
AR 20,52
M v,100,a,232,v,196
DL 7,84,93,3168
M v,100,a,240,v,212
s_add_u32 m0, s92, 50688
s_mov_b32 s93, 115072
M v,100,a,244,v,228
AR 21,53
AR 22,54
M v,100,a,248,v,244
AR 23,55
v_mul_f32 v20, v29, v20
M v,104,a,232,v,200
TR a,232,33888
v_mul_f32 v21, v29, v21
M v,104,a,240,v,216
TR a,234,34016
v_mul_f32 v22, v29, v22
M v,104,a,244,v,232
TR a,240,34144
v_mul_f32 v23, v29, v23
M v,104,a,248,v,248
s_waitcnt lgkmcnt(3)
TR a,242,34272
Z v,112,a,212,v,128
TR a,244,34400
CV 54,20
M v,112,a,216,v,144
TR a,246,34528
CV 55,22
M v,112,a,224,v,160
TR a,248,34656
s_mov_b32 s94, 47185920
M v,112,a,228,v,176
TR a,250,34784
v_and_b32 v5, 60, v11
Z v,116,a,212,v,132
DL 7,72,93,0
M v,116,a,216,v,148
s_bfe_u32 s19, s95, 0x30002
v_mul_u32_u24 v3, 448, v5
M v,116,a,224,v,164
s_lshl_b32 s17, s19, 10
v_lshrrev_b32 v5, 6, v11
M v,116,a,228,v,180
ST 52
Z v,120,a,212,v,136
s_sub_u32 s13, s12, s17
v_lshl_add_u32 v3, v5, 4, v3
M v,120,a,216,v,152
TR a,212,64
AR 24,56
M v,120,a,224,v,168
TR a,214,192
AR 25,57
M v,120,a,228,v,184
s_waitcnt lgkmcnt(2)
s_barrier
M v,112,a,232,v,192
TR a,216,320
AR 26,58
M v,112,a,240,v,208
buffer_load_dword v5, v1, s[88:91], s13 offen offset:0 sc1
M v,112,a,244,v,224
TR a,218,448
AR 27,59
M v,112,a,248,v,240
TR a,224,576
v_mul_f32 v24, v30, v24
M v,116,a,232,v,196
TR a,226,704
v_mul_f32 v25, v30, v25
M v,116,a,240,v,212
TR a,228,832
v_mul_f32 v26, v30, v26
M v,116,a,244,v,228
TR a,230,960
v_mul_f32 v27, v30, v27
M v,116,a,248,v,244
DL 7,76,93,1056
M v,120,a,232,v,200
TR a,232,50752
CV 58,24
M v,120,a,240,v,216
TR a,234,50880
CV 59,26
M v,120,a,244,v,232
TR a,240,51008
s_mov_b32 s94, 48234496
M v,120,a,248,v,248
s_waitcnt lgkmcnt(3)
TR a,242,51136
M v,96,a,212,v,140
TR a,244,51264
MU 64,28
M v,96,a,216,v,156
TR a,246,51392
MU 65,28
M v,96,a,224,v,172
TR a,248,51520
MU 66,28
M v,96,a,228,v,188
TR a,250,51648
MU 67,28
M v,100,a,212,a,12
DL 7,80,93,2112
M v,100,a,216,a,44
MU 80,28
MU 81,28
M v,100,a,224,a,76
MU 82,28
MU 83,28
M v,100,a,228,a,108
ST 56
M v,104,a,212,a,28
TR a,212,96
CV 32,64
M v,104,a,216,a,60
TR a,214,224
CV 33,66
M v,104,a,224,a,92
TR a,216,352
CV 34,80
M v,104,a,228,a,124
s_waitcnt lgkmcnt(3)
TR a,218,480
M v,96,a,232,v,204
TR a,224,608
CV 35,82
M v,96,a,240,v,220
TR a,226,736
s_mov_b32 s94, 50331648
M v,96,a,244,v,236
TR a,228,864
s_lshr_b32 s16, s19, 1
M v,96,a,248,v,252
TR a,230,992
s_lshl_b32 s16, s16, 20
M v,100,a,232,a,140
DL 7,84,93,3168
M v,100,a,240,a,172
s_add_u32 m0, s92, 98816
s_mov_b32 s93, 229888
M v,100,a,244,a,204
s_cmp_lt_u32 s19, 6
s_cselect_b32 s16, s16, 0x40000000
M v,100,a,248,a,236
s_sub_u32 s16, s16, s17
s_add_u32 s16, s16, 33554432
M v,104,a,232,a,156
TR a,232,50784
s_xor_b32 s25, s17, 1024
M v,104,a,240,a,188
TR a,234,50912
s_add_u32 s25, s25, s16
M v,104,a,244,a,220
TR a,240,51040
MU 68,29
M v,104,a,248,a,252
s_waitcnt lgkmcnt(3)
TR a,242,51168
M v,112,a,212,v,140
DL 7,72,93,0
M v,112,a,216,v,156
TR a,244,51296
MU 69,29
M v,112,a,224,v,172
TR a,246,51424
MU 70,29
M v,112,a,228,v,188
TR a,248,51552
MU 71,29
M v,116,a,212,a,12
TR a,250,51680
v_xor_b32 v2, 81920, v2
M v,116,a,216,a,44
CV 36,68
CV 37,70
M v,116,a,224,a,76
MU 72,30
MU 73,30
M v,116,a,228,a,108
ST 32
M v,120,a,212,a,28
MU 74,30
MU 75,30
M v,120,a,216,a,60
CV 40,72
CV 41,74
M v,120,a,224,a,92
DL 7,76,93,1056
M v,120,a,228,a,124
s_waitcnt lgkmcnt(0)
s_waitcnt vmcnt(16)
M v,112,a,232,v,204
s_barrier
TR a,212,16896
M v,112,a,240,v,220
TR a,214,17024
s_add_u32 s14, s25, 0
M v,112,a,244,v,236
TR a,216,17152
MU 84,29
M v,112,a,248,v,252
TR a,218,17280
MU 85,29
M v,116,a,232,a,140
TR a,224,17408
MU 86,29
M v,116,a,240,a,172
TR a,226,17536
s_waitcnt vmcnt(7)
M v,116,a,244,a,204
TR a,228,17664
TR a,230,17792
M v,116,a,248,a,236
v_cmp_gt_u32 vcc, 2, v5
MU 87,29
M v,120,a,232,a,156
s_cbranch_vccz L_sbB1
s_mov_b32 s18, 0x40000
L_sqB1:
buffer_load_dword v5, v1, s[88:91], s13 offen offset:0 sc1
s_waitcnt vmcnt(0)
v_cmp_gt_u32 vcc, 2, v5
s_sub_u32 s18, s18, 1
s_cbranch_scc1 L_sbB1
s_cbranch_vccnz L_sqB1
L_sbB1:
M v,120,a,240,a,188
buffer_load_dwordx4 a[64:67], v4, s[88:91], s14 offen sc1
M v,120,a,244,a,220
TR a,232,33792
CV 38,84
M v,120,a,248,a,252
s_waitcnt lgkmcnt(1)
TR a,234,33920
Z v,64,a,212,v,128
DL 7,80,93,2112
M v,64,a,216,v,144
TR a,240,34048
v_mov_b32 v6, 4
M v,64,a,224,v,160
TR a,242,34176
s_mov_b32 s42, 256
M v,64,a,228,v,176
TR a,244,34304
CV 39,86
Z v,68,a,212,v,132
TR a,246,34432
s_mov_b32 s94, 51380224
M v,68,a,216,v,148
TR a,248,34560
s_xor_b32 s27, s17, 3072
M v,68,a,224,v,164
TR a,250,34688
s_add_u32 s27, s27, s16
M v,68,a,228,v,180
ST 36
Z v,72,a,212,v,136
s_waitcnt vmcnt(7)
s_add_u32 s15, s27, 0
M v,72,a,216,v,152
buffer_store_dword v6, v11, s[40:43], 0 offen offset:128 sc1
M v,72,a,224,v,168
TR a,212,16928
v_bfe_u32 v8, v4, 8, 2
M v,72,a,228,v,184
s_waitcnt lgkmcnt(1)
TR a,214,17056
M v,64,a,232,v,192
DL 7,84,93,3168
M v,64,a,240,v,208
TR a,216,17184
v_lshrrev_b32 v9, 14, s95
M v,64,a,244,v,224
buffer_load_dwordx4 a[68:71], v4, s[88:91], s15 offen sc1
M v,64,a,248,v,240
TR a,218,17312
v_add_lshl_u32 v8, v8, v9, 7
M v,68,a,232,v,196
TR a,224,17440
v_add_u32 v8, 4096, v8
M v,68,a,240,v,212
TR a,226,17568
v_mov_b32 v9, 0
M v,68,a,244,v,228
TR a,228,17696
TR a,230,17824
M v,68,a,248,v,244
s_getpc_b64 s[100:101]
s_and_b32 s100, s100, 0xfffff000
M v,72,a,232,v,200
s_add_u32 m0, s92, 115712
s_mov_b32 s93, 344576
M v,72,a,240,v,216
v_lshl_add_u64 v[8:9], v[8:9], 0, s[100:101]
s_xor_b32 s29, s17, 5120
M v,72,a,244,v,232
DL 7,72,93,0
M v,72,a,248,v,248
s_waitcnt lgkmcnt(0)
s_add_u32 s29, s29, s16
Z v,80,a,212,v,128
s_add_u32 s14, s29, 0
TR a,232,33824
M v,80,a,216,v,144
buffer_load_dwordx4 a[72:75], v4, s[88:91], s14 offen sc1
M v,80,a,224,v,160
TR a,234,33952
MU 88,30
M v,80,a,228,v,176
TR a,240,34080
MU 89,30
Z v,84,a,212,v,132
TR a,242,34208
MU 90,30
M v,84,a,216,v,148
TR a,244,34336
MU 91,30
M v,84,a,224,v,164
TR a,246,34464
TR a,248,34592
M v,84,a,228,v,180
TR a,250,34720
CV 42,88
CV 43,90
Z v,88,a,212,v,136
global_load_dword v10, v[8:9], off
M v,88,a,216,v,152
s_mov_b32 s94, 52428800
s_xor_b32 s31, s17, 7168
M v,88,a,224,v,168
s_add_u32 s31, s31, s16
s_add_u32 s15, s31, 0
M v,88,a,228,v,184
s_waitcnt lgkmcnt(0)
s_waitcnt vmcnt(12)
M v,80,a,232,v,192
DL 7,76,93,1056
M v,80,a,240,v,208
s_mov_b64 exec, 0
s_branch L_pad31
L_ret31:
s_mov_b64 exec, -1
s_barrier
TR a,212,0
M v,80,a,244,v,224
ST 40
M v,80,a,248,v,240
TR a,214,128
s_xor_b32 s24, s17, 0
M v,84,a,232,v,196
TR a,216,256
s_add_u32 s24, s24, s16
M v,84,a,240,v,212
TR a,218,384
MU 96,28
M v,84,a,244,v,228
TR a,224,512
TR a,226,640
M v,84,a,248,v,244
TR a,228,768
TR a,230,896
M v,88,a,232,v,200
buffer_load_dwordx4 a[80:83], v4, s[88:91], s15 offen sc1
M v,88,a,240,v,216
TR a,232,50688
s_add_u32 s14, s24, 4194304
M v,88,a,244,v,232
DL 7,80,93,2112
M v,88,a,248,v,248
s_waitcnt lgkmcnt(1)
TR a,234,50816
M v,64,a,212,v,140
TR a,240,50944
MU 97,28
M v,64,a,216,v,156
TR a,242,51072
MU 98,28
M v,64,a,224,v,172
TR a,244,51200
MU 99,28
M v,64,a,228,v,188
TR a,246,51328
MU 112,28
M v,68,a,212,a,12
TR a,248,51456
MU 113,28
M v,68,a,216,a,44
TR a,250,51584
MU 114,28
M v,68,a,224,a,76
buffer_load_dwordx4 a[84:87], v4, s[88:91], s14 offen sc1
M v,68,a,228,a,108
MU 115,28
CV 48,96
M v,72,a,212,a,28
CV 49,98
CV 50,112
M v,72,a,216,a,60
DL 7,84,93,3168
M v,72,a,224,a,92
CV 51,114
s_mov_b32 s94, 54525952
M v,72,a,228,a,124
s_waitcnt lgkmcnt(0)
TR a,212,32
M v,64,a,232,v,204
TR a,214,160
s_xor_b32 s26, s17, 2048
M v,64,a,240,v,220
TR a,216,288
s_add_u32 s26, s26, s16
M v,64,a,244,v,236
ST 48
M v,64,a,248,v,252
TR a,218,416
s_add_u32 s15, s26, 4194304
M v,68,a,232,a,140
TR a,224,544
s_add_u32 m0, s92, 81920
M v,68,a,240,a,172
TR a,226,672
s_mov_b32 s93, 512
M v,68,a,244,a,204
TR a,228,800
TR a,230,928
M v,68,a,248,a,236
buffer_load_dwordx4 a[88:91], v4, s[88:91], s15 offen sc1
M v,72,a,232,a,156
TR a,232,50720
s_xor_b32 s28, s17, 4096
M v,72,a,240,a,188
DL 7,72,93,0
M v,72,a,244,a,220
TR a,234,50848
s_add_u32 s28, s28, s16
M v,72,a,248,a,252
s_waitcnt lgkmcnt(2)
TR a,240,50976
M v,80,a,212,v,140
TR a,242,51104
s_add_u32 s14, s28, 4194304
M v,80,a,216,v,156
TR a,244,51232
MU 100,29
M v,80,a,224,v,172
TR a,246,51360
MU 101,29
M v,80,a,228,v,188
TR a,248,51488
MU 102,29
M v,84,a,212,a,12
TR a,250,51616
MU 103,29
M v,84,a,216,a,44
DL 7,76,93,1056
M v,84,a,224,a,76
MU 116,29
MU 117,29
M v,84,a,228,a,108
MU 118,29
MU 119,29
M v,88,a,212,a,28
buffer_load_dwordx4 a[96:99], v4, s[88:91], s14 offen sc1
M v,88,a,216,a,60
CV 52,100
CV 53,102
M v,88,a,224,a,92
CV 54,116
CV 55,118
M v,88,a,228,a,124
s_waitcnt lgkmcnt(0)
s_mov_b32 s94, 55574528
M v,80,a,232,v,204
TR a,212,16960
s_xor_b32 s30, s17, 6144
M v,80,a,240,v,220
TR a,214,17088
s_add_u32 s30, s30, s16
M v,80,a,244,v,236
ST 52
M v,80,a,248,v,252
TR a,216,17216
s_add_u32 s15, s30, 4194304
M v,84,a,232,a,140
TR a,218,17344
MU 104,30
M v,84,a,240,a,172
TR a,224,17472
MU 105,30
M v,84,a,244,a,204
TR a,226,17600
TR a,228,17728
M v,84,a,248,a,236
TR a,230,17856
MU 106,30
M v,88,a,232,a,156
DL 7,80,93,2112
M v,88,a,240,a,188
buffer_load_dword v5, v1, s[88:91], s13 offen offset:128 sc1
M v,88,a,244,a,220
buffer_load_dwordx4 a[100:103], v4, s[88:91], s15 offen sc1
M v,88,a,248,a,252
s_waitcnt lgkmcnt(0)
TR a,232,33856
Z v,96,a,212,v,128
TR a,234,33984
MU 107,30
M v,96,a,216,v,144
TR a,240,34112
CV 56,104
M v,96,a,224,v,160
TR a,242,34240
CV 57,106
M v,96,a,228,v,176
TR a,244,34368
MU 120,30
Z v,100,a,212,v,132
TR a,246,34496
MU 121,30
M v,100,a,216,v,148
TR a,248,34624
MU 122,30
M v,100,a,224,v,164
TR a,250,34752
MU 123,30
M v,100,a,228,v,180
DL 7,84,93,3168
Z v,104,a,212,v,136
CV 58,120
CV 59,122
M v,104,a,216,v,152
s_mov_b32 s94, 56623104
TR a,212,16992
M v,104,a,224,v,168
TR a,214,17120
s_add_u32 m0, s92, 132608
M v,104,a,228,v,184
s_waitcnt lgkmcnt(2)
TR a,216,17248
M v,96,a,232,v,192
TR a,218,17376
s_mov_b32 s93, 115200
M v,96,a,240,v,208
TR a,224,17504
v_lshrrev_b32 v20, 6, v11
M v,96,a,244,v,224
TR a,226,17632
v_bfe_u32 v21, v11, 4, 1
M v,96,a,248,v,240
TR a,228,17760
v_xor_b32 v20, v20, v21
M v,100,a,232,v,196
TR a,230,17888
v_and_b32 v21, 1, v20
M v,100,a,240,v,212
ST 56
M v,100,a,244,v,228
DL 7,72,93,0
M v,100,a,248,v,244
v_lshlrev_b32 v20, 1, v20
v_lshl_add_u32 v20, v21, 4, v20
M v,104,a,232,v,200
TR a,232,33888
v_bfe_u32 v21, v11, 5, 1
M v,104,a,240,v,216
TR a,234,34016
v_lshl_add_u32 v20, v21, 1, v20
M v,104,a,244,v,232
TR a,240,34144
v_bfe_u32 v21, v11, 3, 1
M v,104,a,248,v,248
s_waitcnt lgkmcnt(3)
TR a,242,34272
Z v,112,a,212,v,128
TR a,244,34400
v_add_u32 v20, v20, v21
M v,112,a,216,v,144
TR a,246,34528
v_and_b32 v21, 4, v11
M v,112,a,224,v,160
TR a,248,34656
v_lshlrev_b32 v21, 2, v21
M v,112,a,228,v,176
TR a,250,34784
v_mov_b32 v22, 0x3f80
Z v,116,a,212,v,132
DL 7,76,93,1056
M v,116,a,216,v,148
v_lshlrev_b32 v20, v20, 1
v_lshlrev_b32 v21, v21, v22
M v,116,a,224,v,164
MU 64,28
MU 65,28
M v,116,a,228,v,180
MU 66,28
MU 67,28
Z v,120,a,212,v,136
MU 80,28
MU 81,28
M v,120,a,216,v,152
MU 82,28
MU 83,28
M v,120,a,224,v,168
v_bfe_i32 v22, v20, 0, 1
CV 32,64
M v,120,a,228,v,184
s_waitcnt lgkmcnt(0)
s_barrier
M v,112,a,232,v,192
DL 7,80,93,2112
M v,112,a,240,v,208
CV 33,66
CV 34,80
M v,112,a,244,v,224
CV 35,82
s_mov_b32 s94, 58720256
M v,112,a,248,v,240
TR a,212,64
v_and_b32 v22, v22, v21
M v,116,a,232,v,196
TR a,214,192
AW 0,22
M v,116,a,240,v,212
ST 32
M v,116,a,244,v,228
TR a,216,320
v_bfe_i32 v22, v20, 1, 1
M v,116,a,248,v,244
v_and_b32 v22, v22, v21
AW 1,22
M v,120,a,232,v,200
v_bfe_i32 v22, v20, 2, 1
v_and_b32 v22, v22, v21
M v,120,a,240,v,216
AW 2,22
v_bfe_i32 v22, v20, 3, 1
M v,120,a,244,v,232
v_and_b32 v22, v22, v21
AW 3,22
M v,120,a,248,v,248
s_waitcnt vmcnt(6)
s_waitcnt vmcnt(6)
Z v,12,a,0,a,64
v_cmp_gt_u32 vcc, 4, v5
v_bfe_i32 v22, v20, 4, 1
M v,12,a,0,a,68
s_cbranch_vccz L_sbB2
s_mov_b32 s18, 0x40000
L_sqB2:
buffer_load_dword v5, v1, s[88:91], s13 offen offset:128 sc1
s_waitcnt vmcnt(0)
v_cmp_gt_u32 vcc, 4, v5
s_sub_u32 s18, s18, 1
s_cbranch_scc1 L_sbB2
s_cbranch_vccnz L_sqB2
L_sbB2:
M v,12,a,0,a,72
v_and_b32 v22, v22, v21
AW 4,22
M v,12,a,0,a,80
v_bfe_i32 v22, v20, 5, 1
v_and_b32 v22, v22, v21
M v,12,a,0,a,84
AW 5,22
v_bfe_i32 v22, v20, 6, 1
M v,12,a,0,a,88
v_and_b32 v22, v22, v21
AW 6,22
M v,12,a,0,a,96
DL 7,84,93,3168
M v,12,a,0,a,100
v_bfe_i32 v22, v20, 7, 1
v_and_b32 v22, v22, v21
s_add_u32 s14, s25, 8388608
AW 7,22
buffer_load_dwordx4 a[104:107], v4, s[88:91], s14 offen sc1
TR a,218,448
Z v,24,a,4,a,64
TR a,224,576
s_add_u32 m0, s92, 16896
M v,24,a,4,a,68
TR a,226,704
s_mov_b32 s93, 230016
M v,24,a,4,a,72
TR a,228,832
TR a,230,960
M v,24,a,4,a,80
v_mov_b32 v6, 6
s_mov_b32 s42, 384
M v,24,a,4,a,84
DL 7,72,93,0
M v,24,a,4,a,88
MU 68,29
MU 69,29
M v,24,a,4,a,96
s_waitcnt vmcnt(7)
MU 70,29
M v,24,a,4,a,100
s_waitcnt lgkmcnt(0)
MU 71,29
M v,96,a,212,v,140
buffer_store_dword v6, v11, s[40:43], 0 offen offset:256 sc1
M v,96,a,216,v,156
MU 84,29
MU 85,29
M v,96,a,224,v,172
MU 86,29
MU 87,29
M v,96,a,228,v,188
CV 36,68
CV 37,70
M v,100,a,212,a,12
CV 38,84
CV 39,86
M v,100,a,216,a,44
s_mov_b32 s94, 59768832
TR a,232,50752
M v,100,a,224,a,76
ST 36
M v,100,a,228,a,108
TR a,234,50880
TR a,240,51008
M v,104,a,212,a,28
TR a,242,51136
TR a,244,51264
M v,104,a,216,a,60
TR a,246,51392
TR a,248,51520
M v,104,a,224,a,92
TR a,250,51648
s_add_u32 s15, s27, 8388608
M v,104,a,228,a,124
buffer_load_dwordx4 a[112:115], v4, s[88:91], s15 offen sc1
DL 7,76,93,1056
TR a,212,96
TR a,214,224
TR a,216,352
TR a,218,480
TR a,224,608
TR a,226,736
TR a,228,864
TR a,230,992
s_mov_b64 s[8:9], s[6:7]
s_cmp_lt_u32 s19, 6
s_cselect_b32 s10, 27712, 0
s_mov_b32 s11, 0x20000
CV 20,12
CV 21,14
CV 22,24
CV 23,26
s_add_u32 s14, s29, 8388608
buffer_store_dwordx4 v[20:23], v3, s[8:11], 0 offen offset:0 sc1
s_waitcnt lgkmcnt(8)
M v,96,a,232,v,204
MU 72,30
MU 73,30
M v,96,a,240,v,220
MU 74,30
MU 75,30
M v,96,a,244,v,236
MU 88,30
MU 89,30
M v,96,a,248,v,252
buffer_load_dwordx4 a[116:119], v4, s[88:91], s14 offen sc1
M v,100,a,232,a,140
MU 90,30
MU 91,30
M v,100,a,240,a,172
CV 40,72
CV 41,74
M v,100,a,244,a,204
DL 7,80,93,2112
M v,100,a,248,a,236
CV 42,88
CV 43,90
M v,104,a,232,a,156
s_mov_b32 s94, 60817408
TR a,232,50784
M v,104,a,240,a,188
TR a,234,50912
MU 96,28
M v,104,a,244,a,220
TR a,240,51040
MU 97,28
M v,104,a,248,a,252
s_waitcnt lgkmcnt(3)
TR a,242,51168
M v,112,a,212,v,140
TR a,244,51296
s_add_u32 s15, s31, 8388608
M v,112,a,216,v,156
TR a,246,51424
MU 98,28
M v,112,a,224,v,172
TR a,248,51552
MU 99,28
M v,112,a,228,v,188
ST 40
M v,116,a,212,a,12
TR a,250,51680
v_xor_b32 v2, 81920, v2
M v,116,a,216,a,44
CV 48,96
CV 49,98
M v,116,a,224,a,76
DL 7,84,93,3168
M v,116,a,228,a,108
s_add_u32 m0, s92, 33792
s_mov_b32 s93, 344704
M v,120,a,212,a,28
s_mov_b32 s94, 62914560
MU 100,29
M v,120,a,216,a,60
buffer_load_dwordx4 a[120:123], v4, s[88:91], s15 offen sc1
M v,120,a,224,a,92
MU 101,29
MU 102,29
M v,120,a,228,a,124
s_waitcnt lgkmcnt(0)
s_waitcnt vmcnt(17)
M v,112,a,232,v,204
s_mov_b64 exec, 0
s_branch L_pad32
L_ret32:
s_mov_b64 exec, -1
s_barrier
TR a,212,16896
M v,112,a,240,v,220
TR a,214,17024
MU 103,29
M v,112,a,244,v,236
TR a,216,17152
CV 52,100
M v,112,a,248,v,252
TR a,218,17280
s_add_u32 s14, s24, 12582912
M v,116,a,232,a,140
TR a,224,17408
CV 53,102
M v,116,a,240,a,172
TR a,226,17536
MU 104,30
M v,116,a,244,a,204
TR a,228,17664
TR a,230,17792
M v,116,a,248,a,236
DL 7,72,93,0
M v,120,a,232,a,156
MU 112,28
MU 113,28
M v,120,a,240,a,188
MU 114,28
MU 115,28
M v,120,a,244,a,220
buffer_load_dwordx4 a[128:131], v4, s[88:91], s14 offen sc1
M v,120,a,248,a,252
s_waitcnt lgkmcnt(0)
CV 50,112
Z v,64,a,212,v,128
TR a,232,33792
CV 51,114
M v,64,a,216,v,144
TR a,234,33920
MU 116,29
M v,64,a,224,v,160
TR a,240,34048
MU 117,29
M v,64,a,228,v,176
TR a,242,34176
MU 118,29
Z v,68,a,212,v,132
TR a,244,34304
MU 119,29
M v,68,a,216,v,148
TR a,246,34432
s_add_u32 s15, s26, 12582912
M v,68,a,224,v,164
TR a,248,34560
TR a,250,34688
M v,68,a,228,v,180
ST 48
Z v,72,a,212,v,136
DL 7,76,93,1056
M v,72,a,216,v,152
TR a,212,16928
CV 54,116
M v,72,a,224,v,168
TR a,214,17056
CV 55,118
M v,72,a,228,v,184
s_waitcnt lgkmcnt(2)
TR a,216,17184
M v,64,a,232,v,192
TR a,218,17312
s_mov_b32 s94, 63963136
M v,64,a,240,v,208
TR a,224,17440
MU 105,30
M v,64,a,244,v,224
TR a,226,17568
MU 106,30
M v,64,a,248,v,240
TR a,228,17696
MU 107,30
M v,68,a,232,v,196
TR a,230,17824
MU 120,30
M v,68,a,240,v,212
buffer_load_dwordx4 a[132:135], v4, s[88:91], s15 offen sc1
M v,68,a,244,v,228
DL 7,80,93,2112
M v,68,a,248,v,244
MU 121,30
MU 122,30
M v,72,a,232,v,200
TR a,232,33824
s_add_u32 s14, s28, 12582912
M v,72,a,240,v,216
TR a,234,33952
MU 123,30
M v,72,a,244,v,232
TR a,240,34080
CV 56,104
M v,72,a,248,v,248
s_waitcnt lgkmcnt(3)
TR a,242,34208
Z v,80,a,212,v,128
TR a,244,34336
CV 57,106
M v,80,a,216,v,144
TR a,246,34464
CV 58,120
M v,80,a,224,v,160
TR a,248,34592
CV 59,122
M v,80,a,228,v,176
TR a,250,34720
Z v,84,a,212,v,132
DL 7,84,93,3168
M v,84,a,216,v,148
ST 52
M v,84,a,224,v,164
s_add_u32 m0, s92, 0
s_mov_b32 s93, 640
M v,84,a,228,v,180
buffer_load_dwordx4 a[136:139], v4, s[88:91], s14 offen sc1
Z v,88,a,212,v,136
s_mov_b32 s94, 65011712
M v,88,a,216,v,152
M v,88,a,224,v,168
buffer_load_dword v5, v1, s[88:91], s13 offen offset:256 sc1
M v,88,a,228,v,184
s_waitcnt lgkmcnt(0)
s_waitcnt vmcnt(22)
M v,80,a,232,v,192
s_barrier
TR a,212,0
M v,80,a,240,v,208
TR a,214,128
s_add_u32 s15, s30, 12582912
M v,80,a,244,v,224
DL 7,72,93,0
M v,80,a,248,v,240
TR a,216,256
M v,84,a,232,v,196
TR a,218,384
M v,84,a,240,v,212
TR a,224,512
M v,84,a,244,v,228
TR a,226,640
TR a,228,768
M v,84,a,248,v,244
TR a,230,896
M v,88,a,232,v,200
buffer_load_dwordx4 a[144:147], v4, s[88:91], s15 offen sc1
M v,88,a,240,v,216
TR a,232,50688
M v,88,a,244,v,232
TR a,234,50816
M v,88,a,248,v,248
s_waitcnt lgkmcnt(2)
TR a,240,50944
M v,64,a,212,v,140
DL 7,76,93,1056
M v,64,a,216,v,156
TR a,242,51072
M v,64,a,224,v,172
TR a,244,51200
M v,64,a,228,v,188
TR a,246,51328
M v,68,a,212,a,12
TR a,248,51456
M v,68,a,216,a,44
TR a,250,51584
M v,68,a,224,a,76
ST 56
M v,68,a,228,a,108
s_mov_b32 s94, 67108864
M v,72,a,212,a,28
TR a,212,32
M v,72,a,216,a,60
TR a,214,160
M v,72,a,224,a,92
TR a,216,288
M v,72,a,228,a,124
s_waitcnt lgkmcnt(3)
TR a,218,416
M v,64,a,232,v,204
DL 7,80,93,2112
M v,64,a,240,v,220
TR a,224,544
M v,64,a,244,v,236
TR a,226,672
M v,64,a,248,v,252
TR a,228,800
M v,68,a,232,a,140
TR a,230,928
M v,68,a,240,a,172
M v,68,a,244,a,204
M v,68,a,248,a,236
M v,72,a,232,a,156
TR a,232,50720
MU 64,28
M v,72,a,240,a,188
TR a,234,50848
MU 65,28
M v,72,a,244,a,220
TR a,240,50976
MU 66,28
M v,72,a,248,a,252
s_waitcnt lgkmcnt(3)
TR a,242,51104
M v,80,a,212,v,140
DL 7,84,93,3168
M v,80,a,216,v,156
TR a,244,51232
s_add_u32 m0, s92, 50688
M v,80,a,224,v,172
TR a,246,51360
s_mov_b32 s93, 115328
M v,80,a,228,v,188
TR a,248,51488
MU 67,28
M v,84,a,212,a,12
TR a,250,51616
CV 32,64
M v,84,a,216,a,44
CV 33,66
MU 68,29
M v,84,a,224,a,76
MU 69,29
MU 70,29
M v,84,a,228,a,108
MU 71,29
CV 36,68
M v,88,a,212,a,28
TR a,212,16960
CV 37,70
M v,88,a,216,a,60
s_add_u32 s14, s25, 16777216
TR a,214,17088
M v,88,a,224,a,92
DL 7,72,93,0
M v,88,a,228,a,124
s_waitcnt lgkmcnt(2)
TR a,216,17216
M v,80,a,232,v,204
TR a,218,17344
MU 72,30
M v,80,a,240,v,220
s_waitcnt vmcnt(7)
v_cmp_gt_u32 vcc, 6, v5
M v,80,a,244,v,236
s_cbranch_vccz L_sbB3
s_mov_b32 s18, 0x40000
L_sqB3:
buffer_load_dword v5, v1, s[88:91], s13 offen offset:256 sc1
s_waitcnt vmcnt(0)
v_cmp_gt_u32 vcc, 6, v5
s_sub_u32 s18, s18, 1
s_cbranch_scc1 L_sbB3
s_cbranch_vccnz L_sqB3
L_sbB3:
M v,80,a,248,v,252
buffer_load_dwordx4 a[64:67], v4, s[88:91], s14 offen sc1
M v,84,a,232,a,140
TR a,224,17472
MU 73,30
M v,84,a,240,a,172
TR a,226,17600
MU 74,30
M v,84,a,244,a,204
MU 80,28
MU 81,28
M v,84,a,248,a,236
MU 82,28
MU 83,28
M v,88,a,232,a,156
CV 34,80
CV 35,82
M v,88,a,240,a,188
ST 32
M v,88,a,244,a,220
v_mov_b32 v6, 8
s_mov_b32 s42, 512
M v,88,a,248,a,252
s_waitcnt vmcnt(7)
TR a,228,17728
Z v,12,a,0,a,104
DL 7,76,93,1056
M v,12,a,0,a,112
TR a,230,17856
MU 84,29
M v,12,a,0,a,116
s_add_u32 s15, s27, 16777216
TR a,232,33856
M v,12,a,0,a,120
TR a,234,33984
MU 85,29
M v,12,a,0,a,128
s_waitcnt vmcnt(6)
TR a,240,34112
M v,12,a,0,a,132
buffer_store_dword v6, v11, s[40:43], 0 offen offset:384 sc1
M v,12,a,0,a,136
TR a,242,34240
MU 86,29
M v,12,a,0,a,144
TR a,244,34368
MU 87,29
Z v,24,a,4,a,104
DL 7,80,93,2112
M v,24,a,4,a,112
TR a,246,34496
CV 38,84
M v,24,a,4,a,116
TR a,248,34624
CV 39,86
M v,24,a,4,a,120
buffer_load_dwordx4 a[68:71], v4, s[88:91], s15 offen sc1
M v,24,a,4,a,128
TR a,250,34752
s_mov_b32 s94, 68157440
M v,24,a,4,a,132
CV 20,12
CV 21,14
M v,24,a,4,a,136
MU 75,30
MU 88,30
M v,24,a,4,a,144
s_waitcnt lgkmcnt(8)
MU 89,30
Z v,96,a,212,v,128
MU 90,30
MU 91,30
M v,96,a,216,v,144
CV 40,72
CV 41,74
M v,96,a,224,v,160
s_add_u32 s14, s29, 16777216
CV 22,24
M v,96,a,228,v,176
CV 23,26
CV 42,88
Z v,100,a,212,v,132
DL 7,84,93,3168
M v,100,a,216,v,148
CV 43,90
M v,100,a,224,v,164
M v,100,a,228,v,180
ST 36
Z v,104,a,212,v,136
TR a,212,16992
s_mov_b32 s94, 69206016
M v,104,a,216,v,152
TR a,214,17120
M v,104,a,224,v,168
buffer_load_dwordx4 a[72:75], v4, s[88:91], s14 offen sc1
M v,104,a,228,v,184
s_waitcnt lgkmcnt(2)
TR a,216,17248
M v,96,a,232,v,192
TR a,218,17376
M v,96,a,240,v,208
TR a,224,17504
M v,96,a,244,v,224
TR a,226,17632
M v,96,a,248,v,240
TR a,228,17760
M v,100,a,232,v,196
TR a,230,17888
M v,100,a,240,v,212
buffer_store_dwordx4 v[20:23], v3, s[8:11], 0 offen offset:128 sc1
M v,100,a,244,v,228
s_add_u32 s15, s31, 16777216
M v,100,a,248,v,244
M v,104,a,232,v,200
TR a,232,33888
M v,104,a,240,v,216
TR a,234,34016
M v,104,a,244,v,232
TR a,240,34144
M v,104,a,248,v,248
s_waitcnt lgkmcnt(3)
TR a,242,34272
Z v,112,a,212,v,128
buffer_load_dwordx4 a[80:83], v4, s[88:91], s15 offen sc1
M v,112,a,216,v,144
TR a,244,34400
M v,112,a,224,v,160
TR a,246,34528
M v,112,a,228,v,176
TR a,248,34656
Z v,116,a,212,v,132
TR a,250,34784
M v,116,a,216,v,148
M v,116,a,224,v,164
M v,116,a,228,v,180
Z v,120,a,212,v,136
TR a,212,64
M v,120,a,216,v,152
ST 40
M v,120,a,224,v,168
TR a,214,192
s_add_u32 s14, s24, 20971520
M v,120,a,228,v,184
s_waitcnt lgkmcnt(2)
s_barrier
M v,112,a,232,v,192
TR a,216,320
s_add_u32 m0, s92, 98816
M v,112,a,240,v,208
TR a,218,448
s_mov_b32 s93, 230144
M v,112,a,244,v,224
TR a,224,576
s_mov_b32 s94, 71303168
M v,112,a,248,v,240
TR a,226,704
M v,116,a,232,v,196
TR a,228,832
M v,116,a,240,v,212
TR a,230,960
M v,116,a,244,v,228
buffer_load_dwordx4 a[84:87], v4, s[88:91], s14 offen sc1
M v,116,a,248,v,244
M v,120,a,232,v,200
TR a,232,50752
M v,120,a,240,v,216
TR a,234,50880
M v,120,a,244,v,232
TR a,240,51008
M v,120,a,248,v,248
s_waitcnt lgkmcnt(3)
TR a,242,51136
M v,96,a,212,v,140
DL 7,72,93,0
M v,96,a,216,v,156
TR a,244,51264
M v,96,a,224,v,172
TR a,246,51392
M v,96,a,228,v,188
TR a,248,51520
s_add_u32 s15, s26, 20971520
M v,100,a,212,a,12
TR a,250,51648
M v,100,a,216,a,44
M v,100,a,224,a,76
M v,100,a,228,a,108
M v,104,a,212,a,28
TR a,212,96
M v,104,a,216,a,60
buffer_load_dwordx4 a[88:91], v4, s[88:91], s15 offen sc1
M v,104,a,224,a,92
TR a,214,224
v_bfe_u32 v8, v4, 8, 2
M v,104,a,228,a,124
s_waitcnt lgkmcnt(2)
TR a,216,352
M v,96,a,232,v,204
DL 7,76,93,1056
M v,96,a,240,v,220
TR a,218,480
v_lshrrev_b32 v9, 14, s95
M v,96,a,244,v,236
TR a,224,608
v_add_lshl_u32 v8, v8, v9, 7
M v,96,a,248,v,252
TR a,226,736
v_add_u32 v8, 4096, v8
M v,100,a,232,a,140
TR a,228,864
v_mov_b32 v9, 0
M v,100,a,240,a,172
TR a,230,992
M v,100,a,244,a,204
s_getpc_b64 s[100:101]
s_and_b32 s100, s100, 0xfffff000
M v,100,a,248,a,236
v_lshl_add_u64 v[8:9], v[8:9], 0, s[100:101]
s_add_u32 s14, s28, 20971520
M v,104,a,232,a,156
TR a,232,50784
MU 96,28
M v,104,a,240,a,188
DL 7,80,93,2112
M v,104,a,244,a,220
TR a,234,50912
MU 97,28
M v,104,a,248,a,252
s_waitcnt lgkmcnt(2)
TR a,240,51040
M v,112,a,212,v,140
buffer_load_dword v5, v1, s[88:91], s13 offen offset:384 sc1
M v,112,a,216,v,156
TR a,242,51168
MU 98,28
M v,112,a,224,v,172
TR a,244,51296
MU 99,28
M v,112,a,228,v,188
TR a,246,51424
CV 48,96
M v,116,a,212,a,12
TR a,248,51552
CV 49,98
M v,116,a,216,a,44
TR a,250,51680
v_xor_b32 v2, 81920, v2
M v,116,a,224,a,76
buffer_load_dwordx4 a[96:99], v4, s[88:91], s14 offen sc1
M v,116,a,228,a,108
global_load_dword v10, v[8:9], off
M v,120,a,212,a,28
MU 100,29
MU 101,29
M v,120,a,216,a,60
MU 102,29
MU 103,29
M v,120,a,224,a,92
DL 7,84,93,3168
M v,120,a,228,a,124
s_waitcnt lgkmcnt(0)
s_waitcnt vmcnt(24)
M v,112,a,232,v,204
s_mov_b64 exec, 0
s_branch L_pad33
L_ret33:
s_mov_b64 exec, -1
s_barrier
TR a,212,16896
M v,112,a,240,v,220
TR a,214,17024
s_add_u32 s15, s30, 20971520
M v,112,a,244,v,236
TR a,216,17152
s_add_u32 m0, s92, 115712
M v,112,a,248,v,252
TR a,218,17280
s_mov_b32 s93, 344832
M v,116,a,232,a,140
TR a,224,17408
CV 52,100
M v,116,a,240,a,172
TR a,226,17536
CV 53,102
M v,116,a,244,a,204
TR a,228,17664
TR a,230,17792
M v,116,a,248,a,236
MU 112,28
MU 113,28
M v,120,a,232,a,156
MU 114,28
MU 115,28
M v,120,a,240,a,188
buffer_load_dwordx4 a[100:103], v4, s[88:91], s15 offen sc1
M v,120,a,244,a,220
CV 50,112
CV 51,114
M v,120,a,248,a,252
s_waitcnt lgkmcnt(0)
TR a,232,33792
Z v,64,a,212,v,128
ST 48
M v,64,a,216,v,144
DL 7,72,93,0
M v,64,a,224,v,160
TR a,234,33920
MU 116,29
M v,64,a,228,v,176
TR a,240,34048
MU 117,29
Z v,68,a,212,v,132
TR a,242,34176
MU 118,29
M v,68,a,216,v,148
TR a,244,34304
MU 119,29
M v,68,a,224,v,164
TR a,246,34432
TR a,248,34560
M v,68,a,228,v,180
TR a,250,34688
CV 54,116
Z v,72,a,212,v,136
DL 7,76,93,1056
M v,72,a,216,v,152
TR a,212,16928
CV 55,118
M v,72,a,224,v,168
TR a,214,17056
s_mov_b32 s94, 72351744
M v,72,a,228,v,184
s_waitcnt lgkmcnt(2)
TR a,216,17184
M v,64,a,232,v,192
TR a,218,17312
MU 104,30
M v,64,a,240,v,208
TR a,224,17440
MU 105,30
M v,64,a,244,v,224
TR a,226,17568
MU 106,30
M v,64,a,248,v,240
TR a,228,17696
MU 107,30
M v,68,a,232,v,196
TR a,230,17824
MU 120,30
M v,68,a,240,v,212
MU 121,30
MU 122,30
M v,68,a,244,v,228
DL 7,80,93,2112
M v,68,a,248,v,244
MU 123,30
CV 56,104
M v,72,a,232,v,200
TR a,232,33824
CV 57,106
M v,72,a,240,v,216
TR a,234,33952
CV 58,120
M v,72,a,244,v,232
TR a,240,34080
CV 59,122
M v,72,a,248,v,248
s_waitcnt lgkmcnt(3)
TR a,242,34208
Z v,80,a,212,v,128
ST 52
M v,80,a,216,v,144
TR a,244,34336
s_add_u32 s14, s25, 25165824
M v,80,a,224,v,160
TR a,246,34464
s_mov_b32 s94, 73400320
M v,80,a,228,v,176
s_waitcnt vmcnt(9)
v_cmp_gt_u32 vcc, 8, v5
Z v,84,a,212,v,132
TR a,248,34592
M v,84,a,216,v,148
TR a,250,34720
M v,84,a,224,v,164
s_cbranch_vccz L_sbB4
s_mov_b32 s18, 0x40000
L_sqB4:
buffer_load_dword v5, v1, s[88:91], s13 offen offset:384 sc1
s_waitcnt vmcnt(0)
v_cmp_gt_u32 vcc, 8, v5
s_sub_u32 s18, s18, 1
s_cbranch_scc1 L_sbB4
s_cbranch_vccnz L_sqB4
L_sbB4:
M v,84,a,228,v,180
DL 7,84,93,3168
Z v,88,a,212,v,136
s_add_u32 m0, s92, 81920
s_mov_b32 s93, 768
M v,88,a,216,v,152
M v,88,a,224,v,168
buffer_load_dwordx4 a[104:107], v4, s[88:91], s14 offen sc1
M v,88,a,228,v,184
s_waitcnt lgkmcnt(0)
s_waitcnt vmcnt(11)
M v,80,a,232,v,192
s_mov_b64 exec, 0
s_branch L_pad34
L_ret34:
s_mov_b64 exec, -1
s_barrier
TR a,212,0
M v,80,a,240,v,208
TR a,214,128
M v,80,a,244,v,224
TR a,216,256
M v,80,a,248,v,240
TR a,218,384
M v,84,a,232,v,196
TR a,224,512
M v,84,a,240,v,212
DL 7,72,93,0
M v,84,a,244,v,228
s_add_u32 s15, s27, 25165824
TR a,226,640
M v,84,a,248,v,244
TR a,228,768
M v,88,a,232,v,200
TR a,230,896
M v,88,a,240,v,216
TR a,232,50688
M v,88,a,244,v,232
TR a,234,50816
M v,88,a,248,v,248
s_waitcnt vmcnt(8)
TR a,240,50944
Z v,12,a,0,a,64
ST 56
M v,12,a,0,a,68
TR a,242,51072
s_mov_b32 s94, 75497472
M v,12,a,0,a,72
TR a,244,51200
M v,12,a,0,a,80
buffer_load_dwordx4 a[112:115], v4, s[88:91], s15 offen sc1
M v,12,a,0,a,84
TR a,246,51328
M v,12,a,0,a,88
TR a,248,51456
M v,12,a,0,a,96
DL 7,76,93,1056
M v,12,a,0,a,100
TR a,250,51584
Z v,24,a,4,a,64
M v,24,a,4,a,68
M v,24,a,4,a,72
M v,24,a,4,a,80
s_add_u32 s14, s29, 25165824
M v,24,a,4,a,84
M v,24,a,4,a,88
CV 20,12
CV 21,14
M v,24,a,4,a,96
M v,24,a,4,a,100
s_waitcnt lgkmcnt(8)
M v,64,a,212,v,140
DL 7,80,93,2112
M v,64,a,216,v,156
M v,64,a,224,v,172
M v,64,a,228,v,188
buffer_load_dwordx4 a[116:119], v4, s[88:91], s14 offen sc1
M v,68,a,212,a,12
CV 22,24
CV 23,26
M v,68,a,216,a,44
M v,68,a,224,a,76
buffer_store_dwordx4 v[20:23], v3, s[8:11], 0 offen offset:256 sc1
M v,68,a,228,a,108
M v,72,a,212,a,28
TR a,212,32
M v,72,a,216,a,60
TR a,214,160
M v,72,a,224,a,92
DL 7,84,93,3168
M v,72,a,228,a,124
s_waitcnt lgkmcnt(2)
TR a,216,288
M v,64,a,232,v,204
TR a,218,416
s_add_u32 s15, s31, 25165824
M v,64,a,240,v,220
TR a,224,544
s_add_u32 m0, s92, 132608
M v,64,a,244,v,236
TR a,226,672
s_mov_b32 s93, 115456
M v,64,a,248,v,252
TR a,228,800
M v,68,a,232,a,140
TR a,230,928
M v,68,a,240,a,172
M v,68,a,244,a,204
buffer_load_dwordx4 a[120:123], v4, s[88:91], s15 offen sc1
M v,68,a,248,a,236
M v,72,a,232,a,156
TR a,232,50720
MU 64,28
M v,72,a,240,a,188
TR a,234,50848
MU 65,28
M v,72,a,244,a,220
DL 7,72,93,0
M v,72,a,248,a,252
s_waitcnt lgkmcnt(2)
TR a,240,50976
M v,80,a,212,v,140
TR a,242,51104
v_mov_b32 v6, 10
M v,80,a,216,v,156
TR a,244,51232
s_mov_b32 s42, 640
M v,80,a,224,v,172
TR a,246,51360
MU 66,28
M v,80,a,228,v,188
TR a,248,51488
MU 67,28
M v,84,a,212,a,12
TR a,250,51616
CV 32,64
M v,84,a,216,a,44
CV 33,66
MU 68,29
M v,84,a,224,a,76
s_add_u32 s14, s24, 29360128
MU 69,29
M v,84,a,228,a,108
s_waitcnt vmcnt(8)
MU 70,29
M v,88,a,212,a,28
buffer_store_dword v6, v11, s[40:43], 0 offen offset:512 sc1
M v,88,a,216,a,60
TR a,212,16960
MU 71,29
M v,88,a,224,a,92
TR a,214,17088
CV 36,68
M v,88,a,228,a,124
s_waitcnt lgkmcnt(2)
TR a,216,17216
M v,80,a,232,v,204
DL 7,76,93,1056
M v,80,a,240,v,220
TR a,218,17344
CV 37,70
M v,80,a,244,v,236
TR a,224,17472
MU 72,30
M v,80,a,248,v,252
TR a,226,17600
MU 73,30
M v,84,a,232,a,140
TR a,228,17728
MU 74,30
M v,84,a,240,a,172
TR a,230,17856
MU 75,30
M v,84,a,244,a,204
buffer_load_dwordx4 a[128:131], v4, s[88:91], s14 offen sc1
M v,84,a,248,a,236
MU 80,28
MU 81,28
M v,88,a,232,a,156
MU 82,28
MU 83,28
M v,88,a,240,a,188
CV 34,80
CV 35,82
M v,88,a,244,a,220
ST 32
M v,88,a,248,a,252
s_waitcnt lgkmcnt(0)
TR a,232,33856
Z v,96,a,212,v,128
DL 7,80,93,2112
M v,96,a,216,v,144
TR a,234,33984
s_add_u32 s15, s26, 29360128
M v,96,a,224,v,160
TR a,240,34112
MU 84,29
M v,96,a,228,v,176
TR a,242,34240
MU 85,29
Z v,100,a,212,v,132
TR a,244,34368
MU 86,29
M v,100,a,216,v,148
TR a,246,34496
MU 87,29
M v,100,a,224,v,164
TR a,248,34624
TR a,250,34752
M v,100,a,228,v,180
buffer_load_dwordx4 a[132:135], v4, s[88:91], s15 offen sc1
Z v,104,a,212,v,136
TR a,212,16992
CV 38,84
M v,104,a,216,v,152
TR a,214,17120
CV 39,86
M v,104,a,224,v,168
DL 7,84,93,3168
M v,104,a,228,v,184
s_waitcnt lgkmcnt(2)
TR a,216,17248
M v,96,a,232,v,192
TR a,218,17376
s_mov_b32 s94, 76546048
M v,96,a,240,v,208
TR a,224,17504
MU 88,30
M v,96,a,244,v,224
TR a,226,17632
MU 89,30
M v,96,a,248,v,240
TR a,228,17760
MU 90,30
M v,100,a,232,v,196
TR a,230,17888
MU 91,30
M v,100,a,240,v,212
s_add_u32 s14, s28, 29360128
CV 40,72
M v,100,a,244,v,228
CV 41,74
CV 42,88
M v,100,a,248,v,244
CV 43,90
M v,104,a,232,v,200
TR a,232,33888
M v,104,a,240,v,216
TR a,234,34016
M v,104,a,244,v,232
ST 36
M v,104,a,248,v,248
s_waitcnt lgkmcnt(2)
TR a,240,34144
Z v,112,a,212,v,128
TR a,242,34272
s_mov_b32 s94, 77594624
M v,112,a,216,v,144
buffer_load_dwordx4 a[136:139], v4, s[88:91], s14 offen sc1
M v,112,a,224,v,160
TR a,244,34400
M v,112,a,228,v,176
TR a,246,34528
Z v,116,a,212,v,132
TR a,248,34656
M v,116,a,216,v,148
TR a,250,34784
M v,116,a,224,v,164
M v,116,a,228,v,180
Z v,120,a,212,v,136
TR a,212,64
M v,120,a,216,v,152
TR a,214,192
M v,120,a,224,v,168
TR a,216,320
M v,120,a,228,v,184
s_waitcnt lgkmcnt(3)
TR a,218,448
M v,112,a,232,v,192
TR a,224,576
s_add_u32 s15, s30, 29360128
M v,112,a,240,v,208
TR a,226,704
M v,112,a,244,v,224
TR a,228,832
M v,112,a,248,v,240
TR a,230,960
M v,116,a,232,v,196
M v,116,a,240,v,212
buffer_load_dwordx4 a[144:147], v4, s[88:91], s15 offen sc1
M v,116,a,244,v,228
M v,116,a,248,v,244
M v,120,a,232,v,200
TR a,232,50752
M v,120,a,240,v,216
TR a,234,50880
M v,120,a,244,v,232
ST 40
M v,120,a,248,v,248
s_waitcnt lgkmcnt(2)
TR a,240,51008
M v,96,a,212,v,140
TR a,242,51136
s_mov_b32 s94, 79691776
M v,96,a,216,v,156
TR a,244,51264
M v,96,a,224,v,172
TR a,246,51392
M v,96,a,228,v,188
TR a,248,51520
M v,100,a,212,a,12
TR a,250,51648
M v,100,a,216,a,44
M v,100,a,224,a,76
M v,100,a,228,a,108
M v,104,a,212,a,28
TR a,212,96
M v,104,a,216,a,60
TR a,214,224
M v,104,a,224,a,92
TR a,216,352
M v,104,a,228,a,124
s_waitcnt lgkmcnt(3)
TR a,218,480
M v,96,a,232,v,204
TR a,224,608
M v,96,a,240,v,220
TR a,226,736
M v,96,a,244,v,236
TR a,228,864
M v,96,a,248,v,252
TR a,230,992
M v,100,a,232,a,140
M v,100,a,240,a,172
M v,100,a,244,a,204
buffer_load_dword v5, v1, s[88:91], s13 offen offset:512 sc1
M v,100,a,248,a,236
M v,104,a,232,a,156
TR a,232,50784
MU 96,28
M v,104,a,240,a,188
TR a,234,50912
MU 97,28
M v,104,a,244,a,220
TR a,240,51040
MU 98,28
M v,104,a,248,a,252
s_waitcnt lgkmcnt(3)
TR a,242,51168
M v,112,a,212,v,140
TR a,244,51296
MU 99,28
M v,112,a,216,v,156
TR a,246,51424
CV 48,96
M v,112,a,224,v,172
TR a,248,51552
CV 49,98
M v,112,a,228,v,188
TR a,250,51680
v_xor_b32 v2, 81920, v2
M v,116,a,212,a,12
MU 100,29
MU 101,29
M v,116,a,216,a,44
MU 102,29
MU 103,29
M v,116,a,224,a,76
CV 52,100
CV 53,102
M v,116,a,228,a,108
MU 104,30
MU 105,30
M v,120,a,212,a,28
MU 106,30
MU 107,30
M v,120,a,216,a,60
CV 56,104
CV 57,106
M v,120,a,224,a,92
M v,120,a,228,a,124
s_waitcnt lgkmcnt(0)
s_waitcnt vmcnt(20)
M v,112,a,232,v,204
s_barrier
TR a,212,16896
M v,112,a,240,v,220
TR a,214,17024
M v,112,a,244,v,236
TR a,216,17152
M v,112,a,248,v,252
TR a,218,17280
M v,116,a,232,a,140
TR a,224,17408
M v,116,a,240,a,172
TR a,226,17536
M v,116,a,244,a,204
TR a,228,17664
M v,116,a,248,a,236
MU 112,28
MU 113,28
M v,120,a,232,a,156
MU 114,28
MU 115,28
M v,120,a,240,a,188
CV 50,112
CV 51,114
M v,120,a,244,a,220
ST 48
M v,120,a,248,a,252
s_waitcnt vmcnt(3)
TR a,230,17792
Z v,12,a,0,a,104
MU 116,29
MU 117,29
M v,12,a,0,a,112
MU 118,29
MU 119,29
M v,12,a,0,a,116
CV 54,116
CV 55,118
M v,12,a,0,a,120
s_mov_b32 s94, 80740352
TR a,232,33792
M v,12,a,0,a,128
TR a,234,33920
MU 120,30
M v,12,a,0,a,132
TR a,240,34048
MU 121,30
M v,12,a,0,a,136
TR a,242,34176
MU 122,30
M v,12,a,0,a,144
TR a,244,34304
MU 123,30
Z v,24,a,4,a,104
TR a,246,34432
CV 58,120
M v,24,a,4,a,112
TR a,248,34560
CV 59,122
M v,24,a,4,a,116
TR a,250,34688
CV 20,12
M v,24,a,4,a,120
CV 21,14
M v,24,a,4,a,128
M v,24,a,4,a,132
ST 52
M v,24,a,4,a,136
s_mov_b32 s94, 81788928
M v,24,a,4,a,144
s_waitcnt lgkmcnt(8)
Z v,64,a,212,v,128
M v,64,a,216,v,144
M v,64,a,224,v,160
s_add_u32 s14, s25, 33554432
M v,64,a,228,v,176
Z v,68,a,212,v,132
M v,68,a,216,v,148
CV 22,24
CV 23,26
M v,68,a,224,v,164
s_waitcnt vmcnt(2)
v_cmp_gt_u32 vcc, 10, v5
M v,68,a,228,v,180
s_cbranch_vccz L_sbB5
s_mov_b32 s18, 0x40000
L_sqB5:
buffer_load_dword v5, v1, s[88:91], s13 offen offset:512 sc1
s_waitcnt vmcnt(0)
v_cmp_gt_u32 vcc, 10, v5
s_sub_u32 s18, s18, 1
s_cbranch_scc1 L_sbB5
s_cbranch_vccnz L_sqB5
L_sbB5:
Z v,72,a,212,v,136
buffer_load_dwordx4 a[64:67], v4, s[88:91], s14 offen sc1
M v,72,a,216,v,152
TR a,212,16928
M v,72,a,224,v,168
TR a,214,17056
M v,72,a,228,v,184
s_waitcnt lgkmcnt(2)
TR a,216,17184
M v,64,a,232,v,192
ST 56
M v,64,a,240,v,208
TR a,218,17312
s_mov_b32 s94, 83886080
M v,64,a,244,v,224
TR a,224,17440
s_add_u32 s15, s27, 33554432
M v,64,a,248,v,240
TR a,226,17568
M v,68,a,232,v,196
TR a,228,17696
M v,68,a,240,v,212
TR a,230,17824
M v,68,a,244,v,228
M v,68,a,248,v,244
buffer_store_dwordx4 v[20:23], v3, s[8:11], 0 offen offset:384 sc1
M v,72,a,232,v,200
TR a,232,33824
M v,72,a,240,v,216
TR a,234,33952
M v,72,a,244,v,232
buffer_load_dwordx4 a[68:71], v4, s[88:91], s15 offen sc1
M v,72,a,248,v,248
s_waitcnt lgkmcnt(2)
TR a,240,34080
Z v,80,a,212,v,128
TR a,242,34208
M v,80,a,216,v,144
TR a,244,34336
s_add_u32 s14, s29, 33554432
M v,80,a,224,v,160
TR a,246,34464
M v,80,a,228,v,176
TR a,248,34592
Z v,84,a,212,v,132
TR a,250,34720
M v,84,a,216,v,148
M v,84,a,224,v,164
M v,84,a,228,v,180
buffer_load_dwordx4 a[72:75], v4, s[88:91], s14 offen sc1
Z v,88,a,212,v,136
M v,88,a,216,v,152
M v,88,a,224,v,168
M v,88,a,228,v,184
s_waitcnt lgkmcnt(0)
s_waitcnt vmcnt(7)
M v,80,a,232,v,192
s_barrier
TR a,212,0
M v,80,a,240,v,208
TR a,214,128
s_add_u32 s15, s31, 33554432
M v,80,a,244,v,224
TR a,216,256
M v,80,a,248,v,240
TR a,218,384
M v,84,a,232,v,196
TR a,224,512
M v,84,a,240,v,212
TR a,226,640
M v,84,a,244,v,228
TR a,228,768
TR a,230,896
M v,84,a,248,v,244
buffer_load_dwordx4 a[80:83], v4, s[88:91], s15 offen sc1
M v,88,a,232,v,200
v_mov_b32 v6, 12
s_mov_b32 s42, 768
M v,88,a,240,v,216
TR a,232,50688
M v,88,a,244,v,232
TR a,234,50816
M v,88,a,248,v,248
s_waitcnt lgkmcnt(2)
TR a,240,50944
M v,64,a,212,v,140
TR a,242,51072
s_add_u32 s14, s24, 37748736
M v,64,a,216,v,156
TR a,244,51200
M v,64,a,224,v,172
s_waitcnt vmcnt(4)
TR a,246,51328
M v,64,a,228,v,188
buffer_store_dword v6, v11, s[40:43], 0 offen offset:640 sc1
M v,68,a,212,a,12
TR a,248,51456
M v,68,a,216,a,44
TR a,250,51584
M v,68,a,224,a,76
buffer_load_dwordx4 a[84:87], v4, s[88:91], s14 offen sc1
M v,68,a,228,a,108
TR v,76,832
M v,72,a,212,a,28
TR a,212,32
M v,72,a,216,a,60
TR a,214,160
M v,72,a,224,a,92
TR a,216,288
M v,72,a,228,a,124
s_waitcnt lgkmcnt(4)
TR a,218,416
M v,64,a,232,v,204
TR a,224,544
s_add_u32 s15, s26, 37748736
M v,64,a,240,v,220
TR a,226,672
M v,64,a,244,v,236
TR a,228,800
M v,64,a,248,v,252
TR a,230,928
M v,68,a,232,a,140
TR v,78,960
M v,68,a,240,a,172
TR v,92,51520
M v,68,a,244,a,204
buffer_load_dwordx4 a[88:91], v4, s[88:91], s15 offen sc1
M v,68,a,248,a,236
MU 64,28
MU 65,28
M v,72,a,232,a,156
TR a,232,50720
MU 66,28
M v,72,a,240,a,188
TR a,234,50848
MU 67,28
M v,72,a,244,a,220
TR a,240,50976
CV 32,64
M v,72,a,248,a,252
s_waitcnt lgkmcnt(5)
TR a,242,51104
M v,80,a,212,v,140
TR a,244,51232
s_add_u32 s14, s28, 37748736
M v,80,a,216,v,156
TR a,246,51360
CV 33,66
M v,80,a,224,v,172
TR a,248,51488
MU 68,29
M v,80,a,228,v,188
TR a,250,51616
MU 69,29
M v,84,a,212,a,12
MU 70,29
MU 71,29
M v,84,a,216,a,44
buffer_load_dwordx4 a[96:99], v4, s[88:91], s14 offen sc1
M v,84,a,224,a,76
CV 36,68
CV 37,70
M v,84,a,228,a,108
MU 72,30
MU 73,30
M v,88,a,212,a,28
TR a,212,16960
MU 74,30
M v,88,a,216,a,60
TR a,214,17088
MU 75,30
M v,88,a,224,a,92
TR a,216,17216
CV 40,72
M v,88,a,228,a,124
s_waitcnt lgkmcnt(3)
TR a,218,17344
M v,80,a,232,v,204
TR a,224,17472
s_add_u32 s15, s30, 37748736
M v,80,a,240,v,220
TR a,226,17600
CV 41,74
M v,80,a,244,v,236
TR a,228,17728
M v,80,a,248,v,252
TR a,230,17856
M v,84,a,232,a,140
TR v,64,64
M v,84,a,240,a,172
buffer_load_dwordx4 a[100:103], v4, s[88:91], s15 offen sc1
M v,84,a,244,a,204
TR v,66,192
s_nop 0
M v,84,a,248,a,236
MU 80,28
MU 81,28
M v,88,a,232,a,156
MU 82,28
MU 83,28
M v,88,a,240,a,188
CV 34,80
CV 35,82
M v,88,a,244,a,220
ST 32
M v,88,a,248,a,252
s_waitcnt lgkmcnt(2)
TR a,232,16992
Z v,96,a,212,v,128
TR a,234,17120
MU 84,29
M v,96,a,216,v,144
TR a,240,17248
MU 85,29
M v,96,a,224,v,160
TR a,242,17376
MU 86,29
M v,96,a,228,v,176
TR a,244,17504
MU 87,29
Z v,100,a,212,v,132
TR a,246,17632
CV 38,84
M v,100,a,216,v,148
TR a,248,17760
CV 39,86
M v,100,a,224,v,164
TR a,250,17888
s_mov_b32 s94, 84934656
M v,100,a,228,v,180
MU 88,30
MU 89,30
Z v,104,a,212,v,136
TR a,212,33856
MU 90,30
M v,104,a,216,v,152
TR a,214,33984
MU 91,30
M v,104,a,224,v,168
buffer_load_dword v5, v1, s[88:91], s13 offen offset:640 sc1
M v,104,a,228,v,184
s_waitcnt lgkmcnt(2)
TR a,216,34112
Z v,112,a,232,v,128
TR a,218,34240
CV 42,88
M v,112,a,240,v,144
ST 36
M v,112,a,244,v,160
TR a,224,34368
CV 43,90
M v,112,a,248,v,176
TR a,226,34496
s_mov_b32 s94, 85983232
Z v,116,a,232,v,132
TR a,228,34624
M v,116,a,240,v,148
TR a,230,34752
M v,116,a,244,v,164
TR v,68,320
M v,116,a,248,v,180
TR v,70,448
Z v,120,a,232,v,136
TR a,232,33888
M v,120,a,240,v,152
TR a,234,34016
M v,120,a,244,v,168
TR a,240,34144
M v,120,a,248,v,184
s_waitcnt lgkmcnt(5)
TR a,242,34272
M v,96,a,212,v,192
TR a,244,34400
M v,96,a,216,v,208
TR a,246,34528
M v,96,a,224,v,224
TR a,248,34656
M v,96,a,228,v,240
TR a,250,34784
M v,100,a,212,v,196
ST 40
M v,100,a,216,v,212
TR v,72,576
s_mov_b32 s94, 88080384
M v,100,a,224,v,228
TR v,74,704
M v,100,a,228,v,244
TR v,80,50752
M v,104,a,212,v,200
TR v,82,50880
M v,104,a,216,v,216
TR v,84,51008
M v,104,a,224,v,232
TR v,86,51136
M v,104,a,228,v,248
s_waitcnt lgkmcnt(6)
TR v,88,51264
M v,112,a,232,v,192
TR v,90,51392
M v,112,a,240,v,208
TR v,94,51648
M v,112,a,244,v,224
TR v,128,96
M v,112,a,248,v,240
TR v,130,224
M v,116,a,232,v,196
TR v,132,352
s_add_u32 s14, s25, 41943040
M v,116,a,240,v,212
TR v,134,480
M v,116,a,244,v,228
TR v,136,608
M v,116,a,248,v,244
TR v,138,736
M v,120,a,232,v,200
s_waitcnt vmcnt(2)
v_cmp_gt_u32 vcc, 12, v5
M v,120,a,240,v,216
s_cbranch_vccz L_sbB6
s_mov_b32 s18, 0x40000
L_sqB6:
buffer_load_dword v5, v1, s[88:91], s13 offen offset:640 sc1
s_waitcnt vmcnt(0)
v_cmp_gt_u32 vcc, 12, v5
s_sub_u32 s18, s18, 1
s_cbranch_scc1 L_sbB6
s_cbranch_vccnz L_sqB6
L_sbB6:
M v,120,a,244,v,232
buffer_load_dwordx4 a[104:107], v4, s[88:91], s14 offen sc1
M v,120,a,248,v,248
s_waitcnt lgkmcnt(6)
TR v,144,864
M v,96,v,64,v,140
TR v,146,992
s_add_u32 s15, s27, 41943040
M v,96,v,68,v,156
TR v,148,50784
M v,96,v,72,v,172
TR v,150,50912
TR v,152,51040
M v,96,v,76,v,188
TR v,154,51168
TR v,160,51296
M v,96,v,80,v,204
TR v,162,51424
TR v,164,51552
M v,96,v,84,v,220
TR v,166,51680
M v,96,v,88,v,236
buffer_load_dwordx4 a[112:115], v4, s[88:91], s15 offen sc1
M v,96,v,92,v,252
s_waitcnt lgkmcnt(0)
M v,112,v,128,v,140
s_add_u32 s14, s29, 41943040
M v,112,v,132,v,156
M v,112,v,136,v,172
M v,112,v,144,v,188
M v,112,v,148,v,204
M v,112,v,152,v,220
MU 96,28
MU 97,28
M v,112,v,160,v,236
MU 98,28
MU 99,28
M v,112,v,164,v,252
CV 48,96
CV 49,98
M v,100,v,64,a,12
buffer_load_dwordx4 a[116:119], v4, s[88:91], s14 offen sc1
M v,100,v,68,a,44
s_add_u32 s15, s31, 41943040
s_nop 0
M v,100,v,72,a,76
MU 112,28
MU 113,28
M v,100,v,76,a,108
MU 114,28
MU 115,28
M v,100,v,80,a,140
CV 50,112
CV 51,114
M v,100,v,84,a,172
ST 48
M v,100,v,88,a,204
s_mov_b32 s94, 89128960
M v,100,v,92,a,236
M v,116,v,128,a,12
buffer_load_dwordx4 a[120:123], v4, s[88:91], s15 offen sc1
M v,116,v,132,a,44
s_add_u32 s14, s24, 46137344
M v,116,v,136,a,76
M v,116,v,144,a,108
M v,116,v,148,a,140
s_nop 0
MU 100,29
M v,116,v,152,a,172
MU 101,29
MU 102,29
M v,116,v,160,a,204
MU 103,29
CV 52,100
M v,116,v,164,a,236
buffer_load_dwordx4 a[128:131], v4, s[88:91], s14 offen sc1
M v,104,v,64,a,28
CV 53,102
s_add_u32 s15, s26, 46137344
M v,104,v,68,a,60
s_nop 1
M v,104,v,72,a,92
MU 116,29
MU 117,29
M v,104,v,76,a,124
MU 118,29
MU 119,29
M v,104,v,80,a,156
CV 54,116
CV 55,118
M v,104,v,84,a,188
ST 52
M v,104,v,88,a,220
s_mov_b32 s94, 90177536
M v,104,v,92,a,252
v_mov_b32 v6, 14
s_mov_b32 s42, 896
M v,120,v,128,a,28
buffer_load_dwordx4 a[132:135], v4, s[88:91], s15 offen sc1
M v,120,v,132,a,60
s_add_u32 s14, s28, 46137344
M v,120,v,136,a,92
M v,120,v,144,a,124
MU 104,30
MU 105,30
M v,120,v,148,a,156
MU 106,30
MU 107,30
M v,120,v,152,a,188
CV 56,104
CV 57,106
M v,120,v,160,a,220
buffer_load_dwordx4 a[136:139], v4, s[88:91], s14 offen sc1
M v,120,v,164,a,252
s_nop 7
MU 120,30
MU 121,30
MU 122,30
MU 123,30
CV 58,120
CV 59,122
ST 56
s_waitcnt vmcnt(0)
buffer_store_dword v6, v11, s[40:43], 0 offen offset:768 sc1
s_waitcnt vmcnt(1)
Z v,12,a,0,a,64
s_add_u32 s15, s30, 46137344
M v,12,a,0,a,68
M v,12,a,0,a,72
M v,12,a,0,a,80
M v,12,a,0,a,84
M v,12,a,0,a,88
M v,12,a,0,a,96
buffer_load_dwordx4 a[144:147], v4, s[88:91], s15 offen sc1
M v,12,a,0,a,100
Z v,24,a,4,a,64
M v,24,a,4,a,68
s_nop 1
M v,24,a,4,a,72
s_nop 1
M v,24,a,4,a,80
CV 20,12
CV 21,14
M v,24,a,4,a,84
M v,24,a,4,a,88
M v,24,a,4,a,96
M v,24,a,4,a,100
s_waitcnt vmcnt(0)
Z v,12,a,0,a,104
M v,12,a,0,a,112
s_nop 1
M v,12,a,0,a,116
s_nop 1
M v,12,a,0,a,120
CV 22,24
CV 23,26
M v,12,a,0,a,128
buffer_store_dwordx4 v[20:23], v3, s[8:11], 0 offen offset:512 sc1
M v,12,a,0,a,132
M v,12,a,0,a,136
M v,12,a,0,a,144
Z v,24,a,4,a,104
M v,24,a,4,a,112
s_add_u32 s14, s25, 50331648
s_add_u32 s15, s27, 50331648
M v,24,a,4,a,116
s_nop 1
M v,24,a,4,a,120
CV 20,12
CV 21,14
M v,24,a,4,a,128
M v,24,a,4,a,132
M v,24,a,4,a,136
M v,24,a,4,a,144
s_nop 7
CV 22,24
CV 23,26
buffer_store_dwordx4 v[20:23], v3, s[8:11], 0 offen offset:640 sc1
s_waitcnt vmcnt(2)
buffer_load_dword v5, v1, s[88:91], s13 offen offset:768 sc1
s_waitcnt vmcnt(0)
v_cmp_gt_u32 vcc, 14, v5
s_nop 0
s_cbranch_vccz L_sbB7
s_mov_b32 s18, 0x40000
L_sqB7:
buffer_load_dword v5, v1, s[88:91], s13 offen offset:768 sc1
s_waitcnt vmcnt(0)
v_cmp_gt_u32 vcc, 14, v5
s_sub_u32 s18, s18, 1
s_cbranch_scc1 L_sbB7
s_cbranch_vccnz L_sqB7
L_sbB7:
buffer_load_dwordx4 a[64:67], v4, s[88:91], s14 offen sc1
buffer_load_dwordx4 a[68:71], v4, s[88:91], s15 offen sc1
s_add_u32 s14, s29, 50331648
buffer_load_dwordx4 a[72:75], v4, s[88:91], s14 offen sc1
s_add_u32 s15, s31, 50331648
buffer_load_dwordx4 a[80:83], v4, s[88:91], s15 offen sc1
s_add_u32 s14, s24, 54525952
buffer_load_dwordx4 a[84:87], v4, s[88:91], s14 offen sc1
s_add_u32 s15, s26, 54525952
buffer_load_dwordx4 a[88:91], v4, s[88:91], s15 offen sc1
s_add_u32 s14, s28, 54525952
buffer_load_dwordx4 a[96:99], v4, s[88:91], s14 offen sc1
s_add_u32 s15, s30, 54525952
buffer_load_dwordx4 a[100:103], v4, s[88:91], s15 offen sc1
s_waitcnt vmcnt(5)
Z v,12,a,0,a,64
M v,12,a,0,a,68
M v,12,a,0,a,72
Z v,24,a,4,a,64
M v,24,a,4,a,68
M v,24,a,4,a,72
s_waitcnt vmcnt(0)
M v,12,a,0,a,80
M v,12,a,0,a,84
M v,12,a,0,a,88
M v,12,a,0,a,96
M v,12,a,0,a,100
M v,24,a,4,a,80
s_nop 1
M v,24,a,4,a,84
s_nop 1
M v,24,a,4,a,88
s_nop 0
CV 20,12
M v,24,a,4,a,96
CV 21,14
M v,24,a,4,a,100
s_nop 7
CV 22,24
CV 23,26
buffer_store_dwordx4 v[20:23], v3, s[8:11], 0 offen offset:768 sc1
s_endpgm
L_endB:
L_fend:
s_endpgm
.fill 5120, 4, 0xbf800000
s_endpgm
.section .rodata,"a"
.p2align 6
.amdhsa_kernel concat_heads__mha_block_cached__gqa_block_cached__near_ridge_kernel
  .amdhsa_next_free_vgpr 512
  .amdhsa_next_free_sgpr 102
  .amdhsa_accum_offset 256
  .amdhsa_group_segment_fixed_size 0
  .amdhsa_kernarg_size 104
  .amdhsa_user_sgpr_count 2
  .amdhsa_user_sgpr_kernarg_segment_ptr 1
  .amdhsa_system_sgpr_workgroup_id_x 1
.end_amdhsa_kernel
```
